```python
import torch

def _softmax(x, axis=-1):
    return torch.softmax(x, dim=axis)
def _gelu(x):
    return torch.nn.functional.gelu(x, approximate="tanh")
def _silu(x):
    return torch.nn.functional.silu(x)
def _sigmoid(x):
    return torch.sigmoid(x)
def _layernorm(x, axis=-1, eps=1e-5):
    m = x.mean(dim=axis, keepdim=True)
    v = x.var(dim=axis, keepdim=True, unbiased=False)
    return (x - m) / torch.sqrt(v + eps)
def _scatter_add(tgt, idx, src, axis=0):
    return tgt.clone().index_add_(axis, idx, src)
def _segment_sum(src, seg, n):
    out = torch.zeros((n,) + src.shape[1:], dtype=src.dtype)
    return out.index_add_(0, seg, src)
def _pad(x, pw):
    flat = tuple(v for pair in reversed(pw) for v in pair)
    return torch.nn.functional.pad(x, flat)

kernel_name = 'parallel_sum__compressed_kv_cla__dense_activation_silu__prompt'

def setup_inputs():

    _w = (lambda a: (lambda t: t.to(torch.bfloat16) if t.is_floating_point() else t)(torch.as_tensor(a)))
    def _A_setup():
        B, H, Sq, Sk, D, M = 1, 32, 2048, 2048, 128, 640
        Dc = 4 * D
        return {
            "x": _w((lambda *s: torch.randn(*s, dtype=torch.bfloat16) * 0.05)(B, Sq, M)),
            "c_kv": _w((lambda *s: torch.randn(*s, dtype=torch.bfloat16) * 0.4)(B, Sk, Dc)),
            "w_q": _w((lambda *s: torch.randn(*s, dtype=torch.bfloat16) * 3.2)(M, H, D) * (M ** -0.5)),
            "w_uk": _w((lambda *s: torch.randn(*s, dtype=torch.bfloat16) * 3.2)(Dc, H, D) * (Dc ** -0.5)),
            "w_uv": _w((lambda *s: torch.randn(*s, dtype=torch.bfloat16) * 0.4)(Dc, H, D) * (Dc ** -0.5)),
            "w_o": _w((lambda *s: torch.randn(*s, dtype=torch.bfloat16) * 0.4)(H, D, M) * ((H * D) ** -0.5)),
        }
    _A_in = _A_setup()

    def _B_setup():
        B, S, D, F = 1, 2048, 640, 1728
        return {
            "x": _w((lambda *s: torch.randn(*s, dtype=torch.bfloat16) * 0.05)(B, S, D)),
            "w1": _w((lambda *s: torch.randn(*s, dtype=torch.bfloat16) * 0.8)(D, F) * (D ** -0.5)),
            "w2": _w((lambda *s: torch.randn(*s, dtype=torch.bfloat16) * 0.1)(F, D) * (F ** -0.5)),
        }
    _B_in = _B_setup()

    return {
        "A_x": _A_in["x"],
        "A_c_kv": _A_in["c_kv"],
        "A_w_q": _A_in["w_q"],
        "A_w_uk": _A_in["w_uk"],
        "A_w_uv": _A_in["w_uv"],
        "A_w_o": _A_in["w_o"],
        "B_x": _B_in["x"],
        "B_w1": _B_in["w1"],
        "B_w2": _B_in["w2"],
    }

def reference(A_x, A_c_kv, A_w_q, A_w_uk, A_w_uv, A_w_o, B_x, B_w1, B_w2):
    def _A_ref(x, c_kv, w_q, w_uk, w_uv, w_o):
        B, Sq, M = x.shape[0], x.shape[1], x.shape[2]
        Sk = c_kv.shape[1]
        H, D = w_q.shape[1], w_q.shape[2]
        q = torch.einsum("bqm,mhd->bhqd", x, w_q)
        k = torch.einsum("bkc,chd->bhkd", c_kv, w_uk)
        v = torch.einsum("bkc,chd->bhkd", c_kv, w_uv)
        scores = torch.einsum("bhqd,bhkd->bhqk", q, k) * (D ** -0.5)
        off = Sk - Sq
        qi = torch.arange(Sq)[:, None]
        kj = torch.arange(Sk)[None, :]
        cmask = kj <= (qi + off)
        scores = torch.where(cmask[None, None], scores, -1e9)
        p = _softmax(scores, axis=-1)
        ctx = torch.einsum("bhqk,bhkd->bhqd", p, v)
        return torch.einsum("bhqd,hdm->bqm", ctx, w_o)

    def _B_ref(x, w1, w2):
        h = torch.einsum("bsd,df->bsf", x, w1)
        h = _silu(h)
        out = torch.einsum("bsf,fd->bsd", h, w2)
        return out

    x = A_x
    xn = _layernorm(x, axis=-1)
    return x + _A_ref(xn, A_c_kv, A_w_q, A_w_uk, A_w_uv, A_w_o) + _B_ref(xn, B_w1, B_w2)
```

```asm
; @launch grid=(256,1,1) block=(256,1,1) lds=163840
.amdgcn_target "amdgcn-amd-amdhsa--gfx950"
.text
.globl parallel_sum__compressed_kv_cla__dense_activation_silu__prompt_kernel
.p2align 8
.type parallel_sum__compressed_kv_cla__dense_activation_silu__prompt_kernel,@function
parallel_sum__compressed_kv_cla__dense_activation_silu__prompt_kernel:
s_lshr_b32 s3, s2, 8
s_cbranch_scc1 L_end
s_load_dwordx2 s[12:13], s[0:1], 8
s_load_dwordx2 s[16:17], s[0:1], 24
s_getpc_b64 s[52:53]
v_lshlrev_b32 v59, 4, v0
global_load_dword v59, v59, s[52:53]
v_lshrrev_b32 v6, 6, v0
s_lshr_b32 s49, s2, 5
v_readfirstlane_b32 s50, v6
v_and_b32 v7, 63, v0
v_lshrrev_b32 v33, 4, v7
v_lshrrev_b32 v36, 3, v7
v_and_b32 v37, 7, v7
v_xor_b32 v37, v37, v33
v_lshlrev_b32 v36, 6, v36
s_lshl2_add_u32 s51, s49, s50
v_add_u32 v36, v36, v37
s_lshl_b32 s51, s51, 16
v_lshlrev_b32 v36, 4, v36
s_lshl_b32 s66, s50, 13
v_add_u32 v2, s51, v36
s_mov_b32 s14, 2097152
s_mov_b32 s15, 0x20000
s_mov_b32 s54, 0
s_add_u32 m0, s66, 32768
s_waitcnt lgkmcnt(0)
buffer_load_dwordx4 v2, s[12:15], s54 offen offset:0  lds
v_xor_b32 v38, 64, v2
v_add_u32 v3, 7168, v38
v_add_u32 v4, 14336, v2
v_add_u32 v5, 21504, v38
buffer_load_dwordx4 v3, s[12:15], s54 offen offset:1024  lds
s_and_b32 s48, s2, 7
s_bfe_u32 s51, s2, 0x20003
s_lshl2_add_u32 s48, s48, s51
buffer_load_dwordx4 v4, s[12:15], s54 offen offset:2048  lds
v_bfe_u32 v36, v7, 1, 3
v_xor_b32 v36, v36, v33
v_lshlrev_b32 v37, 13, v33
buffer_load_dwordx4 v5, s[12:15], s54 offen offset:3072  lds
v_lshl_add_u32 v37, v36, 5, v37
v_and_b32 v38, 1, v7
v_lshl_add_u32 v37, v38, 4, v37
s_mov_b32 s54, 32768
s_add_u32 m0, s66, 36864
s_nop 0
buffer_load_dwordx4 v2, s[12:15], s54 offen offset:0  lds
s_lshl_b32 s51, s48, 8
s_lshl_b32 s52, s50, 17
s_add_u32 s51, s51, s52
buffer_load_dwordx4 v3, s[12:15], s54 offen offset:1024  lds
s_lshl_b32 s67, s50, 12
s_mov_b32 s18, 4194304
s_mov_b32 s19, 0x20000
buffer_load_dwordx4 v4, s[12:15], s54 offen offset:2048  lds
v_mov_b32 v39, v7
v_add_u32 v6, s51, v37
v_xor_b32 v8, 128, v6
buffer_load_dwordx4 v5, s[12:15], s54 offen offset:3072  lds
v_add_u32 v7, 31744, v6
v_add_u32 v9, 95232, v8
v_add_u32 v8, 63488, v8
s_mov_b32 s54, 0
s_add_u32 m0, s67, 0
s_nop 0
buffer_load_dwordx4 v6, s[16:19], s54 offen offset:0  lds
s_load_dwordx2 s[4:5], s[0:1], 88
s_load_dwordx2 s[8:9], s[0:1], 0
s_load_dwordx2 s[20:21], s[0:1], 32
s_load_dwordx2 s[24:25], s[0:1], 16
s_load_dwordx2 s[28:29], s[0:1], 56
s_load_dwordx2 s[32:33], s[0:1], 40
s_load_dwordx2 s[36:37], s[0:1], 64
s_load_dwordx2 s[40:41], s[0:1], 72
s_load_dwordx2 s[44:45], s[0:1], 80
s_getpc_b64 s[52:53]
s_lshr_b32 s3, s2, 3
s_lshl_b32 s3, s3, 12
s_min_u32 s3, s3, 86016
buffer_load_dwordx4 v7, s[16:19], s54 offen offset:1024  lds
v_lshl_add_u32 v60, v0, 4, s3
global_load_dwordx4 v[60:63], v60, s[52:53]
v_mov_b32 v0, v39
v_lshlrev_b32 v1, 4, v0
s_mov_b32 s6, 268435456
s_mov_b32 s7, 0x20000
s_mov_b32 s10, 2621440
s_mov_b32 s11, 0x20000
s_mov_b32 s22, 4194304
s_mov_b32 s23, 0x20000
s_mov_b32 s26, 5242880
s_mov_b32 s27, 0x20000
s_mov_b32 s30, 2211840
buffer_load_dwordx4 v8, s[16:19], s54 offen offset:2048  lds
s_mov_b32 s31, 0x20000
s_mov_b32 s34, 5242880
s_mov_b32 s35, 0x20000
s_mov_b32 s38, 2211840
s_mov_b32 s39, 0x20000
s_mov_b32 s42, 2621440
s_mov_b32 s43, 0x20000
s_mov_b32 s46, 256
s_mov_b32 s47, 0x20000
v_and_b32 v32, 15, v0
v_bfe_u32 v34, v0, 2, 2
v_and_b32 v35, 3, v0
s_lshr_b32 s51, s2, 3
buffer_load_dwordx4 v9, s[16:19], s54 offen offset:3072  lds
s_lshl_b32 s51, s51, 2
s_add_u32 s51, s51, s50
s_and_b32 s52, s2, 7
v_lshrrev_b32 v36, 3, v0
v_and_b32 v37, 7, v0
v_lshlrev_b32 v37, 7, v37
v_lshl_add_u32 v38, v36, 13, v37
s_lshl_b32 s53, s52, 10
v_add_u32 v38, s53, v38
s_and_b32 s3, s51, 63
s_lshl_b32 s3, s3, 16
s_add_u32 s53, s3, 0x100000
s_cmp_lt_u32 s51, 64
s_cselect_b32 s3, s3, 2130706432
s_cselect_b32 s53, 2130706432, s53
s_mov_b32 s54, 524288
s_add_u32 m0, s67, 16384
s_nop 0
buffer_load_dwordx4 v6, s[16:19], s54 offen offset:0  lds
v_add_u32 v25, s3, v38
v_add_u32 v29, s53, v38
s_lshl_b32 s3, s51, 16
v_add_u32 v26, s3, v38
v_lshl_add_u32 v38, v36, 10, v37
s_lshl_b32 s3, s52, 18
s_lshl_b32 s53, s51, 13
s_add_u32 s3, s3, s53
s_cmp_lt_u32 s51, 32
s_cselect_b32 s3, s3, 2130706432
v_add_u32 v27, s3, v38
v_lshrrev_b32 v36, 2, v0
v_and_b32 v37, 3, v0
buffer_load_dwordx4 v7, s[16:19], s54 offen offset:1024  lds
v_mul_u32_u24 v36, 3456, v36
v_lshl_add_u32 v36, v37, 7, v36
s_min_u32 s3, s52, 5
s_lshl_b32 s52, s52, 2
s_sub_u32 s52, s52, s3
s_lshl_b32 s52, s52, 7
s_sub_u32 s3, s51, 80
s_mul_i32 s53, s3, 55296
s_add_u32 s52, s52, s53
s_cmp_lt_u32 s3, 40
s_cselect_b32 s52, s52, 2130706432
v_add_u32 v28, s52, v36
v_cmp_gt_u32 vcc, 16, v0
buffer_load_dwordx4 v8, s[16:19], s54 offen offset:2048  lds
v_mov_b32 v36, 2130706432
v_cndmask_b32 v25, v36, v25, vcc
v_cndmask_b32 v26, v36, v26, vcc
v_cndmask_b32 v28, v36, v28, vcc
s_lshl_b32 s51, s48, 3
s_sub_u32 s52, 14, s49
s_cmp_lt_u32 s51, 128
s_cselect_b32 s52, s49, s52
s_lshl_b32 s52, s52, 7
s_add_u32 s1, s51, s52
s_lshl_b32 s52, s50, 1
s_add_u32 s51, s1, s52
v_lshrrev_b32 v36, 5, v0
buffer_load_dwordx4 v9, s[16:19], s54 offen offset:3072  lds
v_add_u32 v36, s51, v36
v_and_b32 v37, 31, v0
v_mul_u32_u24 v38, 1280, v36
v_lshl_add_u32 v64, v37, 4, v38
v_mov_b32 v39, 2130706432
v_add_u32 v38, 1024, v64
v_cmp_gt_u32 s[62:63], 16, v37
s_nop 1
v_cndmask_b32 v65, v39, v38, s[62:63]
v_lshrrev_b32 v36, 1, v32
v_xor_b32 v36, v36, v33
v_lshlrev_b32 v36, 4, v36
v_lshl_add_u32 v36, v32, 7, v36
s_mov_b32 s54, 128
s_add_u32 m0, s66, 65536
s_nop 0
buffer_load_dwordx4 v2, s[12:15], s54 offen offset:0  lds
v_add_u32 v18, s66, v36
v_xor_b32 v19, 64, v18
v_add_u32 v20, 65536, v18
v_add_u32 v21, 65536, v19
v_add_u32 v22, 131072, v18
v_add_u32 v23, 131072, v19
v_lshl_add_u32 v38, v33, 3, v34
v_lshlrev_b32 v38, 8, v38
v_lshl_add_u32 v38, v35, 3, v38
v_and_b32 v36, 1, v33
v_lshl_add_u32 v36, v36, 2, v34
v_lshl_add_u32 v10, v36, 5, v38
v_xor_b32 v11, 32, v10
buffer_load_dwordx4 v3, s[12:15], s54 offen offset:1024  lds
v_xor_b32 v12, 64, v10
v_xor_b32 v13, 96, v10
v_xor_b32 v14, 128, v10
v_xor_b32 v15, 160, v10
v_xor_b32 v16, 192, v10
v_xor_b32 v17, 224, v10
v_and_b32 v37, 31, v0
v_lshrrev_b32 v36, 5, v0
v_lshl_add_u32 v36, s50, 1, v36
v_and_b32 v38, 7, v0
v_xor_b32 v36, v36, v38
v_lshlrev_b32 v36, 4, v36
v_lshl_add_u32 v36, v37, 7, v36
buffer_load_dwordx4 v4, s[12:15], s54 offen offset:2048  lds
v_add_u32 v66, 151552, v36
s_lshl_b32 s51, s50, 10
s_add_u32 s51, s51, 151552
v_add_u32 v67, s51, v1
v_lshrrev_b32 v36, 5, v0
v_bfe_u32 v37, v0, 3, 2
v_lshrrev_b32 v38, 3, v0
v_xor_b32 v38, v38, v0
v_and_b32 v38, 7, v38
v_lshlrev_b32 v36, 10, v36
v_lshl_add_u32 v36, v37, 8, v36
v_lshl_add_u32 v36, v38, 4, v36
s_lshr_b32 s51, s1, 4
buffer_load_dwordx4 v5, s[12:15], s54 offen offset:3072  lds
s_mul_i32 s51, s51, 20480
s_and_b32 s52, s1, 8
s_lshl_b32 s52, s52, 4
s_add_u32 s51, s51, s52
s_lshl_b32 s52, s50, 11
s_add_u32 s51, s51, s52
v_add_u32 v68, s51, v36
s_lshl_b32 s51, s48, 20
s_lshl_b32 s52, s49, 2
s_add_u32 s52, s52, s50
s_lshl_b32 s52, s52, 14
s_add_u32 s51, s51, s52
s_add_u32 s51, s51, 4194304
s_mov_b32 s54, 32896
s_add_u32 m0, s66, 69632
s_nop 0
buffer_load_dwordx4 v2, s[12:15], s54 offen offset:0  lds
v_add_u32 v24, s51, v1
s_lshl_b32 s51, s49, 2
s_add_u32 s51, s51, s50
s_lshl_b32 s51, s51, 1
s_sub_u32 s52, 126, s51
s_mul_i32 s76, s51, 20480
s_mul_i32 s78, s52, 20480
s_mul_i32 s80, s51, 186368
s_mul_i32 s82, s52, 186368
s_add_u32 s80, s80, 37748736
s_add_u32 s82, s82, 37748736
s_add_u32 s77, s76, 20480
s_add_u32 s81, s80, 186368
buffer_load_dwordx4 v3, s[12:15], s54 offen offset:1024  lds
s_add_u32 s79, s78, 20480
s_add_u32 s83, s82, 186368
v_lshl_or_b32 v36, s50, 6, v0
v_cmp_eq_u32 vcc, 0, v36
v_mov_b32 v37, 0
v_mov_b32 v39, 2130706432
v_cndmask_b32 v0, v39, v37, vcc
buffer_load_dwordx4 v4, s[12:15], s54 offen offset:2048  lds
buffer_load_dwordx4 v5, s[12:15], s54 offen offset:3072  lds
s_waitcnt vmcnt(17)
ds_read_b128 a[0:3], v18 offset:32768
ds_read_b128 a[4:7], v18 offset:34816
ds_read_b128 a[8:11], v18 offset:36864
ds_read_b128 a[12:15], v18 offset:38912
ds_read_b128 a[16:19], v19 offset:32768
ds_read_b128 a[20:23], v19 offset:34816
ds_read_b128 a[24:27], v19 offset:36864
ds_read_b128 a[28:31], v19 offset:38912
s_mov_b32 s54, 256
s_add_u32 m0, s66, 98304
s_nop 0
buffer_load_dwordx4 v2, s[12:15], s54 offen offset:0  lds
buffer_load_dwordx4 v3, s[12:15], s54 offen offset:1024  lds
buffer_load_dwordx4 v4, s[12:15], s54 offen offset:2048  lds
buffer_load_dwordx4 v5, s[12:15], s54 offen offset:3072  lds
s_mov_b32 s54, 33024
s_add_u32 m0, s66, 102400
s_nop 0
buffer_load_dwordx4 v2, s[12:15], s54 offen offset:0  lds
buffer_load_dwordx4 v3, s[12:15], s54 offen offset:1024  lds
buffer_load_dwordx4 v4, s[12:15], s54 offen offset:2048  lds
buffer_load_dwordx4 v5, s[12:15], s54 offen offset:3072  lds
buffer_load_dword v31, v27, s[12:15], 0 offen
buffer_load_dword v31, v29, s[16:19], 0 offen
s_waitcnt vmcnt(10)
ds_read_b128 a[32:35], v20 offset:0
ds_read_b128 a[36:39], v20 offset:2048
ds_read_b128 a[40:43], v20 offset:4096
ds_read_b128 a[44:47], v20 offset:6144
ds_read_b128 a[48:51], v21 offset:0
ds_read_b128 a[52:55], v21 offset:2048
ds_read_b128 a[56:59], v21 offset:4096
ds_read_b128 a[60:63], v21 offset:6144
s_waitcnt lgkmcnt(0)
s_barrier
ds_read_b64_tr_b16 v[32:33], v10 offset:0
ds_read_b64_tr_b16 v[34:35], v10 offset:1024
ds_read_b64_tr_b16 v[36:37], v10 offset:8192
ds_read_b64_tr_b16 v[38:39], v10 offset:9216
ds_read_b64_tr_b16 v[40:41], v10 offset:16384
ds_read_b64_tr_b16 v[42:43], v10 offset:17408
ds_read_b64_tr_b16 v[44:45], v10 offset:24576
ds_read_b64_tr_b16 v[46:47], v10 offset:25600
s_waitcnt lgkmcnt(6)
v_mfma_f32_16x16x32_bf16 v[128:131], v[32:35], a[0:3], 0
s_waitcnt lgkmcnt(4)
v_mfma_f32_16x16x32_bf16 v[128:131], v[36:39], a[16:19], v[128:131]
s_waitcnt lgkmcnt(2)
s_mov_b32 s54, 1048576
ds_read_b64_tr_b16 v[48:49], v11 offset:0
v_mfma_f32_16x16x32_bf16 v[128:131], v[40:43], a[32:35], v[128:131]
s_waitcnt lgkmcnt(1)
s_add_u32 m0, s67, 32768
ds_read_b64_tr_b16 v[50:51], v11 offset:1024
v_mfma_f32_16x16x32_bf16 v[128:131], v[44:47], a[48:51], v[128:131]
ds_read_b64_tr_b16 v[52:53], v11 offset:8192
v_mfma_f32_16x16x32_bf16 v[132:135], v[32:35], a[4:7], 0
ds_read_b64_tr_b16 v[54:55], v11 offset:9216
v_mfma_f32_16x16x32_bf16 v[132:135], v[36:39], a[20:23], v[132:135]
buffer_load_dwordx4 v6, s[16:19], s54 offen offset:0  lds
v_mfma_f32_16x16x32_bf16 v[132:135], v[40:43], a[36:39], v[132:135]
ds_read_b64_tr_b16 v[56:57], v11 offset:16384
v_mfma_f32_16x16x32_bf16 v[132:135], v[44:47], a[52:55], v[132:135]
v_mfma_f32_16x16x32_bf16 v[136:139], v[32:35], a[8:11], 0
ds_read_b64_tr_b16 v[58:59], v11 offset:17408
v_mfma_f32_16x16x32_bf16 v[136:139], v[36:39], a[24:27], v[136:139]
buffer_load_dwordx4 v7, s[16:19], s54 offen offset:1024  lds
v_mfma_f32_16x16x32_bf16 v[136:139], v[40:43], a[40:43], v[136:139]
ds_read_b64_tr_b16 v[60:61], v11 offset:24576
v_mfma_f32_16x16x32_bf16 v[136:139], v[44:47], a[56:59], v[136:139]
v_mfma_f32_16x16x32_bf16 v[140:143], v[32:35], a[12:15], 0
ds_read_b64_tr_b16 v[62:63], v11 offset:25600
v_mfma_f32_16x16x32_bf16 v[140:143], v[36:39], a[28:31], v[140:143]
ds_read_b64_tr_b16 v[32:33], v12 offset:0
v_mfma_f32_16x16x32_bf16 v[140:143], v[40:43], a[44:47], v[140:143]
buffer_load_dwordx4 v8, s[16:19], s54 offen offset:2048  lds
v_mfma_f32_16x16x32_bf16 v[140:143], v[44:47], a[60:63], v[140:143]
s_waitcnt lgkmcnt(7)
ds_read_b64_tr_b16 v[34:35], v12 offset:1024
v_mfma_f32_16x16x32_bf16 v[144:147], v[48:51], a[0:3], 0
s_waitcnt lgkmcnt(6)
v_mfma_f32_16x16x32_bf16 v[144:147], v[52:55], a[16:19], v[144:147]
s_waitcnt lgkmcnt(4)
ds_read_b64_tr_b16 v[36:37], v12 offset:8192
v_mfma_f32_16x16x32_bf16 v[144:147], v[56:59], a[32:35], v[144:147]
s_waitcnt lgkmcnt(3)
buffer_load_dwordx4 v9, s[16:19], s54 offen offset:3072  lds
v_mfma_f32_16x16x32_bf16 v[144:147], v[60:63], a[48:51], v[144:147]
s_mov_b32 s54, 1572864
ds_read_b64_tr_b16 v[38:39], v12 offset:9216
v_mfma_f32_16x16x32_bf16 v[148:151], v[48:51], a[4:7], 0
s_add_u32 m0, s67, 49152
v_mfma_f32_16x16x32_bf16 v[148:151], v[52:55], a[20:23], v[148:151]
ds_read_b64_tr_b16 v[40:41], v12 offset:16384
v_mfma_f32_16x16x32_bf16 v[148:151], v[56:59], a[36:39], v[148:151]
buffer_load_dwordx4 v6, s[16:19], s54 offen offset:0  lds
v_mfma_f32_16x16x32_bf16 v[148:151], v[60:63], a[52:55], v[148:151]
ds_read_b64_tr_b16 v[42:43], v12 offset:17408
v_mfma_f32_16x16x32_bf16 v[152:155], v[48:51], a[8:11], 0
v_mfma_f32_16x16x32_bf16 v[152:155], v[52:55], a[24:27], v[152:155]
ds_read_b64_tr_b16 v[44:45], v12 offset:24576
v_mfma_f32_16x16x32_bf16 v[152:155], v[56:59], a[40:43], v[152:155]
buffer_load_dwordx4 v7, s[16:19], s54 offen offset:1024  lds
v_mfma_f32_16x16x32_bf16 v[152:155], v[60:63], a[56:59], v[152:155]
ds_read_b64_tr_b16 v[46:47], v12 offset:25600
v_mfma_f32_16x16x32_bf16 v[156:159], v[48:51], a[12:15], 0
v_mfma_f32_16x16x32_bf16 v[156:159], v[52:55], a[28:31], v[156:159]
ds_read_b64_tr_b16 v[48:49], v13 offset:0
v_mfma_f32_16x16x32_bf16 v[156:159], v[56:59], a[44:47], v[156:159]
buffer_load_dwordx4 v8, s[16:19], s54 offen offset:2048  lds
v_mfma_f32_16x16x32_bf16 v[156:159], v[60:63], a[60:63], v[156:159]
s_waitcnt lgkmcnt(7)
ds_read_b64_tr_b16 v[50:51], v13 offset:1024
v_mfma_f32_16x16x32_bf16 v[160:163], v[32:35], a[0:3], 0
s_waitcnt lgkmcnt(6)
v_mfma_f32_16x16x32_bf16 v[160:163], v[36:39], a[16:19], v[160:163]
s_waitcnt lgkmcnt(4)
ds_read_b64_tr_b16 v[52:53], v13 offset:8192
v_mfma_f32_16x16x32_bf16 v[160:163], v[40:43], a[32:35], v[160:163]
s_waitcnt lgkmcnt(3)
buffer_load_dwordx4 v9, s[16:19], s54 offen offset:3072  lds
v_mfma_f32_16x16x32_bf16 v[160:163], v[44:47], a[48:51], v[160:163]
s_mov_b32 s54, 384
ds_read_b64_tr_b16 v[54:55], v13 offset:9216
v_mfma_f32_16x16x32_bf16 v[164:167], v[32:35], a[4:7], 0
s_add_u32 m0, s66, 131072
v_mfma_f32_16x16x32_bf16 v[164:167], v[36:39], a[20:23], v[164:167]
ds_read_b64_tr_b16 v[56:57], v13 offset:16384
v_mfma_f32_16x16x32_bf16 v[164:167], v[40:43], a[36:39], v[164:167]
buffer_load_dwordx4 v2, s[12:15], s54 offen offset:0  lds
v_mfma_f32_16x16x32_bf16 v[164:167], v[44:47], a[52:55], v[164:167]
ds_read_b64_tr_b16 v[58:59], v13 offset:17408
v_mfma_f32_16x16x32_bf16 v[168:171], v[32:35], a[8:11], 0
s_lshl_b32 s53, s2, 8
v_mfma_f32_16x16x32_bf16 v[168:171], v[36:39], a[24:27], v[168:171]
s_add_u32 s53, s53, 85983232
ds_read_b64_tr_b16 v[60:61], v13 offset:24576
v_mfma_f32_16x16x32_bf16 v[168:171], v[40:43], a[40:43], v[168:171]
s_cmp_lt_u32 s2, 136
buffer_load_dwordx4 v3, s[12:15], s54 offen offset:1024  lds
v_mfma_f32_16x16x32_bf16 v[168:171], v[44:47], a[56:59], v[168:171]
s_cselect_b32 s53, s53, 2130706432
ds_read_b64_tr_b16 v[62:63], v13 offset:25600
v_mov_b32 v108, 0
v_mfma_f32_16x16x32_bf16 v[172:175], v[32:35], a[12:15], 0
buffer_store_dword v108, v0, s[4:7], s53 offen sc1
v_mfma_f32_16x16x32_bf16 v[172:175], v[36:39], a[28:31], v[172:175]
ds_read_b64_tr_b16 v[32:33], v14 offset:0
v_mfma_f32_16x16x32_bf16 v[172:175], v[40:43], a[44:47], v[172:175]
buffer_load_dwordx4 v4, s[12:15], s54 offen offset:2048  lds
v_mfma_f32_16x16x32_bf16 v[172:175], v[44:47], a[60:63], v[172:175]
s_waitcnt lgkmcnt(7)
ds_read_b64_tr_b16 v[34:35], v14 offset:1024
v_mfma_f32_16x16x32_bf16 v[176:179], v[48:51], a[0:3], 0
s_waitcnt lgkmcnt(6)
v_mfma_f32_16x16x32_bf16 v[176:179], v[52:55], a[16:19], v[176:179]
s_waitcnt lgkmcnt(4)
ds_read_b64_tr_b16 v[36:37], v14 offset:8192
v_mfma_f32_16x16x32_bf16 v[176:179], v[56:59], a[32:35], v[176:179]
s_waitcnt vmcnt(14) lgkmcnt(3)
buffer_load_dwordx4 v5, s[12:15], s54 offen offset:3072  lds
v_mfma_f32_16x16x32_bf16 v[176:179], v[60:63], a[48:51], v[176:179]
s_mov_b32 s54, 33152
ds_read_b64_tr_b16 v[38:39], v14 offset:9216
v_mfma_f32_16x16x32_bf16 v[180:183], v[48:51], a[4:7], 0
s_add_u32 m0, s66, 135168
ds_read_b128 a[64:67], v20 offset:32768
v_mfma_f32_16x16x32_bf16 v[180:183], v[52:55], a[20:23], v[180:183]
ds_read_b64_tr_b16 v[40:41], v14 offset:16384
v_mfma_f32_16x16x32_bf16 v[180:183], v[56:59], a[36:39], v[180:183]
buffer_load_dwordx4 v2, s[12:15], s54 offen offset:0  lds
v_mfma_f32_16x16x32_bf16 v[180:183], v[60:63], a[52:55], v[180:183]
ds_read_b64_tr_b16 v[42:43], v14 offset:17408
v_mfma_f32_16x16x32_bf16 v[184:187], v[48:51], a[8:11], 0
ds_read_b128 a[68:71], v20 offset:34816
v_mfma_f32_16x16x32_bf16 v[184:187], v[52:55], a[24:27], v[184:187]
ds_read_b64_tr_b16 v[44:45], v14 offset:24576
v_mfma_f32_16x16x32_bf16 v[184:187], v[56:59], a[40:43], v[184:187]
buffer_load_dwordx4 v3, s[12:15], s54 offen offset:1024  lds
v_mfma_f32_16x16x32_bf16 v[184:187], v[60:63], a[56:59], v[184:187]
ds_read_b64_tr_b16 v[46:47], v14 offset:25600
v_mfma_f32_16x16x32_bf16 v[188:191], v[48:51], a[12:15], 0
ds_read_b128 a[72:75], v20 offset:36864
v_mfma_f32_16x16x32_bf16 v[188:191], v[52:55], a[28:31], v[188:191]
ds_read_b64_tr_b16 v[48:49], v15 offset:0
v_mfma_f32_16x16x32_bf16 v[188:191], v[56:59], a[44:47], v[188:191]
buffer_load_dwordx4 v4, s[12:15], s54 offen offset:2048  lds
v_mfma_f32_16x16x32_bf16 v[188:191], v[60:63], a[60:63], v[188:191]
s_waitcnt lgkmcnt(10)
ds_read_b64_tr_b16 v[50:51], v15 offset:1024
v_mfma_f32_16x16x32_bf16 v[192:195], v[32:35], a[0:3], 0
s_waitcnt lgkmcnt(9)
ds_read_b128 a[76:79], v20 offset:38912
v_mfma_f32_16x16x32_bf16 v[192:195], v[36:39], a[16:19], v[192:195]
s_waitcnt lgkmcnt(7)
ds_read_b64_tr_b16 v[52:53], v15 offset:8192
v_mfma_f32_16x16x32_bf16 v[192:195], v[40:43], a[32:35], v[192:195]
s_waitcnt lgkmcnt(5)
buffer_load_dwordx4 v5, s[12:15], s54 offen offset:3072  lds
v_mfma_f32_16x16x32_bf16 v[192:195], v[44:47], a[48:51], v[192:195]
ds_read_b64_tr_b16 v[54:55], v15 offset:9216
v_mfma_f32_16x16x32_bf16 v[196:199], v[32:35], a[4:7], 0
ds_read_b128 a[80:83], v21 offset:32768
v_mfma_f32_16x16x32_bf16 v[196:199], v[36:39], a[20:23], v[196:199]
ds_read_b64_tr_b16 v[56:57], v15 offset:16384
v_mfma_f32_16x16x32_bf16 v[196:199], v[40:43], a[36:39], v[196:199]
buffer_load_dwordx4 v[72:75], v64, s[8:11], 0 offen
v_mfma_f32_16x16x32_bf16 v[196:199], v[44:47], a[52:55], v[196:199]
ds_read_b64_tr_b16 v[58:59], v15 offset:17408
v_mfma_f32_16x16x32_bf16 v[200:203], v[32:35], a[8:11], 0
ds_read_b128 a[84:87], v21 offset:34816
v_mfma_f32_16x16x32_bf16 v[200:203], v[36:39], a[24:27], v[200:203]
ds_read_b64_tr_b16 v[60:61], v15 offset:24576
v_mfma_f32_16x16x32_bf16 v[200:203], v[40:43], a[40:43], v[200:203]
buffer_load_dwordx4 v[76:79], v64, s[8:11], 0 offen offset:512
v_mfma_f32_16x16x32_bf16 v[200:203], v[44:47], a[56:59], v[200:203]
ds_read_b64_tr_b16 v[62:63], v15 offset:25600
v_mfma_f32_16x16x32_bf16 v[204:207], v[32:35], a[12:15], 0
ds_read_b128 a[88:91], v21 offset:36864
v_mfma_f32_16x16x32_bf16 v[204:207], v[36:39], a[28:31], v[204:207]
ds_read_b64_tr_b16 v[32:33], v16 offset:0
v_mfma_f32_16x16x32_bf16 v[204:207], v[40:43], a[44:47], v[204:207]
buffer_load_dwordx4 v[80:83], v65, s[8:11], 0 offen
v_mfma_f32_16x16x32_bf16 v[204:207], v[44:47], a[60:63], v[204:207]
s_waitcnt lgkmcnt(11)
s_mov_b32 s54, 512
ds_read_b64_tr_b16 v[34:35], v16 offset:1024
v_mfma_f32_16x16x32_bf16 v[208:211], v[48:51], a[0:3], 0
s_waitcnt lgkmcnt(9)
s_add_u32 m0, s66, 65536
ds_read_b128 a[92:95], v21 offset:38912
v_mfma_f32_16x16x32_bf16 v[208:211], v[52:55], a[16:19], v[208:211]
s_waitcnt lgkmcnt(7)
ds_read_b64_tr_b16 v[36:37], v16 offset:8192
v_mfma_f32_16x16x32_bf16 v[208:211], v[56:59], a[32:35], v[208:211]
s_waitcnt lgkmcnt(5)
buffer_load_dwordx4 v2, s[12:15], s54 offen offset:0  lds
v_mfma_f32_16x16x32_bf16 v[208:211], v[60:63], a[48:51], v[208:211]
ds_read_b64_tr_b16 v[38:39], v16 offset:9216
v_mfma_f32_16x16x32_bf16 v[212:215], v[48:51], a[4:7], 0
v_mfma_f32_16x16x32_bf16 v[212:215], v[52:55], a[20:23], v[212:215]
ds_read_b64_tr_b16 v[40:41], v16 offset:16384
v_mfma_f32_16x16x32_bf16 v[212:215], v[56:59], a[36:39], v[212:215]
buffer_load_dwordx4 v3, s[12:15], s54 offen offset:1024  lds
v_mfma_f32_16x16x32_bf16 v[212:215], v[60:63], a[52:55], v[212:215]
ds_read_b64_tr_b16 v[42:43], v16 offset:17408
v_mfma_f32_16x16x32_bf16 v[216:219], v[48:51], a[8:11], 0
v_mfma_f32_16x16x32_bf16 v[216:219], v[52:55], a[24:27], v[216:219]
ds_read_b64_tr_b16 v[44:45], v16 offset:24576
v_mfma_f32_16x16x32_bf16 v[216:219], v[56:59], a[40:43], v[216:219]
buffer_load_dwordx4 v4, s[12:15], s54 offen offset:2048  lds
v_mfma_f32_16x16x32_bf16 v[216:219], v[60:63], a[56:59], v[216:219]
ds_read_b64_tr_b16 v[46:47], v16 offset:25600
v_mfma_f32_16x16x32_bf16 v[220:223], v[48:51], a[12:15], 0
v_mfma_f32_16x16x32_bf16 v[220:223], v[52:55], a[28:31], v[220:223]
ds_read_b64_tr_b16 v[48:49], v17 offset:0
v_mfma_f32_16x16x32_bf16 v[220:223], v[56:59], a[44:47], v[220:223]
buffer_load_dwordx4 v5, s[12:15], s54 offen offset:3072  lds
v_mfma_f32_16x16x32_bf16 v[220:223], v[60:63], a[60:63], v[220:223]
s_waitcnt lgkmcnt(8)
s_mov_b32 s54, 33280
ds_read_b64_tr_b16 v[50:51], v17 offset:1024
v_mfma_f32_16x16x32_bf16 v[224:227], v[32:35], a[0:3], 0
s_waitcnt lgkmcnt(6)
s_add_u32 m0, s66, 69632
v_mfma_f32_16x16x32_bf16 v[224:227], v[36:39], a[16:19], v[224:227]
s_waitcnt lgkmcnt(4)
s_mov_b32 s56, 0
ds_read_b64_tr_b16 v[52:53], v17 offset:8192
v_mfma_f32_16x16x32_bf16 v[224:227], v[40:43], a[32:35], v[224:227]
s_waitcnt lgkmcnt(3)
buffer_load_dwordx4 v2, s[12:15], s54 offen offset:0  lds
v_mfma_f32_16x16x32_bf16 v[224:227], v[44:47], a[48:51], v[224:227]
ds_read_b64_tr_b16 v[54:55], v17 offset:9216
v_mfma_f32_16x16x32_bf16 v[228:231], v[32:35], a[4:7], 0
s_waitcnt vmcnt(8)
ds_read_b128 a[96:99], v22 offset:0
v_mfma_f32_16x16x32_bf16 v[228:231], v[36:39], a[20:23], v[228:231]
ds_read_b64_tr_b16 v[56:57], v17 offset:16384
v_mfma_f32_16x16x32_bf16 v[228:231], v[40:43], a[36:39], v[228:231]
buffer_load_dwordx4 v3, s[12:15], s54 offen offset:1024  lds
v_mfma_f32_16x16x32_bf16 v[228:231], v[44:47], a[52:55], v[228:231]
ds_read_b64_tr_b16 v[58:59], v17 offset:17408
v_mfma_f32_16x16x32_bf16 v[232:235], v[32:35], a[8:11], 0
ds_read_b128 a[100:103], v22 offset:2048
v_mfma_f32_16x16x32_bf16 v[232:235], v[36:39], a[24:27], v[232:235]
ds_read_b64_tr_b16 v[60:61], v17 offset:24576
v_mfma_f32_16x16x32_bf16 v[232:235], v[40:43], a[40:43], v[232:235]
buffer_load_dwordx4 v4, s[12:15], s54 offen offset:2048  lds
v_mfma_f32_16x16x32_bf16 v[232:235], v[44:47], a[56:59], v[232:235]
ds_read_b64_tr_b16 v[62:63], v17 offset:25600
v_mfma_f32_16x16x32_bf16 v[236:239], v[32:35], a[12:15], 0
ds_read_b128 a[104:107], v22 offset:4096
v_mfma_f32_16x16x32_bf16 v[236:239], v[36:39], a[28:31], v[236:239]
ds_read_b128 a[108:111], v22 offset:6144
v_mfma_f32_16x16x32_bf16 v[236:239], v[40:43], a[44:47], v[236:239]
buffer_load_dwordx4 v5, s[12:15], s54 offen offset:3072  lds
v_mfma_f32_16x16x32_bf16 v[236:239], v[44:47], a[60:63], v[236:239]
s_waitcnt lgkmcnt(10)
ds_read_b128 a[112:115], v23 offset:0
v_mfma_f32_16x16x32_bf16 v[240:243], v[48:51], a[0:3], 0
s_waitcnt lgkmcnt(0)
s_barrier
ds_read_b128 a[116:119], v23 offset:2048
v_mfma_f32_16x16x32_bf16 v[240:243], v[52:55], a[16:19], v[240:243]
ds_read_b64_tr_b16 v[32:33], v10 offset:32768
v_mfma_f32_16x16x32_bf16 v[240:243], v[56:59], a[32:35], v[240:243]
s_mov_b32 s54, 640
ds_read_b64_tr_b16 v[34:35], v10 offset:33792
v_mfma_f32_16x16x32_bf16 v[240:243], v[60:63], a[48:51], v[240:243]
s_add_u32 m0, s66, 98304
ds_read_b64_tr_b16 v[36:37], v10 offset:40960
v_mfma_f32_16x16x32_bf16 v[244:247], v[48:51], a[4:7], 0
ds_read_b64_tr_b16 v[38:39], v10 offset:41984
v_mfma_f32_16x16x32_bf16 v[244:247], v[52:55], a[20:23], v[244:247]
buffer_load_dwordx4 v2, s[12:15], s54 offen offset:0  lds
v_mfma_f32_16x16x32_bf16 v[244:247], v[56:59], a[36:39], v[244:247]
ds_read_b64_tr_b16 v[40:41], v10 offset:49152
v_mfma_f32_16x16x32_bf16 v[244:247], v[60:63], a[52:55], v[244:247]
ds_read_b128 a[120:123], v23 offset:4096
v_mfma_f32_16x16x32_bf16 v[248:251], v[48:51], a[8:11], 0
ds_read_b64_tr_b16 v[42:43], v10 offset:50176
v_mfma_f32_16x16x32_bf16 v[248:251], v[52:55], a[24:27], v[248:251]
buffer_load_dwordx4 v3, s[12:15], s54 offen offset:1024  lds
v_mfma_f32_16x16x32_bf16 v[248:251], v[56:59], a[40:43], v[248:251]
ds_read_b64_tr_b16 v[44:45], v10 offset:57344
v_mfma_f32_16x16x32_bf16 v[248:251], v[60:63], a[56:59], v[248:251]
ds_read_b128 a[124:127], v23 offset:6144
v_mfma_f32_16x16x32_bf16 v[252:255], v[48:51], a[12:15], 0
ds_read_b64_tr_b16 v[46:47], v10 offset:58368
v_mfma_f32_16x16x32_bf16 v[252:255], v[52:55], a[28:31], v[252:255]
ds_read_b64_tr_b16 v[48:49], v11 offset:32768
v_mfma_f32_16x16x32_bf16 v[252:255], v[56:59], a[44:47], v[252:255]
buffer_load_dwordx4 v4, s[12:15], s54 offen offset:2048  lds
v_mfma_f32_16x16x32_bf16 v[252:255], v[60:63], a[60:63], v[252:255]
s_waitcnt lgkmcnt(9)
ds_read_b64_tr_b16 v[50:51], v11 offset:33792
v_mfma_f32_16x16x32_bf16 v[128:131], v[32:35], a[64:67], v[128:131]
s_waitcnt lgkmcnt(8)
buffer_load_dword v31, v25, s[20:23], s56 offen
v_mfma_f32_16x16x32_bf16 v[128:131], v[36:39], a[80:83], v[128:131]
s_waitcnt lgkmcnt(5)
s_mov_b32 s56, 16384
ds_read_b64_tr_b16 v[52:53], v11 offset:40960
v_mfma_f32_16x16x32_bf16 v[128:131], v[40:43], a[96:99], v[128:131]
s_waitcnt lgkmcnt(3)
buffer_load_dwordx4 v5, s[12:15], s54 offen offset:3072  lds
v_mfma_f32_16x16x32_bf16 v[128:131], v[44:47], a[112:115], v[128:131]
s_mov_b32 s54, 33408
ds_read_b64_tr_b16 v[54:55], v11 offset:41984
v_mfma_f32_16x16x32_bf16 v[132:135], v[32:35], a[68:71], v[132:135]
s_add_u32 m0, s66, 102400
v_mfma_f32_16x16x32_bf16 v[132:135], v[36:39], a[84:87], v[132:135]
ds_read_b64_tr_b16 v[56:57], v11 offset:49152
v_mfma_f32_16x16x32_bf16 v[132:135], v[40:43], a[100:103], v[132:135]
buffer_load_dwordx4 v2, s[12:15], s54 offen offset:0  lds
v_mfma_f32_16x16x32_bf16 v[132:135], v[44:47], a[116:119], v[132:135]
ds_read_b64_tr_b16 v[58:59], v11 offset:50176
v_mfma_f32_16x16x32_bf16 v[136:139], v[32:35], a[72:75], v[136:139]
buffer_load_dword v31, v25, s[20:23], s56 offen
v_mfma_f32_16x16x32_bf16 v[136:139], v[36:39], a[88:91], v[136:139]
s_waitcnt vmcnt(17)
s_mov_b32 s56, 32768
ds_read_b64_tr_b16 v[60:61], v11 offset:57344
v_lshlrev_b32 v84, 16, v72
v_mfma_f32_16x16x32_bf16 v[136:139], v[40:43], a[104:107], v[136:139]
buffer_load_dwordx4 v3, s[12:15], s54 offen offset:1024  lds
v_mfma_f32_16x16x32_bf16 v[136:139], v[44:47], a[120:123], v[136:139]
ds_read_b64_tr_b16 v[62:63], v11 offset:58368
v_and_b32 v85, 0xffff0000, v72
v_mfma_f32_16x16x32_bf16 v[140:143], v[32:35], a[76:79], v[140:143]
v_lshlrev_b32 v86, 16, v73
v_and_b32 v87, 0xffff0000, v73
v_mfma_f32_16x16x32_bf16 v[140:143], v[36:39], a[92:95], v[140:143]
ds_read_b64_tr_b16 v[32:33], v12 offset:32768
v_lshlrev_b32 v88, 16, v74
v_mfma_f32_16x16x32_bf16 v[140:143], v[40:43], a[108:111], v[140:143]
buffer_load_dwordx4 v4, s[12:15], s54 offen offset:2048  lds
v_mfma_f32_16x16x32_bf16 v[140:143], v[44:47], a[124:127], v[140:143]
s_waitcnt lgkmcnt(7)
ds_read_b64_tr_b16 v[34:35], v12 offset:33792
v_and_b32 v89, 0xffff0000, v74
v_mfma_f32_16x16x32_bf16 v[144:147], v[48:51], a[64:67], v[144:147]
s_waitcnt lgkmcnt(6)
buffer_load_dword v31, v25, s[20:23], s56 offen
v_mfma_f32_16x16x32_bf16 v[144:147], v[52:55], a[80:83], v[144:147]
s_waitcnt lgkmcnt(4)
s_mov_b32 s56, 49152
ds_read_b64_tr_b16 v[36:37], v12 offset:40960
v_lshlrev_b32 v90, 16, v75
v_mfma_f32_16x16x32_bf16 v[144:147], v[56:59], a[96:99], v[144:147]
s_waitcnt lgkmcnt(3)
buffer_load_dwordx4 v5, s[12:15], s54 offen offset:3072  lds
v_mfma_f32_16x16x32_bf16 v[144:147], v[60:63], a[112:115], v[144:147]
ds_read_b64_tr_b16 v[38:39], v12 offset:41984
v_and_b32 v91, 0xffff0000, v75
v_mfma_f32_16x16x32_bf16 v[148:151], v[48:51], a[68:71], v[148:151]
s_waitcnt vmcnt(20)
v_lshlrev_b32 v92, 16, v76
v_and_b32 v93, 0xffff0000, v76
v_mfma_f32_16x16x32_bf16 v[148:151], v[52:55], a[84:87], v[148:151]
s_mov_b32 s54, 2097152
ds_read_b64_tr_b16 v[40:41], v12 offset:49152
v_lshlrev_b32 v94, 16, v77
v_mfma_f32_16x16x32_bf16 v[148:151], v[56:59], a[100:103], v[148:151]
s_add_u32 m0, s67, 0
v_and_b32 v95, 0xffff0000, v77
v_lshlrev_b32 v96, 16, v78
v_mfma_f32_16x16x32_bf16 v[148:151], v[60:63], a[116:119], v[148:151]
ds_read_b64_tr_b16 v[42:43], v12 offset:50176
v_and_b32 v97, 0xffff0000, v78
v_mfma_f32_16x16x32_bf16 v[152:155], v[48:51], a[72:75], v[152:155]
buffer_load_dwordx4 v6, s[16:19], s54 offen offset:0  lds
v_mfma_f32_16x16x32_bf16 v[152:155], v[52:55], a[88:91], v[152:155]
ds_read_b64_tr_b16 v[44:45], v12 offset:57344
v_lshlrev_b32 v98, 16, v79
v_mfma_f32_16x16x32_bf16 v[152:155], v[56:59], a[104:107], v[152:155]
buffer_load_dword v31, v25, s[20:23], s56 offen
v_mfma_f32_16x16x32_bf16 v[152:155], v[60:63], a[120:123], v[152:155]
ds_read_b64_tr_b16 v[46:47], v12 offset:58368
v_and_b32 v99, 0xffff0000, v79
v_mfma_f32_16x16x32_bf16 v[156:159], v[48:51], a[76:79], v[156:159]
buffer_load_dwordx4 v7, s[16:19], s54 offen offset:1024  lds
v_mfma_f32_16x16x32_bf16 v[156:159], v[52:55], a[92:95], v[156:159]
s_waitcnt vmcnt(22)
ds_read_b64_tr_b16 v[48:49], v13 offset:32768
v_lshlrev_b32 v100, 16, v80
v_mfma_f32_16x16x32_bf16 v[156:159], v[56:59], a[108:111], v[156:159]
s_waitcnt vmcnt(14)
ds_read_b128 a[128:131], v20 offset:0
v_and_b32 v101, 0xffff0000, v80
v_mfma_f32_16x16x32_bf16 v[156:159], v[60:63], a[124:127], v[156:159]
s_waitcnt lgkmcnt(8)
ds_read_b64_tr_b16 v[50:51], v13 offset:33792
v_lshlrev_b32 v102, 16, v81
v_mfma_f32_16x16x32_bf16 v[160:163], v[32:35], a[64:67], v[160:163]
s_waitcnt lgkmcnt(7)
buffer_load_dwordx4 v8, s[16:19], s54 offen offset:2048  lds
v_mfma_f32_16x16x32_bf16 v[160:163], v[36:39], a[80:83], v[160:163]
s_waitcnt lgkmcnt(5)
ds_read_b64_tr_b16 v[52:53], v13 offset:40960
v_and_b32 v103, 0xffff0000, v81
v_mfma_f32_16x16x32_bf16 v[160:163], v[40:43], a[96:99], v[160:163]
s_waitcnt lgkmcnt(4)
ds_read_b128 a[132:135], v20 offset:2048
v_lshlrev_b32 v104, 16, v82
v_mfma_f32_16x16x32_bf16 v[160:163], v[44:47], a[112:115], v[160:163]
ds_read_b64_tr_b16 v[54:55], v13 offset:41984
v_and_b32 v105, 0xffff0000, v82
v_mfma_f32_16x16x32_bf16 v[164:167], v[32:35], a[68:71], v[164:167]
buffer_load_dwordx4 v9, s[16:19], s54 offen offset:3072  lds
v_mfma_f32_16x16x32_bf16 v[164:167], v[36:39], a[84:87], v[164:167]
s_mov_b32 s54, 2621440
ds_read_b64_tr_b16 v[56:57], v13 offset:49152
v_lshlrev_b32 v106, 16, v83
v_mfma_f32_16x16x32_bf16 v[164:167], v[40:43], a[100:103], v[164:167]
s_add_u32 m0, s67, 16384
ds_read_b128 a[136:139], v20 offset:4096
v_and_b32 v107, 0xffff0000, v83
v_mfma_f32_16x16x32_bf16 v[164:167], v[44:47], a[116:119], v[164:167]
ds_read_b64_tr_b16 v[58:59], v13 offset:50176
v_add_f32 v108, v84, v85
v_mfma_f32_16x16x32_bf16 v[168:171], v[32:35], a[72:75], v[168:171]
buffer_load_dwordx4 v6, s[16:19], s54 offen offset:0  lds
v_mfma_f32_16x16x32_bf16 v[168:171], v[36:39], a[88:91], v[168:171]
ds_read_b64_tr_b16 v[60:61], v13 offset:57344
v_add_f32 v109, v86, v87
v_mfma_f32_16x16x32_bf16 v[168:171], v[40:43], a[104:107], v[168:171]
ds_read_b128 a[140:143], v20 offset:6144
v_add_f32 v108, v108, v88
v_mfma_f32_16x16x32_bf16 v[168:171], v[44:47], a[120:123], v[168:171]
ds_read_b64_tr_b16 v[62:63], v13 offset:58368
v_add_f32 v109, v109, v89
v_mfma_f32_16x16x32_bf16 v[172:175], v[32:35], a[76:79], v[172:175]
buffer_load_dwordx4 v7, s[16:19], s54 offen offset:1024  lds
v_mfma_f32_16x16x32_bf16 v[172:175], v[36:39], a[92:95], v[172:175]
ds_read_b64_tr_b16 v[32:33], v14 offset:32768
v_add_f32 v108, v108, v90
v_mfma_f32_16x16x32_bf16 v[172:175], v[40:43], a[108:111], v[172:175]
ds_read_b128 a[144:147], v21 offset:0
v_add_f32 v109, v109, v91
v_mfma_f32_16x16x32_bf16 v[172:175], v[44:47], a[124:127], v[172:175]
s_waitcnt lgkmcnt(11)
ds_read_b64_tr_b16 v[34:35], v14 offset:33792
v_add_f32 v108, v108, v92
v_mfma_f32_16x16x32_bf16 v[176:179], v[48:51], a[64:67], v[176:179]
s_waitcnt lgkmcnt(9)
buffer_load_dwordx4 v8, s[16:19], s54 offen offset:2048  lds
v_mfma_f32_16x16x32_bf16 v[176:179], v[52:55], a[80:83], v[176:179]
s_waitcnt lgkmcnt(6)
ds_read_b64_tr_b16 v[36:37], v14 offset:40960
v_add_f32 v109, v109, v93
v_mfma_f32_16x16x32_bf16 v[176:179], v[56:59], a[96:99], v[176:179]
s_waitcnt lgkmcnt(4)
ds_read_b128 a[148:151], v21 offset:2048
v_add_f32 v108, v108, v94
v_mfma_f32_16x16x32_bf16 v[176:179], v[60:63], a[112:115], v[176:179]
ds_read_b64_tr_b16 v[38:39], v14 offset:41984
v_add_f32 v109, v109, v95
v_mfma_f32_16x16x32_bf16 v[180:183], v[48:51], a[68:71], v[180:183]
buffer_load_dwordx4 v9, s[16:19], s54 offen offset:3072  lds
v_mfma_f32_16x16x32_bf16 v[180:183], v[52:55], a[84:87], v[180:183]
ds_read_b64_tr_b16 v[40:41], v14 offset:49152
v_add_f32 v108, v108, v96
v_mfma_f32_16x16x32_bf16 v[180:183], v[56:59], a[100:103], v[180:183]
ds_read_b128 a[152:155], v21 offset:4096
v_add_f32 v109, v109, v97
v_mfma_f32_16x16x32_bf16 v[180:183], v[60:63], a[116:119], v[180:183]
ds_read_b64_tr_b16 v[42:43], v14 offset:50176
v_add_f32 v108, v108, v98
v_mfma_f32_16x16x32_bf16 v[184:187], v[48:51], a[72:75], v[184:187]
s_mov_b32 s54, 768
ds_read_b128 a[156:159], v21 offset:6144
v_add_f32 v109, v109, v99
v_mfma_f32_16x16x32_bf16 v[184:187], v[52:55], a[88:91], v[184:187]
s_add_u32 m0, s66, 131072
ds_read_b64_tr_b16 v[44:45], v14 offset:57344
v_add_f32 v108, v108, v100
v_mfma_f32_16x16x32_bf16 v[184:187], v[56:59], a[104:107], v[184:187]
buffer_load_dwordx4 v2, s[12:15], s54 offen offset:0  lds
v_mfma_f32_16x16x32_bf16 v[184:187], v[60:63], a[120:123], v[184:187]
ds_read_b64_tr_b16 v[46:47], v14 offset:58368
v_add_f32 v109, v109, v101
v_mfma_f32_16x16x32_bf16 v[188:191], v[48:51], a[76:79], v[188:191]
v_add_f32 v108, v108, v102
v_add_f32 v109, v109, v103
v_mfma_f32_16x16x32_bf16 v[188:191], v[52:55], a[92:95], v[188:191]
ds_read_b64_tr_b16 v[48:49], v15 offset:32768
v_add_f32 v108, v108, v104
v_mfma_f32_16x16x32_bf16 v[188:191], v[56:59], a[108:111], v[188:191]
buffer_load_dwordx4 v3, s[12:15], s54 offen offset:1024  lds
v_mfma_f32_16x16x32_bf16 v[188:191], v[60:63], a[124:127], v[188:191]
s_waitcnt lgkmcnt(10)
ds_read_b64_tr_b16 v[50:51], v15 offset:33792
v_add_f32 v109, v109, v105
v_mfma_f32_16x16x32_bf16 v[192:195], v[32:35], a[64:67], v[192:195]
s_waitcnt lgkmcnt(8)
v_add_f32 v108, v108, v106
v_add_f32 v109, v109, v107
v_mfma_f32_16x16x32_bf16 v[192:195], v[36:39], a[80:83], v[192:195]
s_waitcnt lgkmcnt(5)
ds_read_b64_tr_b16 v[52:53], v15 offset:40960
v_add_f32 v108, v108, v109
v_mfma_f32_16x16x32_bf16 v[192:195], v[40:43], a[96:99], v[192:195]
s_waitcnt lgkmcnt(3)
buffer_load_dwordx4 v4, s[12:15], s54 offen offset:2048  lds
v_mfma_f32_16x16x32_bf16 v[192:195], v[44:47], a[112:115], v[192:195]
ds_read_b64_tr_b16 v[54:55], v15 offset:41984
v_add_f32_dpp v108, v108, v108 row_ror:8 row_mask:0xf bank_mask:0xf
v_mfma_f32_16x16x32_bf16 v[196:199], v[32:35], a[68:71], v[196:199]
s_nop 0
v_add_f32_dpp v108, v108, v108 row_ror:4 row_mask:0xf bank_mask:0xf
s_nop 1
v_add_f32_dpp v108, v108, v108 row_ror:2 row_mask:0xf bank_mask:0xf
v_mfma_f32_16x16x32_bf16 v[196:199], v[36:39], a[84:87], v[196:199]
ds_read_b64_tr_b16 v[56:57], v15 offset:49152
v_add_f32_dpp v108, v108, v108 row_ror:1 row_mask:0xf bank_mask:0xf
v_mfma_f32_16x16x32_bf16 v[196:199], v[40:43], a[100:103], v[196:199]
buffer_load_dwordx4 v5, s[12:15], s54 offen offset:3072  lds
v_mfma_f32_16x16x32_bf16 v[196:199], v[44:47], a[116:119], v[196:199]
s_mov_b32 s54, 33536
ds_read_b64_tr_b16 v[58:59], v15 offset:50176
v_mov_b32 v109, v108
v_mfma_f32_16x16x32_bf16 v[200:203], v[32:35], a[72:75], v[200:203]
s_add_u32 m0, s66, 135168
v_permlane16_swap_b32 v108, v109
v_add_f32 v108, v108, v109
v_mfma_f32_16x16x32_bf16 v[200:203], v[36:39], a[88:91], v[200:203]
ds_read_b64_tr_b16 v[60:61], v15 offset:57344
v_mul_f32 v108, 0.0015625, v108
v_mfma_f32_16x16x32_bf16 v[200:203], v[40:43], a[104:107], v[200:203]
buffer_load_dwordx4 v2, s[12:15], s54 offen offset:0  lds
v_mfma_f32_16x16x32_bf16 v[200:203], v[44:47], a[120:123], v[200:203]
ds_read_b64_tr_b16 v[62:63], v15 offset:58368
v_sub_f32 v110, v84, v108
v_mfma_f32_16x16x32_bf16 v[204:207], v[32:35], a[76:79], v[204:207]
s_waitcnt vmcnt(14)
ds_read_b128 a[160:163], v20 offset:32768
v_mul_f32 v109, v110, v110
v_mfma_f32_16x16x32_bf16 v[204:207], v[36:39], a[92:95], v[204:207]
ds_read_b64_tr_b16 v[32:33], v16 offset:32768
v_sub_f32 v111, v85, v108
v_mfma_f32_16x16x32_bf16 v[204:207], v[40:43], a[108:111], v[204:207]
buffer_load_dwordx4 v3, s[12:15], s54 offen offset:1024  lds
v_mfma_f32_16x16x32_bf16 v[204:207], v[44:47], a[124:127], v[204:207]
s_waitcnt lgkmcnt(8)
ds_read_b64_tr_b16 v[34:35], v16 offset:33792
v_fmac_f32 v109, v111, v111
v_mfma_f32_16x16x32_bf16 v[208:211], v[48:51], a[64:67], v[208:211]
s_waitcnt lgkmcnt(7)
ds_read_b128 a[164:167], v20 offset:34816
v_sub_f32 v110, v86, v108
v_mfma_f32_16x16x32_bf16 v[208:211], v[52:55], a[80:83], v[208:211]
s_waitcnt lgkmcnt(6)
ds_read_b64_tr_b16 v[36:37], v16 offset:40960
v_fmac_f32 v109, v110, v110
v_mfma_f32_16x16x32_bf16 v[208:211], v[56:59], a[96:99], v[208:211]
s_waitcnt lgkmcnt(5)
buffer_load_dwordx4 v4, s[12:15], s54 offen offset:2048  lds
v_mfma_f32_16x16x32_bf16 v[208:211], v[60:63], a[112:115], v[208:211]
ds_read_b64_tr_b16 v[38:39], v16 offset:41984
v_sub_f32 v111, v87, v108
v_mfma_f32_16x16x32_bf16 v[212:215], v[48:51], a[68:71], v[212:215]
ds_read_b128 a[168:171], v20 offset:36864
v_fmac_f32 v109, v111, v111
v_mfma_f32_16x16x32_bf16 v[212:215], v[52:55], a[84:87], v[212:215]
ds_read_b64_tr_b16 v[40:41], v16 offset:49152
v_sub_f32 v110, v88, v108
v_mfma_f32_16x16x32_bf16 v[212:215], v[56:59], a[100:103], v[212:215]
buffer_load_dwordx4 v5, s[12:15], s54 offen offset:3072  lds
v_mfma_f32_16x16x32_bf16 v[212:215], v[60:63], a[116:119], v[212:215]
ds_read_b64_tr_b16 v[42:43], v16 offset:50176
v_fmac_f32 v109, v110, v110
v_mfma_f32_16x16x32_bf16 v[216:219], v[48:51], a[72:75], v[216:219]
ds_read_b128 a[172:175], v20 offset:38912
v_sub_f32 v111, v89, v108
v_mfma_f32_16x16x32_bf16 v[216:219], v[52:55], a[88:91], v[216:219]
ds_read_b64_tr_b16 v[44:45], v16 offset:57344
v_fmac_f32 v109, v111, v111
v_mfma_f32_16x16x32_bf16 v[216:219], v[56:59], a[104:107], v[216:219]
s_mov_b32 s54, 896
ds_read_b128 a[176:179], v21 offset:32768
v_sub_f32 v110, v90, v108
v_mfma_f32_16x16x32_bf16 v[216:219], v[60:63], a[120:123], v[216:219]
s_add_u32 m0, s66, 65536
ds_read_b64_tr_b16 v[46:47], v16 offset:58368
v_fmac_f32 v109, v110, v110
v_mfma_f32_16x16x32_bf16 v[220:223], v[48:51], a[76:79], v[220:223]
buffer_load_dwordx4 v2, s[12:15], s54 offen offset:0  lds
v_mfma_f32_16x16x32_bf16 v[220:223], v[52:55], a[92:95], v[220:223]
ds_read_b64_tr_b16 v[48:49], v17 offset:32768
v_sub_f32 v111, v91, v108
v_mfma_f32_16x16x32_bf16 v[220:223], v[56:59], a[108:111], v[220:223]
ds_read_b128 a[180:183], v21 offset:34816
v_fmac_f32 v109, v111, v111
v_mfma_f32_16x16x32_bf16 v[220:223], v[60:63], a[124:127], v[220:223]
s_waitcnt lgkmcnt(12)
ds_read_b64_tr_b16 v[50:51], v17 offset:33792
v_sub_f32 v110, v92, v108
v_mfma_f32_16x16x32_bf16 v[224:227], v[32:35], a[64:67], v[224:227]
s_waitcnt lgkmcnt(10)
buffer_load_dwordx4 v3, s[12:15], s54 offen offset:1024  lds
v_mfma_f32_16x16x32_bf16 v[224:227], v[36:39], a[80:83], v[224:227]
s_waitcnt lgkmcnt(7)
ds_read_b64_tr_b16 v[52:53], v17 offset:40960
v_fmac_f32 v109, v110, v110
v_mfma_f32_16x16x32_bf16 v[224:227], v[40:43], a[96:99], v[224:227]
s_waitcnt lgkmcnt(4)
ds_read_b128 a[184:187], v21 offset:36864
v_sub_f32 v111, v93, v108
v_mfma_f32_16x16x32_bf16 v[224:227], v[44:47], a[112:115], v[224:227]
ds_read_b64_tr_b16 v[54:55], v17 offset:41984
v_fmac_f32 v109, v111, v111
v_mfma_f32_16x16x32_bf16 v[228:231], v[32:35], a[68:71], v[228:231]
buffer_load_dwordx4 v4, s[12:15], s54 offen offset:2048  lds
v_mfma_f32_16x16x32_bf16 v[228:231], v[36:39], a[84:87], v[228:231]
ds_read_b64_tr_b16 v[56:57], v17 offset:49152
v_sub_f32 v110, v94, v108
v_mfma_f32_16x16x32_bf16 v[228:231], v[40:43], a[100:103], v[228:231]
ds_read_b128 a[188:191], v21 offset:38912
v_fmac_f32 v109, v110, v110
v_mfma_f32_16x16x32_bf16 v[228:231], v[44:47], a[116:119], v[228:231]
ds_read_b64_tr_b16 v[58:59], v17 offset:50176
v_sub_f32 v111, v95, v108
v_mfma_f32_16x16x32_bf16 v[232:235], v[32:35], a[72:75], v[232:235]
buffer_load_dwordx4 v5, s[12:15], s54 offen offset:3072  lds
v_mfma_f32_16x16x32_bf16 v[232:235], v[36:39], a[88:91], v[232:235]
s_mov_b32 s54, 33664
ds_read_b64_tr_b16 v[60:61], v17 offset:57344
v_fmac_f32 v109, v111, v111
v_mfma_f32_16x16x32_bf16 v[232:235], v[40:43], a[104:107], v[232:235]
s_add_u32 m0, s66, 69632
v_sub_f32 v110, v96, v108
v_fmac_f32 v109, v110, v110
v_mfma_f32_16x16x32_bf16 v[232:235], v[44:47], a[120:123], v[232:235]
ds_read_b64_tr_b16 v[62:63], v17 offset:58368
v_sub_f32 v111, v97, v108
v_mfma_f32_16x16x32_bf16 v[236:239], v[32:35], a[76:79], v[236:239]
buffer_load_dwordx4 v2, s[12:15], s54 offen offset:0  lds
v_mfma_f32_16x16x32_bf16 v[236:239], v[36:39], a[92:95], v[236:239]
v_fmac_f32 v109, v111, v111
v_sub_f32 v110, v98, v108
v_mfma_f32_16x16x32_bf16 v[236:239], v[40:43], a[108:111], v[236:239]
v_fmac_f32 v109, v110, v110
v_sub_f32 v111, v99, v108
v_mfma_f32_16x16x32_bf16 v[236:239], v[44:47], a[124:127], v[236:239]
s_waitcnt lgkmcnt(8)
v_fmac_f32 v109, v111, v111
v_sub_f32 v110, v100, v108
v_mfma_f32_16x16x32_bf16 v[240:243], v[48:51], a[64:67], v[240:243]
s_waitcnt vmcnt(13)
s_waitcnt lgkmcnt(0)
s_barrier
buffer_load_dwordx4 v3, s[12:15], s54 offen offset:1024  lds
v_mfma_f32_16x16x32_bf16 v[240:243], v[52:55], a[80:83], v[240:243]
ds_read_b64_tr_b16 v[32:33], v10 offset:0
v_fmac_f32 v109, v110, v110
v_mfma_f32_16x16x32_bf16 v[240:243], v[56:59], a[96:99], v[240:243]
ds_read_b64_tr_b16 v[34:35], v10 offset:1024
v_sub_f32 v111, v101, v108
v_mfma_f32_16x16x32_bf16 v[240:243], v[60:63], a[112:115], v[240:243]
ds_read_b64_tr_b16 v[36:37], v10 offset:8192
v_fmac_f32 v109, v111, v111
v_mfma_f32_16x16x32_bf16 v[244:247], v[48:51], a[68:71], v[244:247]
ds_read_b64_tr_b16 v[38:39], v10 offset:9216
v_sub_f32 v110, v102, v108
v_mfma_f32_16x16x32_bf16 v[244:247], v[52:55], a[84:87], v[244:247]
buffer_load_dwordx4 v4, s[12:15], s54 offen offset:2048  lds
v_mfma_f32_16x16x32_bf16 v[244:247], v[56:59], a[100:103], v[244:247]
ds_read_b64_tr_b16 v[40:41], v10 offset:16384
v_fmac_f32 v109, v110, v110
v_mfma_f32_16x16x32_bf16 v[244:247], v[60:63], a[116:119], v[244:247]
v_sub_f32 v111, v103, v108
v_fmac_f32 v109, v111, v111
v_mfma_f32_16x16x32_bf16 v[248:251], v[48:51], a[72:75], v[248:251]
ds_read_b64_tr_b16 v[42:43], v10 offset:17408
v_sub_f32 v110, v104, v108
v_mfma_f32_16x16x32_bf16 v[248:251], v[52:55], a[88:91], v[248:251]
buffer_load_dwordx4 v5, s[12:15], s54 offen offset:3072  lds
v_mfma_f32_16x16x32_bf16 v[248:251], v[56:59], a[104:107], v[248:251]
ds_read_b64_tr_b16 v[44:45], v10 offset:24576
v_fmac_f32 v109, v110, v110
v_mfma_f32_16x16x32_bf16 v[248:251], v[60:63], a[120:123], v[248:251]
v_sub_f32 v111, v105, v108
v_fmac_f32 v109, v111, v111
v_mfma_f32_16x16x32_bf16 v[252:255], v[48:51], a[76:79], v[252:255]
s_mov_b32 s54, 3145728
ds_read_b64_tr_b16 v[46:47], v10 offset:25600
v_sub_f32 v110, v106, v108
v_mfma_f32_16x16x32_bf16 v[252:255], v[52:55], a[92:95], v[252:255]
s_add_u32 m0, s67, 32768
ds_read_b64_tr_b16 v[48:49], v11 offset:0
v_fmac_f32 v109, v110, v110
v_mfma_f32_16x16x32_bf16 v[252:255], v[56:59], a[108:111], v[252:255]
buffer_load_dwordx4 v6, s[16:19], s54 offen offset:0  lds
v_mfma_f32_16x16x32_bf16 v[252:255], v[60:63], a[124:127], v[252:255]
s_waitcnt lgkmcnt(7)
ds_read_b64_tr_b16 v[50:51], v11 offset:1024
v_sub_f32 v111, v107, v108
v_mfma_f32_16x16x32_bf16 v[128:131], v[32:35], a[128:131], v[128:131]
s_waitcnt lgkmcnt(6)
v_fmac_f32 v109, v111, v111
s_nop 1
v_add_f32_dpp v109, v109, v109 row_ror:8 row_mask:0xf bank_mask:0xf
v_mfma_f32_16x16x32_bf16 v[128:131], v[36:39], a[144:147], v[128:131]
s_waitcnt lgkmcnt(4)
ds_read_b64_tr_b16 v[52:53], v11 offset:8192
v_add_f32_dpp v109, v109, v109 row_ror:4 row_mask:0xf bank_mask:0xf
v_mfma_f32_16x16x32_bf16 v[128:131], v[40:43], a[160:163], v[128:131]
s_waitcnt lgkmcnt(3)
buffer_load_dwordx4 v7, s[16:19], s54 offen offset:1024  lds
v_mfma_f32_16x16x32_bf16 v[128:131], v[44:47], a[176:179], v[128:131]
ds_read_b64_tr_b16 v[54:55], v11 offset:9216
v_add_f32_dpp v109, v109, v109 row_ror:2 row_mask:0xf bank_mask:0xf
v_mfma_f32_16x16x32_bf16 v[132:135], v[32:35], a[132:135], v[132:135]
s_nop 0
v_add_f32_dpp v109, v109, v109 row_ror:1 row_mask:0xf bank_mask:0xf
v_mov_b32 v110, v109
v_mfma_f32_16x16x32_bf16 v[132:135], v[36:39], a[148:151], v[132:135]
ds_read_b64_tr_b16 v[56:57], v11 offset:16384
v_permlane16_swap_b32 v109, v110
v_mfma_f32_16x16x32_bf16 v[132:135], v[40:43], a[164:167], v[132:135]
buffer_load_dwordx4 v8, s[16:19], s54 offen offset:2048  lds
v_mfma_f32_16x16x32_bf16 v[132:135], v[44:47], a[180:183], v[132:135]
ds_read_b64_tr_b16 v[58:59], v11 offset:17408
v_add_f32 v109, v109, v110
v_mfma_f32_16x16x32_bf16 v[136:139], v[32:35], a[136:139], v[136:139]
v_mul_f32 v110, v108, v108
v_fmac_f32 v109, 0xc3000000, v110
v_mfma_f32_16x16x32_bf16 v[136:139], v[36:39], a[152:155], v[136:139]
ds_read_b64_tr_b16 v[60:61], v11 offset:24576
v_mul_f32 v109, 0.0015625, v109
v_mfma_f32_16x16x32_bf16 v[136:139], v[40:43], a[168:171], v[136:139]
buffer_load_dwordx4 v9, s[16:19], s54 offen offset:3072  lds
v_mfma_f32_16x16x32_bf16 v[136:139], v[44:47], a[184:187], v[136:139]
s_mov_b32 s54, 3670016
ds_read_b64_tr_b16 v[62:63], v11 offset:25600
v_cvt_pk_bf16_f32 v108, v108, v109
v_mfma_f32_16x16x32_bf16 v[140:143], v[32:35], a[140:143], v[140:143]
s_add_u32 m0, s67, 49152
v_and_b32 v109, 0xffff0000, v108
v_lshlrev_b32 v108, 16, v108
v_mfma_f32_16x16x32_bf16 v[140:143], v[36:39], a[156:159], v[140:143]
ds_read_b64_tr_b16 v[32:33], v12 offset:0
v_add_f32 v109, 0x3727c5ac, v109
v_mfma_f32_16x16x32_bf16 v[140:143], v[40:43], a[172:175], v[140:143]
buffer_load_dwordx4 v6, s[16:19], s54 offen offset:0  lds
v_mfma_f32_16x16x32_bf16 v[140:143], v[44:47], a[188:191], v[140:143]
s_waitcnt lgkmcnt(7)
ds_read_b64_tr_b16 v[34:35], v12 offset:1024
v_cvt_pk_bf16_f32 v109, v109, v109
v_mfma_f32_16x16x32_bf16 v[144:147], v[48:51], a[128:131], v[144:147]
s_waitcnt lgkmcnt(6)
v_lshlrev_b32 v109, 16, v109
v_mfma_f32_16x16x32_bf16 v[144:147], v[52:55], a[144:147], v[144:147]
s_waitcnt lgkmcnt(4)
ds_read_b64_tr_b16 v[36:37], v12 offset:8192
v_mfma_f32_16x16x32_bf16 v[144:147], v[56:59], a[160:163], v[144:147]
s_waitcnt lgkmcnt(3)
buffer_load_dwordx4 v7, s[16:19], s54 offen offset:1024  lds
v_mfma_f32_16x16x32_bf16 v[144:147], v[60:63], a[176:179], v[144:147]
ds_read_b64_tr_b16 v[38:39], v12 offset:9216
v_mfma_f32_16x16x32_bf16 v[148:151], v[48:51], a[132:135], v[148:151]
v_sqrt_f32 v109, v109
v_mfma_f32_16x16x32_bf16 v[148:151], v[52:55], a[148:151], v[148:151]
ds_read_b64_tr_b16 v[40:41], v12 offset:16384
v_cvt_pk_bf16_f32 v109, v109, v109
v_mfma_f32_16x16x32_bf16 v[148:151], v[56:59], a[164:167], v[148:151]
buffer_load_dwordx4 v8, s[16:19], s54 offen offset:2048  lds
v_mfma_f32_16x16x32_bf16 v[148:151], v[60:63], a[180:183], v[148:151]
ds_read_b64_tr_b16 v[42:43], v12 offset:17408
v_lshlrev_b32 v109, 16, v109
v_mfma_f32_16x16x32_bf16 v[152:155], v[48:51], a[136:139], v[152:155]
v_rcp_f32 v109, v109
v_mfma_f32_16x16x32_bf16 v[152:155], v[52:55], a[152:155], v[152:155]
ds_read_b64_tr_b16 v[44:45], v12 offset:24576
v_sub_f32 v84, v84, v108
v_mfma_f32_16x16x32_bf16 v[152:155], v[56:59], a[168:171], v[152:155]
buffer_load_dwordx4 v9, s[16:19], s54 offen offset:3072  lds
v_mfma_f32_16x16x32_bf16 v[152:155], v[60:63], a[184:187], v[152:155]
s_mov_b32 s54, 0
ds_read_b64_tr_b16 v[46:47], v12 offset:25600
v_sub_f32 v85, v85, v108
v_mfma_f32_16x16x32_bf16 v[156:159], v[48:51], a[140:143], v[156:159]
s_add_u32 m0, s67, 98304
v_cvt_pk_bf16_f32 v84, v84, v85
v_and_b32 v85, 0xffff0000, v84
v_mfma_f32_16x16x32_bf16 v[156:159], v[52:55], a[156:159], v[156:159]
ds_read_b64_tr_b16 v[48:49], v13 offset:0
v_lshlrev_b32 v84, 16, v84
v_mfma_f32_16x16x32_bf16 v[156:159], v[56:59], a[172:175], v[156:159]
buffer_load_dwordx4 v6, s[20:23], s54 offen offset:0  lds
v_mfma_f32_16x16x32_bf16 v[156:159], v[60:63], a[188:191], v[156:159]
s_waitcnt lgkmcnt(7)
ds_read_b64_tr_b16 v[50:51], v13 offset:1024
v_mul_f32 v84, v84, v109
v_mfma_f32_16x16x32_bf16 v[160:163], v[32:35], a[128:131], v[160:163]
s_waitcnt lgkmcnt(6)
v_mul_f32 v85, v85, v109
v_cvt_pk_bf16_f32 v72, v84, v85
v_mfma_f32_16x16x32_bf16 v[160:163], v[36:39], a[144:147], v[160:163]
s_waitcnt lgkmcnt(4)
ds_read_b64_tr_b16 v[52:53], v13 offset:8192
v_sub_f32 v86, v86, v108
v_mfma_f32_16x16x32_bf16 v[160:163], v[40:43], a[160:163], v[160:163]
s_waitcnt lgkmcnt(3)
buffer_load_dwordx4 v7, s[20:23], s54 offen offset:1024  lds
v_mfma_f32_16x16x32_bf16 v[160:163], v[44:47], a[176:179], v[160:163]
ds_read_b64_tr_b16 v[54:55], v13 offset:9216
v_sub_f32 v87, v87, v108
v_mfma_f32_16x16x32_bf16 v[164:167], v[32:35], a[132:135], v[164:167]
v_cvt_pk_bf16_f32 v86, v86, v87
v_and_b32 v87, 0xffff0000, v86
v_mfma_f32_16x16x32_bf16 v[164:167], v[36:39], a[148:151], v[164:167]
ds_read_b64_tr_b16 v[56:57], v13 offset:16384
v_lshlrev_b32 v86, 16, v86
v_mfma_f32_16x16x32_bf16 v[164:167], v[40:43], a[164:167], v[164:167]
buffer_load_dwordx4 v8, s[20:23], s54 offen offset:2048  lds
v_mfma_f32_16x16x32_bf16 v[164:167], v[44:47], a[180:183], v[164:167]
ds_read_b64_tr_b16 v[58:59], v13 offset:17408
v_mul_f32 v86, v86, v109
v_mfma_f32_16x16x32_bf16 v[168:171], v[32:35], a[136:139], v[168:171]
v_mul_f32 v87, v87, v109
v_cvt_pk_bf16_f32 v73, v86, v87
v_mfma_f32_16x16x32_bf16 v[168:171], v[36:39], a[152:155], v[168:171]
ds_read_b64_tr_b16 v[60:61], v13 offset:24576
v_sub_f32 v88, v88, v108
v_mfma_f32_16x16x32_bf16 v[168:171], v[40:43], a[168:171], v[168:171]
buffer_load_dwordx4 v9, s[20:23], s54 offen offset:3072  lds
v_mfma_f32_16x16x32_bf16 v[168:171], v[44:47], a[184:187], v[168:171]
s_mov_b32 s54, 524288
ds_read_b64_tr_b16 v[62:63], v13 offset:25600
v_sub_f32 v89, v89, v108
v_mfma_f32_16x16x32_bf16 v[172:175], v[32:35], a[140:143], v[172:175]
s_add_u32 m0, s67, 114688
s_waitcnt vmcnt(20)
ds_read_b128 a[192:195], v22 offset:0
v_cvt_pk_bf16_f32 v88, v88, v89
v_mfma_f32_16x16x32_bf16 v[172:175], v[36:39], a[156:159], v[172:175]
ds_read_b64_tr_b16 v[32:33], v14 offset:0
v_and_b32 v89, 0xffff0000, v88
v_mfma_f32_16x16x32_bf16 v[172:175], v[40:43], a[172:175], v[172:175]
buffer_load_dwordx4 v6, s[20:23], s54 offen offset:0  lds
v_mfma_f32_16x16x32_bf16 v[172:175], v[44:47], a[188:191], v[172:175]
s_waitcnt lgkmcnt(8)
ds_read_b64_tr_b16 v[34:35], v14 offset:1024
v_lshlrev_b32 v88, 16, v88
v_mfma_f32_16x16x32_bf16 v[176:179], v[48:51], a[128:131], v[176:179]
s_waitcnt lgkmcnt(7)
ds_read_b128 a[196:199], v22 offset:2048
v_mul_f32 v88, v88, v109
v_mfma_f32_16x16x32_bf16 v[176:179], v[52:55], a[144:147], v[176:179]
s_waitcnt lgkmcnt(6)
ds_read_b64_tr_b16 v[36:37], v14 offset:8192
v_mul_f32 v89, v89, v109
v_mfma_f32_16x16x32_bf16 v[176:179], v[56:59], a[160:163], v[176:179]
s_waitcnt lgkmcnt(5)
buffer_load_dwordx4 v7, s[20:23], s54 offen offset:1024  lds
v_mfma_f32_16x16x32_bf16 v[176:179], v[60:63], a[176:179], v[176:179]
ds_read_b64_tr_b16 v[38:39], v14 offset:9216
v_cvt_pk_bf16_f32 v74, v88, v89
v_mfma_f32_16x16x32_bf16 v[180:183], v[48:51], a[132:135], v[180:183]
ds_read_b128 a[200:203], v22 offset:4096
v_sub_f32 v90, v90, v108
v_mfma_f32_16x16x32_bf16 v[180:183], v[52:55], a[148:151], v[180:183]
ds_read_b64_tr_b16 v[40:41], v14 offset:16384
v_sub_f32 v91, v91, v108
v_mfma_f32_16x16x32_bf16 v[180:183], v[56:59], a[164:167], v[180:183]
buffer_load_dwordx4 v8, s[20:23], s54 offen offset:2048  lds
v_mfma_f32_16x16x32_bf16 v[180:183], v[60:63], a[180:183], v[180:183]
ds_read_b64_tr_b16 v[42:43], v14 offset:17408
v_cvt_pk_bf16_f32 v90, v90, v91
v_mfma_f32_16x16x32_bf16 v[184:187], v[48:51], a[136:139], v[184:187]
ds_read_b128 a[204:207], v22 offset:6144
v_and_b32 v91, 0xffff0000, v90
v_mfma_f32_16x16x32_bf16 v[184:187], v[52:55], a[152:155], v[184:187]
ds_read_b64_tr_b16 v[44:45], v14 offset:24576
v_lshlrev_b32 v90, 16, v90
v_mfma_f32_16x16x32_bf16 v[184:187], v[56:59], a[168:171], v[184:187]
buffer_load_dwordx4 v9, s[20:23], s54 offen offset:3072  lds
v_mfma_f32_16x16x32_bf16 v[184:187], v[60:63], a[184:187], v[184:187]
ds_read_b64_tr_b16 v[46:47], v14 offset:25600
v_mul_f32 v90, v90, v109
v_mfma_f32_16x16x32_bf16 v[188:191], v[48:51], a[140:143], v[188:191]
ds_read_b128 a[208:211], v23 offset:0
v_mul_f32 v91, v91, v109
v_mfma_f32_16x16x32_bf16 v[188:191], v[52:55], a[156:159], v[188:191]
ds_read_b64_tr_b16 v[48:49], v15 offset:0
v_cvt_pk_bf16_f32 v75, v90, v91
v_mfma_f32_16x16x32_bf16 v[188:191], v[56:59], a[172:175], v[188:191]
ds_read_b128 a[212:215], v23 offset:2048
v_sub_f32 v92, v92, v108
v_mfma_f32_16x16x32_bf16 v[188:191], v[60:63], a[188:191], v[188:191]
s_waitcnt lgkmcnt(12)
ds_read_b64_tr_b16 v[50:51], v15 offset:1024
v_sub_f32 v93, v93, v108
v_mfma_f32_16x16x32_bf16 v[192:195], v[32:35], a[128:131], v[192:195]
s_waitcnt lgkmcnt(10)
ds_read_b128 a[216:219], v23 offset:4096
v_cvt_pk_bf16_f32 v92, v92, v93
v_mfma_f32_16x16x32_bf16 v[192:195], v[36:39], a[144:147], v[192:195]
s_waitcnt lgkmcnt(8)
ds_read_b64_tr_b16 v[52:53], v15 offset:8192
v_and_b32 v93, 0xffff0000, v92
v_mfma_f32_16x16x32_bf16 v[192:195], v[40:43], a[160:163], v[192:195]
s_waitcnt lgkmcnt(6)
ds_read_b128 a[220:223], v23 offset:6144
v_lshlrev_b32 v92, 16, v92
v_mfma_f32_16x16x32_bf16 v[192:195], v[44:47], a[176:179], v[192:195]
ds_read_b64_tr_b16 v[54:55], v15 offset:9216
v_mul_f32 v92, v92, v109
v_mfma_f32_16x16x32_bf16 v[196:199], v[32:35], a[132:135], v[196:199]
v_mul_f32 v93, v93, v109
v_cvt_pk_bf16_f32 v76, v92, v93
v_mfma_f32_16x16x32_bf16 v[196:199], v[36:39], a[148:151], v[196:199]
ds_read_b64_tr_b16 v[56:57], v15 offset:16384
v_sub_f32 v94, v94, v108
v_mfma_f32_16x16x32_bf16 v[196:199], v[40:43], a[164:167], v[196:199]
v_sub_f32 v95, v95, v108
v_cvt_pk_bf16_f32 v94, v94, v95
v_mfma_f32_16x16x32_bf16 v[196:199], v[44:47], a[180:183], v[196:199]
ds_read_b64_tr_b16 v[58:59], v15 offset:17408
v_and_b32 v95, 0xffff0000, v94
v_mfma_f32_16x16x32_bf16 v[200:203], v[32:35], a[136:139], v[200:203]
v_lshlrev_b32 v94, 16, v94
v_mul_f32 v94, v94, v109
v_mfma_f32_16x16x32_bf16 v[200:203], v[36:39], a[152:155], v[200:203]
ds_read_b64_tr_b16 v[60:61], v15 offset:24576
v_mul_f32 v95, v95, v109
v_mfma_f32_16x16x32_bf16 v[200:203], v[40:43], a[168:171], v[200:203]
v_cvt_pk_bf16_f32 v77, v94, v95
v_sub_f32 v96, v96, v108
v_mfma_f32_16x16x32_bf16 v[200:203], v[44:47], a[184:187], v[200:203]
ds_read_b64_tr_b16 v[62:63], v15 offset:25600
v_sub_f32 v97, v97, v108
v_mfma_f32_16x16x32_bf16 v[204:207], v[32:35], a[140:143], v[204:207]
v_cvt_pk_bf16_f32 v96, v96, v97
v_and_b32 v97, 0xffff0000, v96
v_mfma_f32_16x16x32_bf16 v[204:207], v[36:39], a[156:159], v[204:207]
ds_read_b64_tr_b16 v[32:33], v16 offset:0
v_lshlrev_b32 v96, 16, v96
v_mfma_f32_16x16x32_bf16 v[204:207], v[40:43], a[172:175], v[204:207]
s_waitcnt vmcnt(16)
ds_read_b128 a[224:227], v20 offset:0
v_mul_f32 v96, v96, v109
v_mfma_f32_16x16x32_bf16 v[204:207], v[44:47], a[188:191], v[204:207]
s_waitcnt lgkmcnt(10)
ds_read_b64_tr_b16 v[34:35], v16 offset:1024
v_mul_f32 v97, v97, v109
v_mfma_f32_16x16x32_bf16 v[208:211], v[48:51], a[128:131], v[208:211]
s_waitcnt lgkmcnt(7)
ds_read_b128 a[228:231], v20 offset:2048
v_cvt_pk_bf16_f32 v78, v96, v97
v_mfma_f32_16x16x32_bf16 v[208:211], v[52:55], a[144:147], v[208:211]
s_waitcnt lgkmcnt(6)
ds_read_b64_tr_b16 v[36:37], v16 offset:8192
v_sub_f32 v98, v98, v108
v_mfma_f32_16x16x32_bf16 v[208:211], v[56:59], a[160:163], v[208:211]
s_waitcnt lgkmcnt(5)
ds_read_b128 a[232:235], v20 offset:4096
v_sub_f32 v99, v99, v108
v_mfma_f32_16x16x32_bf16 v[208:211], v[60:63], a[176:179], v[208:211]
ds_read_b64_tr_b16 v[38:39], v16 offset:9216
v_cvt_pk_bf16_f32 v98, v98, v99
v_mfma_f32_16x16x32_bf16 v[212:215], v[48:51], a[132:135], v[212:215]
ds_read_b128 a[236:239], v20 offset:6144
v_and_b32 v99, 0xffff0000, v98
v_mfma_f32_16x16x32_bf16 v[212:215], v[52:55], a[148:151], v[212:215]
ds_read_b64_tr_b16 v[40:41], v16 offset:16384
v_lshlrev_b32 v98, 16, v98
v_mfma_f32_16x16x32_bf16 v[212:215], v[56:59], a[164:167], v[212:215]
ds_read_b128 a[240:243], v21 offset:0
v_mul_f32 v98, v98, v109
v_mfma_f32_16x16x32_bf16 v[212:215], v[60:63], a[180:183], v[212:215]
ds_read_b64_tr_b16 v[42:43], v16 offset:17408
v_mul_f32 v99, v99, v109
v_mfma_f32_16x16x32_bf16 v[216:219], v[48:51], a[136:139], v[216:219]
ds_read_b128 a[244:247], v21 offset:2048
v_cvt_pk_bf16_f32 v79, v98, v99
v_mfma_f32_16x16x32_bf16 v[216:219], v[52:55], a[152:155], v[216:219]
ds_read_b64_tr_b16 v[44:45], v16 offset:24576
v_sub_f32 v100, v100, v108
v_mfma_f32_16x16x32_bf16 v[216:219], v[56:59], a[168:171], v[216:219]
ds_read_b128 a[248:251], v21 offset:4096
v_sub_f32 v101, v101, v108
v_mfma_f32_16x16x32_bf16 v[216:219], v[60:63], a[184:187], v[216:219]
ds_read_b64_tr_b16 v[46:47], v16 offset:25600
v_cvt_pk_bf16_f32 v100, v100, v101
v_mfma_f32_16x16x32_bf16 v[220:223], v[48:51], a[140:143], v[220:223]
ds_read_b128 a[252:255], v21 offset:6144
v_and_b32 v101, 0xffff0000, v100
v_mfma_f32_16x16x32_bf16 v[220:223], v[52:55], a[156:159], v[220:223]
ds_read_b64_tr_b16 v[48:49], v17 offset:0
v_lshlrev_b32 v100, 16, v100
v_mfma_f32_16x16x32_bf16 v[220:223], v[56:59], a[172:175], v[220:223]
v_mul_f32 v100, v100, v109
v_mul_f32 v101, v101, v109
v_mfma_f32_16x16x32_bf16 v[220:223], v[60:63], a[188:191], v[220:223]
s_waitcnt lgkmcnt(14)
ds_read_b64_tr_b16 v[50:51], v17 offset:1024
v_cvt_pk_bf16_f32 v80, v100, v101
v_mfma_f32_16x16x32_bf16 v[224:227], v[32:35], a[128:131], v[224:227]
s_waitcnt lgkmcnt(11)
v_sub_f32 v102, v102, v108
v_sub_f32 v103, v103, v108
v_mfma_f32_16x16x32_bf16 v[224:227], v[36:39], a[144:147], v[224:227]
s_waitcnt lgkmcnt(7)
ds_read_b64_tr_b16 v[52:53], v17 offset:8192
v_cvt_pk_bf16_f32 v102, v102, v103
v_mfma_f32_16x16x32_bf16 v[224:227], v[40:43], a[160:163], v[224:227]
s_waitcnt lgkmcnt(4)
v_and_b32 v103, 0xffff0000, v102
v_lshlrev_b32 v102, 16, v102
v_mfma_f32_16x16x32_bf16 v[224:227], v[44:47], a[176:179], v[224:227]
ds_read_b64_tr_b16 v[54:55], v17 offset:9216
v_mul_f32 v102, v102, v109
v_mfma_f32_16x16x32_bf16 v[228:231], v[32:35], a[132:135], v[228:231]
v_mul_f32 v103, v103, v109
v_cvt_pk_bf16_f32 v81, v102, v103
v_mfma_f32_16x16x32_bf16 v[228:231], v[36:39], a[148:151], v[228:231]
ds_read_b64_tr_b16 v[56:57], v17 offset:16384
v_sub_f32 v104, v104, v108
v_mfma_f32_16x16x32_bf16 v[228:231], v[40:43], a[164:167], v[228:231]
v_sub_f32 v105, v105, v108
v_cvt_pk_bf16_f32 v104, v104, v105
v_mfma_f32_16x16x32_bf16 v[228:231], v[44:47], a[180:183], v[228:231]
ds_read_b64_tr_b16 v[58:59], v17 offset:17408
v_and_b32 v105, 0xffff0000, v104
v_mfma_f32_16x16x32_bf16 v[232:235], v[32:35], a[136:139], v[232:235]
v_lshlrev_b32 v104, 16, v104
v_mul_f32 v104, v104, v109
v_mfma_f32_16x16x32_bf16 v[232:235], v[36:39], a[152:155], v[232:235]
ds_read_b64_tr_b16 v[60:61], v17 offset:24576
v_mul_f32 v105, v105, v109
v_mfma_f32_16x16x32_bf16 v[232:235], v[40:43], a[168:171], v[232:235]
v_cvt_pk_bf16_f32 v82, v104, v105
v_sub_f32 v106, v106, v108
v_mfma_f32_16x16x32_bf16 v[232:235], v[44:47], a[184:187], v[232:235]
ds_read_b64_tr_b16 v[62:63], v17 offset:25600
v_sub_f32 v107, v107, v108
v_mfma_f32_16x16x32_bf16 v[236:239], v[32:35], a[140:143], v[236:239]
v_cvt_pk_bf16_f32 v106, v106, v107
v_and_b32 v107, 0xffff0000, v106
v_mfma_f32_16x16x32_bf16 v[236:239], v[36:39], a[156:159], v[236:239]
v_lshlrev_b32 v106, 16, v106
v_mul_f32 v106, v106, v109
v_mfma_f32_16x16x32_bf16 v[236:239], v[40:43], a[172:175], v[236:239]
v_mul_f32 v107, v107, v109
v_cvt_pk_bf16_f32 v83, v106, v107
v_mfma_f32_16x16x32_bf16 v[236:239], v[44:47], a[188:191], v[236:239]
s_waitcnt lgkmcnt(6)
v_mfma_f32_16x16x32_bf16 v[240:243], v[48:51], a[128:131], v[240:243]
s_waitcnt vmcnt(8)
s_waitcnt lgkmcnt(0)
s_barrier
v_mfma_f32_16x16x32_bf16 v[240:243], v[52:55], a[144:147], v[240:243]
ds_read_b64_tr_b16 v[32:33], v10 offset:32768
v_mfma_f32_16x16x32_bf16 v[240:243], v[56:59], a[160:163], v[240:243]
s_mov_b32 s54, 1048576
ds_read_b64_tr_b16 v[34:35], v10 offset:33792
v_mfma_f32_16x16x32_bf16 v[240:243], v[60:63], a[176:179], v[240:243]
s_add_u32 m0, s67, 0
ds_read_b64_tr_b16 v[36:37], v10 offset:40960
v_mfma_f32_16x16x32_bf16 v[244:247], v[48:51], a[132:135], v[244:247]
ds_read_b64_tr_b16 v[38:39], v10 offset:41984
v_mfma_f32_16x16x32_bf16 v[244:247], v[52:55], a[148:151], v[244:247]
buffer_load_dwordx4 v6, s[20:23], s54 offen offset:0  lds
v_mfma_f32_16x16x32_bf16 v[244:247], v[56:59], a[164:167], v[244:247]
ds_read_b64_tr_b16 v[40:41], v10 offset:49152
v_mfma_f32_16x16x32_bf16 v[244:247], v[60:63], a[180:183], v[244:247]
ds_write_b128 v66, v[72:75] offset:0
v_mfma_f32_16x16x32_bf16 v[248:251], v[48:51], a[136:139], v[248:251]
ds_read_b64_tr_b16 v[42:43], v10 offset:50176
v_mfma_f32_16x16x32_bf16 v[248:251], v[52:55], a[152:155], v[248:251]
ds_write_b128 v66, v[76:79] offset:4096
v_mfma_f32_16x16x32_bf16 v[248:251], v[56:59], a[168:171], v[248:251]
ds_read_b64_tr_b16 v[44:45], v10 offset:57344
v_mfma_f32_16x16x32_bf16 v[248:251], v[60:63], a[184:187], v[248:251]
buffer_load_dwordx4 v7, s[20:23], s54 offen offset:1024  lds
v_mfma_f32_16x16x32_bf16 v[252:255], v[48:51], a[140:143], v[252:255]
ds_read_b64_tr_b16 v[46:47], v10 offset:58368
v_mfma_f32_16x16x32_bf16 v[252:255], v[52:55], a[156:159], v[252:255]
ds_read_b64_tr_b16 v[48:49], v11 offset:32768
v_add_u32 v10, 0x18000, v10
v_mfma_f32_16x16x32_bf16 v[252:255], v[56:59], a[172:175], v[252:255]
ds_write_b128 v66, v[80:83] offset:8192
v_mfma_f32_16x16x32_bf16 v[252:255], v[60:63], a[188:191], v[252:255]
ds_read_b64_tr_b16 v[50:51], v11 offset:33792
s_add_u32 s51, s48, 1
s_lshr_b32 s52, s51, 2
s_min_u32 s52, s52, 5
s_sub_u32 s66, s48, s52
s_and_b32 s51, s51, 3
s_cmp_lt_u32 s48, 20
s_cselect_b32 s51, s51, 1
s_cmp_eq_u32 s51, 0
s_cselect_b32 s66, 0x10000, s66
s_waitcnt lgkmcnt(11)
v_mfma_f32_16x16x32_bf16 v[128:131], v[32:35], a[192:195], v[128:131]
s_waitcnt lgkmcnt(9)
buffer_load_dwordx4 v8, s[20:23], s54 offen offset:2048  lds
v_mfma_f32_16x16x32_bf16 v[128:131], v[36:39], a[208:211], v[128:131]
s_waitcnt lgkmcnt(6)
ds_read_b64_tr_b16 v[52:53], v11 offset:40960
v_mfma_f32_16x16x32_bf16 v[128:131], v[40:43], a[224:227], v[128:131]
s_waitcnt lgkmcnt(4)
v_mfma_f32_16x16x32_bf16 v[128:131], v[44:47], a[240:243], v[128:131]
ds_read_b64_tr_b16 v[54:55], v11 offset:41984
v_mfma_f32_16x16x32_bf16 v[132:135], v[32:35], a[196:199], v[132:135]
s_waitcnt lgkmcnt(0)
s_barrier
ds_read_b128 v[72:75], v67 offset:0
v_mfma_f32_16x16x32_bf16 v[132:135], v[36:39], a[212:215], v[132:135]
ds_read_b64_tr_b16 v[56:57], v11 offset:49152
v_mfma_f32_16x16x32_bf16 v[132:135], v[40:43], a[228:231], v[132:135]
buffer_load_dwordx4 v9, s[20:23], s54 offen offset:3072  lds
v_mfma_f32_16x16x32_bf16 v[132:135], v[44:47], a[244:247], v[132:135]
s_mov_b32 s54, 1572864
ds_read_b64_tr_b16 v[58:59], v11 offset:50176
v_mfma_f32_16x16x32_bf16 v[136:139], v[32:35], a[200:203], v[136:139]
s_add_u32 m0, s67, 16384
ds_read_b128 v[76:79], v67 offset:4096
v_mfma_f32_16x16x32_bf16 v[136:139], v[36:39], a[216:219], v[136:139]
ds_read_b64_tr_b16 v[60:61], v11 offset:57344
v_mfma_f32_16x16x32_bf16 v[136:139], v[40:43], a[232:235], v[136:139]
ds_read_b128 v[80:83], v67 offset:8192
v_mfma_f32_16x16x32_bf16 v[136:139], v[44:47], a[248:251], v[136:139]
ds_read_b64_tr_b16 v[62:63], v11 offset:58368
v_mfma_f32_16x16x32_bf16 v[140:143], v[32:35], a[204:207], v[140:143]
v_add_u32 v11, 0x18000, v11
v_mfma_f32_16x16x32_bf16 v[140:143], v[36:39], a[220:223], v[140:143]
ds_read_b64_tr_b16 v[32:33], v12 offset:32768
v_mfma_f32_16x16x32_bf16 v[140:143], v[40:43], a[236:239], v[140:143]
buffer_load_dwordx4 v6, s[20:23], s54 offen offset:0  lds
v_mfma_f32_16x16x32_bf16 v[140:143], v[44:47], a[252:255], v[140:143]
ds_read_b64_tr_b16 v[34:35], v12 offset:33792
v_mfma_f32_16x16x32_bf16 v[144:147], v[48:51], a[192:195], v[144:147]
s_waitcnt lgkmcnt(8)
s_mov_b32 s55, 0
buffer_store_dwordx4 v[72:75], v68, s[4:7], s55 offen sc1
v_mfma_f32_16x16x32_bf16 v[144:147], v[52:55], a[208:211], v[144:147]
s_waitcnt lgkmcnt(6)
s_mov_b32 s55, 8192
ds_read_b64_tr_b16 v[36:37], v12 offset:40960
v_mfma_f32_16x16x32_bf16 v[144:147], v[56:59], a[224:227], v[144:147]
s_waitcnt lgkmcnt(3)
buffer_store_dwordx4 v[76:79], v68, s[4:7], s55 offen sc1
v_mfma_f32_16x16x32_bf16 v[144:147], v[60:63], a[240:243], v[144:147]
s_mov_b32 s55, 16384
ds_read_b64_tr_b16 v[38:39], v12 offset:41984
v_mfma_f32_16x16x32_bf16 v[148:151], v[48:51], a[196:199], v[148:151]
s_cmp_lt_u32 s50, 2
buffer_load_dwordx4 v7, s[20:23], s54 offen offset:1024  lds
v_mfma_f32_16x16x32_bf16 v[148:151], v[52:55], a[212:215], v[148:151]
s_cselect_b32 s55, s55, 2130706432
ds_read_b64_tr_b16 v[40:41], v12 offset:49152
v_mfma_f32_16x16x32_bf16 v[148:151], v[56:59], a[228:231], v[148:151]
buffer_store_dwordx4 v[80:83], v68, s[4:7], s55 offen sc1
v_mfma_f32_16x16x32_bf16 v[148:151], v[60:63], a[244:247], v[148:151]
ds_read_b64_tr_b16 v[42:43], v12 offset:50176
v_mfma_f32_16x16x32_bf16 v[152:155], v[48:51], a[200:203], v[152:155]
v_mfma_f32_16x16x32_bf16 v[152:155], v[52:55], a[216:219], v[152:155]
ds_read_b64_tr_b16 v[44:45], v12 offset:57344
v_mfma_f32_16x16x32_bf16 v[152:155], v[56:59], a[232:235], v[152:155]
buffer_load_dwordx4 v8, s[20:23], s54 offen offset:2048  lds
v_mfma_f32_16x16x32_bf16 v[152:155], v[60:63], a[248:251], v[152:155]
ds_read_b64_tr_b16 v[46:47], v12 offset:58368
v_mfma_f32_16x16x32_bf16 v[156:159], v[48:51], a[204:207], v[156:159]
v_add_u32 v12, 0x18000, v12
v_mfma_f32_16x16x32_bf16 v[156:159], v[52:55], a[220:223], v[156:159]
ds_read_b64_tr_b16 v[48:49], v13 offset:32768
v_mfma_f32_16x16x32_bf16 v[156:159], v[56:59], a[236:239], v[156:159]
v_mfma_f32_16x16x32_bf16 v[156:159], v[60:63], a[252:255], v[156:159]
s_waitcnt lgkmcnt(7)
ds_read_b64_tr_b16 v[50:51], v13 offset:33792
v_mfma_f32_16x16x32_bf16 v[160:163], v[32:35], a[192:195], v[160:163]
s_waitcnt lgkmcnt(6)
buffer_load_dwordx4 v9, s[20:23], s54 offen offset:3072  lds
v_mfma_f32_16x16x32_bf16 v[160:163], v[36:39], a[208:211], v[160:163]
s_waitcnt lgkmcnt(4)
s_mov_b32 s54, 2097152
ds_read_b64_tr_b16 v[52:53], v13 offset:40960
v_mfma_f32_16x16x32_bf16 v[160:163], v[40:43], a[224:227], v[160:163]
s_waitcnt lgkmcnt(3)
s_add_u32 m0, s67, 65536
v_mfma_f32_16x16x32_bf16 v[160:163], v[44:47], a[240:243], v[160:163]
ds_read_b64_tr_b16 v[54:55], v13 offset:41984
v_mfma_f32_16x16x32_bf16 v[164:167], v[32:35], a[196:199], v[164:167]
v_mul_f32 v128, 0.12751743082459868, v128
v_mul_f32 v129, 0.12751743082459868, v129
v_mfma_f32_16x16x32_bf16 v[164:167], v[36:39], a[212:215], v[164:167]
ds_read_b64_tr_b16 v[56:57], v13 offset:49152
v_mul_f32 v130, 0.12751743082459868, v130
v_mfma_f32_16x16x32_bf16 v[164:167], v[40:43], a[228:231], v[164:167]
buffer_load_dwordx4 v6, s[20:23], s54 offen offset:0  lds
v_mfma_f32_16x16x32_bf16 v[164:167], v[44:47], a[244:247], v[164:167]
ds_read_b64_tr_b16 v[58:59], v13 offset:50176
v_mul_f32 v131, 0.12751743082459868, v131
v_mfma_f32_16x16x32_bf16 v[168:171], v[32:35], a[200:203], v[168:171]
v_mul_f32 v144, 0.12751743082459868, v144
v_mul_f32 v145, 0.12751743082459868, v145
v_mfma_f32_16x16x32_bf16 v[168:171], v[36:39], a[216:219], v[168:171]
ds_read_b64_tr_b16 v[60:61], v13 offset:57344
v_mul_f32 v146, 0.12751743082459868, v146
v_mfma_f32_16x16x32_bf16 v[168:171], v[40:43], a[232:235], v[168:171]
v_mul_f32 v147, 0.12751743082459868, v147
v_cvt_pk_bf16_f32 v64, v128, v129
v_mfma_f32_16x16x32_bf16 v[168:171], v[44:47], a[248:251], v[168:171]
ds_read_b64_tr_b16 v[62:63], v13 offset:58368
v_cvt_pk_bf16_f32 v65, v130, v131
v_mfma_f32_16x16x32_bf16 v[172:175], v[32:35], a[204:207], v[172:175]
v_add_u32 v13, 0x18000, v13
v_cvt_pk_bf16_f32 v66, v144, v145
v_mfma_f32_16x16x32_bf16 v[172:175], v[36:39], a[220:223], v[172:175]
ds_read_b64_tr_b16 v[32:33], v14 offset:32768
v_cvt_pk_bf16_f32 v67, v146, v147
v_mfma_f32_16x16x32_bf16 v[172:175], v[40:43], a[236:239], v[172:175]
s_mov_b32 s55, 0
buffer_load_dwordx4 v7, s[20:23], s54 offen offset:1024  lds
v_mfma_f32_16x16x32_bf16 v[172:175], v[44:47], a[252:255], v[172:175]
s_waitcnt lgkmcnt(7)
ds_read_b64_tr_b16 v[34:35], v14 offset:33792
v_mul_f32 v132, 0.12751743082459868, v132
v_mfma_f32_16x16x32_bf16 v[176:179], v[48:51], a[192:195], v[176:179]
s_waitcnt lgkmcnt(6)
buffer_store_dwordx4 v[64:67], v24, s[4:7], s55 offen
v_mfma_f32_16x16x32_bf16 v[176:179], v[52:55], a[208:211], v[176:179]
s_waitcnt lgkmcnt(4)
ds_read_b64_tr_b16 v[36:37], v14 offset:40960
v_mul_f32 v133, 0.12751743082459868, v133
v_mfma_f32_16x16x32_bf16 v[176:179], v[56:59], a[224:227], v[176:179]
s_waitcnt lgkmcnt(3)
v_mul_f32 v134, 0.12751743082459868, v134
v_mul_f32 v135, 0.12751743082459868, v135
v_mfma_f32_16x16x32_bf16 v[176:179], v[60:63], a[240:243], v[176:179]
ds_read_b64_tr_b16 v[38:39], v14 offset:41984
v_mul_f32 v148, 0.12751743082459868, v148
v_mfma_f32_16x16x32_bf16 v[180:183], v[48:51], a[196:199], v[180:183]
buffer_load_dwordx4 v8, s[20:23], s54 offen offset:2048  lds
v_mfma_f32_16x16x32_bf16 v[180:183], v[52:55], a[212:215], v[180:183]
ds_read_b64_tr_b16 v[40:41], v14 offset:49152
v_mul_f32 v149, 0.12751743082459868, v149
v_mfma_f32_16x16x32_bf16 v[180:183], v[56:59], a[228:231], v[180:183]
v_mul_f32 v150, 0.12751743082459868, v150
v_mul_f32 v151, 0.12751743082459868, v151
v_mfma_f32_16x16x32_bf16 v[180:183], v[60:63], a[244:247], v[180:183]
ds_read_b64_tr_b16 v[42:43], v14 offset:50176
v_cvt_pk_bf16_f32 v68, v132, v133
v_mfma_f32_16x16x32_bf16 v[184:187], v[48:51], a[200:203], v[184:187]
v_cvt_pk_bf16_f32 v69, v134, v135
v_cvt_pk_bf16_f32 v70, v148, v149
v_mfma_f32_16x16x32_bf16 v[184:187], v[52:55], a[216:219], v[184:187]
ds_read_b64_tr_b16 v[44:45], v14 offset:57344
v_cvt_pk_bf16_f32 v71, v150, v151
v_mfma_f32_16x16x32_bf16 v[184:187], v[56:59], a[232:235], v[184:187]
buffer_load_dwordx4 v9, s[20:23], s54 offen offset:3072  lds
v_mfma_f32_16x16x32_bf16 v[184:187], v[60:63], a[248:251], v[184:187]
s_mov_b32 s54, 2621440
ds_read_b64_tr_b16 v[46:47], v14 offset:58368
v_mul_f32 v136, 0.12751743082459868, v136
v_mfma_f32_16x16x32_bf16 v[188:191], v[48:51], a[204:207], v[188:191]
s_add_u32 m0, s67, 81920
v_add_u32 v14, 0x18000, v14
v_mul_f32 v137, 0.12751743082459868, v137
v_mfma_f32_16x16x32_bf16 v[188:191], v[52:55], a[220:223], v[188:191]
ds_read_b64_tr_b16 v[48:49], v15 offset:32768
v_mul_f32 v138, 0.12751743082459868, v138
v_mfma_f32_16x16x32_bf16 v[188:191], v[56:59], a[236:239], v[188:191]
v_mul_f32 v139, 0.12751743082459868, v139
v_mul_f32 v152, 0.12751743082459868, v152
v_mfma_f32_16x16x32_bf16 v[188:191], v[60:63], a[252:255], v[188:191]
s_waitcnt lgkmcnt(7)
ds_read_b64_tr_b16 v[50:51], v15 offset:33792
v_mul_f32 v153, 0.12751743082459868, v153
v_mfma_f32_16x16x32_bf16 v[192:195], v[32:35], a[192:195], v[192:195]
s_waitcnt lgkmcnt(6)
buffer_load_dwordx4 v6, s[20:23], s54 offen offset:0  lds
v_mfma_f32_16x16x32_bf16 v[192:195], v[36:39], a[208:211], v[192:195]
s_waitcnt lgkmcnt(4)
ds_read_b64_tr_b16 v[52:53], v15 offset:40960
v_mul_f32 v154, 0.12751743082459868, v154
v_mfma_f32_16x16x32_bf16 v[192:195], v[40:43], a[224:227], v[192:195]
s_waitcnt lgkmcnt(3)
v_mul_f32 v155, 0.12751743082459868, v155
v_cvt_pk_bf16_f32 v72, v136, v137
v_mfma_f32_16x16x32_bf16 v[192:195], v[44:47], a[240:243], v[192:195]
ds_read_b64_tr_b16 v[54:55], v15 offset:41984
v_cvt_pk_bf16_f32 v73, v138, v139
v_mfma_f32_16x16x32_bf16 v[196:199], v[32:35], a[196:199], v[196:199]
v_cvt_pk_bf16_f32 v74, v152, v153
v_cvt_pk_bf16_f32 v75, v154, v155
v_mfma_f32_16x16x32_bf16 v[196:199], v[36:39], a[212:215], v[196:199]
s_mov_b32 s55, 4096
ds_read_b64_tr_b16 v[56:57], v15 offset:49152
v_mul_f32 v140, 0.12751743082459868, v140
v_mfma_f32_16x16x32_bf16 v[196:199], v[40:43], a[228:231], v[196:199]
buffer_load_dwordx4 v7, s[20:23], s54 offen offset:1024  lds
v_mfma_f32_16x16x32_bf16 v[196:199], v[44:47], a[244:247], v[196:199]
ds_read_b64_tr_b16 v[58:59], v15 offset:50176
v_mul_f32 v141, 0.12751743082459868, v141
v_mfma_f32_16x16x32_bf16 v[200:203], v[32:35], a[200:203], v[200:203]
buffer_store_dwordx4 v[68:71], v24, s[4:7], s55 offen
v_mfma_f32_16x16x32_bf16 v[200:203], v[36:39], a[216:219], v[200:203]
ds_read_b64_tr_b16 v[60:61], v15 offset:57344
v_mul_f32 v142, 0.12751743082459868, v142
v_mfma_f32_16x16x32_bf16 v[200:203], v[40:43], a[232:235], v[200:203]
v_mul_f32 v143, 0.12751743082459868, v143
v_mul_f32 v156, 0.12751743082459868, v156
v_mfma_f32_16x16x32_bf16 v[200:203], v[44:47], a[248:251], v[200:203]
ds_read_b64_tr_b16 v[62:63], v15 offset:58368
v_mul_f32 v157, 0.12751743082459868, v157
v_mfma_f32_16x16x32_bf16 v[204:207], v[32:35], a[204:207], v[204:207]
v_add_u32 v15, 0x18000, v15
v_mul_f32 v158, 0.12751743082459868, v158
v_mfma_f32_16x16x32_bf16 v[204:207], v[36:39], a[220:223], v[204:207]
ds_read_b64_tr_b16 v[32:33], v16 offset:32768
v_mul_f32 v159, 0.12751743082459868, v159
v_mfma_f32_16x16x32_bf16 v[204:207], v[40:43], a[236:239], v[204:207]
buffer_load_dwordx4 v8, s[20:23], s54 offen offset:2048  lds
v_mfma_f32_16x16x32_bf16 v[204:207], v[44:47], a[252:255], v[204:207]
s_waitcnt lgkmcnt(7)
ds_read_b64_tr_b16 v[34:35], v16 offset:33792
v_cvt_pk_bf16_f32 v76, v140, v141
v_mfma_f32_16x16x32_bf16 v[208:211], v[48:51], a[192:195], v[208:211]
s_waitcnt lgkmcnt(6)
v_cvt_pk_bf16_f32 v77, v142, v143
v_cvt_pk_bf16_f32 v78, v156, v157
v_mfma_f32_16x16x32_bf16 v[208:211], v[52:55], a[208:211], v[208:211]
s_waitcnt lgkmcnt(4)
ds_read_b64_tr_b16 v[36:37], v16 offset:40960
v_cvt_pk_bf16_f32 v79, v158, v159
v_mfma_f32_16x16x32_bf16 v[208:211], v[56:59], a[224:227], v[208:211]
s_waitcnt lgkmcnt(3)
v_mul_f32 v160, 0.12751743082459868, v160
v_mul_f32 v161, 0.12751743082459868, v161
v_mfma_f32_16x16x32_bf16 v[208:211], v[60:63], a[240:243], v[208:211]
ds_read_b64_tr_b16 v[38:39], v16 offset:41984
v_mul_f32 v162, 0.12751743082459868, v162
v_mfma_f32_16x16x32_bf16 v[212:215], v[48:51], a[196:199], v[212:215]
buffer_load_dwordx4 v9, s[20:23], s54 offen offset:3072  lds
v_mfma_f32_16x16x32_bf16 v[212:215], v[52:55], a[212:215], v[212:215]
ds_read_b64_tr_b16 v[40:41], v16 offset:49152
v_mul_f32 v163, 0.12751743082459868, v163
v_mfma_f32_16x16x32_bf16 v[212:215], v[56:59], a[228:231], v[212:215]
v_mul_f32 v176, 0.12751743082459868, v176
v_mul_f32 v177, 0.12751743082459868, v177
v_mfma_f32_16x16x32_bf16 v[212:215], v[60:63], a[244:247], v[212:215]
ds_read_b64_tr_b16 v[42:43], v16 offset:50176
v_mul_f32 v178, 0.12751743082459868, v178
v_mfma_f32_16x16x32_bf16 v[216:219], v[48:51], a[200:203], v[216:219]
v_mul_f32 v179, 0.12751743082459868, v179
v_cvt_pk_bf16_f32 v80, v160, v161
v_mfma_f32_16x16x32_bf16 v[216:219], v[52:55], a[216:219], v[216:219]
ds_read_b64_tr_b16 v[44:45], v16 offset:57344
v_cvt_pk_bf16_f32 v81, v162, v163
v_mfma_f32_16x16x32_bf16 v[216:219], v[56:59], a[232:235], v[216:219]
v_cvt_pk_bf16_f32 v82, v176, v177
v_cvt_pk_bf16_f32 v83, v178, v179
v_mfma_f32_16x16x32_bf16 v[216:219], v[60:63], a[248:251], v[216:219]
ds_read_b64_tr_b16 v[46:47], v16 offset:58368
v_mul_f32 v164, 0.12751743082459868, v164
v_mfma_f32_16x16x32_bf16 v[220:223], v[48:51], a[204:207], v[220:223]
v_add_u32 v16, 0x18000, v16
v_mul_f32 v165, 0.12751743082459868, v165
v_mfma_f32_16x16x32_bf16 v[220:223], v[52:55], a[220:223], v[220:223]
s_mov_b32 s55, 8192
ds_read_b64_tr_b16 v[48:49], v17 offset:32768
v_mul_f32 v166, 0.12751743082459868, v166
v_mfma_f32_16x16x32_bf16 v[220:223], v[56:59], a[236:239], v[220:223]
buffer_store_dwordx4 v[72:75], v24, s[4:7], s55 offen
v_mfma_f32_16x16x32_bf16 v[220:223], v[60:63], a[252:255], v[220:223]
s_waitcnt lgkmcnt(7)
ds_read_b64_tr_b16 v[50:51], v17 offset:33792
v_mul_f32 v167, 0.12751743082459868, v167
v_mfma_f32_16x16x32_bf16 v[224:227], v[32:35], a[192:195], v[224:227]
s_waitcnt lgkmcnt(6)
v_mul_f32 v180, 0.12751743082459868, v180
v_mul_f32 v181, 0.12751743082459868, v181
v_mfma_f32_16x16x32_bf16 v[224:227], v[36:39], a[208:211], v[224:227]
s_waitcnt lgkmcnt(4)
ds_read_b64_tr_b16 v[52:53], v17 offset:40960
v_mul_f32 v182, 0.12751743082459868, v182
v_mfma_f32_16x16x32_bf16 v[224:227], v[40:43], a[224:227], v[224:227]
s_waitcnt lgkmcnt(3)
v_mul_f32 v183, 0.12751743082459868, v183
v_cvt_pk_bf16_f32 v84, v164, v165
v_mfma_f32_16x16x32_bf16 v[224:227], v[44:47], a[240:243], v[224:227]
ds_read_b64_tr_b16 v[54:55], v17 offset:41984
v_cvt_pk_bf16_f32 v85, v166, v167
v_mfma_f32_16x16x32_bf16 v[228:231], v[32:35], a[196:199], v[228:231]
v_cvt_pk_bf16_f32 v86, v180, v181
v_cvt_pk_bf16_f32 v87, v182, v183
v_mfma_f32_16x16x32_bf16 v[228:231], v[36:39], a[212:215], v[228:231]
ds_read_b64_tr_b16 v[56:57], v17 offset:49152
v_mul_f32 v168, 0.12751743082459868, v168
v_mfma_f32_16x16x32_bf16 v[228:231], v[40:43], a[228:231], v[228:231]
v_mul_f32 v169, 0.12751743082459868, v169
v_mul_f32 v170, 0.12751743082459868, v170
v_mfma_f32_16x16x32_bf16 v[228:231], v[44:47], a[244:247], v[228:231]
ds_read_b64_tr_b16 v[58:59], v17 offset:50176
v_mul_f32 v171, 0.12751743082459868, v171
v_mfma_f32_16x16x32_bf16 v[232:235], v[32:35], a[200:203], v[232:235]
v_mul_f32 v184, 0.12751743082459868, v184
v_mul_f32 v185, 0.12751743082459868, v185
v_mfma_f32_16x16x32_bf16 v[232:235], v[36:39], a[216:219], v[232:235]
ds_read_b64_tr_b16 v[60:61], v17 offset:57344
v_mul_f32 v186, 0.12751743082459868, v186
v_mfma_f32_16x16x32_bf16 v[232:235], v[40:43], a[232:235], v[232:235]
v_mul_f32 v187, 0.12751743082459868, v187
v_cvt_pk_bf16_f32 v88, v168, v169
v_mfma_f32_16x16x32_bf16 v[232:235], v[44:47], a[248:251], v[232:235]
ds_read_b64_tr_b16 v[62:63], v17 offset:58368
v_cvt_pk_bf16_f32 v89, v170, v171
v_mfma_f32_16x16x32_bf16 v[236:239], v[32:35], a[204:207], v[236:239]
v_add_u32 v17, 0x18000, v17
v_cvt_pk_bf16_f32 v90, v184, v185
v_mfma_f32_16x16x32_bf16 v[236:239], v[36:39], a[220:223], v[236:239]
v_cvt_pk_bf16_f32 v91, v186, v187
v_mul_f32 v172, 0.12751743082459868, v172
v_mfma_f32_16x16x32_bf16 v[236:239], v[40:43], a[236:239], v[236:239]
v_mul_f32 v173, 0.12751743082459868, v173
v_mul_f32 v174, 0.12751743082459868, v174
v_mfma_f32_16x16x32_bf16 v[236:239], v[44:47], a[252:255], v[236:239]
s_waitcnt lgkmcnt(6)
v_mul_f32 v175, 0.12751743082459868, v175
v_mul_f32 v188, 0.12751743082459868, v188
v_mfma_f32_16x16x32_bf16 v[240:243], v[48:51], a[192:195], v[240:243]
s_waitcnt vmcnt(22)
s_waitcnt vmcnt(13)
s_waitcnt lgkmcnt(0)
s_barrier
v_mul_f32 v189, 0.12751743082459868, v189
v_mul_f32 v190, 0.12751743082459868, v190
v_mfma_f32_16x16x32_bf16 v[240:243], v[52:55], a[208:211], v[240:243]
ds_read_b64_tr_b16 v[32:33], v10 offset:0
v_mul_f32 v191, 0.12751743082459868, v191
v_mfma_f32_16x16x32_bf16 v[240:243], v[56:59], a[224:227], v[240:243]
s_mov_b32 s54, 3145728
ds_read_b64_tr_b16 v[34:35], v10 offset:1024
v_cvt_pk_bf16_f32 v92, v172, v173
v_mfma_f32_16x16x32_bf16 v[240:243], v[60:63], a[240:243], v[240:243]
s_add_u32 m0, s67, 32768
ds_read_b64_tr_b16 v[36:37], v10 offset:8192
v_cvt_pk_bf16_f32 v93, v174, v175
v_mfma_f32_16x16x32_bf16 v[244:247], v[48:51], a[196:199], v[244:247]
s_getreg_b32 s51, hwreg(HW_REG_XCC_ID, 0, 4)
ds_read_b64_tr_b16 v[38:39], v10 offset:9216
v_cvt_pk_bf16_f32 v94, v188, v189
v_mfma_f32_16x16x32_bf16 v[244:247], v[52:55], a[212:215], v[244:247]
s_mul_i32 s52, s51, s51
buffer_load_dwordx4 v6, s[20:23], s54 offen offset:0  lds
v_mfma_f32_16x16x32_bf16 v[244:247], v[56:59], a[228:231], v[244:247]
s_lshl_b32 s52, s52, 10
ds_read_b64_tr_b16 v[40:41], v10 offset:16384
v_cvt_pk_bf16_f32 v95, v190, v191
v_mfma_f32_16x16x32_bf16 v[244:247], v[60:63], a[244:247], v[244:247]
s_lshl_b32 s51, s51, 4
v_mul_f32 v192, 0.12751743082459868, v192
v_mul_f32 v193, 0.12751743082459868, v193
v_mfma_f32_16x16x32_bf16 v[248:251], v[48:51], a[200:203], v[248:251]
s_add_u32 s51, s51, s52
ds_read_b64_tr_b16 v[42:43], v10 offset:17408
v_mul_f32 v194, 0.12751743082459868, v194
v_mfma_f32_16x16x32_bf16 v[248:251], v[52:55], a[216:219], v[248:251]
s_add_u32 s51, s51, 1
v_mul_f32 v195, 0.12751743082459868, v195
v_mul_f32 v208, 0.12751743082459868, v208
v_mfma_f32_16x16x32_bf16 v[248:251], v[56:59], a[232:235], v[248:251]
s_lshl_b32 s53, s48, 2
ds_read_b64_tr_b16 v[44:45], v10 offset:24576
v_mov_b32 v2, s51
v_mfma_f32_16x16x32_bf16 v[248:251], v[60:63], a[248:251], v[248:251]
s_mov_b32 s55, 12288
buffer_load_dwordx4 v7, s[20:23], s54 offen offset:1024  lds
v_mfma_f32_16x16x32_bf16 v[252:255], v[48:51], a[204:207], v[252:255]
ds_read_b64_tr_b16 v[46:47], v10 offset:25600
v_mul_f32 v209, 0.12751743082459868, v209
v_mfma_f32_16x16x32_bf16 v[252:255], v[52:55], a[220:223], v[252:255]
ds_read_b64_tr_b16 v[48:49], v11 offset:0
v_add_u32 v10, 0xfffe8000, v10
v_mfma_f32_16x16x32_bf16 v[252:255], v[56:59], a[236:239], v[252:255]
buffer_atomic_add v2, v0, s[44:47], s53 offen sc1
v_mfma_f32_16x16x32_bf16 v[252:255], v[60:63], a[252:255], v[252:255]
s_waitcnt lgkmcnt(7)
ds_read_b64_tr_b16 v[50:51], v11 offset:1024
v_mul_f32 v210, 0.12751743082459868, v210
v_mfma_f32_16x16x32_bf16 v[128:131], a[0:3], v[32:35], 0
s_waitcnt lgkmcnt(6)
buffer_load_dwordx4 v8, s[20:23], s54 offen offset:2048  lds
v_mfma_f32_16x16x32_bf16 v[128:131], a[16:19], v[36:39], v[128:131]
s_waitcnt lgkmcnt(4)
ds_read_b64_tr_b16 v[52:53], v11 offset:8192
v_mul_f32 v211, 0.12751743082459868, v211
v_mfma_f32_16x16x32_bf16 v[128:131], a[32:35], v[40:43], v[128:131]
s_waitcnt lgkmcnt(3)
buffer_store_dwordx4 v[76:79], v24, s[4:7], s55 offen
v_mfma_f32_16x16x32_bf16 v[128:131], a[48:51], v[44:47], v[128:131]
ds_read_b64_tr_b16 v[54:55], v11 offset:9216
v_cvt_pk_bf16_f32 v96, v192, v193
v_mfma_f32_16x16x32_bf16 v[132:135], a[4:7], v[32:35], 0
v_cvt_pk_bf16_f32 v97, v194, v195
v_cvt_pk_bf16_f32 v98, v208, v209
v_mfma_f32_16x16x32_bf16 v[132:135], a[20:23], v[36:39], v[132:135]
ds_read_b64_tr_b16 v[56:57], v11 offset:16384
v_cvt_pk_bf16_f32 v99, v210, v211
v_mfma_f32_16x16x32_bf16 v[132:135], a[36:39], v[40:43], v[132:135]
buffer_load_dwordx4 v9, s[20:23], s54 offen offset:3072  lds
v_mfma_f32_16x16x32_bf16 v[132:135], a[52:55], v[44:47], v[132:135]
s_mov_b32 s54, 3670016
ds_read_b64_tr_b16 v[58:59], v11 offset:17408
v_mul_f32 v196, 0.12751743082459868, v196
v_mfma_f32_16x16x32_bf16 v[136:139], a[8:11], v[32:35], 0
s_add_u32 m0, s67, 49152
v_mul_f32 v197, 0.12751743082459868, v197
v_mul_f32 v198, 0.12751743082459868, v198
v_mfma_f32_16x16x32_bf16 v[136:139], a[24:27], v[36:39], v[136:139]
s_mov_b32 s56, 0
ds_read_b64_tr_b16 v[60:61], v11 offset:24576
v_mul_f32 v199, 0.12751743082459868, v199
v_mfma_f32_16x16x32_bf16 v[136:139], a[40:43], v[40:43], v[136:139]
buffer_load_dword v31, v26, s[24:27], s56 offen
v_mfma_f32_16x16x32_bf16 v[136:139], a[56:59], v[44:47], v[136:139]
s_mov_b32 s56, 16384
ds_read_b64_tr_b16 v[62:63], v11 offset:25600
v_mul_f32 v212, 0.12751743082459868, v212
v_mfma_f32_16x16x32_bf16 v[140:143], a[12:15], v[32:35], 0
v_add_u32 v11, 0xfffe8000, v11
v_mul_f32 v213, 0.12751743082459868, v213
v_mfma_f32_16x16x32_bf16 v[140:143], a[28:31], v[36:39], v[140:143]
ds_read_b64_tr_b16 v[32:33], v12 offset:0
v_mul_f32 v214, 0.12751743082459868, v214
v_mfma_f32_16x16x32_bf16 v[140:143], a[44:47], v[40:43], v[140:143]
buffer_load_dwordx4 v6, s[20:23], s54 offen offset:0  lds
v_mfma_f32_16x16x32_bf16 v[140:143], a[60:63], v[44:47], v[140:143]
s_waitcnt lgkmcnt(7)
ds_read_b64_tr_b16 v[34:35], v12 offset:1024
v_mul_f32 v215, 0.12751743082459868, v215
v_mfma_f32_16x16x32_bf16 v[144:147], a[0:3], v[48:51], 0
s_waitcnt lgkmcnt(6)
v_cvt_pk_bf16_f32 v100, v196, v197
v_cvt_pk_bf16_f32 v101, v198, v199
v_mfma_f32_16x16x32_bf16 v[144:147], a[16:19], v[52:55], v[144:147]
s_waitcnt lgkmcnt(4)
ds_read_b64_tr_b16 v[36:37], v12 offset:8192
v_cvt_pk_bf16_f32 v102, v212, v213
v_mfma_f32_16x16x32_bf16 v[144:147], a[32:35], v[56:59], v[144:147]
s_waitcnt lgkmcnt(3)
buffer_load_dword v31, v26, s[24:27], s56 offen
v_mfma_f32_16x16x32_bf16 v[144:147], a[48:51], v[60:63], v[144:147]
s_mov_b32 s56, 32768
ds_read_b64_tr_b16 v[38:39], v12 offset:9216
v_cvt_pk_bf16_f32 v103, v214, v215
v_mfma_f32_16x16x32_bf16 v[148:151], a[4:7], v[48:51], 0
buffer_load_dwordx4 v7, s[20:23], s54 offen offset:1024  lds
v_mfma_f32_16x16x32_bf16 v[148:151], a[20:23], v[52:55], v[148:151]
ds_read_b64_tr_b16 v[40:41], v12 offset:16384
v_mul_f32 v200, 0.12751743082459868, v200
v_mfma_f32_16x16x32_bf16 v[148:151], a[36:39], v[56:59], v[148:151]
v_mul_f32 v201, 0.12751743082459868, v201
v_mul_f32 v202, 0.12751743082459868, v202
v_mfma_f32_16x16x32_bf16 v[148:151], a[52:55], v[60:63], v[148:151]
s_mov_b32 s55, 1024
ds_read_b64_tr_b16 v[42:43], v12 offset:17408
v_mul_f32 v203, 0.12751743082459868, v203
v_mfma_f32_16x16x32_bf16 v[152:155], a[8:11], v[48:51], 0
buffer_store_dwordx4 v[80:83], v24, s[4:7], s55 offen
v_mfma_f32_16x16x32_bf16 v[152:155], a[24:27], v[52:55], v[152:155]
ds_read_b64_tr_b16 v[44:45], v12 offset:24576
v_mul_f32 v216, 0.12751743082459868, v216
v_mfma_f32_16x16x32_bf16 v[152:155], a[40:43], v[56:59], v[152:155]
buffer_load_dwordx4 v8, s[20:23], s54 offen offset:2048  lds
v_mfma_f32_16x16x32_bf16 v[152:155], a[56:59], v[60:63], v[152:155]
ds_read_b64_tr_b16 v[46:47], v12 offset:25600
v_mul_f32 v217, 0.12751743082459868, v217
v_mfma_f32_16x16x32_bf16 v[156:159], a[12:15], v[48:51], 0
v_add_u32 v12, 0xfffe8000, v12
v_mul_f32 v218, 0.12751743082459868, v218
v_mfma_f32_16x16x32_bf16 v[156:159], a[28:31], v[52:55], v[156:159]
ds_read_b64_tr_b16 v[48:49], v13 offset:0
v_mul_f32 v219, 0.12751743082459868, v219
v_mfma_f32_16x16x32_bf16 v[156:159], a[44:47], v[56:59], v[156:159]
buffer_load_dword v31, v26, s[24:27], s56 offen
v_mfma_f32_16x16x32_bf16 v[156:159], a[60:63], v[60:63], v[156:159]
s_waitcnt lgkmcnt(7)
s_mov_b32 s56, 49152
ds_read_b64_tr_b16 v[50:51], v13 offset:1024
v_cvt_pk_bf16_f32 v104, v200, v201
v_mfma_f32_16x16x32_bf16 v[160:163], a[0:3], v[32:35], 0
s_waitcnt lgkmcnt(6)
buffer_load_dwordx4 v9, s[20:23], s54 offen offset:3072  lds
v_mfma_f32_16x16x32_bf16 v[160:163], a[16:19], v[36:39], v[160:163]
s_waitcnt lgkmcnt(4)
ds_read_b64_tr_b16 v[52:53], v13 offset:8192
v_cvt_pk_bf16_f32 v105, v202, v203
v_mfma_f32_16x16x32_bf16 v[160:163], a[32:35], v[40:43], v[160:163]
s_waitcnt lgkmcnt(3)
v_cvt_pk_bf16_f32 v106, v216, v217
v_cvt_pk_bf16_f32 v107, v218, v219
v_mfma_f32_16x16x32_bf16 v[160:163], a[48:51], v[44:47], v[160:163]
ds_read_b64_tr_b16 v[54:55], v13 offset:9216
v_mul_f32 v204, 0.12751743082459868, v204
v_mfma_f32_16x16x32_bf16 v[164:167], a[4:7], v[32:35], 0
v_mul_f32 v205, 0.12751743082459868, v205
v_mul_f32 v206, 0.12751743082459868, v206
v_mfma_f32_16x16x32_bf16 v[164:167], a[20:23], v[36:39], v[164:167]
ds_read_b64_tr_b16 v[56:57], v13 offset:16384
v_mul_f32 v207, 0.12751743082459868, v207
v_mfma_f32_16x16x32_bf16 v[164:167], a[36:39], v[40:43], v[164:167]
buffer_load_dword v31, v26, s[24:27], s56 offen
v_mfma_f32_16x16x32_bf16 v[164:167], a[52:55], v[44:47], v[164:167]
s_mov_b32 s56, 0
ds_read_b64_tr_b16 v[58:59], v13 offset:17408
v_mul_f32 v220, 0.12751743082459868, v220
v_mfma_f32_16x16x32_bf16 v[168:171], a[8:11], v[32:35], 0
v_mul_f32 v221, 0.12751743082459868, v221
v_mul_f32 v222, 0.12751743082459868, v222
v_mfma_f32_16x16x32_bf16 v[168:171], a[24:27], v[36:39], v[168:171]
ds_read_b64_tr_b16 v[60:61], v13 offset:24576
v_mul_f32 v223, 0.12751743082459868, v223
v_mfma_f32_16x16x32_bf16 v[168:171], a[40:43], v[40:43], v[168:171]
v_cvt_pk_bf16_f32 v108, v204, v205
v_cvt_pk_bf16_f32 v109, v206, v207
v_mfma_f32_16x16x32_bf16 v[168:171], a[56:59], v[44:47], v[168:171]
ds_read_b64_tr_b16 v[62:63], v13 offset:25600
v_cvt_pk_bf16_f32 v110, v220, v221
v_mfma_f32_16x16x32_bf16 v[172:175], a[12:15], v[32:35], 0
v_add_u32 v13, 0xfffe8000, v13
v_cvt_pk_bf16_f32 v111, v222, v223
v_mfma_f32_16x16x32_bf16 v[172:175], a[28:31], v[36:39], v[172:175]
s_mov_b32 s55, 5120
ds_read_b64_tr_b16 v[32:33], v14 offset:0
v_mul_f32 v224, 0.12751743082459868, v224
v_mfma_f32_16x16x32_bf16 v[172:175], a[44:47], v[40:43], v[172:175]
buffer_load_dword v31, v28, s[28:31], s56 offen
v_mfma_f32_16x16x32_bf16 v[172:175], a[60:63], v[44:47], v[172:175]
s_waitcnt lgkmcnt(7)
s_mov_b32 s56, 13824
ds_read_b64_tr_b16 v[34:35], v14 offset:1024
v_mul_f32 v225, 0.12751743082459868, v225
v_mfma_f32_16x16x32_bf16 v[176:179], a[0:3], v[48:51], 0
s_waitcnt lgkmcnt(6)
buffer_store_dwordx4 v[84:87], v24, s[4:7], s55 offen
v_mfma_f32_16x16x32_bf16 v[176:179], a[16:19], v[52:55], v[176:179]
s_waitcnt lgkmcnt(4)
ds_read_b64_tr_b16 v[36:37], v14 offset:8192
v_mul_f32 v226, 0.12751743082459868, v226
v_mfma_f32_16x16x32_bf16 v[176:179], a[32:35], v[56:59], v[176:179]
s_waitcnt lgkmcnt(3)
v_mul_f32 v227, 0.12751743082459868, v227
v_mul_f32 v240, 0.12751743082459868, v240
v_mfma_f32_16x16x32_bf16 v[176:179], a[48:51], v[60:63], v[176:179]
ds_read_b64_tr_b16 v[38:39], v14 offset:9216
v_mul_f32 v241, 0.12751743082459868, v241
v_mfma_f32_16x16x32_bf16 v[180:183], a[4:7], v[48:51], 0
v_mul_f32 v242, 0.12751743082459868, v242
v_mul_f32 v243, 0.12751743082459868, v243
v_mfma_f32_16x16x32_bf16 v[180:183], a[20:23], v[52:55], v[180:183]
ds_read_b64_tr_b16 v[40:41], v14 offset:16384
v_cvt_pk_bf16_f32 v112, v224, v225
v_mfma_f32_16x16x32_bf16 v[180:183], a[36:39], v[56:59], v[180:183]
buffer_load_dword v31, v28, s[28:31], s56 offen
v_mfma_f32_16x16x32_bf16 v[180:183], a[52:55], v[60:63], v[180:183]
s_mov_b32 s56, 27648
ds_read_b64_tr_b16 v[42:43], v14 offset:17408
v_cvt_pk_bf16_f32 v113, v226, v227
v_mfma_f32_16x16x32_bf16 v[184:187], a[8:11], v[48:51], 0
v_cvt_pk_bf16_f32 v114, v240, v241
v_cvt_pk_bf16_f32 v115, v242, v243
v_mfma_f32_16x16x32_bf16 v[184:187], a[24:27], v[52:55], v[184:187]
ds_read_b64_tr_b16 v[44:45], v14 offset:24576
v_mul_f32 v228, 0.12751743082459868, v228
v_mfma_f32_16x16x32_bf16 v[184:187], a[40:43], v[56:59], v[184:187]
v_mul_f32 v229, 0.12751743082459868, v229
v_mul_f32 v230, 0.12751743082459868, v230
v_mfma_f32_16x16x32_bf16 v[184:187], a[56:59], v[60:63], v[184:187]
ds_read_b64_tr_b16 v[46:47], v14 offset:25600
v_mul_f32 v231, 0.12751743082459868, v231
v_mfma_f32_16x16x32_bf16 v[188:191], a[12:15], v[48:51], 0
v_add_u32 v14, 0xfffe8000, v14
v_mul_f32 v244, 0.12751743082459868, v244
v_mfma_f32_16x16x32_bf16 v[188:191], a[28:31], v[52:55], v[188:191]
ds_read_b64_tr_b16 v[48:49], v15 offset:0
v_mul_f32 v245, 0.12751743082459868, v245
v_mfma_f32_16x16x32_bf16 v[188:191], a[44:47], v[56:59], v[188:191]
buffer_load_dword v31, v28, s[28:31], s56 offen
v_mfma_f32_16x16x32_bf16 v[188:191], a[60:63], v[60:63], v[188:191]
s_waitcnt lgkmcnt(7)
s_mov_b32 s56, 41472
ds_read_b64_tr_b16 v[50:51], v15 offset:1024
v_mul_f32 v246, 0.12751743082459868, v246
v_mfma_f32_16x16x32_bf16 v[192:195], a[0:3], v[32:35], 0
s_waitcnt lgkmcnt(6)
v_mul_f32 v247, 0.12751743082459868, v247
v_cvt_pk_bf16_f32 v116, v228, v229
v_mfma_f32_16x16x32_bf16 v[192:195], a[16:19], v[36:39], v[192:195]
s_waitcnt lgkmcnt(4)
ds_read_b64_tr_b16 v[52:53], v15 offset:8192
v_cvt_pk_bf16_f32 v117, v230, v231
v_mfma_f32_16x16x32_bf16 v[192:195], a[32:35], v[40:43], v[192:195]
s_waitcnt lgkmcnt(3)
v_cvt_pk_bf16_f32 v118, v244, v245
v_cvt_pk_bf16_f32 v119, v246, v247
v_mfma_f32_16x16x32_bf16 v[192:195], a[48:51], v[44:47], v[192:195]
ds_read_b64_tr_b16 v[54:55], v15 offset:9216
v_mul_f32 v232, 0.12751743082459868, v232
v_mfma_f32_16x16x32_bf16 v[196:199], a[4:7], v[32:35], 0
v_mul_f32 v233, 0.12751743082459868, v233
v_mul_f32 v234, 0.12751743082459868, v234
v_mfma_f32_16x16x32_bf16 v[196:199], a[20:23], v[36:39], v[196:199]
s_mov_b32 s55, 9216
ds_read_b64_tr_b16 v[56:57], v15 offset:16384
v_mul_f32 v235, 0.12751743082459868, v235
v_mfma_f32_16x16x32_bf16 v[196:199], a[36:39], v[40:43], v[196:199]
buffer_load_dword v31, v28, s[28:31], s56 offen
v_mfma_f32_16x16x32_bf16 v[196:199], a[52:55], v[44:47], v[196:199]
ds_read_b64_tr_b16 v[58:59], v15 offset:17408
v_mul_f32 v248, 0.12751743082459868, v248
v_mfma_f32_16x16x32_bf16 v[200:203], a[8:11], v[32:35], 0
buffer_store_dwordx4 v[88:91], v24, s[4:7], s55 offen
v_mfma_f32_16x16x32_bf16 v[200:203], a[24:27], v[36:39], v[200:203]
ds_read_b64_tr_b16 v[60:61], v15 offset:24576
v_mul_f32 v249, 0.12751743082459868, v249
v_mfma_f32_16x16x32_bf16 v[200:203], a[40:43], v[40:43], v[200:203]
v_mul_f32 v250, 0.12751743082459868, v250
v_mul_f32 v251, 0.12751743082459868, v251
v_mfma_f32_16x16x32_bf16 v[200:203], a[56:59], v[44:47], v[200:203]
ds_read_b64_tr_b16 v[62:63], v15 offset:25600
v_cvt_pk_bf16_f32 v120, v232, v233
v_mfma_f32_16x16x32_bf16 v[204:207], a[12:15], v[32:35], 0
v_add_u32 v15, 0xfffe8000, v15
v_cvt_pk_bf16_f32 v121, v234, v235
v_mfma_f32_16x16x32_bf16 v[204:207], a[28:31], v[36:39], v[204:207]
ds_read_b64_tr_b16 v[32:33], v16 offset:0
v_cvt_pk_bf16_f32 v122, v248, v249
v_mfma_f32_16x16x32_bf16 v[204:207], a[44:47], v[40:43], v[204:207]
v_cvt_pk_bf16_f32 v123, v250, v251
v_mul_f32 v236, 0.12751743082459868, v236
v_mfma_f32_16x16x32_bf16 v[204:207], a[60:63], v[44:47], v[204:207]
s_waitcnt lgkmcnt(7)
ds_read_b64_tr_b16 v[34:35], v16 offset:1024
v_mul_f32 v237, 0.12751743082459868, v237
v_mfma_f32_16x16x32_bf16 v[208:211], a[0:3], v[48:51], 0
s_waitcnt lgkmcnt(6)
v_mul_f32 v238, 0.12751743082459868, v238
v_mul_f32 v239, 0.12751743082459868, v239
v_mfma_f32_16x16x32_bf16 v[208:211], a[16:19], v[52:55], v[208:211]
s_waitcnt lgkmcnt(4)
ds_read_b64_tr_b16 v[36:37], v16 offset:8192
v_mul_f32 v252, 0.12751743082459868, v252
v_mfma_f32_16x16x32_bf16 v[208:211], a[32:35], v[56:59], v[208:211]
s_waitcnt lgkmcnt(3)
v_mul_f32 v253, 0.12751743082459868, v253
v_mul_f32 v254, 0.12751743082459868, v254
v_mfma_f32_16x16x32_bf16 v[208:211], a[48:51], v[60:63], v[208:211]
ds_read_b64_tr_b16 v[38:39], v16 offset:9216
v_mul_f32 v255, 0.12751743082459868, v255
v_mfma_f32_16x16x32_bf16 v[212:215], a[4:7], v[48:51], 0
v_cvt_pk_bf16_f32 v124, v236, v237
v_cvt_pk_bf16_f32 v125, v238, v239
v_mfma_f32_16x16x32_bf16 v[212:215], a[20:23], v[52:55], v[212:215]
ds_read_b64_tr_b16 v[40:41], v16 offset:16384
v_cvt_pk_bf16_f32 v126, v252, v253
v_mfma_f32_16x16x32_bf16 v[212:215], a[36:39], v[56:59], v[212:215]
v_cvt_pk_bf16_f32 v127, v254, v255
v_mfma_f32_16x16x32_bf16 v[212:215], a[52:55], v[60:63], v[212:215]
ds_read_b64_tr_b16 v[42:43], v16 offset:17408
v_mfma_f32_16x16x32_bf16 v[216:219], a[8:11], v[48:51], 0
v_mfma_f32_16x16x32_bf16 v[216:219], a[24:27], v[52:55], v[216:219]
ds_read_b64_tr_b16 v[44:45], v16 offset:24576
v_mfma_f32_16x16x32_bf16 v[216:219], a[40:43], v[56:59], v[216:219]
v_mfma_f32_16x16x32_bf16 v[216:219], a[56:59], v[60:63], v[216:219]
ds_read_b64_tr_b16 v[46:47], v16 offset:25600
v_mfma_f32_16x16x32_bf16 v[220:223], a[12:15], v[48:51], 0
v_add_u32 v16, 0xfffe8000, v16
v_mfma_f32_16x16x32_bf16 v[220:223], a[28:31], v[52:55], v[220:223]
s_mov_b32 s55, 13312
ds_read_b64_tr_b16 v[48:49], v17 offset:0
v_mfma_f32_16x16x32_bf16 v[220:223], a[44:47], v[56:59], v[220:223]
buffer_store_dwordx4 v[92:95], v24, s[4:7], s55 offen
v_mfma_f32_16x16x32_bf16 v[220:223], a[60:63], v[60:63], v[220:223]
s_waitcnt lgkmcnt(7)
ds_read_b64_tr_b16 v[50:51], v17 offset:1024
v_mfma_f32_16x16x32_bf16 v[224:227], a[0:3], v[32:35], 0
s_waitcnt lgkmcnt(6)
v_mfma_f32_16x16x32_bf16 v[224:227], a[16:19], v[36:39], v[224:227]
s_waitcnt lgkmcnt(4)
ds_read_b64_tr_b16 v[52:53], v17 offset:8192
v_mfma_f32_16x16x32_bf16 v[224:227], a[32:35], v[40:43], v[224:227]
s_waitcnt lgkmcnt(3)
v_mfma_f32_16x16x32_bf16 v[224:227], a[48:51], v[44:47], v[224:227]
ds_read_b64_tr_b16 v[54:55], v17 offset:9216
v_mfma_f32_16x16x32_bf16 v[228:231], a[4:7], v[32:35], 0
v_mfma_f32_16x16x32_bf16 v[228:231], a[20:23], v[36:39], v[228:231]
ds_read_b64_tr_b16 v[56:57], v17 offset:16384
v_mfma_f32_16x16x32_bf16 v[228:231], a[36:39], v[40:43], v[228:231]
v_mfma_f32_16x16x32_bf16 v[228:231], a[52:55], v[44:47], v[228:231]
ds_read_b64_tr_b16 v[58:59], v17 offset:17408
v_mfma_f32_16x16x32_bf16 v[232:235], a[8:11], v[32:35], 0
v_mfma_f32_16x16x32_bf16 v[232:235], a[24:27], v[36:39], v[232:235]
ds_read_b64_tr_b16 v[60:61], v17 offset:24576
v_mfma_f32_16x16x32_bf16 v[232:235], a[40:43], v[40:43], v[232:235]
v_mfma_f32_16x16x32_bf16 v[232:235], a[56:59], v[44:47], v[232:235]
ds_read_b64_tr_b16 v[62:63], v17 offset:25600
v_mfma_f32_16x16x32_bf16 v[236:239], a[12:15], v[32:35], 0
v_add_u32 v17, 0xfffe8000, v17
v_mfma_f32_16x16x32_bf16 v[236:239], a[28:31], v[36:39], v[236:239]
v_mfma_f32_16x16x32_bf16 v[236:239], a[44:47], v[40:43], v[236:239]
v_mfma_f32_16x16x32_bf16 v[236:239], a[60:63], v[44:47], v[236:239]
s_waitcnt lgkmcnt(6)
v_mfma_f32_16x16x32_bf16 v[240:243], a[0:3], v[48:51], 0
s_waitcnt vmcnt(33)
s_waitcnt lgkmcnt(0)
s_barrier
v_mfma_f32_16x16x32_bf16 v[240:243], a[16:19], v[52:55], v[240:243]
ds_read_b64_tr_b16 v[32:33], v10 offset:0
v_mfma_f32_16x16x32_bf16 v[240:243], a[32:35], v[56:59], v[240:243]
s_mov_b32 s54, 0
ds_read_b64_tr_b16 v[34:35], v10 offset:1024
v_mfma_f32_16x16x32_bf16 v[240:243], a[48:51], v[60:63], v[240:243]
s_mov_b32 s55, 2048
ds_read_b64_tr_b16 v[36:37], v10 offset:8192
v_mfma_f32_16x16x32_bf16 v[244:247], a[4:7], v[48:51], 0
s_add_u32 m0, s67, 98304
ds_read_b64_tr_b16 v[38:39], v10 offset:9216
v_mfma_f32_16x16x32_bf16 v[244:247], a[20:23], v[52:55], v[244:247]
buffer_store_dwordx4 v[96:99], v24, s[4:7], s55 offen
v_mfma_f32_16x16x32_bf16 v[244:247], a[36:39], v[56:59], v[244:247]
ds_read_b64_tr_b16 v[40:41], v10 offset:16384
v_mfma_f32_16x16x32_bf16 v[244:247], a[52:55], v[60:63], v[244:247]
buffer_load_dwordx4 v6, s[24:27], s54 offen offset:0  lds
v_mfma_f32_16x16x32_bf16 v[248:251], a[8:11], v[48:51], 0
ds_read_b64_tr_b16 v[42:43], v10 offset:17408
v_mfma_f32_16x16x32_bf16 v[248:251], a[24:27], v[52:55], v[248:251]
v_mfma_f32_16x16x32_bf16 v[248:251], a[40:43], v[56:59], v[248:251]
ds_read_b64_tr_b16 v[44:45], v10 offset:24576
v_mfma_f32_16x16x32_bf16 v[248:251], a[56:59], v[60:63], v[248:251]
v_mfma_f32_16x16x32_bf16 v[252:255], a[12:15], v[48:51], 0
ds_read_b64_tr_b16 v[46:47], v10 offset:25600
v_mfma_f32_16x16x32_bf16 v[252:255], a[28:31], v[52:55], v[252:255]
ds_read_b64_tr_b16 v[48:49], v11 offset:0
v_add_u32 v10, 0x10000, v10
v_mfma_f32_16x16x32_bf16 v[252:255], a[44:47], v[56:59], v[252:255]
buffer_load_dwordx4 v7, s[24:27], s54 offen offset:1024  lds
v_mfma_f32_16x16x32_bf16 v[252:255], a[60:63], v[60:63], v[252:255]
s_waitcnt lgkmcnt(7)
ds_read_b64_tr_b16 v[50:51], v11 offset:1024
v_mfma_f32_16x16x32_bf16 v[128:131], a[64:67], v[32:35], v[128:131]
s_waitcnt lgkmcnt(6)
v_bfe_u32 v29, v1, 7, 2
v_lshrrev_b32 v22, 9, v1
v_mfma_f32_16x16x32_bf16 v[128:131], a[80:83], v[36:39], v[128:131]
s_waitcnt lgkmcnt(4)
ds_read_b64_tr_b16 v[52:53], v11 offset:8192
v_lshl_add_u32 v29, v22, 3, v29
v_mfma_f32_16x16x32_bf16 v[128:131], a[96:99], v[40:43], v[128:131]
s_waitcnt lgkmcnt(3)
v_mul_u32_u24 v29, 3456, v29
v_bfe_u32 v22, v1, 5, 2
v_mfma_f32_16x16x32_bf16 v[128:131], a[112:115], v[44:47], v[128:131]
ds_read_b64_tr_b16 v[54:55], v11 offset:9216
v_lshrrev_b32 v23, 8, v1
v_mfma_f32_16x16x32_bf16 v[132:135], a[68:71], v[32:35], v[132:135]
buffer_load_dwordx4 v8, s[24:27], s54 offen offset:2048  lds
v_mfma_f32_16x16x32_bf16 v[132:135], a[84:87], v[36:39], v[132:135]
ds_read_b64_tr_b16 v[56:57], v11 offset:16384
v_xor_b32 v22, v22, v23
v_mfma_f32_16x16x32_bf16 v[132:135], a[100:103], v[40:43], v[132:135]
v_lshl_add_u32 v29, v22, 5, v29
v_and_b32 v22, 16, v1
v_mfma_f32_16x16x32_bf16 v[132:135], a[116:119], v[44:47], v[132:135]
ds_read_b64_tr_b16 v[58:59], v11 offset:17408
v_add_u32 v29, v29, v22
v_mfma_f32_16x16x32_bf16 v[136:139], a[72:75], v[32:35], v[136:139]
s_mul_i32 s51, s50, 110592
v_mfma_f32_16x16x32_bf16 v[136:139], a[88:91], v[36:39], v[136:139]
s_lshl_b32 s52, s66, 7
ds_read_b64_tr_b16 v[60:61], v11 offset:24576
v_mfma_f32_16x16x32_bf16 v[136:139], a[104:107], v[40:43], v[136:139]
s_mov_b32 s55, 6144
buffer_store_dwordx4 v[100:103], v24, s[4:7], s55 offen
v_mfma_f32_16x16x32_bf16 v[136:139], a[120:123], v[44:47], v[136:139]
s_add_u32 s51, s51, s52
ds_read_b64_tr_b16 v[62:63], v11 offset:25600
v_add_u32 v25, s51, v29
v_mfma_f32_16x16x32_bf16 v[140:143], a[76:79], v[32:35], v[140:143]
v_add_u32 v11, 0x10000, v11
v_add_u32 v26, 12800, v25
v_mfma_f32_16x16x32_bf16 v[140:143], a[92:95], v[36:39], v[140:143]
ds_read_b64_tr_b16 v[32:33], v12 offset:0
v_add_u32 v27, 53248, v25
v_mfma_f32_16x16x32_bf16 v[140:143], a[108:111], v[40:43], v[140:143]
buffer_load_dwordx4 v9, s[24:27], s54 offen offset:3072  lds
v_mfma_f32_16x16x32_bf16 v[140:143], a[124:127], v[44:47], v[140:143]
s_waitcnt lgkmcnt(7)
s_mov_b32 s54, 524288
ds_read_b64_tr_b16 v[34:35], v12 offset:1024
v_add_u32 v28, 66048, v25
v_mfma_f32_16x16x32_bf16 v[144:147], a[64:67], v[48:51], v[144:147]
s_waitcnt lgkmcnt(6)
s_add_u32 m0, s67, 114688
v_bfe_u32 v5, v1, 6, 2
v_bfe_u32 v29, v1, 8, 1
v_mfma_f32_16x16x32_bf16 v[144:147], a[80:83], v[52:55], v[144:147]
s_waitcnt lgkmcnt(4)
ds_read_b64_tr_b16 v[36:37], v12 offset:8192
v_lshrrev_b32 v30, 9, v1
v_mfma_f32_16x16x32_bf16 v[144:147], a[96:99], v[56:59], v[144:147]
s_waitcnt lgkmcnt(3)
v_lshl_add_u32 v22, v29, 2, v5
v_lshl_add_u32 v22, v30, 4, v22
v_mfma_f32_16x16x32_bf16 v[144:147], a[112:115], v[60:63], v[144:147]
ds_read_b64_tr_b16 v[38:39], v12 offset:9216
v_lshlrev_b32 v22, 7, v22
v_mfma_f32_16x16x32_bf16 v[148:151], a[68:71], v[48:51], v[148:151]
buffer_load_dwordx4 v6, s[24:27], s54 offen offset:0  lds
v_mfma_f32_16x16x32_bf16 v[148:151], a[84:87], v[52:55], v[148:151]
ds_read_b64_tr_b16 v[40:41], v12 offset:16384
v_bfe_u32 v30, v1, 4, 2
v_mfma_f32_16x16x32_bf16 v[148:151], a[100:103], v[56:59], v[148:151]
v_lshl_add_u32 v22, v30, 3, v22
v_lshrrev_b32 v5, 1, v5
v_mfma_f32_16x16x32_bf16 v[148:151], a[116:119], v[60:63], v[148:151]
ds_read_b64_tr_b16 v[42:43], v12 offset:17408
v_lshl_add_u32 v5, v29, 1, v5
v_mfma_f32_16x16x32_bf16 v[152:155], a[72:75], v[48:51], v[152:155]
v_lshl_add_u32 v22, v5, 5, v22
v_add_u32 v22, 0, v22
v_mfma_f32_16x16x32_bf16 v[152:155], a[88:91], v[52:55], v[152:155]
ds_read_b64_tr_b16 v[44:45], v12 offset:24576
v_xor_b32 v23, 32, v22
v_mfma_f32_16x16x32_bf16 v[152:155], a[104:107], v[56:59], v[152:155]
buffer_load_dwordx4 v7, s[24:27], s54 offen offset:1024  lds
v_mfma_f32_16x16x32_bf16 v[152:155], a[120:123], v[60:63], v[152:155]
ds_read_b64_tr_b16 v[46:47], v12 offset:25600
v_xor_b32 v29, 64, v22
v_mfma_f32_16x16x32_bf16 v[156:159], a[76:79], v[48:51], v[156:159]
v_add_u32 v12, 0x10000, v12
v_xor_b32 v30, 96, v22
v_mfma_f32_16x16x32_bf16 v[156:159], a[92:95], v[52:55], v[156:159]
ds_read_b64_tr_b16 v[48:49], v13 offset:0
v_mfma_f32_16x16x32_bf16 v[156:159], a[108:111], v[56:59], v[156:159]
v_mfma_f32_16x16x32_bf16 v[156:159], a[124:127], v[60:63], v[156:159]
s_waitcnt lgkmcnt(7)
s_mov_b32 s55, 10240
ds_read_b64_tr_b16 v[50:51], v13 offset:1024
v_mfma_f32_16x16x32_bf16 v[160:163], a[64:67], v[32:35], v[160:163]
s_waitcnt lgkmcnt(6)
buffer_store_dwordx4 v[104:107], v24, s[4:7], s55 offen
v_mfma_f32_16x16x32_bf16 v[160:163], a[80:83], v[36:39], v[160:163]
s_waitcnt lgkmcnt(4)
ds_read_b64_tr_b16 v[52:53], v13 offset:8192
v_mfma_f32_16x16x32_bf16 v[160:163], a[96:99], v[40:43], v[160:163]
s_waitcnt lgkmcnt(3)
buffer_load_dwordx4 v8, s[24:27], s54 offen offset:2048  lds
v_mfma_f32_16x16x32_bf16 v[160:163], a[112:115], v[44:47], v[160:163]
ds_read_b64_tr_b16 v[54:55], v13 offset:9216
v_mfma_f32_16x16x32_bf16 v[164:167], a[68:71], v[32:35], v[164:167]
v_mfma_f32_16x16x32_bf16 v[164:167], a[84:87], v[36:39], v[164:167]
ds_read_b64_tr_b16 v[56:57], v13 offset:16384
v_mfma_f32_16x16x32_bf16 v[164:167], a[100:103], v[40:43], v[164:167]
v_mfma_f32_16x16x32_bf16 v[164:167], a[116:119], v[44:47], v[164:167]
ds_read_b64_tr_b16 v[58:59], v13 offset:17408
v_mfma_f32_16x16x32_bf16 v[168:171], a[72:75], v[32:35], v[168:171]
buffer_load_dwordx4 v9, s[24:27], s54 offen offset:3072  lds
v_mfma_f32_16x16x32_bf16 v[168:171], a[88:91], v[36:39], v[168:171]
ds_read_b64_tr_b16 v[60:61], v13 offset:24576
v_mfma_f32_16x16x32_bf16 v[168:171], a[104:107], v[40:43], v[168:171]
v_mfma_f32_16x16x32_bf16 v[168:171], a[120:123], v[44:47], v[168:171]
ds_read_b64_tr_b16 v[62:63], v13 offset:25600
v_mfma_f32_16x16x32_bf16 v[172:175], a[76:79], v[32:35], v[172:175]
v_add_u32 v13, 0x10000, v13
v_mfma_f32_16x16x32_bf16 v[172:175], a[92:95], v[36:39], v[172:175]
ds_read_b64_tr_b16 v[32:33], v14 offset:0
v_mfma_f32_16x16x32_bf16 v[172:175], a[108:111], v[40:43], v[172:175]
v_mfma_f32_16x16x32_bf16 v[172:175], a[124:127], v[44:47], v[172:175]
s_waitcnt lgkmcnt(7)
ds_read_b64_tr_b16 v[34:35], v14 offset:1024
v_mfma_f32_16x16x32_bf16 v[176:179], a[64:67], v[48:51], v[176:179]
s_waitcnt lgkmcnt(6)
v_mfma_f32_16x16x32_bf16 v[176:179], a[80:83], v[52:55], v[176:179]
s_waitcnt lgkmcnt(4)
ds_read_b64_tr_b16 v[36:37], v14 offset:8192
v_mfma_f32_16x16x32_bf16 v[176:179], a[96:99], v[56:59], v[176:179]
s_waitcnt lgkmcnt(3)
v_mfma_f32_16x16x32_bf16 v[176:179], a[112:115], v[60:63], v[176:179]
ds_read_b64_tr_b16 v[38:39], v14 offset:9216
v_mfma_f32_16x16x32_bf16 v[180:183], a[68:71], v[48:51], v[180:183]
v_mfma_f32_16x16x32_bf16 v[180:183], a[84:87], v[52:55], v[180:183]
s_mov_b32 s55, 14336
ds_read_b64_tr_b16 v[40:41], v14 offset:16384
v_mfma_f32_16x16x32_bf16 v[180:183], a[100:103], v[56:59], v[180:183]
buffer_store_dwordx4 v[108:111], v24, s[4:7], s55 offen
v_mfma_f32_16x16x32_bf16 v[180:183], a[116:119], v[60:63], v[180:183]
ds_read_b64_tr_b16 v[42:43], v14 offset:17408
v_mfma_f32_16x16x32_bf16 v[184:187], a[72:75], v[48:51], v[184:187]
v_mfma_f32_16x16x32_bf16 v[184:187], a[88:91], v[52:55], v[184:187]
ds_read_b64_tr_b16 v[44:45], v14 offset:24576
v_mfma_f32_16x16x32_bf16 v[184:187], a[104:107], v[56:59], v[184:187]
v_mfma_f32_16x16x32_bf16 v[184:187], a[120:123], v[60:63], v[184:187]
ds_read_b64_tr_b16 v[46:47], v14 offset:25600
v_mfma_f32_16x16x32_bf16 v[188:191], a[76:79], v[48:51], v[188:191]
v_add_u32 v14, 0x10000, v14
v_mfma_f32_16x16x32_bf16 v[188:191], a[92:95], v[52:55], v[188:191]
ds_read_b64_tr_b16 v[48:49], v15 offset:0
v_mfma_f32_16x16x32_bf16 v[188:191], a[108:111], v[56:59], v[188:191]
v_mfma_f32_16x16x32_bf16 v[188:191], a[124:127], v[60:63], v[188:191]
s_waitcnt lgkmcnt(7)
ds_read_b64_tr_b16 v[50:51], v15 offset:1024
v_mfma_f32_16x16x32_bf16 v[192:195], a[64:67], v[32:35], v[192:195]
s_waitcnt lgkmcnt(6)
v_mfma_f32_16x16x32_bf16 v[192:195], a[80:83], v[36:39], v[192:195]
s_waitcnt lgkmcnt(4)
ds_read_b64_tr_b16 v[52:53], v15 offset:8192
v_mfma_f32_16x16x32_bf16 v[192:195], a[96:99], v[40:43], v[192:195]
s_waitcnt lgkmcnt(3)
v_mfma_f32_16x16x32_bf16 v[192:195], a[112:115], v[44:47], v[192:195]
ds_read_b64_tr_b16 v[54:55], v15 offset:9216
v_mfma_f32_16x16x32_bf16 v[196:199], a[68:71], v[32:35], v[196:199]
v_mfma_f32_16x16x32_bf16 v[196:199], a[84:87], v[36:39], v[196:199]
ds_read_b64_tr_b16 v[56:57], v15 offset:16384
v_mfma_f32_16x16x32_bf16 v[196:199], a[100:103], v[40:43], v[196:199]
v_mfma_f32_16x16x32_bf16 v[196:199], a[116:119], v[44:47], v[196:199]
ds_read_b64_tr_b16 v[58:59], v15 offset:17408
v_mfma_f32_16x16x32_bf16 v[200:203], a[72:75], v[32:35], v[200:203]
v_mfma_f32_16x16x32_bf16 v[200:203], a[88:91], v[36:39], v[200:203]
ds_read_b64_tr_b16 v[60:61], v15 offset:24576
v_mfma_f32_16x16x32_bf16 v[200:203], a[104:107], v[40:43], v[200:203]
v_mfma_f32_16x16x32_bf16 v[200:203], a[120:123], v[44:47], v[200:203]
s_mov_b32 s55, 3072
ds_read_b64_tr_b16 v[62:63], v15 offset:25600
v_mfma_f32_16x16x32_bf16 v[204:207], a[76:79], v[32:35], v[204:207]
v_add_u32 v15, 0x10000, v15
v_mfma_f32_16x16x32_bf16 v[204:207], a[92:95], v[36:39], v[204:207]
ds_read_b64_tr_b16 v[32:33], v16 offset:0
v_mfma_f32_16x16x32_bf16 v[204:207], a[108:111], v[40:43], v[204:207]
buffer_store_dwordx4 v[112:115], v24, s[4:7], s55 offen
v_mfma_f32_16x16x32_bf16 v[204:207], a[124:127], v[44:47], v[204:207]
s_waitcnt lgkmcnt(7)
ds_read_b64_tr_b16 v[34:35], v16 offset:1024
v_mfma_f32_16x16x32_bf16 v[208:211], a[64:67], v[48:51], v[208:211]
s_waitcnt lgkmcnt(6)
v_mfma_f32_16x16x32_bf16 v[208:211], a[80:83], v[52:55], v[208:211]
s_waitcnt lgkmcnt(4)
ds_read_b64_tr_b16 v[36:37], v16 offset:8192
v_mfma_f32_16x16x32_bf16 v[208:211], a[96:99], v[56:59], v[208:211]
s_waitcnt lgkmcnt(3)
v_mfma_f32_16x16x32_bf16 v[208:211], a[112:115], v[60:63], v[208:211]
ds_read_b64_tr_b16 v[38:39], v16 offset:9216
v_mfma_f32_16x16x32_bf16 v[212:215], a[68:71], v[48:51], v[212:215]
v_mfma_f32_16x16x32_bf16 v[212:215], a[84:87], v[52:55], v[212:215]
ds_read_b64_tr_b16 v[40:41], v16 offset:16384
v_mfma_f32_16x16x32_bf16 v[212:215], a[100:103], v[56:59], v[212:215]
v_mfma_f32_16x16x32_bf16 v[212:215], a[116:119], v[60:63], v[212:215]
ds_read_b64_tr_b16 v[42:43], v16 offset:17408
v_mfma_f32_16x16x32_bf16 v[216:219], a[72:75], v[48:51], v[216:219]
v_mfma_f32_16x16x32_bf16 v[216:219], a[88:91], v[52:55], v[216:219]
ds_read_b64_tr_b16 v[44:45], v16 offset:24576
v_mfma_f32_16x16x32_bf16 v[216:219], a[104:107], v[56:59], v[216:219]
v_mfma_f32_16x16x32_bf16 v[216:219], a[120:123], v[60:63], v[216:219]
ds_read_b64_tr_b16 v[46:47], v16 offset:25600
v_mfma_f32_16x16x32_bf16 v[220:223], a[76:79], v[48:51], v[220:223]
v_add_u32 v16, 0x10000, v16
v_mfma_f32_16x16x32_bf16 v[220:223], a[92:95], v[52:55], v[220:223]
ds_read_b64_tr_b16 v[48:49], v17 offset:0
v_mfma_f32_16x16x32_bf16 v[220:223], a[108:111], v[56:59], v[220:223]
v_mfma_f32_16x16x32_bf16 v[220:223], a[124:127], v[60:63], v[220:223]
s_waitcnt lgkmcnt(7)
ds_read_b64_tr_b16 v[50:51], v17 offset:1024
v_mfma_f32_16x16x32_bf16 v[224:227], a[64:67], v[32:35], v[224:227]
s_waitcnt lgkmcnt(6)
v_mfma_f32_16x16x32_bf16 v[224:227], a[80:83], v[36:39], v[224:227]
s_waitcnt lgkmcnt(4)
ds_read_b64_tr_b16 v[52:53], v17 offset:8192
v_mfma_f32_16x16x32_bf16 v[224:227], a[96:99], v[40:43], v[224:227]
s_waitcnt lgkmcnt(3)
v_mfma_f32_16x16x32_bf16 v[224:227], a[112:115], v[44:47], v[224:227]
s_mov_b32 s55, 7168
ds_read_b64_tr_b16 v[54:55], v17 offset:9216
v_mfma_f32_16x16x32_bf16 v[228:231], a[68:71], v[32:35], v[228:231]
buffer_store_dwordx4 v[116:119], v24, s[4:7], s55 offen
v_mfma_f32_16x16x32_bf16 v[228:231], a[84:87], v[36:39], v[228:231]
ds_read_b64_tr_b16 v[56:57], v17 offset:16384
v_mfma_f32_16x16x32_bf16 v[228:231], a[100:103], v[40:43], v[228:231]
v_mfma_f32_16x16x32_bf16 v[228:231], a[116:119], v[44:47], v[228:231]
ds_read_b64_tr_b16 v[58:59], v17 offset:17408
v_mfma_f32_16x16x32_bf16 v[232:235], a[72:75], v[32:35], v[232:235]
v_mfma_f32_16x16x32_bf16 v[232:235], a[88:91], v[36:39], v[232:235]
ds_read_b64_tr_b16 v[60:61], v17 offset:24576
v_mfma_f32_16x16x32_bf16 v[232:235], a[104:107], v[40:43], v[232:235]
v_mfma_f32_16x16x32_bf16 v[232:235], a[120:123], v[44:47], v[232:235]
ds_read_b64_tr_b16 v[62:63], v17 offset:25600
v_mfma_f32_16x16x32_bf16 v[236:239], a[76:79], v[32:35], v[236:239]
v_add_u32 v17, 0x10000, v17
v_mfma_f32_16x16x32_bf16 v[236:239], a[92:95], v[36:39], v[236:239]
v_mfma_f32_16x16x32_bf16 v[236:239], a[108:111], v[40:43], v[236:239]
v_mfma_f32_16x16x32_bf16 v[236:239], a[124:127], v[44:47], v[236:239]
s_waitcnt lgkmcnt(6)
v_mfma_f32_16x16x32_bf16 v[240:243], a[64:67], v[48:51], v[240:243]
s_waitcnt vmcnt(37)
s_waitcnt lgkmcnt(0)
s_barrier
v_mfma_f32_16x16x32_bf16 v[240:243], a[80:83], v[52:55], v[240:243]
ds_read_b64_tr_b16 v[32:33], v10 offset:0
v_mfma_f32_16x16x32_bf16 v[240:243], a[96:99], v[56:59], v[240:243]
ds_read_b64_tr_b16 v[34:35], v10 offset:1024
v_mfma_f32_16x16x32_bf16 v[240:243], a[112:115], v[60:63], v[240:243]
ds_read_b64_tr_b16 v[36:37], v10 offset:8192
v_mfma_f32_16x16x32_bf16 v[244:247], a[68:71], v[48:51], v[244:247]
s_mov_b32 s54, 0
ds_read_b64_tr_b16 v[38:39], v10 offset:9216
v_mfma_f32_16x16x32_bf16 v[244:247], a[84:87], v[52:55], v[244:247]
s_add_u32 m0, s67, 0
v_mfma_f32_16x16x32_bf16 v[244:247], a[100:103], v[56:59], v[244:247]
ds_read_b64_tr_b16 v[40:41], v10 offset:16384
v_mfma_f32_16x16x32_bf16 v[244:247], a[116:119], v[60:63], v[244:247]
buffer_load_dwordx4 v25, s[28:31], s54 offen offset:0  lds
v_mfma_f32_16x16x32_bf16 v[248:251], a[72:75], v[48:51], v[248:251]
ds_read_b64_tr_b16 v[42:43], v10 offset:17408
v_mfma_f32_16x16x32_bf16 v[248:251], a[88:91], v[52:55], v[248:251]
s_mov_b32 s55, 11264
buffer_store_dwordx4 v[120:123], v24, s[4:7], s55 offen
v_mfma_f32_16x16x32_bf16 v[248:251], a[104:107], v[56:59], v[248:251]
ds_read_b64_tr_b16 v[44:45], v10 offset:24576
v_mfma_f32_16x16x32_bf16 v[248:251], a[120:123], v[60:63], v[248:251]
v_mfma_f32_16x16x32_bf16 v[252:255], a[76:79], v[48:51], v[252:255]
ds_read_b64_tr_b16 v[46:47], v10 offset:25600
v_mfma_f32_16x16x32_bf16 v[252:255], a[92:95], v[52:55], v[252:255]
ds_read_b64_tr_b16 v[48:49], v11 offset:0
v_add_u32 v10, 0xffff8000, v10
v_mfma_f32_16x16x32_bf16 v[252:255], a[108:111], v[56:59], v[252:255]
buffer_load_dwordx4 v26, s[28:31], s54 offen offset:1024  lds
v_mfma_f32_16x16x32_bf16 v[252:255], a[124:127], v[60:63], v[252:255]
s_waitcnt lgkmcnt(7)
ds_read_b64_tr_b16 v[50:51], v11 offset:1024
v_mfma_f32_16x16x32_bf16 v[128:131], a[128:131], v[32:35], v[128:131]
s_waitcnt lgkmcnt(6)
v_mfma_f32_16x16x32_bf16 v[128:131], a[144:147], v[36:39], v[128:131]
s_waitcnt lgkmcnt(4)
ds_read_b64_tr_b16 v[52:53], v11 offset:8192
v_mfma_f32_16x16x32_bf16 v[128:131], a[160:163], v[40:43], v[128:131]
s_waitcnt lgkmcnt(3)
v_mfma_f32_16x16x32_bf16 v[128:131], a[176:179], v[44:47], v[128:131]
ds_read_b64_tr_b16 v[54:55], v11 offset:9216
v_mfma_f32_16x16x32_bf16 v[132:135], a[132:135], v[32:35], v[132:135]
buffer_load_dwordx4 v27, s[28:31], s54 offen offset:2048  lds
v_mfma_f32_16x16x32_bf16 v[132:135], a[148:151], v[36:39], v[132:135]
ds_read_b64_tr_b16 v[56:57], v11 offset:16384
v_mfma_f32_16x16x32_bf16 v[132:135], a[164:167], v[40:43], v[132:135]
v_mfma_f32_16x16x32_bf16 v[132:135], a[180:183], v[44:47], v[132:135]
ds_read_b64_tr_b16 v[58:59], v11 offset:17408
v_mfma_f32_16x16x32_bf16 v[136:139], a[136:139], v[32:35], v[136:139]
v_mfma_f32_16x16x32_bf16 v[136:139], a[152:155], v[36:39], v[136:139]
ds_read_b64_tr_b16 v[60:61], v11 offset:24576
v_mfma_f32_16x16x32_bf16 v[136:139], a[168:171], v[40:43], v[136:139]
buffer_load_dwordx4 v28, s[28:31], s54 offen offset:3072  lds
v_mfma_f32_16x16x32_bf16 v[136:139], a[184:187], v[44:47], v[136:139]
s_mov_b32 s54, 442368
ds_read_b64_tr_b16 v[62:63], v11 offset:25600
v_mfma_f32_16x16x32_bf16 v[140:143], a[140:143], v[32:35], v[140:143]
s_add_u32 m0, s67, 16384
v_add_u32 v11, 0xffff8000, v11
v_mfma_f32_16x16x32_bf16 v[140:143], a[156:159], v[36:39], v[140:143]
ds_read_b64_tr_b16 v[32:33], v12 offset:0
v_mfma_f32_16x16x32_bf16 v[140:143], a[172:175], v[40:43], v[140:143]
s_mov_b32 s55, 15360
buffer_store_dwordx4 v[124:127], v24, s[4:7], s55 offen
v_mfma_f32_16x16x32_bf16 v[140:143], a[188:191], v[44:47], v[140:143]
s_waitcnt lgkmcnt(7)
ds_read_b64_tr_b16 v[34:35], v12 offset:1024
v_mfma_f32_16x16x32_bf16 v[144:147], a[128:131], v[48:51], v[144:147]
s_waitcnt lgkmcnt(6)
buffer_load_dwordx4 v25, s[28:31], s54 offen offset:0  lds
v_mfma_f32_16x16x32_bf16 v[144:147], a[144:147], v[52:55], v[144:147]
s_waitcnt lgkmcnt(4)
ds_read_b64_tr_b16 v[36:37], v12 offset:8192
v_mfma_f32_16x16x32_bf16 v[144:147], a[160:163], v[56:59], v[144:147]
s_waitcnt lgkmcnt(3)
v_mfma_f32_16x16x32_bf16 v[144:147], a[176:179], v[60:63], v[144:147]
ds_read_b64_tr_b16 v[38:39], v12 offset:9216
v_mfma_f32_16x16x32_bf16 v[148:151], a[132:135], v[48:51], v[148:151]
v_mfma_f32_16x16x32_bf16 v[148:151], a[148:151], v[52:55], v[148:151]
ds_read_b64_tr_b16 v[40:41], v12 offset:16384
v_mfma_f32_16x16x32_bf16 v[148:151], a[164:167], v[56:59], v[148:151]
buffer_load_dwordx4 v26, s[28:31], s54 offen offset:1024  lds
v_mfma_f32_16x16x32_bf16 v[148:151], a[180:183], v[60:63], v[148:151]
ds_read_b64_tr_b16 v[42:43], v12 offset:17408
v_mfma_f32_16x16x32_bf16 v[152:155], a[136:139], v[48:51], v[152:155]
v_mfma_f32_16x16x32_bf16 v[152:155], a[152:155], v[52:55], v[152:155]
ds_read_b64_tr_b16 v[44:45], v12 offset:24576
v_mfma_f32_16x16x32_bf16 v[152:155], a[168:171], v[56:59], v[152:155]
v_mfma_f32_16x16x32_bf16 v[152:155], a[184:187], v[60:63], v[152:155]
ds_read_b64_tr_b16 v[46:47], v12 offset:25600
v_mfma_f32_16x16x32_bf16 v[156:159], a[140:143], v[48:51], v[156:159]
v_add_u32 v12, 0xffff8000, v12
v_mfma_f32_16x16x32_bf16 v[156:159], a[156:159], v[52:55], v[156:159]
ds_read_b64_tr_b16 v[48:49], v13 offset:0
v_mfma_f32_16x16x32_bf16 v[156:159], a[172:175], v[56:59], v[156:159]
buffer_load_dwordx4 v27, s[28:31], s54 offen offset:2048  lds
v_mfma_f32_16x16x32_bf16 v[156:159], a[188:191], v[60:63], v[156:159]
s_waitcnt lgkmcnt(7)
ds_read_b64_tr_b16 v[50:51], v13 offset:1024
v_mfma_f32_16x16x32_bf16 v[160:163], a[128:131], v[32:35], v[160:163]
s_waitcnt lgkmcnt(6)
v_mfma_f32_16x16x32_bf16 v[160:163], a[144:147], v[36:39], v[160:163]
s_waitcnt lgkmcnt(4)
ds_read_b64_tr_b16 v[52:53], v13 offset:8192
v_mfma_f32_16x16x32_bf16 v[160:163], a[160:163], v[40:43], v[160:163]
s_waitcnt lgkmcnt(3)
v_mfma_f32_16x16x32_bf16 v[160:163], a[176:179], v[44:47], v[160:163]
ds_read_b64_tr_b16 v[54:55], v13 offset:9216
v_mfma_f32_16x16x32_bf16 v[164:167], a[132:135], v[32:35], v[164:167]
buffer_load_dwordx4 v28, s[28:31], s54 offen offset:3072  lds
v_mfma_f32_16x16x32_bf16 v[164:167], a[148:151], v[36:39], v[164:167]
ds_read_b64_tr_b16 v[56:57], v13 offset:16384
v_mfma_f32_16x16x32_bf16 v[164:167], a[164:167], v[40:43], v[164:167]
v_mfma_f32_16x16x32_bf16 v[164:167], a[180:183], v[44:47], v[164:167]
ds_read_b64_tr_b16 v[58:59], v13 offset:17408
v_mfma_f32_16x16x32_bf16 v[168:171], a[136:139], v[32:35], v[168:171]
s_mov_b32 s1, 0
v_lshl_add_u32 v19, s50, 10, v1
v_cmp_gt_u32 vcc, 512, v19
v_mfma_f32_16x16x32_bf16 v[168:171], a[152:155], v[36:39], v[168:171]
ds_read_b64_tr_b16 v[60:61], v13 offset:24576
v_lshrrev_b32 v18, 2, v1
v_mfma_f32_16x16x32_bf16 v[168:171], a[168:171], v[40:43], v[168:171]
v_mov_b32 v20, 2130706432
v_mov_b32 v19, 8
v_mfma_f32_16x16x32_bf16 v[168:171], a[184:187], v[44:47], v[168:171]
ds_read_b64_tr_b16 v[62:63], v13 offset:25600
v_cndmask_b32 v18, v20, v18, vcc
v_mfma_f32_16x16x32_bf16 v[172:175], a[140:143], v[32:35], v[172:175]
v_add_u32 v13, 0xffff8000, v13
v_cndmask_b32 v19, 0, v19, vcc
v_mfma_f32_16x16x32_bf16 v[172:175], a[156:159], v[36:39], v[172:175]
ds_read_b64_tr_b16 v[32:33], v14 offset:0
v_mfma_f32_16x16x32_bf16 v[172:175], a[172:175], v[40:43], v[172:175]
buffer_load_dword v20, v18, s[44:47], s1 offen sc1
v_mfma_f32_16x16x32_bf16 v[172:175], a[188:191], v[44:47], v[172:175]
s_waitcnt lgkmcnt(7)
ds_read_b64_tr_b16 v[34:35], v14 offset:1024
v_mfma_f32_16x16x32_bf16 v[176:179], a[128:131], v[48:51], v[176:179]
s_waitcnt lgkmcnt(6)
v_mfma_f32_16x16x32_bf16 v[176:179], a[144:147], v[52:55], v[176:179]
s_waitcnt lgkmcnt(4)
ds_read_b64_tr_b16 v[36:37], v14 offset:8192
v_mfma_f32_16x16x32_bf16 v[176:179], a[160:163], v[56:59], v[176:179]
s_waitcnt lgkmcnt(3)
v_mfma_f32_16x16x32_bf16 v[176:179], a[176:179], v[60:63], v[176:179]
ds_read_b64_tr_b16 v[38:39], v14 offset:9216
v_mfma_f32_16x16x32_bf16 v[180:183], a[132:135], v[48:51], v[180:183]
v_mfma_f32_16x16x32_bf16 v[180:183], a[148:151], v[52:55], v[180:183]
ds_read_b64_tr_b16 v[40:41], v14 offset:16384
v_mfma_f32_16x16x32_bf16 v[180:183], a[164:167], v[56:59], v[180:183]
v_mfma_f32_16x16x32_bf16 v[180:183], a[180:183], v[60:63], v[180:183]
ds_read_b64_tr_b16 v[42:43], v14 offset:17408
v_mfma_f32_16x16x32_bf16 v[184:187], a[136:139], v[48:51], v[184:187]
v_mfma_f32_16x16x32_bf16 v[184:187], a[152:155], v[52:55], v[184:187]
ds_read_b64_tr_b16 v[44:45], v14 offset:24576
v_mfma_f32_16x16x32_bf16 v[184:187], a[168:171], v[56:59], v[184:187]
v_mfma_f32_16x16x32_bf16 v[184:187], a[184:187], v[60:63], v[184:187]
ds_read_b64_tr_b16 v[46:47], v14 offset:25600
v_mfma_f32_16x16x32_bf16 v[188:191], a[140:143], v[48:51], v[188:191]
v_add_u32 v14, 0xffff8000, v14
v_mfma_f32_16x16x32_bf16 v[188:191], a[156:159], v[52:55], v[188:191]
ds_read_b64_tr_b16 v[48:49], v15 offset:0
v_mfma_f32_16x16x32_bf16 v[188:191], a[172:175], v[56:59], v[188:191]
v_mfma_f32_16x16x32_bf16 v[188:191], a[188:191], v[60:63], v[188:191]
s_waitcnt lgkmcnt(7)
ds_read_b64_tr_b16 v[50:51], v15 offset:1024
v_mfma_f32_16x16x32_bf16 v[192:195], a[128:131], v[32:35], v[192:195]
s_waitcnt lgkmcnt(6)
v_mfma_f32_16x16x32_bf16 v[192:195], a[144:147], v[36:39], v[192:195]
s_waitcnt lgkmcnt(4)
ds_read_b64_tr_b16 v[52:53], v15 offset:8192
v_mfma_f32_16x16x32_bf16 v[192:195], a[160:163], v[40:43], v[192:195]
s_waitcnt lgkmcnt(3)
v_mfma_f32_16x16x32_bf16 v[192:195], a[176:179], v[44:47], v[192:195]
ds_read_b64_tr_b16 v[54:55], v15 offset:9216
v_mfma_f32_16x16x32_bf16 v[196:199], a[132:135], v[32:35], v[196:199]
v_mfma_f32_16x16x32_bf16 v[196:199], a[148:151], v[36:39], v[196:199]
ds_read_b64_tr_b16 v[56:57], v15 offset:16384
v_mfma_f32_16x16x32_bf16 v[196:199], a[164:167], v[40:43], v[196:199]
v_mfma_f32_16x16x32_bf16 v[196:199], a[180:183], v[44:47], v[196:199]
ds_read_b64_tr_b16 v[58:59], v15 offset:17408
v_mfma_f32_16x16x32_bf16 v[200:203], a[136:139], v[32:35], v[200:203]
v_mfma_f32_16x16x32_bf16 v[200:203], a[152:155], v[36:39], v[200:203]
ds_read_b64_tr_b16 v[60:61], v15 offset:24576
v_mfma_f32_16x16x32_bf16 v[200:203], a[168:171], v[40:43], v[200:203]
v_mfma_f32_16x16x32_bf16 v[200:203], a[184:187], v[44:47], v[200:203]
ds_read_b64_tr_b16 v[62:63], v15 offset:25600
v_mfma_f32_16x16x32_bf16 v[204:207], a[140:143], v[32:35], v[204:207]
v_add_u32 v15, 0xffff8000, v15
v_mfma_f32_16x16x32_bf16 v[204:207], a[156:159], v[36:39], v[204:207]
ds_read_b64_tr_b16 v[32:33], v16 offset:0
v_mfma_f32_16x16x32_bf16 v[204:207], a[172:175], v[40:43], v[204:207]
v_mfma_f32_16x16x32_bf16 v[204:207], a[188:191], v[44:47], v[204:207]
s_waitcnt lgkmcnt(7)
ds_read_b64_tr_b16 v[34:35], v16 offset:1024
v_mfma_f32_16x16x32_bf16 v[208:211], a[128:131], v[48:51], v[208:211]
s_waitcnt lgkmcnt(6)
v_mfma_f32_16x16x32_bf16 v[208:211], a[144:147], v[52:55], v[208:211]
s_waitcnt lgkmcnt(4)
ds_read_b64_tr_b16 v[36:37], v16 offset:8192
v_mfma_f32_16x16x32_bf16 v[208:211], a[160:163], v[56:59], v[208:211]
s_waitcnt lgkmcnt(3)
v_mfma_f32_16x16x32_bf16 v[208:211], a[176:179], v[60:63], v[208:211]
ds_read_b64_tr_b16 v[38:39], v16 offset:9216
v_mfma_f32_16x16x32_bf16 v[212:215], a[132:135], v[48:51], v[212:215]
v_mfma_f32_16x16x32_bf16 v[212:215], a[148:151], v[52:55], v[212:215]
ds_read_b64_tr_b16 v[40:41], v16 offset:16384
v_mfma_f32_16x16x32_bf16 v[212:215], a[164:167], v[56:59], v[212:215]
v_mfma_f32_16x16x32_bf16 v[212:215], a[180:183], v[60:63], v[212:215]
ds_read_b64_tr_b16 v[42:43], v16 offset:17408
v_mfma_f32_16x16x32_bf16 v[216:219], a[136:139], v[48:51], v[216:219]
v_mfma_f32_16x16x32_bf16 v[216:219], a[152:155], v[52:55], v[216:219]
ds_read_b64_tr_b16 v[44:45], v16 offset:24576
v_mfma_f32_16x16x32_bf16 v[216:219], a[168:171], v[56:59], v[216:219]
v_mfma_f32_16x16x32_bf16 v[216:219], a[184:187], v[60:63], v[216:219]
ds_read_b64_tr_b16 v[46:47], v16 offset:25600
v_mfma_f32_16x16x32_bf16 v[220:223], a[140:143], v[48:51], v[220:223]
v_add_u32 v16, 0xffff8000, v16
v_mfma_f32_16x16x32_bf16 v[220:223], a[156:159], v[52:55], v[220:223]
ds_read_b64_tr_b16 v[48:49], v17 offset:0
v_mfma_f32_16x16x32_bf16 v[220:223], a[172:175], v[56:59], v[220:223]
v_mfma_f32_16x16x32_bf16 v[220:223], a[188:191], v[60:63], v[220:223]
s_waitcnt lgkmcnt(7)
ds_read_b64_tr_b16 v[50:51], v17 offset:1024
v_mfma_f32_16x16x32_bf16 v[224:227], a[128:131], v[32:35], v[224:227]
s_waitcnt lgkmcnt(6)
v_mfma_f32_16x16x32_bf16 v[224:227], a[144:147], v[36:39], v[224:227]
s_waitcnt lgkmcnt(4)
ds_read_b64_tr_b16 v[52:53], v17 offset:8192
v_mfma_f32_16x16x32_bf16 v[224:227], a[160:163], v[40:43], v[224:227]
s_waitcnt lgkmcnt(3)
v_mfma_f32_16x16x32_bf16 v[224:227], a[176:179], v[44:47], v[224:227]
ds_read_b64_tr_b16 v[54:55], v17 offset:9216
v_mfma_f32_16x16x32_bf16 v[228:231], a[132:135], v[32:35], v[228:231]
v_mfma_f32_16x16x32_bf16 v[228:231], a[148:151], v[36:39], v[228:231]
ds_read_b64_tr_b16 v[56:57], v17 offset:16384
v_mfma_f32_16x16x32_bf16 v[228:231], a[164:167], v[40:43], v[228:231]
v_mfma_f32_16x16x32_bf16 v[228:231], a[180:183], v[44:47], v[228:231]
ds_read_b64_tr_b16 v[58:59], v17 offset:17408
v_mfma_f32_16x16x32_bf16 v[232:235], a[136:139], v[32:35], v[232:235]
v_mfma_f32_16x16x32_bf16 v[232:235], a[152:155], v[36:39], v[232:235]
ds_read_b64_tr_b16 v[60:61], v17 offset:24576
v_mfma_f32_16x16x32_bf16 v[232:235], a[168:171], v[40:43], v[232:235]
v_mfma_f32_16x16x32_bf16 v[232:235], a[184:187], v[44:47], v[232:235]
ds_read_b64_tr_b16 v[62:63], v17 offset:25600
v_mfma_f32_16x16x32_bf16 v[236:239], a[140:143], v[32:35], v[236:239]
v_add_u32 v17, 0xffff8000, v17
v_mfma_f32_16x16x32_bf16 v[236:239], a[156:159], v[36:39], v[236:239]
v_mfma_f32_16x16x32_bf16 v[236:239], a[172:175], v[40:43], v[236:239]
v_mfma_f32_16x16x32_bf16 v[236:239], a[188:191], v[44:47], v[236:239]
s_waitcnt vmcnt(0)
v_and_b32 v20, 15, v20
v_cmp_ge_u32 vcc, v20, v19
s_nop 3
s_cmp_eq_u64 vcc, -1
s_cbranch_scc0 L_spin_xn
L_back_xn:
s_waitcnt lgkmcnt(6)
v_mfma_f32_16x16x32_bf16 v[240:243], a[128:131], v[48:51], v[240:243]
s_waitcnt lgkmcnt(0)
s_barrier
v_mfma_f32_16x16x32_bf16 v[240:243], a[144:147], v[52:55], v[240:243]
ds_read_b64_tr_b16 v[32:33], v10 offset:0
v_mfma_f32_16x16x32_bf16 v[240:243], a[160:163], v[56:59], v[240:243]
s_add_u32 s54, s76, 0
ds_read_b64_tr_b16 v[34:35], v10 offset:1024
v_mfma_f32_16x16x32_bf16 v[240:243], a[176:179], v[60:63], v[240:243]
s_and_b32 s1, s48, 28
ds_read_b64_tr_b16 v[36:37], v10 offset:8192
v_mfma_f32_16x16x32_bf16 v[244:247], a[132:135], v[48:51], v[244:247]
s_lshl_b32 s1, s1, 2
ds_read_b64_tr_b16 v[38:39], v10 offset:9216
v_mfma_f32_16x16x32_bf16 v[244:247], a[148:151], v[52:55], v[244:247]
buffer_load_dwordx4 v[2:5], v0, s[44:47], s1 offen sc1
v_mfma_f32_16x16x32_bf16 v[244:247], a[164:167], v[56:59], v[244:247]
ds_read_b64_tr_b16 v[40:41], v10 offset:16384
v_mfma_f32_16x16x32_bf16 v[244:247], a[180:183], v[60:63], v[244:247]
buffer_load_dwordx4 a[0:3], v1, s[4:7], s54 offen offset:0 sc1
v_mfma_f32_16x16x32_bf16 v[248:251], a[136:139], v[48:51], v[248:251]
ds_read_b64_tr_b16 v[42:43], v10 offset:17408
v_mfma_f32_16x16x32_bf16 v[248:251], a[152:155], v[52:55], v[248:251]
v_mfma_f32_16x16x32_bf16 v[248:251], a[168:171], v[56:59], v[248:251]
ds_read_b64_tr_b16 v[44:45], v10 offset:24576
v_mfma_f32_16x16x32_bf16 v[248:251], a[184:187], v[60:63], v[248:251]
buffer_load_dwordx4 a[4:7], v1, s[4:7], s54 offen offset:1024 sc1
v_mfma_f32_16x16x32_bf16 v[252:255], a[140:143], v[48:51], v[252:255]
ds_read_b64_tr_b16 v[46:47], v10 offset:25600
v_mfma_f32_16x16x32_bf16 v[252:255], a[156:159], v[52:55], v[252:255]
v_add_u32 v10, 0x10000, v10
v_mfma_f32_16x16x32_bf16 v[252:255], a[172:175], v[56:59], v[252:255]
v_mfma_f32_16x16x32_bf16 v[252:255], a[188:191], v[60:63], v[252:255]
s_cmp_ge_u32 s66, 27
s_cbranch_scc1 L_varN
s_waitcnt lgkmcnt(6)
v_mfma_f32_16x16x32_bf16 v[128:131], a[192:195], v[32:35], v[128:131]
s_waitcnt lgkmcnt(4)
s_add_u32 s54, s76, 0
buffer_load_dwordx4 a[8:11], v1, s[4:7], s54 offen offset:2048 sc1
v_mfma_f32_16x16x32_bf16 v[128:131], a[208:211], v[36:39], v[128:131]
s_waitcnt lgkmcnt(2)
ds_read_b64_tr_b16 v[48:49], v11 offset:0
v_mfma_f32_16x16x32_bf16 v[128:131], a[224:227], v[40:43], v[128:131]
s_waitcnt lgkmcnt(1)
ds_read_b64_tr_b16 v[50:51], v11 offset:1024
v_mfma_f32_16x16x32_bf16 v[128:131], a[240:243], v[44:47], v[128:131]
ds_read_b64_tr_b16 v[52:53], v11 offset:8192
v_mfma_f32_16x16x32_bf16 v[132:135], a[196:199], v[32:35], v[132:135]
ds_read_b64_tr_b16 v[54:55], v11 offset:9216
v_mfma_f32_16x16x32_bf16 v[132:135], a[212:215], v[36:39], v[132:135]
buffer_load_dwordx4 a[12:15], v1, s[4:7], s54 offen offset:3072 sc1
v_mfma_f32_16x16x32_bf16 v[132:135], a[228:231], v[40:43], v[132:135]
s_add_u32 s54, s77, 0
ds_read_b64_tr_b16 v[56:57], v11 offset:16384
v_mfma_f32_16x16x32_bf16 v[132:135], a[244:247], v[44:47], v[132:135]
v_mfma_f32_16x16x32_bf16 v[136:139], a[200:203], v[32:35], v[136:139]
ds_read_b64_tr_b16 v[58:59], v11 offset:17408
v_mfma_f32_16x16x32_bf16 v[136:139], a[216:219], v[36:39], v[136:139]
buffer_load_dwordx4 a[16:19], v1, s[4:7], s54 offen offset:0 sc1
v_mfma_f32_16x16x32_bf16 v[136:139], a[232:235], v[40:43], v[136:139]
ds_read_b64_tr_b16 v[60:61], v11 offset:24576
v_mfma_f32_16x16x32_bf16 v[136:139], a[248:251], v[44:47], v[136:139]
v_mfma_f32_16x16x32_bf16 v[140:143], a[204:207], v[32:35], v[140:143]
ds_read_b64_tr_b16 v[62:63], v11 offset:25600
v_mfma_f32_16x16x32_bf16 v[140:143], a[220:223], v[36:39], v[140:143]
ds_read_b64_tr_b16 v[32:33], v12 offset:0
v_add_u32 v11, 0x10000, v11
v_mfma_f32_16x16x32_bf16 v[140:143], a[236:239], v[40:43], v[140:143]
s_getreg_b32 s51, hwreg(HW_REG_XCC_ID, 0, 4)
buffer_load_dwordx4 a[20:23], v1, s[4:7], s54 offen offset:1024 sc1
v_mfma_f32_16x16x32_bf16 v[140:143], a[252:255], v[44:47], v[140:143]
s_waitcnt lgkmcnt(7)
s_mul_i32 s52, s51, s51
ds_read_b64_tr_b16 v[34:35], v12 offset:1024
v_mfma_f32_16x16x32_bf16 v[144:147], a[192:195], v[48:51], v[144:147]
s_waitcnt lgkmcnt(6)
s_lshl_b32 s52, s52, 10
v_mfma_f32_16x16x32_bf16 v[144:147], a[208:211], v[52:55], v[144:147]
s_waitcnt lgkmcnt(4)
s_lshl_b32 s51, s51, 4
ds_read_b64_tr_b16 v[36:37], v12 offset:8192
v_mfma_f32_16x16x32_bf16 v[144:147], a[224:227], v[56:59], v[144:147]
s_waitcnt lgkmcnt(3)
s_add_u32 s51, s51, s52
buffer_load_dwordx4 a[24:27], v1, s[4:7], s54 offen offset:2048 sc1
v_mfma_f32_16x16x32_bf16 v[144:147], a[240:243], v[60:63], v[144:147]
s_add_u32 s51, s51, 1
ds_read_b64_tr_b16 v[38:39], v12 offset:9216
v_mfma_f32_16x16x32_bf16 v[148:151], a[196:199], v[48:51], v[148:151]
s_waitcnt vmcnt(7)
s_lshl_b32 s51, s51, 3
v_xor_b32 v2, s51, v2
v_xor_b32 v3, s51, v3
v_mfma_f32_16x16x32_bf16 v[148:151], a[212:215], v[52:55], v[148:151]
ds_read_b64_tr_b16 v[40:41], v12 offset:16384
v_xor_b32 v4, s51, v4
v_mfma_f32_16x16x32_bf16 v[148:151], a[228:231], v[56:59], v[148:151]
buffer_load_dwordx4 a[28:31], v1, s[4:7], s54 offen offset:3072 sc1
v_mfma_f32_16x16x32_bf16 v[148:151], a[244:247], v[60:63], v[148:151]
s_add_u32 s54, s78, 0
ds_read_b64_tr_b16 v[42:43], v12 offset:17408
v_xor_b32 v5, s51, v5
v_mfma_f32_16x16x32_bf16 v[152:155], a[200:203], v[48:51], v[152:155]
v_or3_b32 v2, v2, v3, v4
v_or_b32 v2, v2, v5
v_mfma_f32_16x16x32_bf16 v[152:155], a[216:219], v[52:55], v[152:155]
s_nop 0
ds_read_b64_tr_b16 v[44:45], v12 offset:24576
v_readfirstlane_b32 s23, v2
v_mfma_f32_16x16x32_bf16 v[152:155], a[232:235], v[56:59], v[152:155]
buffer_load_dwordx4 a[32:35], v1, s[4:7], s54 offen offset:0 sc1
v_mfma_f32_16x16x32_bf16 v[152:155], a[248:251], v[60:63], v[152:155]
ds_read_b64_tr_b16 v[46:47], v12 offset:25600
v_mfma_f32_16x16x32_bf16 v[156:159], a[204:207], v[48:51], v[156:159]
v_add_u32 v12, 0x10000, v12
v_mfma_f32_16x16x32_bf16 v[156:159], a[220:223], v[52:55], v[156:159]
ds_read_b64_tr_b16 v[48:49], v13 offset:0
v_mfma_f32_16x16x32_bf16 v[156:159], a[236:239], v[56:59], v[156:159]
buffer_load_dwordx4 a[36:39], v1, s[4:7], s54 offen offset:1024 sc1
v_mfma_f32_16x16x32_bf16 v[156:159], a[252:255], v[60:63], v[156:159]
s_waitcnt lgkmcnt(7)
ds_read_b64_tr_b16 v[50:51], v13 offset:1024
v_mfma_f32_16x16x32_bf16 v[160:163], a[192:195], v[32:35], v[160:163]
s_waitcnt lgkmcnt(6)
v_mfma_f32_16x16x32_bf16 v[160:163], a[208:211], v[36:39], v[160:163]
s_waitcnt lgkmcnt(4)
ds_read_b64_tr_b16 v[52:53], v13 offset:8192
v_mfma_f32_16x16x32_bf16 v[160:163], a[224:227], v[40:43], v[160:163]
s_waitcnt lgkmcnt(3)
buffer_load_dwordx4 a[40:43], v1, s[4:7], s54 offen offset:2048 sc1
v_mfma_f32_16x16x32_bf16 v[160:163], a[240:243], v[44:47], v[160:163]
ds_read_b64_tr_b16 v[54:55], v13 offset:9216
v_mfma_f32_16x16x32_bf16 v[164:167], a[196:199], v[32:35], v[164:167]
v_cvt_pk_bf16_f32 v2, v128, v129
v_cvt_pk_bf16_f32 v3, v130, v131
v_mfma_f32_16x16x32_bf16 v[164:167], a[212:215], v[36:39], v[164:167]
ds_read_b64_tr_b16 v[56:57], v13 offset:16384
v_cvt_pk_bf16_f32 v4, v132, v133
v_mfma_f32_16x16x32_bf16 v[164:167], a[228:231], v[40:43], v[164:167]
buffer_load_dwordx4 a[44:47], v1, s[4:7], s54 offen offset:3072 sc1
v_mfma_f32_16x16x32_bf16 v[164:167], a[244:247], v[44:47], v[164:167]
s_add_u32 s54, s79, 0
ds_read_b64_tr_b16 v[58:59], v13 offset:17408
v_cvt_pk_bf16_f32 v5, v134, v135
v_mfma_f32_16x16x32_bf16 v[168:171], a[200:203], v[32:35], v[168:171]
s_mov_b32 s55, 524288
buffer_store_dwordx4 v[2:5], v24, s[4:7], s55 offen
v_mfma_f32_16x16x32_bf16 v[168:171], a[216:219], v[36:39], v[168:171]
ds_read_b64_tr_b16 v[60:61], v13 offset:24576
v_mfma_f32_16x16x32_bf16 v[168:171], a[232:235], v[40:43], v[168:171]
buffer_load_dwordx4 a[48:51], v1, s[4:7], s54 offen offset:0 sc1
v_mfma_f32_16x16x32_bf16 v[168:171], a[248:251], v[44:47], v[168:171]
ds_read_b64_tr_b16 v[62:63], v13 offset:25600
v_mfma_f32_16x16x32_bf16 v[172:175], a[204:207], v[32:35], v[172:175]
v_add_u32 v13, 0x10000, v13
v_mfma_f32_16x16x32_bf16 v[172:175], a[220:223], v[36:39], v[172:175]
ds_read_b64_tr_b16 v[32:33], v14 offset:0
v_mfma_f32_16x16x32_bf16 v[172:175], a[236:239], v[40:43], v[172:175]
buffer_load_dwordx4 a[52:55], v1, s[4:7], s54 offen offset:1024 sc1
v_mfma_f32_16x16x32_bf16 v[172:175], a[252:255], v[44:47], v[172:175]
s_waitcnt lgkmcnt(7)
ds_read_b64_tr_b16 v[34:35], v14 offset:1024
v_mfma_f32_16x16x32_bf16 v[176:179], a[192:195], v[48:51], v[176:179]
s_waitcnt lgkmcnt(6)
v_mfma_f32_16x16x32_bf16 v[176:179], a[208:211], v[52:55], v[176:179]
s_waitcnt lgkmcnt(4)
ds_read_b64_tr_b16 v[36:37], v14 offset:8192
v_mfma_f32_16x16x32_bf16 v[176:179], a[224:227], v[56:59], v[176:179]
s_waitcnt lgkmcnt(3)
buffer_load_dwordx4 a[56:59], v1, s[4:7], s54 offen offset:2048 sc1
v_mfma_f32_16x16x32_bf16 v[176:179], a[240:243], v[60:63], v[176:179]
ds_read_b64_tr_b16 v[38:39], v14 offset:9216
v_cvt_pk_bf16_f32 v18, v144, v145
v_mfma_f32_16x16x32_bf16 v[180:183], a[196:199], v[48:51], v[180:183]
v_cvt_pk_bf16_f32 v19, v146, v147
v_cvt_pk_bf16_f32 v20, v148, v149
v_mfma_f32_16x16x32_bf16 v[180:183], a[212:215], v[52:55], v[180:183]
ds_read_b64_tr_b16 v[40:41], v14 offset:16384
v_cvt_pk_bf16_f32 v21, v150, v151
v_mfma_f32_16x16x32_bf16 v[180:183], a[228:231], v[56:59], v[180:183]
s_mov_b32 s55, 525312
buffer_load_dwordx4 a[60:63], v1, s[4:7], s54 offen offset:3072 sc1
v_mfma_f32_16x16x32_bf16 v[180:183], a[244:247], v[60:63], v[180:183]
s_mov_b32 s54, 1048576
ds_read_b64_tr_b16 v[42:43], v14 offset:17408
v_mfma_f32_16x16x32_bf16 v[184:187], a[200:203], v[48:51], v[184:187]
s_add_u32 m0, s67, 65536
buffer_store_dwordx4 v[18:21], v24, s[4:7], s55 offen
v_mfma_f32_16x16x32_bf16 v[184:187], a[216:219], v[52:55], v[184:187]
ds_read_b64_tr_b16 v[44:45], v14 offset:24576
v_mfma_f32_16x16x32_bf16 v[184:187], a[232:235], v[56:59], v[184:187]
buffer_load_dwordx4 v6, s[24:27], s54 offen offset:0  lds
v_mfma_f32_16x16x32_bf16 v[184:187], a[248:251], v[60:63], v[184:187]
ds_read_b64_tr_b16 v[46:47], v14 offset:25600
v_mfma_f32_16x16x32_bf16 v[188:191], a[204:207], v[48:51], v[188:191]
v_add_u32 v14, 0x10000, v14
v_mfma_f32_16x16x32_bf16 v[188:191], a[220:223], v[52:55], v[188:191]
ds_read_b64_tr_b16 v[48:49], v15 offset:0
v_mfma_f32_16x16x32_bf16 v[188:191], a[236:239], v[56:59], v[188:191]
buffer_load_dwordx4 v7, s[24:27], s54 offen offset:1024  lds
v_mfma_f32_16x16x32_bf16 v[188:191], a[252:255], v[60:63], v[188:191]
s_waitcnt lgkmcnt(7)
ds_read_b64_tr_b16 v[50:51], v15 offset:1024
v_mfma_f32_16x16x32_bf16 v[192:195], a[192:195], v[32:35], v[192:195]
s_waitcnt lgkmcnt(6)
v_mfma_f32_16x16x32_bf16 v[192:195], a[208:211], v[36:39], v[192:195]
s_waitcnt lgkmcnt(4)
ds_read_b64_tr_b16 v[52:53], v15 offset:8192
v_mfma_f32_16x16x32_bf16 v[192:195], a[224:227], v[40:43], v[192:195]
s_waitcnt lgkmcnt(3)
buffer_load_dwordx4 v8, s[24:27], s54 offen offset:2048  lds
v_mfma_f32_16x16x32_bf16 v[192:195], a[240:243], v[44:47], v[192:195]
ds_read_b64_tr_b16 v[54:55], v15 offset:9216
v_cvt_pk_bf16_f32 v2, v136, v137
v_mfma_f32_16x16x32_bf16 v[196:199], a[196:199], v[32:35], v[196:199]
v_cvt_pk_bf16_f32 v3, v138, v139
v_cvt_pk_bf16_f32 v4, v140, v141
v_mfma_f32_16x16x32_bf16 v[196:199], a[212:215], v[36:39], v[196:199]
ds_read_b64_tr_b16 v[56:57], v15 offset:16384
v_cvt_pk_bf16_f32 v5, v142, v143
v_mfma_f32_16x16x32_bf16 v[196:199], a[228:231], v[40:43], v[196:199]
s_mov_b32 s55, 532480
buffer_load_dwordx4 v9, s[24:27], s54 offen offset:3072  lds
v_mfma_f32_16x16x32_bf16 v[196:199], a[244:247], v[44:47], v[196:199]
s_mov_b32 s54, 1572864
ds_read_b64_tr_b16 v[58:59], v15 offset:17408
v_mfma_f32_16x16x32_bf16 v[200:203], a[200:203], v[32:35], v[200:203]
s_add_u32 m0, s67, 81920
buffer_store_dwordx4 v[2:5], v24, s[4:7], s55 offen
v_mfma_f32_16x16x32_bf16 v[200:203], a[216:219], v[36:39], v[200:203]
ds_read_b64_tr_b16 v[60:61], v15 offset:24576
v_mfma_f32_16x16x32_bf16 v[200:203], a[232:235], v[40:43], v[200:203]
buffer_load_dwordx4 v6, s[24:27], s54 offen offset:0  lds
v_mfma_f32_16x16x32_bf16 v[200:203], a[248:251], v[44:47], v[200:203]
ds_read_b64_tr_b16 v[62:63], v15 offset:25600
v_mfma_f32_16x16x32_bf16 v[204:207], a[204:207], v[32:35], v[204:207]
v_add_u32 v15, 0x10000, v15
v_mfma_f32_16x16x32_bf16 v[204:207], a[220:223], v[36:39], v[204:207]
ds_read_b64_tr_b16 v[32:33], v16 offset:0
v_mfma_f32_16x16x32_bf16 v[204:207], a[236:239], v[40:43], v[204:207]
buffer_load_dwordx4 v7, s[24:27], s54 offen offset:1024  lds
v_mfma_f32_16x16x32_bf16 v[204:207], a[252:255], v[44:47], v[204:207]
s_waitcnt lgkmcnt(7)
ds_read_b64_tr_b16 v[34:35], v16 offset:1024
v_mfma_f32_16x16x32_bf16 v[208:211], a[192:195], v[48:51], v[208:211]
s_waitcnt lgkmcnt(6)
v_mfma_f32_16x16x32_bf16 v[208:211], a[208:211], v[52:55], v[208:211]
s_waitcnt lgkmcnt(4)
ds_read_b64_tr_b16 v[36:37], v16 offset:8192
v_cvt_pk_bf16_f32 v18, v152, v153
v_mfma_f32_16x16x32_bf16 v[208:211], a[224:227], v[56:59], v[208:211]
s_waitcnt lgkmcnt(3)
buffer_load_dwordx4 v8, s[24:27], s54 offen offset:2048  lds
v_mfma_f32_16x16x32_bf16 v[208:211], a[240:243], v[60:63], v[208:211]
ds_read_b64_tr_b16 v[38:39], v16 offset:9216
v_cvt_pk_bf16_f32 v19, v154, v155
v_mfma_f32_16x16x32_bf16 v[212:215], a[196:199], v[48:51], v[212:215]
v_cvt_pk_bf16_f32 v20, v156, v157
v_cvt_pk_bf16_f32 v21, v158, v159
v_mfma_f32_16x16x32_bf16 v[212:215], a[212:215], v[52:55], v[212:215]
s_mov_b32 s55, 533504
ds_read_b64_tr_b16 v[40:41], v16 offset:16384
v_mfma_f32_16x16x32_bf16 v[212:215], a[228:231], v[56:59], v[212:215]
buffer_load_dwordx4 v9, s[24:27], s54 offen offset:3072  lds
v_mfma_f32_16x16x32_bf16 v[212:215], a[244:247], v[60:63], v[212:215]
ds_read_b64_tr_b16 v[42:43], v16 offset:17408
v_mfma_f32_16x16x32_bf16 v[216:219], a[200:203], v[48:51], v[216:219]
buffer_store_dwordx4 v[18:21], v24, s[4:7], s55 offen
v_mfma_f32_16x16x32_bf16 v[216:219], a[216:219], v[52:55], v[216:219]
s_add_u32 s54, s76, 4096
ds_read_b64_tr_b16 v[44:45], v16 offset:24576
v_mfma_f32_16x16x32_bf16 v[216:219], a[232:235], v[56:59], v[216:219]
buffer_load_dwordx4 a[64:67], v1, s[4:7], s54 offen offset:0 sc1
v_mfma_f32_16x16x32_bf16 v[216:219], a[248:251], v[60:63], v[216:219]
ds_read_b64_tr_b16 v[46:47], v16 offset:25600
v_mfma_f32_16x16x32_bf16 v[220:223], a[204:207], v[48:51], v[220:223]
v_add_u32 v16, 0x10000, v16
v_mfma_f32_16x16x32_bf16 v[220:223], a[220:223], v[52:55], v[220:223]
ds_read_b64_tr_b16 v[48:49], v17 offset:0
v_mfma_f32_16x16x32_bf16 v[220:223], a[236:239], v[56:59], v[220:223]
v_mfma_f32_16x16x32_bf16 v[220:223], a[252:255], v[60:63], v[220:223]
s_waitcnt lgkmcnt(7)
ds_read_b64_tr_b16 v[50:51], v17 offset:1024
v_mfma_f32_16x16x32_bf16 v[224:227], a[192:195], v[32:35], v[224:227]
s_waitcnt lgkmcnt(6)
buffer_load_dwordx4 a[68:71], v1, s[4:7], s54 offen offset:1024 sc1
v_mfma_f32_16x16x32_bf16 v[224:227], a[208:211], v[36:39], v[224:227]
s_waitcnt lgkmcnt(4)
ds_read_b64_tr_b16 v[52:53], v17 offset:8192
v_cvt_pk_bf16_f32 v2, v160, v161
v_mfma_f32_16x16x32_bf16 v[224:227], a[224:227], v[40:43], v[224:227]
s_waitcnt lgkmcnt(3)
v_cvt_pk_bf16_f32 v3, v162, v163
v_cvt_pk_bf16_f32 v4, v164, v165
v_mfma_f32_16x16x32_bf16 v[224:227], a[240:243], v[44:47], v[224:227]
ds_read_b64_tr_b16 v[54:55], v17 offset:9216
v_cvt_pk_bf16_f32 v5, v166, v167
v_mfma_f32_16x16x32_bf16 v[228:231], a[196:199], v[32:35], v[228:231]
s_mov_b32 s55, 526336
buffer_store_dwordx4 v[2:5], v24, s[4:7], s55 offen
v_mfma_f32_16x16x32_bf16 v[228:231], a[212:215], v[36:39], v[228:231]
ds_read_b64_tr_b16 v[56:57], v17 offset:16384
v_mfma_f32_16x16x32_bf16 v[228:231], a[228:231], v[40:43], v[228:231]
buffer_load_dwordx4 a[72:75], v1, s[4:7], s54 offen offset:2048 sc1
v_mfma_f32_16x16x32_bf16 v[228:231], a[244:247], v[44:47], v[228:231]
ds_read_b64_tr_b16 v[58:59], v17 offset:17408
v_mfma_f32_16x16x32_bf16 v[232:235], a[200:203], v[32:35], v[232:235]
v_mfma_f32_16x16x32_bf16 v[232:235], a[216:219], v[36:39], v[232:235]
ds_read_b64_tr_b16 v[60:61], v17 offset:24576
v_mfma_f32_16x16x32_bf16 v[232:235], a[232:235], v[40:43], v[232:235]
v_mfma_f32_16x16x32_bf16 v[232:235], a[248:251], v[44:47], v[232:235]
ds_read_b64_tr_b16 v[62:63], v17 offset:25600
v_mfma_f32_16x16x32_bf16 v[236:239], a[204:207], v[32:35], v[236:239]
v_add_u32 v17, 0x10000, v17
v_mfma_f32_16x16x32_bf16 v[236:239], a[220:223], v[36:39], v[236:239]
buffer_load_dwordx4 a[76:79], v1, s[4:7], s54 offen offset:3072 sc1
v_mfma_f32_16x16x32_bf16 v[236:239], a[236:239], v[40:43], v[236:239]
s_add_u32 s54, s77, 4096
v_mfma_f32_16x16x32_bf16 v[236:239], a[252:255], v[44:47], v[236:239]
s_waitcnt lgkmcnt(6)
v_cvt_pk_bf16_f32 v18, v176, v177
v_cvt_pk_bf16_f32 v19, v178, v179
v_mfma_f32_16x16x32_bf16 v[240:243], a[192:195], v[48:51], v[240:243]
s_waitcnt lgkmcnt(0)
s_barrier
v_cvt_pk_bf16_f32 v20, v180, v181
v_cvt_pk_bf16_f32 v21, v182, v183
v_mfma_f32_16x16x32_bf16 v[240:243], a[208:211], v[52:55], v[240:243]
s_mov_b32 s55, 527360
ds_read_b64_tr_b16 v[32:33], v22 offset:0
v_mfma_f32_16x16x32_bf16 v[240:243], a[224:227], v[56:59], v[240:243]
ds_read_b64_tr_b16 v[34:35], v22 offset:1024
v_mfma_f32_16x16x32_bf16 v[240:243], a[240:243], v[60:63], v[240:243]
ds_read_b64_tr_b16 v[36:37], v22 offset:4096
v_mfma_f32_16x16x32_bf16 v[244:247], a[196:199], v[48:51], v[244:247]
ds_read_b64_tr_b16 v[38:39], v22 offset:5120
v_mfma_f32_16x16x32_bf16 v[244:247], a[212:215], v[52:55], v[244:247]
buffer_load_dwordx4 a[80:83], v1, s[4:7], s54 offen offset:0 sc1
v_mfma_f32_16x16x32_bf16 v[244:247], a[228:231], v[56:59], v[244:247]
ds_read_b64_tr_b16 v[40:41], v22 offset:8192
v_mfma_f32_16x16x32_bf16 v[244:247], a[244:247], v[60:63], v[244:247]
buffer_store_dwordx4 v[18:21], v24, s[4:7], s55 offen
v_mfma_f32_16x16x32_bf16 v[248:251], a[200:203], v[48:51], v[248:251]
ds_read_b64_tr_b16 v[42:43], v22 offset:9216
v_mfma_f32_16x16x32_bf16 v[248:251], a[216:219], v[52:55], v[248:251]
v_mfma_f32_16x16x32_bf16 v[248:251], a[232:235], v[56:59], v[248:251]
ds_read_b64_tr_b16 v[44:45], v22 offset:12288
v_mfma_f32_16x16x32_bf16 v[248:251], a[248:251], v[60:63], v[248:251]
buffer_load_dwordx4 a[84:87], v1, s[4:7], s54 offen offset:1024 sc1
v_mfma_f32_16x16x32_bf16 v[252:255], a[204:207], v[48:51], v[252:255]
ds_read_b64_tr_b16 v[46:47], v22 offset:13312
v_mfma_f32_16x16x32_bf16 v[252:255], a[220:223], v[52:55], v[252:255]
ds_read_b64_tr_b16 v[48:49], v23 offset:0
v_mfma_f32_16x16x32_bf16 v[252:255], a[236:239], v[56:59], v[252:255]
v_cvt_pk_bf16_f32 v2, v168, v169
v_cvt_pk_bf16_f32 v3, v170, v171
v_mfma_f32_16x16x32_bf16 v[252:255], a[252:255], v[60:63], v[252:255]
s_waitcnt vmcnt(35) lgkmcnt(7)
ds_read_b64_tr_b16 v[50:51], v23 offset:1024
v_cvt_pk_bf16_f32 v4, v172, v173
v_mfma_f32_16x16x32_bf16 v[64:67], v[32:35], a[0:3], 0
s_waitcnt vmcnt(34) lgkmcnt(6)
buffer_load_dwordx4 a[88:91], v1, s[4:7], s54 offen offset:2048 sc1
v_mfma_f32_16x16x32_bf16 v[64:67], v[36:39], a[4:7], v[64:67]
s_waitcnt vmcnt(34) lgkmcnt(4)
ds_read_b64_tr_b16 v[52:53], v23 offset:4096
v_cvt_pk_bf16_f32 v5, v174, v175
v_mfma_f32_16x16x32_bf16 v[64:67], v[40:43], a[8:11], v[64:67]
s_waitcnt vmcnt(33) lgkmcnt(3)
s_mov_b32 s55, 534528
buffer_store_dwordx4 v[2:5], v24, s[4:7], s55 offen
v_mfma_f32_16x16x32_bf16 v[64:67], v[44:47], a[12:15], v[64:67]
s_waitcnt vmcnt(33)
ds_read_b64_tr_b16 v[54:55], v23 offset:5120
v_mfma_f32_16x16x32_bf16 v[68:71], v[32:35], a[16:19], 0
s_waitcnt vmcnt(32)
v_mfma_f32_16x16x32_bf16 v[68:71], v[36:39], a[20:23], v[68:71]
s_waitcnt vmcnt(31)
ds_read_b64_tr_b16 v[56:57], v23 offset:8192
v_mfma_f32_16x16x32_bf16 v[68:71], v[40:43], a[24:27], v[68:71]
s_waitcnt vmcnt(30)
buffer_load_dwordx4 a[92:95], v1, s[4:7], s54 offen offset:3072 sc1
v_mfma_f32_16x16x32_bf16 v[68:71], v[44:47], a[28:31], v[68:71]
s_waitcnt vmcnt(30)
s_add_u32 s54, s78, 4096
ds_read_b64_tr_b16 v[58:59], v23 offset:9216
v_mfma_f32_16x16x32_bf16 v[72:75], v[32:35], a[32:35], 0
s_waitcnt vmcnt(29)
v_mfma_f32_16x16x32_bf16 v[72:75], v[36:39], a[36:39], v[72:75]
s_waitcnt vmcnt(28)
ds_read_b64_tr_b16 v[60:61], v23 offset:12288
v_mfma_f32_16x16x32_bf16 v[72:75], v[40:43], a[40:43], v[72:75]
s_waitcnt vmcnt(27)
v_mfma_f32_16x16x32_bf16 v[72:75], v[44:47], a[44:47], v[72:75]
s_waitcnt vmcnt(25)
ds_read_b64_tr_b16 v[62:63], v23 offset:13312
v_mfma_f32_16x16x32_bf16 v[76:79], v[32:35], a[48:51], 0
s_waitcnt vmcnt(24)
buffer_load_dwordx4 a[96:99], v1, s[4:7], s54 offen offset:0 sc1
v_mfma_f32_16x16x32_bf16 v[76:79], v[36:39], a[52:55], v[76:79]
s_waitcnt vmcnt(24)
ds_read_b64_tr_b16 v[32:33], v29 offset:0
v_cvt_pk_bf16_f32 v18, v184, v185
v_mfma_f32_16x16x32_bf16 v[76:79], v[40:43], a[56:59], v[76:79]
s_waitcnt vmcnt(23)
v_cvt_pk_bf16_f32 v19, v186, v187
v_cvt_pk_bf16_f32 v20, v188, v189
v_mfma_f32_16x16x32_bf16 v[76:79], v[44:47], a[60:63], v[76:79]
s_waitcnt lgkmcnt(7)
ds_read_b64_tr_b16 v[34:35], v29 offset:1024
v_cvt_pk_bf16_f32 v21, v190, v191
v_mfma_f32_16x16x32_bf16 v[80:83], v[48:51], a[0:3], 0
s_waitcnt lgkmcnt(6)
s_mov_b32 s55, 535552
buffer_store_dwordx4 v[18:21], v24, s[4:7], s55 offen
v_mfma_f32_16x16x32_bf16 v[80:83], v[52:55], a[4:7], v[80:83]
s_waitcnt lgkmcnt(4)
ds_read_b64_tr_b16 v[36:37], v29 offset:4096
v_mfma_f32_16x16x32_bf16 v[80:83], v[56:59], a[8:11], v[80:83]
s_waitcnt lgkmcnt(3)
buffer_load_dwordx4 a[100:103], v1, s[4:7], s54 offen offset:1024 sc1
v_mfma_f32_16x16x32_bf16 v[80:83], v[60:63], a[12:15], v[80:83]
ds_read_b64_tr_b16 v[38:39], v29 offset:5120
v_mfma_f32_16x16x32_bf16 v[84:87], v[48:51], a[16:19], 0
v_mfma_f32_16x16x32_bf16 v[84:87], v[52:55], a[20:23], v[84:87]
ds_read_b64_tr_b16 v[40:41], v29 offset:8192
v_mfma_f32_16x16x32_bf16 v[84:87], v[56:59], a[24:27], v[84:87]
v_mfma_f32_16x16x32_bf16 v[84:87], v[60:63], a[28:31], v[84:87]
ds_read_b64_tr_b16 v[42:43], v29 offset:9216
v_mfma_f32_16x16x32_bf16 v[88:91], v[48:51], a[32:35], 0
buffer_load_dwordx4 a[104:107], v1, s[4:7], s54 offen offset:2048 sc1
v_mfma_f32_16x16x32_bf16 v[88:91], v[52:55], a[36:39], v[88:91]
ds_read_b64_tr_b16 v[44:45], v29 offset:12288
v_mfma_f32_16x16x32_bf16 v[88:91], v[56:59], a[40:43], v[88:91]
v_mfma_f32_16x16x32_bf16 v[88:91], v[60:63], a[44:47], v[88:91]
ds_read_b64_tr_b16 v[46:47], v29 offset:13312
v_mfma_f32_16x16x32_bf16 v[92:95], v[48:51], a[48:51], 0
v_cvt_pk_bf16_f32 v2, v192, v193
v_cvt_pk_bf16_f32 v3, v194, v195
v_mfma_f32_16x16x32_bf16 v[92:95], v[52:55], a[52:55], v[92:95]
ds_read_b64_tr_b16 v[48:49], v30 offset:0
v_cvt_pk_bf16_f32 v4, v196, v197
v_mfma_f32_16x16x32_bf16 v[92:95], v[56:59], a[56:59], v[92:95]
buffer_load_dwordx4 a[108:111], v1, s[4:7], s54 offen offset:3072 sc1
v_mfma_f32_16x16x32_bf16 v[92:95], v[60:63], a[60:63], v[92:95]
s_waitcnt lgkmcnt(7)
s_add_u32 s54, s79, 4096
ds_read_b64_tr_b16 v[50:51], v30 offset:1024
v_cvt_pk_bf16_f32 v5, v198, v199
v_mfma_f32_16x16x32_bf16 v[96:99], v[32:35], a[0:3], 0
s_waitcnt lgkmcnt(6)
s_mov_b32 s55, 528384
buffer_store_dwordx4 v[2:5], v24, s[4:7], s55 offen
v_mfma_f32_16x16x32_bf16 v[96:99], v[36:39], a[4:7], v[96:99]
s_waitcnt lgkmcnt(4)
ds_read_b64_tr_b16 v[52:53], v30 offset:4096
v_mfma_f32_16x16x32_bf16 v[96:99], v[40:43], a[8:11], v[96:99]
s_waitcnt lgkmcnt(3)
v_mfma_f32_16x16x32_bf16 v[96:99], v[44:47], a[12:15], v[96:99]
ds_read_b64_tr_b16 v[54:55], v30 offset:5120
v_mfma_f32_16x16x32_bf16 v[100:103], v[32:35], a[16:19], 0
buffer_load_dwordx4 a[112:115], v1, s[4:7], s54 offen offset:0 sc1
v_mfma_f32_16x16x32_bf16 v[100:103], v[36:39], a[20:23], v[100:103]
ds_read_b64_tr_b16 v[56:57], v30 offset:8192
v_mfma_f32_16x16x32_bf16 v[100:103], v[40:43], a[24:27], v[100:103]
v_mfma_f32_16x16x32_bf16 v[100:103], v[44:47], a[28:31], v[100:103]
ds_read_b64_tr_b16 v[58:59], v30 offset:9216
v_mfma_f32_16x16x32_bf16 v[104:107], v[32:35], a[32:35], 0
v_mfma_f32_16x16x32_bf16 v[104:107], v[36:39], a[36:39], v[104:107]
ds_read_b64_tr_b16 v[60:61], v30 offset:12288
v_mfma_f32_16x16x32_bf16 v[104:107], v[40:43], a[40:43], v[104:107]
buffer_load_dwordx4 a[116:119], v1, s[4:7], s54 offen offset:1024 sc1
v_mfma_f32_16x16x32_bf16 v[104:107], v[44:47], a[44:47], v[104:107]
ds_read_b64_tr_b16 v[62:63], v30 offset:13312
v_cvt_pk_bf16_f32 v18, v208, v209
v_mfma_f32_16x16x32_bf16 v[108:111], v[32:35], a[48:51], 0
v_cvt_pk_bf16_f32 v19, v210, v211
v_cvt_pk_bf16_f32 v20, v212, v213
v_mfma_f32_16x16x32_bf16 v[108:111], v[36:39], a[52:55], v[108:111]
ds_read_b64_tr_b16 v[32:33], v10 offset:0
v_cvt_pk_bf16_f32 v21, v214, v215
v_mfma_f32_16x16x32_bf16 v[108:111], v[40:43], a[56:59], v[108:111]
s_mov_b32 s55, 529408
buffer_store_dwordx4 v[18:21], v24, s[4:7], s55 offen
v_mfma_f32_16x16x32_bf16 v[108:111], v[44:47], a[60:63], v[108:111]
s_waitcnt lgkmcnt(7)
ds_read_b64_tr_b16 v[34:35], v10 offset:1024
v_mfma_f32_16x16x32_bf16 v[112:115], v[48:51], a[0:3], 0
s_waitcnt lgkmcnt(6)
buffer_load_dwordx4 a[120:123], v1, s[4:7], s54 offen offset:2048 sc1
v_mfma_f32_16x16x32_bf16 v[112:115], v[52:55], a[4:7], v[112:115]
s_waitcnt lgkmcnt(4)
ds_read_b64_tr_b16 v[36:37], v10 offset:8192
v_mfma_f32_16x16x32_bf16 v[112:115], v[56:59], a[8:11], v[112:115]
s_waitcnt lgkmcnt(3)
v_mfma_f32_16x16x32_bf16 v[112:115], v[60:63], a[12:15], v[112:115]
ds_read_b64_tr_b16 v[38:39], v10 offset:9216
v_mfma_f32_16x16x32_bf16 v[116:119], v[48:51], a[16:19], 0
v_mfma_f32_16x16x32_bf16 v[116:119], v[52:55], a[20:23], v[116:119]
ds_read_b64_tr_b16 v[40:41], v10 offset:16384
v_mfma_f32_16x16x32_bf16 v[116:119], v[56:59], a[24:27], v[116:119]
buffer_load_dwordx4 a[124:127], v1, s[4:7], s54 offen offset:3072 sc1
v_mfma_f32_16x16x32_bf16 v[116:119], v[60:63], a[28:31], v[116:119]
ds_read_b64_tr_b16 v[42:43], v10 offset:17408
v_mfma_f32_16x16x32_bf16 v[120:123], v[48:51], a[32:35], 0
v_mfma_f32_16x16x32_bf16 v[120:123], v[52:55], a[36:39], v[120:123]
ds_read_b64_tr_b16 v[44:45], v10 offset:24576
v_mfma_f32_16x16x32_bf16 v[120:123], v[56:59], a[40:43], v[120:123]
s_mov_b32 s54, 2097152
v_cvt_pk_bf16_f32 v2, v200, v201
v_cvt_pk_bf16_f32 v3, v202, v203
v_mfma_f32_16x16x32_bf16 v[120:123], v[60:63], a[44:47], v[120:123]
s_add_u32 m0, s67, 32768
ds_read_b64_tr_b16 v[46:47], v10 offset:25600
v_cvt_pk_bf16_f32 v4, v204, v205
v_mfma_f32_16x16x32_bf16 v[124:127], v[48:51], a[48:51], 0
v_add_u32 v10, 0xffff8000, v10
v_cvt_pk_bf16_f32 v5, v206, v207
v_mfma_f32_16x16x32_bf16 v[124:127], v[52:55], a[52:55], v[124:127]
s_mov_b32 s55, 536576
ds_read_b64_tr_b16 v[48:49], v11 offset:0
v_mfma_f32_16x16x32_bf16 v[124:127], v[56:59], a[56:59], v[124:127]
buffer_store_dwordx4 v[2:5], v24, s[4:7], s55 offen
v_mfma_f32_16x16x32_bf16 v[124:127], v[60:63], a[60:63], v[124:127]
s_waitcnt lgkmcnt(7)
ds_read_b64_tr_b16 v[50:51], v11 offset:1024
v_mfma_f32_16x16x32_bf16 v[128:131], v[32:35], a[0:3], 0
s_waitcnt lgkmcnt(6)
buffer_load_dwordx4 v6, s[24:27], s54 offen offset:0  lds
v_mfma_f32_16x16x32_bf16 v[128:131], v[36:39], a[4:7], v[128:131]
s_waitcnt lgkmcnt(4)
ds_read_b64_tr_b16 v[52:53], v11 offset:8192
v_mfma_f32_16x16x32_bf16 v[128:131], v[40:43], a[8:11], v[128:131]
s_waitcnt lgkmcnt(3)
v_mfma_f32_16x16x32_bf16 v[128:131], v[44:47], a[12:15], v[128:131]
ds_read_b64_tr_b16 v[54:55], v11 offset:9216
v_mfma_f32_16x16x32_bf16 v[132:135], v[32:35], a[16:19], 0
v_mfma_f32_16x16x32_bf16 v[132:135], v[36:39], a[20:23], v[132:135]
ds_read_b64_tr_b16 v[56:57], v11 offset:16384
v_mfma_f32_16x16x32_bf16 v[132:135], v[40:43], a[24:27], v[132:135]
buffer_load_dwordx4 v7, s[24:27], s54 offen offset:1024  lds
v_mfma_f32_16x16x32_bf16 v[132:135], v[44:47], a[28:31], v[132:135]
ds_read_b64_tr_b16 v[58:59], v11 offset:17408
v_mfma_f32_16x16x32_bf16 v[136:139], v[32:35], a[32:35], 0
v_mfma_f32_16x16x32_bf16 v[136:139], v[36:39], a[36:39], v[136:139]
ds_read_b64_tr_b16 v[60:61], v11 offset:24576
v_cvt_pk_bf16_f32 v18, v216, v217
v_mfma_f32_16x16x32_bf16 v[136:139], v[40:43], a[40:43], v[136:139]
v_cvt_pk_bf16_f32 v19, v218, v219
v_cvt_pk_bf16_f32 v20, v220, v221
v_mfma_f32_16x16x32_bf16 v[136:139], v[44:47], a[44:47], v[136:139]
ds_read_b64_tr_b16 v[62:63], v11 offset:25600
v_cvt_pk_bf16_f32 v21, v222, v223
v_mfma_f32_16x16x32_bf16 v[140:143], v[32:35], a[48:51], 0
s_mov_b32 s55, 537600
v_add_u32 v11, 0xffff8000, v11
v_mfma_f32_16x16x32_bf16 v[140:143], v[36:39], a[52:55], v[140:143]
ds_read_b64_tr_b16 v[32:33], v12 offset:0
v_mfma_f32_16x16x32_bf16 v[140:143], v[40:43], a[56:59], v[140:143]
buffer_store_dwordx4 v[18:21], v24, s[4:7], s55 offen
v_mfma_f32_16x16x32_bf16 v[140:143], v[44:47], a[60:63], v[140:143]
s_waitcnt lgkmcnt(7)
ds_read_b64_tr_b16 v[34:35], v12 offset:1024
v_mfma_f32_16x16x32_bf16 v[144:147], v[48:51], a[0:3], 0
s_waitcnt lgkmcnt(6)
buffer_load_dwordx4 v8, s[24:27], s54 offen offset:2048  lds
v_mfma_f32_16x16x32_bf16 v[144:147], v[52:55], a[4:7], v[144:147]
s_waitcnt lgkmcnt(4)
ds_read_b64_tr_b16 v[36:37], v12 offset:8192
v_mfma_f32_16x16x32_bf16 v[144:147], v[56:59], a[8:11], v[144:147]
s_waitcnt lgkmcnt(3)
v_mfma_f32_16x16x32_bf16 v[144:147], v[60:63], a[12:15], v[144:147]
ds_read_b64_tr_b16 v[38:39], v12 offset:9216
v_mfma_f32_16x16x32_bf16 v[148:151], v[48:51], a[16:19], 0
v_mfma_f32_16x16x32_bf16 v[148:151], v[52:55], a[20:23], v[148:151]
ds_read_b64_tr_b16 v[40:41], v12 offset:16384
v_mfma_f32_16x16x32_bf16 v[148:151], v[56:59], a[24:27], v[148:151]
buffer_load_dwordx4 v9, s[24:27], s54 offen offset:3072  lds
v_mfma_f32_16x16x32_bf16 v[148:151], v[60:63], a[28:31], v[148:151]
s_mov_b32 s54, 2621440
ds_read_b64_tr_b16 v[42:43], v12 offset:17408
v_mfma_f32_16x16x32_bf16 v[152:155], v[48:51], a[32:35], 0
s_add_u32 m0, s67, 49152
v_cvt_pk_bf16_f32 v2, v224, v225
v_cvt_pk_bf16_f32 v3, v226, v227
v_mfma_f32_16x16x32_bf16 v[152:155], v[52:55], a[36:39], v[152:155]
ds_read_b64_tr_b16 v[44:45], v12 offset:24576
v_cvt_pk_bf16_f32 v4, v228, v229
v_mfma_f32_16x16x32_bf16 v[152:155], v[56:59], a[40:43], v[152:155]
v_cvt_pk_bf16_f32 v5, v230, v231
v_mfma_f32_16x16x32_bf16 v[152:155], v[60:63], a[44:47], v[152:155]
s_mov_b32 s55, 530432
ds_read_b64_tr_b16 v[46:47], v12 offset:25600
v_mfma_f32_16x16x32_bf16 v[156:159], v[48:51], a[48:51], 0
v_add_u32 v12, 0xffff8000, v12
v_mfma_f32_16x16x32_bf16 v[156:159], v[52:55], a[52:55], v[156:159]
ds_read_b64_tr_b16 v[48:49], v13 offset:0
v_mfma_f32_16x16x32_bf16 v[156:159], v[56:59], a[56:59], v[156:159]
buffer_store_dwordx4 v[2:5], v24, s[4:7], s55 offen
v_mfma_f32_16x16x32_bf16 v[156:159], v[60:63], a[60:63], v[156:159]
s_waitcnt lgkmcnt(7)
ds_read_b64_tr_b16 v[50:51], v13 offset:1024
v_mfma_f32_16x16x32_bf16 v[160:163], v[32:35], a[0:3], 0
s_waitcnt lgkmcnt(6)
buffer_load_dwordx4 v6, s[24:27], s54 offen offset:0  lds
v_mfma_f32_16x16x32_bf16 v[160:163], v[36:39], a[4:7], v[160:163]
s_waitcnt lgkmcnt(4)
ds_read_b64_tr_b16 v[52:53], v13 offset:8192
v_mfma_f32_16x16x32_bf16 v[160:163], v[40:43], a[8:11], v[160:163]
s_waitcnt lgkmcnt(3)
v_mfma_f32_16x16x32_bf16 v[160:163], v[44:47], a[12:15], v[160:163]
ds_read_b64_tr_b16 v[54:55], v13 offset:9216
v_mfma_f32_16x16x32_bf16 v[164:167], v[32:35], a[16:19], 0
v_mfma_f32_16x16x32_bf16 v[164:167], v[36:39], a[20:23], v[164:167]
ds_read_b64_tr_b16 v[56:57], v13 offset:16384
v_mfma_f32_16x16x32_bf16 v[164:167], v[40:43], a[24:27], v[164:167]
buffer_load_dwordx4 v7, s[24:27], s54 offen offset:1024  lds
v_mfma_f32_16x16x32_bf16 v[164:167], v[44:47], a[28:31], v[164:167]
ds_read_b64_tr_b16 v[58:59], v13 offset:17408
v_cvt_pk_bf16_f32 v18, v240, v241
v_mfma_f32_16x16x32_bf16 v[168:171], v[32:35], a[32:35], 0
v_cvt_pk_bf16_f32 v19, v242, v243
v_cvt_pk_bf16_f32 v20, v244, v245
v_mfma_f32_16x16x32_bf16 v[168:171], v[36:39], a[36:39], v[168:171]
ds_read_b64_tr_b16 v[60:61], v13 offset:24576
v_cvt_pk_bf16_f32 v21, v246, v247
v_mfma_f32_16x16x32_bf16 v[168:171], v[40:43], a[40:43], v[168:171]
s_mov_b32 s55, 531456
buffer_store_dwordx4 v[18:21], v24, s[4:7], s55 offen
v_mfma_f32_16x16x32_bf16 v[168:171], v[44:47], a[44:47], v[168:171]
ds_read_b64_tr_b16 v[62:63], v13 offset:25600
v_mfma_f32_16x16x32_bf16 v[172:175], v[32:35], a[48:51], 0
v_add_u32 v13, 0xffff8000, v13
v_mfma_f32_16x16x32_bf16 v[172:175], v[36:39], a[52:55], v[172:175]
ds_read_b64_tr_b16 v[32:33], v14 offset:0
v_mfma_f32_16x16x32_bf16 v[172:175], v[40:43], a[56:59], v[172:175]
buffer_load_dwordx4 v8, s[24:27], s54 offen offset:2048  lds
v_mfma_f32_16x16x32_bf16 v[172:175], v[44:47], a[60:63], v[172:175]
s_waitcnt lgkmcnt(7)
ds_read_b64_tr_b16 v[34:35], v14 offset:1024
v_mfma_f32_16x16x32_bf16 v[176:179], v[48:51], a[0:3], 0
s_waitcnt lgkmcnt(6)
v_mfma_f32_16x16x32_bf16 v[176:179], v[52:55], a[4:7], v[176:179]
s_waitcnt lgkmcnt(4)
ds_read_b64_tr_b16 v[36:37], v14 offset:8192
v_mfma_f32_16x16x32_bf16 v[176:179], v[56:59], a[8:11], v[176:179]
s_waitcnt lgkmcnt(3)
v_mfma_f32_16x16x32_bf16 v[176:179], v[60:63], a[12:15], v[176:179]
ds_read_b64_tr_b16 v[38:39], v14 offset:9216
v_mfma_f32_16x16x32_bf16 v[180:183], v[48:51], a[16:19], 0
buffer_load_dwordx4 v9, s[24:27], s54 offen offset:3072  lds
v_mfma_f32_16x16x32_bf16 v[180:183], v[52:55], a[20:23], v[180:183]
s_mov_b32 s54, 884736
ds_read_b64_tr_b16 v[40:41], v14 offset:16384
v_mfma_f32_16x16x32_bf16 v[180:183], v[56:59], a[24:27], v[180:183]
s_add_u32 m0, s67, 131072
v_cvt_pk_bf16_f32 v2, v232, v233
v_cvt_pk_bf16_f32 v3, v234, v235
v_mfma_f32_16x16x32_bf16 v[180:183], v[60:63], a[28:31], v[180:183]
ds_read_b64_tr_b16 v[42:43], v14 offset:17408
v_cvt_pk_bf16_f32 v4, v236, v237
v_mfma_f32_16x16x32_bf16 v[184:187], v[48:51], a[32:35], 0
v_cvt_pk_bf16_f32 v5, v238, v239
v_mfma_f32_16x16x32_bf16 v[184:187], v[52:55], a[36:39], v[184:187]
s_mov_b32 s55, 538624
ds_read_b64_tr_b16 v[44:45], v14 offset:24576
v_mfma_f32_16x16x32_bf16 v[184:187], v[56:59], a[40:43], v[184:187]
buffer_store_dwordx4 v[2:5], v24, s[4:7], s55 offen
v_mfma_f32_16x16x32_bf16 v[184:187], v[60:63], a[44:47], v[184:187]
ds_read_b64_tr_b16 v[46:47], v14 offset:25600
v_mfma_f32_16x16x32_bf16 v[188:191], v[48:51], a[48:51], 0
v_add_u32 v14, 0xffff8000, v14
v_mfma_f32_16x16x32_bf16 v[188:191], v[52:55], a[52:55], v[188:191]
ds_read_b64_tr_b16 v[48:49], v15 offset:0
v_mfma_f32_16x16x32_bf16 v[188:191], v[56:59], a[56:59], v[188:191]
buffer_load_dwordx4 v25, s[28:31], s54 offen offset:0  lds
v_mfma_f32_16x16x32_bf16 v[188:191], v[60:63], a[60:63], v[188:191]
s_waitcnt lgkmcnt(7)
ds_read_b64_tr_b16 v[50:51], v15 offset:1024
v_mfma_f32_16x16x32_bf16 v[192:195], v[32:35], a[0:3], 0
s_waitcnt lgkmcnt(6)
v_mfma_f32_16x16x32_bf16 v[192:195], v[36:39], a[4:7], v[192:195]
s_waitcnt lgkmcnt(4)
ds_read_b64_tr_b16 v[52:53], v15 offset:8192
v_mfma_f32_16x16x32_bf16 v[192:195], v[40:43], a[8:11], v[192:195]
s_waitcnt lgkmcnt(3)
v_mfma_f32_16x16x32_bf16 v[192:195], v[44:47], a[12:15], v[192:195]
ds_read_b64_tr_b16 v[54:55], v15 offset:9216
v_mfma_f32_16x16x32_bf16 v[196:199], v[32:35], a[16:19], 0
buffer_load_dwordx4 v26, s[28:31], s54 offen offset:1024  lds
v_mfma_f32_16x16x32_bf16 v[196:199], v[36:39], a[20:23], v[196:199]
ds_read_b64_tr_b16 v[56:57], v15 offset:16384
v_cvt_pk_bf16_f32 v18, v248, v249
v_mfma_f32_16x16x32_bf16 v[196:199], v[40:43], a[24:27], v[196:199]
v_cvt_pk_bf16_f32 v19, v250, v251
v_cvt_pk_bf16_f32 v20, v252, v253
v_mfma_f32_16x16x32_bf16 v[196:199], v[44:47], a[28:31], v[196:199]
ds_read_b64_tr_b16 v[58:59], v15 offset:17408
v_cvt_pk_bf16_f32 v21, v254, v255
v_mfma_f32_16x16x32_bf16 v[200:203], v[32:35], a[32:35], 0
s_mov_b32 s55, 539648
buffer_store_dwordx4 v[18:21], v24, s[4:7], s55 offen
v_mfma_f32_16x16x32_bf16 v[200:203], v[36:39], a[36:39], v[200:203]
ds_read_b64_tr_b16 v[60:61], v15 offset:24576
v_mfma_f32_16x16x32_bf16 v[200:203], v[40:43], a[40:43], v[200:203]
buffer_load_dwordx4 v27, s[28:31], s54 offen offset:2048  lds
v_mfma_f32_16x16x32_bf16 v[200:203], v[44:47], a[44:47], v[200:203]
ds_read_b64_tr_b16 v[62:63], v15 offset:25600
v_mfma_f32_16x16x32_bf16 v[204:207], v[32:35], a[48:51], 0
v_add_u32 v15, 0xffff8000, v15
v_mfma_f32_16x16x32_bf16 v[204:207], v[36:39], a[52:55], v[204:207]
ds_read_b64_tr_b16 v[32:33], v16 offset:0
v_mfma_f32_16x16x32_bf16 v[204:207], v[40:43], a[56:59], v[204:207]
v_mfma_f32_16x16x32_bf16 v[204:207], v[44:47], a[60:63], v[204:207]
s_waitcnt lgkmcnt(7)
ds_read_b64_tr_b16 v[34:35], v16 offset:1024
v_mfma_f32_16x16x32_bf16 v[208:211], v[48:51], a[0:3], 0
s_waitcnt lgkmcnt(6)
buffer_load_dwordx4 v28, s[28:31], s54 offen offset:3072  lds
v_mfma_f32_16x16x32_bf16 v[208:211], v[52:55], a[4:7], v[208:211]
s_waitcnt lgkmcnt(4)
s_mov_b32 s54, 1327104
ds_read_b64_tr_b16 v[36:37], v16 offset:8192
v_mfma_f32_16x16x32_bf16 v[208:211], v[56:59], a[8:11], v[208:211]
s_waitcnt lgkmcnt(3)
s_add_u32 m0, s67, 147456
v_mfma_f32_16x16x32_bf16 v[208:211], v[60:63], a[12:15], v[208:211]
ds_read_b64_tr_b16 v[38:39], v16 offset:9216
v_mfma_f32_16x16x32_bf16 v[212:215], v[48:51], a[16:19], 0
v_mfma_f32_16x16x32_bf16 v[212:215], v[52:55], a[20:23], v[212:215]
ds_read_b64_tr_b16 v[40:41], v16 offset:16384
v_mfma_f32_16x16x32_bf16 v[212:215], v[56:59], a[24:27], v[212:215]
buffer_load_dwordx4 v25, s[28:31], s54 offen offset:0  lds
v_mfma_f32_16x16x32_bf16 v[212:215], v[60:63], a[28:31], v[212:215]
ds_read_b64_tr_b16 v[42:43], v16 offset:17408
v_mfma_f32_16x16x32_bf16 v[216:219], v[48:51], a[32:35], 0
v_mfma_f32_16x16x32_bf16 v[216:219], v[52:55], a[36:39], v[216:219]
ds_read_b64_tr_b16 v[44:45], v16 offset:24576
v_mfma_f32_16x16x32_bf16 v[216:219], v[56:59], a[40:43], v[216:219]
v_mfma_f32_16x16x32_bf16 v[216:219], v[60:63], a[44:47], v[216:219]
ds_read_b64_tr_b16 v[46:47], v16 offset:25600
v_mfma_f32_16x16x32_bf16 v[220:223], v[48:51], a[48:51], 0
v_add_u32 v16, 0xffff8000, v16
v_mfma_f32_16x16x32_bf16 v[220:223], v[52:55], a[52:55], v[220:223]
ds_read_b64_tr_b16 v[48:49], v17 offset:0
v_mfma_f32_16x16x32_bf16 v[220:223], v[56:59], a[56:59], v[220:223]
buffer_load_dwordx4 v26, s[28:31], s54 offen offset:1024  lds
v_mfma_f32_16x16x32_bf16 v[220:223], v[60:63], a[60:63], v[220:223]
s_waitcnt lgkmcnt(7)
ds_read_b64_tr_b16 v[50:51], v17 offset:1024
v_mfma_f32_16x16x32_bf16 v[224:227], v[32:35], a[0:3], 0
s_waitcnt lgkmcnt(6)
v_mfma_f32_16x16x32_bf16 v[224:227], v[36:39], a[4:7], v[224:227]
s_waitcnt lgkmcnt(4)
ds_read_b64_tr_b16 v[52:53], v17 offset:8192
v_mfma_f32_16x16x32_bf16 v[224:227], v[40:43], a[8:11], v[224:227]
s_waitcnt lgkmcnt(3)
v_mfma_f32_16x16x32_bf16 v[224:227], v[44:47], a[12:15], v[224:227]
ds_read_b64_tr_b16 v[54:55], v17 offset:9216
v_mfma_f32_16x16x32_bf16 v[228:231], v[32:35], a[16:19], 0
buffer_load_dwordx4 v27, s[28:31], s54 offen offset:2048  lds
v_mfma_f32_16x16x32_bf16 v[228:231], v[36:39], a[20:23], v[228:231]
ds_read_b64_tr_b16 v[56:57], v17 offset:16384
v_mfma_f32_16x16x32_bf16 v[228:231], v[40:43], a[24:27], v[228:231]
v_mfma_f32_16x16x32_bf16 v[228:231], v[44:47], a[28:31], v[228:231]
ds_read_b64_tr_b16 v[58:59], v17 offset:17408
v_mfma_f32_16x16x32_bf16 v[232:235], v[32:35], a[32:35], 0
v_mfma_f32_16x16x32_bf16 v[232:235], v[36:39], a[36:39], v[232:235]
ds_read_b64_tr_b16 v[60:61], v17 offset:24576
v_mfma_f32_16x16x32_bf16 v[232:235], v[40:43], a[40:43], v[232:235]
buffer_load_dwordx4 v28, s[28:31], s54 offen offset:3072  lds
v_mfma_f32_16x16x32_bf16 v[232:235], v[44:47], a[44:47], v[232:235]
ds_read_b64_tr_b16 v[62:63], v17 offset:25600
v_mfma_f32_16x16x32_bf16 v[236:239], v[32:35], a[48:51], 0
v_add_u32 v17, 0xffff8000, v17
v_mfma_f32_16x16x32_bf16 v[236:239], v[36:39], a[52:55], v[236:239]
v_mfma_f32_16x16x32_bf16 v[236:239], v[40:43], a[56:59], v[236:239]
s_add_u32 s54, s76, 8192
buffer_load_dwordx4 a[128:131], v1, s[4:7], s54 offen offset:0 sc1
v_mfma_f32_16x16x32_bf16 v[236:239], v[44:47], a[60:63], v[236:239]
s_waitcnt lgkmcnt(6)
v_mfma_f32_16x16x32_bf16 v[240:243], v[48:51], a[0:3], 0
s_waitcnt vmcnt(46)
s_waitcnt lgkmcnt(0)
s_barrier
v_mfma_f32_16x16x32_bf16 v[240:243], v[52:55], a[4:7], v[240:243]
ds_read_b64_tr_b16 v[32:33], v22 offset:16384
v_mfma_f32_16x16x32_bf16 v[240:243], v[56:59], a[8:11], v[240:243]
ds_read_b64_tr_b16 v[34:35], v22 offset:17408
v_mfma_f32_16x16x32_bf16 v[240:243], v[60:63], a[12:15], v[240:243]
ds_read_b64_tr_b16 v[36:37], v22 offset:20480
v_mfma_f32_16x16x32_bf16 v[244:247], v[48:51], a[16:19], 0
ds_read_b64_tr_b16 v[38:39], v22 offset:21504
v_mfma_f32_16x16x32_bf16 v[244:247], v[52:55], a[20:23], v[244:247]
buffer_load_dwordx4 a[132:135], v1, s[4:7], s54 offen offset:1024 sc1
v_mfma_f32_16x16x32_bf16 v[244:247], v[56:59], a[24:27], v[244:247]
ds_read_b64_tr_b16 v[40:41], v22 offset:24576
v_mfma_f32_16x16x32_bf16 v[244:247], v[60:63], a[28:31], v[244:247]
v_mfma_f32_16x16x32_bf16 v[248:251], v[48:51], a[32:35], 0
ds_read_b64_tr_b16 v[42:43], v22 offset:25600
v_mfma_f32_16x16x32_bf16 v[248:251], v[52:55], a[36:39], v[248:251]
v_mfma_f32_16x16x32_bf16 v[248:251], v[56:59], a[40:43], v[248:251]
ds_read_b64_tr_b16 v[44:45], v22 offset:28672
v_mfma_f32_16x16x32_bf16 v[248:251], v[60:63], a[44:47], v[248:251]
buffer_load_dwordx4 a[136:139], v1, s[4:7], s54 offen offset:2048 sc1
v_mfma_f32_16x16x32_bf16 v[252:255], v[48:51], a[48:51], 0
ds_read_b64_tr_b16 v[46:47], v22 offset:29696
v_mfma_f32_16x16x32_bf16 v[252:255], v[52:55], a[52:55], v[252:255]
ds_read_b64_tr_b16 v[48:49], v23 offset:16384
v_add_u32 v22, 0x20000, v22
v_mfma_f32_16x16x32_bf16 v[252:255], v[56:59], a[56:59], v[252:255]
v_mfma_f32_16x16x32_bf16 v[252:255], v[60:63], a[60:63], v[252:255]
s_waitcnt vmcnt(46) lgkmcnt(7)
ds_read_b64_tr_b16 v[50:51], v23 offset:17408
v_mfma_f32_16x16x32_bf16 v[64:67], v[32:35], a[64:67], v[64:67]
s_waitcnt vmcnt(45) lgkmcnt(6)
s_lshl_b32 s66, s66, 11
buffer_load_dwordx4 a[140:143], v1, s[4:7], s54 offen offset:3072 sc1
v_mfma_f32_16x16x32_bf16 v[64:67], v[36:39], a[68:71], v[64:67]
s_waitcnt vmcnt(44) lgkmcnt(4)
s_add_u32 s54, s77, 8192
ds_read_b64_tr_b16 v[52:53], v23 offset:20480
v_mfma_f32_16x16x32_bf16 v[64:67], v[40:43], a[72:75], v[64:67]
s_waitcnt vmcnt(43) lgkmcnt(3)
s_add_u32 s66, s66, 131072
v_mfma_f32_16x16x32_bf16 v[64:67], v[44:47], a[76:79], v[64:67]
s_waitcnt vmcnt(42)
ds_read_b64_tr_b16 v[54:55], v23 offset:21504
v_mfma_f32_16x16x32_bf16 v[68:71], v[32:35], a[80:83], v[68:71]
s_waitcnt vmcnt(40)
v_mfma_f32_16x16x32_bf16 v[68:71], v[36:39], a[84:87], v[68:71]
s_waitcnt vmcnt(39)
ds_read_b64_tr_b16 v[56:57], v23 offset:24576
v_mfma_f32_16x16x32_bf16 v[68:71], v[40:43], a[88:91], v[68:71]
s_waitcnt vmcnt(37)
buffer_load_dwordx4 a[144:147], v1, s[4:7], s54 offen offset:0 sc1
v_mfma_f32_16x16x32_bf16 v[68:71], v[44:47], a[92:95], v[68:71]
s_waitcnt vmcnt(37)
ds_read_b64_tr_b16 v[58:59], v23 offset:25600
v_mfma_f32_16x16x32_bf16 v[72:75], v[32:35], a[96:99], v[72:75]
s_waitcnt vmcnt(35)
v_lshrrev_b32 v2, 6, v1
v_and_b32 v2, 12, v2
v_mfma_f32_16x16x32_bf16 v[72:75], v[36:39], a[100:103], v[72:75]
s_waitcnt vmcnt(34)
ds_read_b64_tr_b16 v[60:61], v23 offset:28672
v_bfe_u32 v3, v1, 4, 4
v_mfma_f32_16x16x32_bf16 v[72:75], v[40:43], a[104:107], v[72:75]
s_waitcnt vmcnt(33)
v_add_u32 v4, 0, v2
v_cmp_gt_u32 s[68:69], v4, v3
v_mfma_f32_16x16x32_bf16 v[72:75], v[44:47], a[108:111], v[72:75]
s_waitcnt vmcnt(31)
ds_read_b64_tr_b16 v[62:63], v23 offset:29696
v_add_u32 v4, 1, v2
v_mfma_f32_16x16x32_bf16 v[76:79], v[32:35], a[112:115], v[76:79]
s_waitcnt vmcnt(30)
v_add_u32 v23, 0x20000, v23
v_cmp_gt_u32 s[70:71], v4, v3
v_mfma_f32_16x16x32_bf16 v[76:79], v[36:39], a[116:119], v[76:79]
s_waitcnt vmcnt(28)
ds_read_b64_tr_b16 v[32:33], v29 offset:16384
v_add_u32 v4, 2, v2
v_mfma_f32_16x16x32_bf16 v[76:79], v[40:43], a[120:123], v[76:79]
s_waitcnt vmcnt(27)
buffer_load_dwordx4 a[148:151], v1, s[4:7], s54 offen offset:1024 sc1
v_mfma_f32_16x16x32_bf16 v[76:79], v[44:47], a[124:127], v[76:79]
s_waitcnt lgkmcnt(7)
ds_read_b64_tr_b16 v[34:35], v29 offset:17408
v_cmp_gt_u32 s[72:73], v4, v3
v_mfma_f32_16x16x32_bf16 v[80:83], v[48:51], a[64:67], v[80:83]
s_waitcnt lgkmcnt(6)
v_add_u32 v4, 3, v2
v_cmp_gt_u32 s[74:75], v4, v3
v_mfma_f32_16x16x32_bf16 v[80:83], v[52:55], a[68:71], v[80:83]
s_waitcnt lgkmcnt(4)
ds_read_b64_tr_b16 v[36:37], v29 offset:20480
v_mfma_f32_16x16x32_bf16 v[80:83], v[56:59], a[72:75], v[80:83]
s_waitcnt lgkmcnt(3)
v_mfma_f32_16x16x32_bf16 v[80:83], v[60:63], a[76:79], v[80:83]
ds_read_b64_tr_b16 v[38:39], v29 offset:21504
v_mfma_f32_16x16x32_bf16 v[84:87], v[48:51], a[80:83], v[84:87]
buffer_load_dwordx4 a[152:155], v1, s[4:7], s54 offen offset:2048 sc1
v_mfma_f32_16x16x32_bf16 v[84:87], v[52:55], a[84:87], v[84:87]
ds_read_b64_tr_b16 v[40:41], v29 offset:24576
v_mfma_f32_16x16x32_bf16 v[84:87], v[56:59], a[88:91], v[84:87]
v_mfma_f32_16x16x32_bf16 v[84:87], v[60:63], a[92:95], v[84:87]
ds_read_b64_tr_b16 v[42:43], v29 offset:25600
v_mfma_f32_16x16x32_bf16 v[88:91], v[48:51], a[96:99], v[88:91]
v_mfma_f32_16x16x32_bf16 v[88:91], v[52:55], a[100:103], v[88:91]
ds_read_b64_tr_b16 v[44:45], v29 offset:28672
v_mfma_f32_16x16x32_bf16 v[88:91], v[56:59], a[104:107], v[88:91]
buffer_load_dwordx4 a[156:159], v1, s[4:7], s54 offen offset:3072 sc1
v_mfma_f32_16x16x32_bf16 v[88:91], v[60:63], a[108:111], v[88:91]
s_add_u32 s54, s78, 8192
ds_read_b64_tr_b16 v[46:47], v29 offset:29696
v_mfma_f32_16x16x32_bf16 v[92:95], v[48:51], a[112:115], v[92:95]
v_add_u32 v29, 0x20000, v29
v_mfma_f32_16x16x32_bf16 v[92:95], v[52:55], a[116:119], v[92:95]
ds_read_b64_tr_b16 v[48:49], v30 offset:16384
v_mfma_f32_16x16x32_bf16 v[92:95], v[56:59], a[120:123], v[92:95]
v_mfma_f32_16x16x32_bf16 v[92:95], v[60:63], a[124:127], v[92:95]
s_waitcnt lgkmcnt(7)
ds_read_b64_tr_b16 v[50:51], v30 offset:17408
v_mfma_f32_16x16x32_bf16 v[96:99], v[32:35], a[64:67], v[96:99]
s_waitcnt lgkmcnt(6)
buffer_load_dwordx4 a[160:163], v1, s[4:7], s54 offen offset:0 sc1
v_mfma_f32_16x16x32_bf16 v[96:99], v[36:39], a[68:71], v[96:99]
s_waitcnt lgkmcnt(4)
ds_read_b64_tr_b16 v[52:53], v30 offset:20480
v_mfma_f32_16x16x32_bf16 v[96:99], v[40:43], a[72:75], v[96:99]
s_waitcnt lgkmcnt(3)
v_mfma_f32_16x16x32_bf16 v[96:99], v[44:47], a[76:79], v[96:99]
ds_read_b64_tr_b16 v[54:55], v30 offset:21504
v_mfma_f32_16x16x32_bf16 v[100:103], v[32:35], a[80:83], v[100:103]
v_mfma_f32_16x16x32_bf16 v[100:103], v[36:39], a[84:87], v[100:103]
ds_read_b64_tr_b16 v[56:57], v30 offset:24576
v_mfma_f32_16x16x32_bf16 v[100:103], v[40:43], a[88:91], v[100:103]
buffer_load_dwordx4 a[164:167], v1, s[4:7], s54 offen offset:1024 sc1
v_mfma_f32_16x16x32_bf16 v[100:103], v[44:47], a[92:95], v[100:103]
ds_read_b64_tr_b16 v[58:59], v30 offset:25600
v_mfma_f32_16x16x32_bf16 v[104:107], v[32:35], a[96:99], v[104:107]
v_mfma_f32_16x16x32_bf16 v[104:107], v[36:39], a[100:103], v[104:107]
ds_read_b64_tr_b16 v[60:61], v30 offset:28672
v_mfma_f32_16x16x32_bf16 v[104:107], v[40:43], a[104:107], v[104:107]
v_mfma_f32_16x16x32_bf16 v[104:107], v[44:47], a[108:111], v[104:107]
ds_read_b64_tr_b16 v[62:63], v30 offset:29696
v_mfma_f32_16x16x32_bf16 v[108:111], v[32:35], a[112:115], v[108:111]
v_add_u32 v30, 0x20000, v30
v_mfma_f32_16x16x32_bf16 v[108:111], v[36:39], a[116:119], v[108:111]
ds_read_b64_tr_b16 v[32:33], v10 offset:0
v_mfma_f32_16x16x32_bf16 v[108:111], v[40:43], a[120:123], v[108:111]
buffer_load_dwordx4 a[168:171], v1, s[4:7], s54 offen offset:2048 sc1
v_mfma_f32_16x16x32_bf16 v[108:111], v[44:47], a[124:127], v[108:111]
s_waitcnt lgkmcnt(7)
ds_read_b64_tr_b16 v[34:35], v10 offset:1024
v_mfma_f32_16x16x32_bf16 v[112:115], v[48:51], a[64:67], v[112:115]
s_waitcnt lgkmcnt(6)
v_mfma_f32_16x16x32_bf16 v[112:115], v[52:55], a[68:71], v[112:115]
s_waitcnt lgkmcnt(4)
ds_read_b64_tr_b16 v[36:37], v10 offset:8192
v_mfma_f32_16x16x32_bf16 v[112:115], v[56:59], a[72:75], v[112:115]
s_waitcnt lgkmcnt(3)
v_mfma_f32_16x16x32_bf16 v[112:115], v[60:63], a[76:79], v[112:115]
ds_read_b64_tr_b16 v[38:39], v10 offset:9216
v_mfma_f32_16x16x32_bf16 v[116:119], v[48:51], a[80:83], v[116:119]
buffer_load_dwordx4 a[172:175], v1, s[4:7], s54 offen offset:3072 sc1
v_mfma_f32_16x16x32_bf16 v[116:119], v[52:55], a[84:87], v[116:119]
s_add_u32 s54, s79, 8192
ds_read_b64_tr_b16 v[40:41], v10 offset:16384
v_mfma_f32_16x16x32_bf16 v[116:119], v[56:59], a[88:91], v[116:119]
v_mfma_f32_16x16x32_bf16 v[116:119], v[60:63], a[92:95], v[116:119]
ds_read_b64_tr_b16 v[42:43], v10 offset:17408
v_mfma_f32_16x16x32_bf16 v[120:123], v[48:51], a[96:99], v[120:123]
v_mfma_f32_16x16x32_bf16 v[120:123], v[52:55], a[100:103], v[120:123]
ds_read_b64_tr_b16 v[44:45], v10 offset:24576
v_mfma_f32_16x16x32_bf16 v[120:123], v[56:59], a[104:107], v[120:123]
buffer_load_dwordx4 a[176:179], v1, s[4:7], s54 offen offset:0 sc1
v_mfma_f32_16x16x32_bf16 v[120:123], v[60:63], a[108:111], v[120:123]
ds_read_b64_tr_b16 v[46:47], v10 offset:25600
v_mfma_f32_16x16x32_bf16 v[124:127], v[48:51], a[112:115], v[124:127]
v_add_u32 v10, 0xffff8000, v10
v_mfma_f32_16x16x32_bf16 v[124:127], v[52:55], a[116:119], v[124:127]
ds_read_b64_tr_b16 v[48:49], v11 offset:0
v_mfma_f32_16x16x32_bf16 v[124:127], v[56:59], a[120:123], v[124:127]
v_mfma_f32_16x16x32_bf16 v[124:127], v[60:63], a[124:127], v[124:127]
s_waitcnt lgkmcnt(7)
ds_read_b64_tr_b16 v[50:51], v11 offset:1024
v_mfma_f32_16x16x32_bf16 v[128:131], v[32:35], a[64:67], v[128:131]
s_waitcnt lgkmcnt(6)
buffer_load_dwordx4 a[180:183], v1, s[4:7], s54 offen offset:1024 sc1
v_mfma_f32_16x16x32_bf16 v[128:131], v[36:39], a[68:71], v[128:131]
s_waitcnt lgkmcnt(4)
ds_read_b64_tr_b16 v[52:53], v11 offset:8192
v_mfma_f32_16x16x32_bf16 v[128:131], v[40:43], a[72:75], v[128:131]
s_waitcnt lgkmcnt(3)
v_mfma_f32_16x16x32_bf16 v[128:131], v[44:47], a[76:79], v[128:131]
ds_read_b64_tr_b16 v[54:55], v11 offset:9216
v_mfma_f32_16x16x32_bf16 v[132:135], v[32:35], a[80:83], v[132:135]
v_mfma_f32_16x16x32_bf16 v[132:135], v[36:39], a[84:87], v[132:135]
ds_read_b64_tr_b16 v[56:57], v11 offset:16384
v_mfma_f32_16x16x32_bf16 v[132:135], v[40:43], a[88:91], v[132:135]
buffer_load_dwordx4 a[184:187], v1, s[4:7], s54 offen offset:2048 sc1
v_mfma_f32_16x16x32_bf16 v[132:135], v[44:47], a[92:95], v[132:135]
ds_read_b64_tr_b16 v[58:59], v11 offset:17408
v_mfma_f32_16x16x32_bf16 v[136:139], v[32:35], a[96:99], v[136:139]
v_mfma_f32_16x16x32_bf16 v[136:139], v[36:39], a[100:103], v[136:139]
ds_read_b64_tr_b16 v[60:61], v11 offset:24576
v_mfma_f32_16x16x32_bf16 v[136:139], v[40:43], a[104:107], v[136:139]
v_mfma_f32_16x16x32_bf16 v[136:139], v[44:47], a[108:111], v[136:139]
ds_read_b64_tr_b16 v[62:63], v11 offset:25600
v_mfma_f32_16x16x32_bf16 v[140:143], v[32:35], a[112:115], v[140:143]
v_add_u32 v11, 0xffff8000, v11
v_mfma_f32_16x16x32_bf16 v[140:143], v[36:39], a[116:119], v[140:143]
ds_read_b64_tr_b16 v[32:33], v12 offset:0
v_mfma_f32_16x16x32_bf16 v[140:143], v[40:43], a[120:123], v[140:143]
buffer_load_dwordx4 a[188:191], v1, s[4:7], s54 offen offset:3072 sc1
v_mfma_f32_16x16x32_bf16 v[140:143], v[44:47], a[124:127], v[140:143]
s_waitcnt lgkmcnt(7)
ds_read_b64_tr_b16 v[34:35], v12 offset:1024
v_mfma_f32_16x16x32_bf16 v[144:147], v[48:51], a[64:67], v[144:147]
s_waitcnt lgkmcnt(6)
v_mfma_f32_16x16x32_bf16 v[144:147], v[52:55], a[68:71], v[144:147]
s_waitcnt lgkmcnt(4)
ds_read_b64_tr_b16 v[36:37], v12 offset:8192
v_mfma_f32_16x16x32_bf16 v[144:147], v[56:59], a[72:75], v[144:147]
s_waitcnt lgkmcnt(3)
s_add_u32 s54, s76, 12288
buffer_load_dwordx4 a[192:195], v1, s[4:7], s54 offen offset:0 sc1
v_mfma_f32_16x16x32_bf16 v[144:147], v[60:63], a[76:79], v[144:147]
ds_read_b64_tr_b16 v[38:39], v12 offset:9216
v_mfma_f32_16x16x32_bf16 v[148:151], v[48:51], a[80:83], v[148:151]
v_mfma_f32_16x16x32_bf16 v[148:151], v[52:55], a[84:87], v[148:151]
ds_read_b64_tr_b16 v[40:41], v12 offset:16384
v_mfma_f32_16x16x32_bf16 v[148:151], v[56:59], a[88:91], v[148:151]
v_mfma_f32_16x16x32_bf16 v[148:151], v[60:63], a[92:95], v[148:151]
ds_read_b64_tr_b16 v[42:43], v12 offset:17408
v_mfma_f32_16x16x32_bf16 v[152:155], v[48:51], a[96:99], v[152:155]
buffer_load_dwordx4 a[196:199], v1, s[4:7], s54 offen offset:1024 sc1
v_mfma_f32_16x16x32_bf16 v[152:155], v[52:55], a[100:103], v[152:155]
ds_read_b64_tr_b16 v[44:45], v12 offset:24576
v_mfma_f32_16x16x32_bf16 v[152:155], v[56:59], a[104:107], v[152:155]
v_mfma_f32_16x16x32_bf16 v[152:155], v[60:63], a[108:111], v[152:155]
ds_read_b64_tr_b16 v[46:47], v12 offset:25600
v_mfma_f32_16x16x32_bf16 v[156:159], v[48:51], a[112:115], v[156:159]
v_add_u32 v12, 0xffff8000, v12
v_mfma_f32_16x16x32_bf16 v[156:159], v[52:55], a[116:119], v[156:159]
ds_read_b64_tr_b16 v[48:49], v13 offset:0
v_mfma_f32_16x16x32_bf16 v[156:159], v[56:59], a[120:123], v[156:159]
buffer_load_dwordx4 a[200:203], v1, s[4:7], s54 offen offset:2048 sc1
v_mfma_f32_16x16x32_bf16 v[156:159], v[60:63], a[124:127], v[156:159]
s_waitcnt lgkmcnt(7)
ds_read_b64_tr_b16 v[50:51], v13 offset:1024
v_mfma_f32_16x16x32_bf16 v[160:163], v[32:35], a[64:67], v[160:163]
s_waitcnt lgkmcnt(6)
v_mfma_f32_16x16x32_bf16 v[160:163], v[36:39], a[68:71], v[160:163]
s_waitcnt lgkmcnt(4)
ds_read_b64_tr_b16 v[52:53], v13 offset:8192
v_mfma_f32_16x16x32_bf16 v[160:163], v[40:43], a[72:75], v[160:163]
s_waitcnt lgkmcnt(3)
v_mfma_f32_16x16x32_bf16 v[160:163], v[44:47], a[76:79], v[160:163]
ds_read_b64_tr_b16 v[54:55], v13 offset:9216
v_mfma_f32_16x16x32_bf16 v[164:167], v[32:35], a[80:83], v[164:167]
buffer_load_dwordx4 a[204:207], v1, s[4:7], s54 offen offset:3072 sc1
v_mfma_f32_16x16x32_bf16 v[164:167], v[36:39], a[84:87], v[164:167]
s_add_u32 s54, s77, 12288
ds_read_b64_tr_b16 v[56:57], v13 offset:16384
v_mfma_f32_16x16x32_bf16 v[164:167], v[40:43], a[88:91], v[164:167]
v_mfma_f32_16x16x32_bf16 v[164:167], v[44:47], a[92:95], v[164:167]
ds_read_b64_tr_b16 v[58:59], v13 offset:17408
v_mfma_f32_16x16x32_bf16 v[168:171], v[32:35], a[96:99], v[168:171]
v_mfma_f32_16x16x32_bf16 v[168:171], v[36:39], a[100:103], v[168:171]
ds_read_b64_tr_b16 v[60:61], v13 offset:24576
v_mfma_f32_16x16x32_bf16 v[168:171], v[40:43], a[104:107], v[168:171]
buffer_load_dwordx4 a[208:211], v1, s[4:7], s54 offen offset:0 sc1
v_mfma_f32_16x16x32_bf16 v[168:171], v[44:47], a[108:111], v[168:171]
ds_read_b64_tr_b16 v[62:63], v13 offset:25600
v_mfma_f32_16x16x32_bf16 v[172:175], v[32:35], a[112:115], v[172:175]
v_add_u32 v13, 0xffff8000, v13
v_mfma_f32_16x16x32_bf16 v[172:175], v[36:39], a[116:119], v[172:175]
ds_read_b64_tr_b16 v[32:33], v14 offset:0
v_mfma_f32_16x16x32_bf16 v[172:175], v[40:43], a[120:123], v[172:175]
v_mfma_f32_16x16x32_bf16 v[172:175], v[44:47], a[124:127], v[172:175]
s_waitcnt lgkmcnt(7)
ds_read_b64_tr_b16 v[34:35], v14 offset:1024
v_mfma_f32_16x16x32_bf16 v[176:179], v[48:51], a[64:67], v[176:179]
s_waitcnt lgkmcnt(6)
buffer_load_dwordx4 a[212:215], v1, s[4:7], s54 offen offset:1024 sc1
v_mfma_f32_16x16x32_bf16 v[176:179], v[52:55], a[68:71], v[176:179]
s_waitcnt lgkmcnt(4)
ds_read_b64_tr_b16 v[36:37], v14 offset:8192
v_mfma_f32_16x16x32_bf16 v[176:179], v[56:59], a[72:75], v[176:179]
s_waitcnt lgkmcnt(3)
v_mfma_f32_16x16x32_bf16 v[176:179], v[60:63], a[76:79], v[176:179]
ds_read_b64_tr_b16 v[38:39], v14 offset:9216
v_mfma_f32_16x16x32_bf16 v[180:183], v[48:51], a[80:83], v[180:183]
v_mfma_f32_16x16x32_bf16 v[180:183], v[52:55], a[84:87], v[180:183]
ds_read_b64_tr_b16 v[40:41], v14 offset:16384
v_mfma_f32_16x16x32_bf16 v[180:183], v[56:59], a[88:91], v[180:183]
buffer_load_dwordx4 a[216:219], v1, s[4:7], s54 offen offset:2048 sc1
v_mfma_f32_16x16x32_bf16 v[180:183], v[60:63], a[92:95], v[180:183]
ds_read_b64_tr_b16 v[42:43], v14 offset:17408
v_mfma_f32_16x16x32_bf16 v[184:187], v[48:51], a[96:99], v[184:187]
v_mfma_f32_16x16x32_bf16 v[184:187], v[52:55], a[100:103], v[184:187]
ds_read_b64_tr_b16 v[44:45], v14 offset:24576
v_mfma_f32_16x16x32_bf16 v[184:187], v[56:59], a[104:107], v[184:187]
v_mfma_f32_16x16x32_bf16 v[184:187], v[60:63], a[108:111], v[184:187]
ds_read_b64_tr_b16 v[46:47], v14 offset:25600
v_mfma_f32_16x16x32_bf16 v[188:191], v[48:51], a[112:115], v[188:191]
v_add_u32 v14, 0xffff8000, v14
v_mfma_f32_16x16x32_bf16 v[188:191], v[52:55], a[116:119], v[188:191]
ds_read_b64_tr_b16 v[48:49], v15 offset:0
v_mfma_f32_16x16x32_bf16 v[188:191], v[56:59], a[120:123], v[188:191]
buffer_load_dwordx4 a[220:223], v1, s[4:7], s54 offen offset:3072 sc1
v_mfma_f32_16x16x32_bf16 v[188:191], v[60:63], a[124:127], v[188:191]
s_waitcnt lgkmcnt(7)
s_add_u32 s54, s78, 12288
ds_read_b64_tr_b16 v[50:51], v15 offset:1024
v_mfma_f32_16x16x32_bf16 v[192:195], v[32:35], a[64:67], v[192:195]
s_waitcnt lgkmcnt(6)
v_mfma_f32_16x16x32_bf16 v[192:195], v[36:39], a[68:71], v[192:195]
s_waitcnt lgkmcnt(4)
ds_read_b64_tr_b16 v[52:53], v15 offset:8192
v_mfma_f32_16x16x32_bf16 v[192:195], v[40:43], a[72:75], v[192:195]
s_waitcnt lgkmcnt(3)
v_mfma_f32_16x16x32_bf16 v[192:195], v[44:47], a[76:79], v[192:195]
ds_read_b64_tr_b16 v[54:55], v15 offset:9216
v_mfma_f32_16x16x32_bf16 v[196:199], v[32:35], a[80:83], v[196:199]
buffer_load_dwordx4 a[224:227], v1, s[4:7], s54 offen offset:0 sc1
v_mfma_f32_16x16x32_bf16 v[196:199], v[36:39], a[84:87], v[196:199]
ds_read_b64_tr_b16 v[56:57], v15 offset:16384
v_mfma_f32_16x16x32_bf16 v[196:199], v[40:43], a[88:91], v[196:199]
v_mfma_f32_16x16x32_bf16 v[196:199], v[44:47], a[92:95], v[196:199]
ds_read_b64_tr_b16 v[58:59], v15 offset:17408
v_mfma_f32_16x16x32_bf16 v[200:203], v[32:35], a[96:99], v[200:203]
v_mfma_f32_16x16x32_bf16 v[200:203], v[36:39], a[100:103], v[200:203]
ds_read_b64_tr_b16 v[60:61], v15 offset:24576
v_mfma_f32_16x16x32_bf16 v[200:203], v[40:43], a[104:107], v[200:203]
buffer_load_dwordx4 a[228:231], v1, s[4:7], s54 offen offset:1024 sc1
v_mfma_f32_16x16x32_bf16 v[200:203], v[44:47], a[108:111], v[200:203]
ds_read_b64_tr_b16 v[62:63], v15 offset:25600
v_mfma_f32_16x16x32_bf16 v[204:207], v[32:35], a[112:115], v[204:207]
v_add_u32 v15, 0xffff8000, v15
v_mfma_f32_16x16x32_bf16 v[204:207], v[36:39], a[116:119], v[204:207]
ds_read_b64_tr_b16 v[32:33], v16 offset:0
v_mfma_f32_16x16x32_bf16 v[204:207], v[40:43], a[120:123], v[204:207]
v_mfma_f32_16x16x32_bf16 v[204:207], v[44:47], a[124:127], v[204:207]
s_waitcnt lgkmcnt(7)
ds_read_b64_tr_b16 v[34:35], v16 offset:1024
v_mfma_f32_16x16x32_bf16 v[208:211], v[48:51], a[64:67], v[208:211]
s_waitcnt lgkmcnt(6)
buffer_load_dwordx4 a[232:235], v1, s[4:7], s54 offen offset:2048 sc1
v_mfma_f32_16x16x32_bf16 v[208:211], v[52:55], a[68:71], v[208:211]
s_waitcnt lgkmcnt(4)
ds_read_b64_tr_b16 v[36:37], v16 offset:8192
v_mfma_f32_16x16x32_bf16 v[208:211], v[56:59], a[72:75], v[208:211]
s_waitcnt lgkmcnt(3)
v_mfma_f32_16x16x32_bf16 v[208:211], v[60:63], a[76:79], v[208:211]
ds_read_b64_tr_b16 v[38:39], v16 offset:9216
v_mfma_f32_16x16x32_bf16 v[212:215], v[48:51], a[80:83], v[212:215]
v_mfma_f32_16x16x32_bf16 v[212:215], v[52:55], a[84:87], v[212:215]
ds_read_b64_tr_b16 v[40:41], v16 offset:16384
v_mfma_f32_16x16x32_bf16 v[212:215], v[56:59], a[88:91], v[212:215]
buffer_load_dwordx4 a[236:239], v1, s[4:7], s54 offen offset:3072 sc1
v_mfma_f32_16x16x32_bf16 v[212:215], v[60:63], a[92:95], v[212:215]
s_add_u32 s54, s79, 12288
ds_read_b64_tr_b16 v[42:43], v16 offset:17408
v_mfma_f32_16x16x32_bf16 v[216:219], v[48:51], a[96:99], v[216:219]
v_mfma_f32_16x16x32_bf16 v[216:219], v[52:55], a[100:103], v[216:219]
ds_read_b64_tr_b16 v[44:45], v16 offset:24576
v_mfma_f32_16x16x32_bf16 v[216:219], v[56:59], a[104:107], v[216:219]
v_mfma_f32_16x16x32_bf16 v[216:219], v[60:63], a[108:111], v[216:219]
ds_read_b64_tr_b16 v[46:47], v16 offset:25600
v_mfma_f32_16x16x32_bf16 v[220:223], v[48:51], a[112:115], v[220:223]
v_add_u32 v16, 0xffff8000, v16
v_mfma_f32_16x16x32_bf16 v[220:223], v[52:55], a[116:119], v[220:223]
ds_read_b64_tr_b16 v[48:49], v17 offset:0
v_mfma_f32_16x16x32_bf16 v[220:223], v[56:59], a[120:123], v[220:223]
buffer_load_dwordx4 a[240:243], v1, s[4:7], s54 offen offset:0 sc1
v_mfma_f32_16x16x32_bf16 v[220:223], v[60:63], a[124:127], v[220:223]
s_waitcnt lgkmcnt(7)
ds_read_b64_tr_b16 v[50:51], v17 offset:1024
v_mfma_f32_16x16x32_bf16 v[224:227], v[32:35], a[64:67], v[224:227]
s_waitcnt lgkmcnt(6)
v_mfma_f32_16x16x32_bf16 v[224:227], v[36:39], a[68:71], v[224:227]
s_waitcnt lgkmcnt(4)
ds_read_b64_tr_b16 v[52:53], v17 offset:8192
v_mfma_f32_16x16x32_bf16 v[224:227], v[40:43], a[72:75], v[224:227]
s_waitcnt lgkmcnt(3)
v_mfma_f32_16x16x32_bf16 v[224:227], v[44:47], a[76:79], v[224:227]
ds_read_b64_tr_b16 v[54:55], v17 offset:9216
v_mfma_f32_16x16x32_bf16 v[228:231], v[32:35], a[80:83], v[228:231]
buffer_load_dwordx4 a[244:247], v1, s[4:7], s54 offen offset:1024 sc1
v_mfma_f32_16x16x32_bf16 v[228:231], v[36:39], a[84:87], v[228:231]
ds_read_b64_tr_b16 v[56:57], v17 offset:16384
v_mfma_f32_16x16x32_bf16 v[228:231], v[40:43], a[88:91], v[228:231]
v_mfma_f32_16x16x32_bf16 v[228:231], v[44:47], a[92:95], v[228:231]
ds_read_b64_tr_b16 v[58:59], v17 offset:17408
v_mfma_f32_16x16x32_bf16 v[232:235], v[32:35], a[96:99], v[232:235]
v_mfma_f32_16x16x32_bf16 v[232:235], v[36:39], a[100:103], v[232:235]
ds_read_b64_tr_b16 v[60:61], v17 offset:24576
v_mfma_f32_16x16x32_bf16 v[232:235], v[40:43], a[104:107], v[232:235]
buffer_load_dwordx4 a[248:251], v1, s[4:7], s54 offen offset:2048 sc1
v_mfma_f32_16x16x32_bf16 v[232:235], v[44:47], a[108:111], v[232:235]
ds_read_b64_tr_b16 v[62:63], v17 offset:25600
v_mfma_f32_16x16x32_bf16 v[236:239], v[32:35], a[112:115], v[236:239]
v_add_u32 v17, 0xffff8000, v17
v_mfma_f32_16x16x32_bf16 v[236:239], v[36:39], a[116:119], v[236:239]
v_mfma_f32_16x16x32_bf16 v[236:239], v[40:43], a[120:123], v[236:239]
v_mfma_f32_16x16x32_bf16 v[236:239], v[44:47], a[124:127], v[236:239]
s_waitcnt lgkmcnt(6)
buffer_load_dwordx4 a[252:255], v1, s[4:7], s54 offen offset:3072 sc1
v_mfma_f32_16x16x32_bf16 v[240:243], v[48:51], a[64:67], v[240:243]
s_waitcnt vmcnt(32)
s_waitcnt lgkmcnt(0)
s_barrier
v_mfma_f32_16x16x32_bf16 v[240:243], v[52:55], a[68:71], v[240:243]
ds_read_b64_tr_b16 v[32:33], v22 offset:0
v_mfma_f32_16x16x32_bf16 v[240:243], v[56:59], a[72:75], v[240:243]
ds_read_b64_tr_b16 v[34:35], v22 offset:1024
v_mfma_f32_16x16x32_bf16 v[240:243], v[60:63], a[76:79], v[240:243]
s_mov_b32 s54, 3145728
ds_read_b64_tr_b16 v[36:37], v22 offset:4096
s_cmp_eq_u32 s50, 0
s_cselect_b32 s3, s23, 0
s_cmp_eq_u32 s3, 0
s_cbranch_scc1 L_samedieH
buffer_wbl2 sc1
s_waitcnt vmcnt(0)
L_samedieH:
v_mfma_f32_16x16x32_bf16 v[244:247], v[48:51], a[80:83], v[244:247]
s_add_u32 m0, s67, 98304
ds_read_b64_tr_b16 v[38:39], v22 offset:5120
v_mfma_f32_16x16x32_bf16 v[244:247], v[52:55], a[84:87], v[244:247]
s_lshl_b32 s53, s48, 8
buffer_load_dwordx4 v6, s[24:27], s54 offen offset:0  lds
v_mfma_f32_16x16x32_bf16 v[244:247], v[56:59], a[88:91], v[244:247]
s_add_u32 s53, s53, 85983232
ds_read_b64_tr_b16 v[40:41], v22 offset:8192
v_mov_b32 v31, 1
v_mfma_f32_16x16x32_bf16 v[244:247], v[60:63], a[92:95], v[244:247]
buffer_atomic_add v31, v0, s[4:7], s53 offen sc1
v_mfma_f32_16x16x32_bf16 v[248:251], v[48:51], a[96:99], v[248:251]
ds_read_b64_tr_b16 v[42:43], v22 offset:9216
v_mfma_f32_16x16x32_bf16 v[248:251], v[52:55], a[100:103], v[248:251]
v_mfma_f32_16x16x32_bf16 v[248:251], v[56:59], a[104:107], v[248:251]
ds_read_b64_tr_b16 v[44:45], v22 offset:12288
v_mfma_f32_16x16x32_bf16 v[248:251], v[60:63], a[108:111], v[248:251]
buffer_load_dwordx4 v7, s[24:27], s54 offen offset:1024  lds
v_mfma_f32_16x16x32_bf16 v[252:255], v[48:51], a[112:115], v[252:255]
ds_read_b64_tr_b16 v[46:47], v22 offset:13312
v_mfma_f32_16x16x32_bf16 v[252:255], v[52:55], a[116:119], v[252:255]
ds_read_b64_tr_b16 v[48:49], v23 offset:0
v_mfma_f32_16x16x32_bf16 v[252:255], v[56:59], a[120:123], v[252:255]
v_mfma_f32_16x16x32_bf16 v[252:255], v[60:63], a[124:127], v[252:255]
s_waitcnt vmcnt(34) lgkmcnt(7)
ds_read_b64_tr_b16 v[50:51], v23 offset:1024
v_mfma_f32_16x16x32_bf16 v[64:67], v[32:35], a[128:131], v[64:67]
s_waitcnt vmcnt(33) lgkmcnt(6)
buffer_load_dwordx4 v8, s[24:27], s54 offen offset:2048  lds
v_mfma_f32_16x16x32_bf16 v[64:67], v[36:39], a[132:135], v[64:67]
s_waitcnt vmcnt(33) lgkmcnt(4)
ds_read_b64_tr_b16 v[52:53], v23 offset:4096
v_mfma_f32_16x16x32_bf16 v[64:67], v[40:43], a[136:139], v[64:67]
s_waitcnt vmcnt(32) lgkmcnt(3)
v_mfma_f32_16x16x32_bf16 v[64:67], v[44:47], a[140:143], v[64:67]
s_waitcnt vmcnt(31)
ds_read_b64_tr_b16 v[54:55], v23 offset:5120
v_mfma_f32_16x16x32_bf16 v[68:71], v[32:35], a[144:147], v[68:71]
s_waitcnt vmcnt(30)
v_mfma_f32_16x16x32_bf16 v[68:71], v[36:39], a[148:151], v[68:71]
s_waitcnt vmcnt(29)
ds_read_b64_tr_b16 v[56:57], v23 offset:8192
v_mfma_f32_16x16x32_bf16 v[68:71], v[40:43], a[152:155], v[68:71]
s_waitcnt vmcnt(28)
buffer_load_dwordx4 v9, s[24:27], s54 offen offset:3072  lds
v_mfma_f32_16x16x32_bf16 v[68:71], v[44:47], a[156:159], v[68:71]
s_waitcnt vmcnt(28)
s_mov_b32 s54, 3670016
ds_read_b64_tr_b16 v[58:59], v23 offset:9216
v_mfma_f32_16x16x32_bf16 v[72:75], v[32:35], a[160:163], v[72:75]
s_waitcnt vmcnt(27)
s_add_u32 m0, s67, 114688
v_mfma_f32_16x16x32_bf16 v[72:75], v[36:39], a[164:167], v[72:75]
s_waitcnt vmcnt(26)
ds_read_b64_tr_b16 v[60:61], v23 offset:12288
v_mfma_f32_16x16x32_bf16 v[72:75], v[40:43], a[168:171], v[72:75]
s_waitcnt vmcnt(25)
v_mfma_f32_16x16x32_bf16 v[72:75], v[44:47], a[172:175], v[72:75]
s_waitcnt vmcnt(24)
ds_read_b64_tr_b16 v[62:63], v23 offset:13312
v_mfma_f32_16x16x32_bf16 v[76:79], v[32:35], a[176:179], v[76:79]
s_waitcnt vmcnt(23)
buffer_load_dwordx4 v6, s[24:27], s54 offen offset:0  lds
v_mfma_f32_16x16x32_bf16 v[76:79], v[36:39], a[180:183], v[76:79]
s_waitcnt vmcnt(23)
ds_read_b64_tr_b16 v[32:33], v29 offset:0
v_mfma_f32_16x16x32_bf16 v[76:79], v[40:43], a[184:187], v[76:79]
s_waitcnt vmcnt(22)
v_mfma_f32_16x16x32_bf16 v[76:79], v[44:47], a[188:191], v[76:79]
s_waitcnt lgkmcnt(7)
ds_read_b64_tr_b16 v[34:35], v29 offset:1024
v_mfma_f32_16x16x32_bf16 v[80:83], v[48:51], a[128:131], v[80:83]
s_waitcnt lgkmcnt(6)
v_mfma_f32_16x16x32_bf16 v[80:83], v[52:55], a[132:135], v[80:83]
s_waitcnt lgkmcnt(4)
ds_read_b64_tr_b16 v[36:37], v29 offset:4096
v_mfma_f32_16x16x32_bf16 v[80:83], v[56:59], a[136:139], v[80:83]
s_waitcnt lgkmcnt(3)
buffer_load_dwordx4 v7, s[24:27], s54 offen offset:1024  lds
v_mfma_f32_16x16x32_bf16 v[80:83], v[60:63], a[140:143], v[80:83]
ds_read_b64_tr_b16 v[38:39], v29 offset:5120
v_mfma_f32_16x16x32_bf16 v[84:87], v[48:51], a[144:147], v[84:87]
v_mfma_f32_16x16x32_bf16 v[84:87], v[52:55], a[148:151], v[84:87]
ds_read_b64_tr_b16 v[40:41], v29 offset:8192
v_mfma_f32_16x16x32_bf16 v[84:87], v[56:59], a[152:155], v[84:87]
v_mfma_f32_16x16x32_bf16 v[84:87], v[60:63], a[156:159], v[84:87]
ds_read_b64_tr_b16 v[42:43], v29 offset:9216
v_mfma_f32_16x16x32_bf16 v[88:91], v[48:51], a[160:163], v[88:91]
buffer_load_dwordx4 v8, s[24:27], s54 offen offset:2048  lds
v_mfma_f32_16x16x32_bf16 v[88:91], v[52:55], a[164:167], v[88:91]
ds_read_b64_tr_b16 v[44:45], v29 offset:12288
v_mfma_f32_16x16x32_bf16 v[88:91], v[56:59], a[168:171], v[88:91]
v_mfma_f32_16x16x32_bf16 v[88:91], v[60:63], a[172:175], v[88:91]
ds_read_b64_tr_b16 v[46:47], v29 offset:13312
v_mfma_f32_16x16x32_bf16 v[92:95], v[48:51], a[176:179], v[92:95]
v_mfma_f32_16x16x32_bf16 v[92:95], v[52:55], a[180:183], v[92:95]
ds_read_b64_tr_b16 v[48:49], v30 offset:0
v_mfma_f32_16x16x32_bf16 v[92:95], v[56:59], a[184:187], v[92:95]
buffer_load_dwordx4 v9, s[24:27], s54 offen offset:3072  lds
v_mfma_f32_16x16x32_bf16 v[92:95], v[60:63], a[188:191], v[92:95]
s_waitcnt lgkmcnt(7)
s_mov_b32 s54, 1769472
ds_read_b64_tr_b16 v[50:51], v30 offset:1024
v_mfma_f32_16x16x32_bf16 v[96:99], v[32:35], a[128:131], v[96:99]
s_waitcnt lgkmcnt(6)
s_add_u32 m0, s67, 0
v_mfma_f32_16x16x32_bf16 v[96:99], v[36:39], a[132:135], v[96:99]
s_waitcnt lgkmcnt(4)
ds_read_b64_tr_b16 v[52:53], v30 offset:4096
v_mfma_f32_16x16x32_bf16 v[96:99], v[40:43], a[136:139], v[96:99]
s_waitcnt lgkmcnt(3)
v_mfma_f32_16x16x32_bf16 v[96:99], v[44:47], a[140:143], v[96:99]
ds_read_b64_tr_b16 v[54:55], v30 offset:5120
v_mfma_f32_16x16x32_bf16 v[100:103], v[32:35], a[144:147], v[100:103]
buffer_load_dwordx4 v25, s[28:31], s54 offen offset:0  lds
v_mfma_f32_16x16x32_bf16 v[100:103], v[36:39], a[148:151], v[100:103]
ds_read_b64_tr_b16 v[56:57], v30 offset:8192
v_mfma_f32_16x16x32_bf16 v[100:103], v[40:43], a[152:155], v[100:103]
v_mfma_f32_16x16x32_bf16 v[100:103], v[44:47], a[156:159], v[100:103]
ds_read_b64_tr_b16 v[58:59], v30 offset:9216
v_mfma_f32_16x16x32_bf16 v[104:107], v[32:35], a[160:163], v[104:107]
v_mfma_f32_16x16x32_bf16 v[104:107], v[36:39], a[164:167], v[104:107]
ds_read_b64_tr_b16 v[60:61], v30 offset:12288
v_mfma_f32_16x16x32_bf16 v[104:107], v[40:43], a[168:171], v[104:107]
buffer_load_dwordx4 v26, s[28:31], s54 offen offset:1024  lds
v_mfma_f32_16x16x32_bf16 v[104:107], v[44:47], a[172:175], v[104:107]
ds_read_b64_tr_b16 v[62:63], v30 offset:13312
v_mfma_f32_16x16x32_bf16 v[108:111], v[32:35], a[176:179], v[108:111]
v_mfma_f32_16x16x32_bf16 v[108:111], v[36:39], a[180:183], v[108:111]
ds_read_b64_tr_b16 v[32:33], v22 offset:16384
v_mfma_f32_16x16x32_bf16 v[108:111], v[40:43], a[184:187], v[108:111]
v_mfma_f32_16x16x32_bf16 v[108:111], v[44:47], a[188:191], v[108:111]
s_waitcnt lgkmcnt(7)
ds_read_b64_tr_b16 v[34:35], v22 offset:17408
v_mfma_f32_16x16x32_bf16 v[112:115], v[48:51], a[128:131], v[112:115]
s_waitcnt lgkmcnt(6)
buffer_load_dwordx4 v27, s[28:31], s54 offen offset:2048  lds
v_mfma_f32_16x16x32_bf16 v[112:115], v[52:55], a[132:135], v[112:115]
s_waitcnt lgkmcnt(4)
ds_read_b64_tr_b16 v[36:37], v22 offset:20480
v_mfma_f32_16x16x32_bf16 v[112:115], v[56:59], a[136:139], v[112:115]
s_waitcnt lgkmcnt(3)
v_mfma_f32_16x16x32_bf16 v[112:115], v[60:63], a[140:143], v[112:115]
ds_read_b64_tr_b16 v[38:39], v22 offset:21504
v_mfma_f32_16x16x32_bf16 v[116:119], v[48:51], a[144:147], v[116:119]
v_mfma_f32_16x16x32_bf16 v[116:119], v[52:55], a[148:151], v[116:119]
ds_read_b64_tr_b16 v[40:41], v22 offset:24576
v_mfma_f32_16x16x32_bf16 v[116:119], v[56:59], a[152:155], v[116:119]
buffer_load_dwordx4 v28, s[28:31], s54 offen offset:3072  lds
v_mfma_f32_16x16x32_bf16 v[116:119], v[60:63], a[156:159], v[116:119]
ds_read_b64_tr_b16 v[42:43], v22 offset:25600
v_mfma_f32_16x16x32_bf16 v[120:123], v[48:51], a[160:163], v[120:123]
v_mfma_f32_16x16x32_bf16 v[120:123], v[52:55], a[164:167], v[120:123]
ds_read_b64_tr_b16 v[44:45], v22 offset:28672
v_mfma_f32_16x16x32_bf16 v[120:123], v[56:59], a[168:171], v[120:123]
s_lshl_b32 s57, s2, 2
v_mfma_f32_16x16x32_bf16 v[120:123], v[60:63], a[172:175], v[120:123]
s_add_u32 s57, s57, s50
ds_read_b64_tr_b16 v[46:47], v22 offset:29696
v_mfma_f32_16x16x32_bf16 v[124:127], v[48:51], a[176:179], v[124:127]
s_mul_i32 s22, s57, 2176
v_add_u32 v22, 0xfffe0000, v22
v_mfma_f32_16x16x32_bf16 v[124:127], v[52:55], a[180:183], v[124:127]
s_mul_i32 s57, s57, 5120
ds_read_b64_tr_b16 v[48:49], v23 offset:16384
v_cmp_gt_u32 vcc, 320, v1
v_mfma_f32_16x16x32_bf16 v[124:127], v[56:59], a[184:187], v[124:127]
v_lshlrev_b32 v24, 3, v1
v_mov_b32 v31, 2130706432
v_mfma_f32_16x16x32_bf16 v[124:127], v[60:63], a[188:191], v[124:127]
s_waitcnt vmcnt(28) lgkmcnt(7)
ds_read_b64_tr_b16 v[50:51], v23 offset:17408
v_cndmask_b32 v24, v31, v24, vcc
v_mfma_f32_16x16x32_bf16 v[64:67], v[32:35], a[192:195], v[64:67]
s_waitcnt vmcnt(27) lgkmcnt(6)
buffer_load_dword v31, v24, s[32:35], s57 offen
v_mfma_f32_16x16x32_bf16 v[64:67], v[36:39], a[196:199], v[64:67]
s_waitcnt vmcnt(27) lgkmcnt(4)
ds_read_b64_tr_b16 v[52:53], v23 offset:20480
v_mfma_f32_16x16x32_bf16 v[64:67], v[40:43], a[200:203], v[64:67]
s_waitcnt vmcnt(26) lgkmcnt(3)
v_mfma_f32_16x16x32_bf16 v[64:67], v[44:47], a[204:207], v[64:67]
s_waitcnt vmcnt(25)
ds_read_b64_tr_b16 v[54:55], v23 offset:21504
v_mfma_f32_16x16x32_bf16 v[68:71], v[32:35], a[208:211], v[68:71]
s_waitcnt vmcnt(24)
v_mfma_f32_16x16x32_bf16 v[68:71], v[36:39], a[212:215], v[68:71]
s_waitcnt vmcnt(23)
ds_read_b64_tr_b16 v[56:57], v23 offset:24576
v_mfma_f32_16x16x32_bf16 v[68:71], v[40:43], a[216:219], v[68:71]
s_waitcnt vmcnt(22)
v_mfma_f32_16x16x32_bf16 v[68:71], v[44:47], a[220:223], v[68:71]
s_waitcnt vmcnt(21)
ds_read_b64_tr_b16 v[58:59], v23 offset:25600
v_mfma_f32_16x16x32_bf16 v[72:75], v[32:35], a[224:227], v[72:75]
s_waitcnt vmcnt(20)
buffer_load_dword v31, v24, s[32:35], s57 offen offset:2560
v_mfma_f32_16x16x32_bf16 v[72:75], v[36:39], a[228:231], v[72:75]
s_waitcnt vmcnt(20)
ds_read_b64_tr_b16 v[60:61], v23 offset:28672
v_mfma_f32_16x16x32_bf16 v[72:75], v[40:43], a[232:235], v[72:75]
s_waitcnt vmcnt(19)
v_mfma_f32_16x16x32_bf16 v[72:75], v[44:47], a[236:239], v[72:75]
s_waitcnt vmcnt(18)
ds_read_b64_tr_b16 v[62:63], v23 offset:29696
v_mfma_f32_16x16x32_bf16 v[76:79], v[32:35], a[240:243], v[76:79]
s_waitcnt vmcnt(17)
v_add_u32 v23, 0xfffe0000, v23
v_mfma_f32_16x16x32_bf16 v[76:79], v[36:39], a[244:247], v[76:79]
s_waitcnt vmcnt(16)
ds_read_b64_tr_b16 v[32:33], v29 offset:16384
v_mfma_f32_16x16x32_bf16 v[76:79], v[40:43], a[248:251], v[76:79]
s_waitcnt vmcnt(15)
v_mfma_f32_16x16x32_bf16 v[76:79], v[44:47], a[252:255], v[76:79]
s_waitcnt lgkmcnt(7)
s_add_u32 s54, s76, 16384
ds_read_b64_tr_b16 v[34:35], v29 offset:17408
v_mfma_f32_16x16x32_bf16 v[80:83], v[48:51], a[192:195], v[80:83]
s_waitcnt lgkmcnt(6)
buffer_load_dwordx4 a[0:3], v1, s[4:7], s54 offen offset:0 sc1
v_mfma_f32_16x16x32_bf16 v[80:83], v[52:55], a[196:199], v[80:83]
s_waitcnt lgkmcnt(4)
ds_read_b64_tr_b16 v[36:37], v29 offset:20480
v_mfma_f32_16x16x32_bf16 v[80:83], v[56:59], a[200:203], v[80:83]
s_waitcnt lgkmcnt(3)
v_mfma_f32_16x16x32_bf16 v[80:83], v[60:63], a[204:207], v[80:83]
ds_read_b64_tr_b16 v[38:39], v29 offset:21504
v_mfma_f32_16x16x32_bf16 v[84:87], v[48:51], a[208:211], v[84:87]
v_mfma_f32_16x16x32_bf16 v[84:87], v[52:55], a[212:215], v[84:87]
ds_read_b64_tr_b16 v[40:41], v29 offset:24576
v_mfma_f32_16x16x32_bf16 v[84:87], v[56:59], a[216:219], v[84:87]
buffer_load_dwordx4 a[4:7], v1, s[4:7], s54 offen offset:1024 sc1
v_mfma_f32_16x16x32_bf16 v[84:87], v[60:63], a[220:223], v[84:87]
ds_read_b64_tr_b16 v[42:43], v29 offset:25600
v_mfma_f32_16x16x32_bf16 v[88:91], v[48:51], a[224:227], v[88:91]
v_mfma_f32_16x16x32_bf16 v[88:91], v[52:55], a[228:231], v[88:91]
ds_read_b64_tr_b16 v[44:45], v29 offset:28672
v_mfma_f32_16x16x32_bf16 v[88:91], v[56:59], a[232:235], v[88:91]
v_mfma_f32_16x16x32_bf16 v[88:91], v[60:63], a[236:239], v[88:91]
ds_read_b64_tr_b16 v[46:47], v29 offset:29696
v_mfma_f32_16x16x32_bf16 v[92:95], v[48:51], a[240:243], v[92:95]
v_add_u32 v29, 0xfffe0000, v29
v_mfma_f32_16x16x32_bf16 v[92:95], v[52:55], a[244:247], v[92:95]
ds_read_b64_tr_b16 v[48:49], v30 offset:16384
v_mfma_f32_16x16x32_bf16 v[92:95], v[56:59], a[248:251], v[92:95]
buffer_load_dwordx4 a[8:11], v1, s[4:7], s54 offen offset:2048 sc1
v_mfma_f32_16x16x32_bf16 v[92:95], v[60:63], a[252:255], v[92:95]
s_waitcnt lgkmcnt(7)
ds_read_b64_tr_b16 v[50:51], v30 offset:17408
v_mfma_f32_16x16x32_bf16 v[96:99], v[32:35], a[192:195], v[96:99]
s_waitcnt lgkmcnt(6)
v_mfma_f32_16x16x32_bf16 v[96:99], v[36:39], a[196:199], v[96:99]
s_waitcnt lgkmcnt(4)
ds_read_b64_tr_b16 v[52:53], v30 offset:20480
v_mfma_f32_16x16x32_bf16 v[96:99], v[40:43], a[200:203], v[96:99]
s_waitcnt lgkmcnt(3)
v_mfma_f32_16x16x32_bf16 v[96:99], v[44:47], a[204:207], v[96:99]
ds_read_b64_tr_b16 v[54:55], v30 offset:21504
v_mfma_f32_16x16x32_bf16 v[100:103], v[32:35], a[208:211], v[100:103]
buffer_load_dwordx4 a[12:15], v1, s[4:7], s54 offen offset:3072 sc1
v_mfma_f32_16x16x32_bf16 v[100:103], v[36:39], a[212:215], v[100:103]
s_add_u32 s54, s77, 16384
ds_read_b64_tr_b16 v[56:57], v30 offset:24576
v_mfma_f32_16x16x32_bf16 v[100:103], v[40:43], a[216:219], v[100:103]
v_mfma_f32_16x16x32_bf16 v[100:103], v[44:47], a[220:223], v[100:103]
ds_read_b64_tr_b16 v[58:59], v30 offset:25600
v_mfma_f32_16x16x32_bf16 v[104:107], v[32:35], a[224:227], v[104:107]
v_mfma_f32_16x16x32_bf16 v[104:107], v[36:39], a[228:231], v[104:107]
ds_read_b64_tr_b16 v[60:61], v30 offset:28672
v_mfma_f32_16x16x32_bf16 v[104:107], v[40:43], a[232:235], v[104:107]
buffer_load_dwordx4 a[16:19], v1, s[4:7], s54 offen offset:0 sc1
v_mfma_f32_16x16x32_bf16 v[104:107], v[44:47], a[236:239], v[104:107]
ds_read_b64_tr_b16 v[62:63], v30 offset:29696
v_mfma_f32_16x16x32_bf16 v[108:111], v[32:35], a[240:243], v[108:111]
v_add_u32 v30, 0xfffe0000, v30
v_mfma_f32_16x16x32_bf16 v[108:111], v[36:39], a[244:247], v[108:111]
ds_read_b64_tr_b16 v[32:33], v10 offset:0
v_mfma_f32_16x16x32_bf16 v[108:111], v[40:43], a[248:251], v[108:111]
v_mfma_f32_16x16x32_bf16 v[108:111], v[44:47], a[252:255], v[108:111]
s_waitcnt lgkmcnt(7)
ds_read_b64_tr_b16 v[34:35], v10 offset:1024
v_mfma_f32_16x16x32_bf16 v[112:115], v[48:51], a[192:195], v[112:115]
s_waitcnt lgkmcnt(6)
buffer_load_dwordx4 a[20:23], v1, s[4:7], s54 offen offset:1024 sc1
v_mfma_f32_16x16x32_bf16 v[112:115], v[52:55], a[196:199], v[112:115]
s_waitcnt lgkmcnt(4)
ds_read_b64_tr_b16 v[36:37], v10 offset:8192
v_mfma_f32_16x16x32_bf16 v[112:115], v[56:59], a[200:203], v[112:115]
s_waitcnt lgkmcnt(3)
v_mfma_f32_16x16x32_bf16 v[112:115], v[60:63], a[204:207], v[112:115]
ds_read_b64_tr_b16 v[38:39], v10 offset:9216
v_mfma_f32_16x16x32_bf16 v[116:119], v[48:51], a[208:211], v[116:119]
v_mfma_f32_16x16x32_bf16 v[116:119], v[52:55], a[212:215], v[116:119]
ds_read_b64_tr_b16 v[40:41], v10 offset:16384
v_mfma_f32_16x16x32_bf16 v[116:119], v[56:59], a[216:219], v[116:119]
buffer_load_dwordx4 a[24:27], v1, s[4:7], s54 offen offset:2048 sc1
v_mfma_f32_16x16x32_bf16 v[116:119], v[60:63], a[220:223], v[116:119]
ds_read_b64_tr_b16 v[42:43], v10 offset:17408
v_mfma_f32_16x16x32_bf16 v[120:123], v[48:51], a[224:227], v[120:123]
v_mfma_f32_16x16x32_bf16 v[120:123], v[52:55], a[228:231], v[120:123]
ds_read_b64_tr_b16 v[44:45], v10 offset:24576
v_mfma_f32_16x16x32_bf16 v[120:123], v[56:59], a[232:235], v[120:123]
v_mfma_f32_16x16x32_bf16 v[120:123], v[60:63], a[236:239], v[120:123]
ds_read_b64_tr_b16 v[46:47], v10 offset:25600
v_mfma_f32_16x16x32_bf16 v[124:127], v[48:51], a[240:243], v[124:127]
v_add_u32 v10, 0x10000, v10
v_mfma_f32_16x16x32_bf16 v[124:127], v[52:55], a[244:247], v[124:127]
ds_read_b64_tr_b16 v[48:49], v11 offset:0
v_mfma_f32_16x16x32_bf16 v[124:127], v[56:59], a[248:251], v[124:127]
buffer_load_dwordx4 a[28:31], v1, s[4:7], s54 offen offset:3072 sc1
v_mfma_f32_16x16x32_bf16 v[124:127], v[60:63], a[252:255], v[124:127]
s_waitcnt lgkmcnt(7)
s_add_u32 s54, s78, 16384
ds_read_b64_tr_b16 v[50:51], v11 offset:1024
v_mfma_f32_16x16x32_bf16 v[128:131], v[32:35], a[128:131], v[128:131]
s_waitcnt lgkmcnt(6)
v_mfma_f32_16x16x32_bf16 v[128:131], v[36:39], a[132:135], v[128:131]
s_waitcnt lgkmcnt(4)
ds_read_b64_tr_b16 v[52:53], v11 offset:8192
v_mfma_f32_16x16x32_bf16 v[128:131], v[40:43], a[136:139], v[128:131]
s_waitcnt lgkmcnt(3)
v_mfma_f32_16x16x32_bf16 v[128:131], v[44:47], a[140:143], v[128:131]
ds_read_b64_tr_b16 v[54:55], v11 offset:9216
v_mfma_f32_16x16x32_bf16 v[132:135], v[32:35], a[144:147], v[132:135]
buffer_load_dwordx4 a[32:35], v1, s[4:7], s54 offen offset:0 sc1
v_mfma_f32_16x16x32_bf16 v[132:135], v[36:39], a[148:151], v[132:135]
ds_read_b64_tr_b16 v[56:57], v11 offset:16384
v_mfma_f32_16x16x32_bf16 v[132:135], v[40:43], a[152:155], v[132:135]
v_mfma_f32_16x16x32_bf16 v[132:135], v[44:47], a[156:159], v[132:135]
ds_read_b64_tr_b16 v[58:59], v11 offset:17408
v_mfma_f32_16x16x32_bf16 v[136:139], v[32:35], a[160:163], v[136:139]
v_mfma_f32_16x16x32_bf16 v[136:139], v[36:39], a[164:167], v[136:139]
ds_read_b64_tr_b16 v[60:61], v11 offset:24576
v_mfma_f32_16x16x32_bf16 v[136:139], v[40:43], a[168:171], v[136:139]
buffer_load_dwordx4 a[36:39], v1, s[4:7], s54 offen offset:1024 sc1
v_mfma_f32_16x16x32_bf16 v[136:139], v[44:47], a[172:175], v[136:139]
ds_read_b64_tr_b16 v[62:63], v11 offset:25600
v_mfma_f32_16x16x32_bf16 v[140:143], v[32:35], a[176:179], v[140:143]
v_add_u32 v11, 0x10000, v11
v_mfma_f32_16x16x32_bf16 v[140:143], v[36:39], a[180:183], v[140:143]
ds_read_b64_tr_b16 v[32:33], v12 offset:0
v_mfma_f32_16x16x32_bf16 v[140:143], v[40:43], a[184:187], v[140:143]
v_mfma_f32_16x16x32_bf16 v[140:143], v[44:47], a[188:191], v[140:143]
s_waitcnt lgkmcnt(7)
ds_read_b64_tr_b16 v[34:35], v12 offset:1024
v_mfma_f32_16x16x32_bf16 v[144:147], v[48:51], a[128:131], v[144:147]
s_waitcnt lgkmcnt(6)
buffer_load_dwordx4 a[40:43], v1, s[4:7], s54 offen offset:2048 sc1
v_mfma_f32_16x16x32_bf16 v[144:147], v[52:55], a[132:135], v[144:147]
s_waitcnt lgkmcnt(4)
ds_read_b64_tr_b16 v[36:37], v12 offset:8192
v_mfma_f32_16x16x32_bf16 v[144:147], v[56:59], a[136:139], v[144:147]
s_waitcnt lgkmcnt(3)
v_mfma_f32_16x16x32_bf16 v[144:147], v[60:63], a[140:143], v[144:147]
ds_read_b64_tr_b16 v[38:39], v12 offset:9216
v_mfma_f32_16x16x32_bf16 v[148:151], v[48:51], a[144:147], v[148:151]
v_mfma_f32_16x16x32_bf16 v[148:151], v[52:55], a[148:151], v[148:151]
ds_read_b64_tr_b16 v[40:41], v12 offset:16384
v_mfma_f32_16x16x32_bf16 v[148:151], v[56:59], a[152:155], v[148:151]
buffer_load_dwordx4 a[44:47], v1, s[4:7], s54 offen offset:3072 sc1
v_mfma_f32_16x16x32_bf16 v[148:151], v[60:63], a[156:159], v[148:151]
s_add_u32 s54, s79, 16384
ds_read_b64_tr_b16 v[42:43], v12 offset:17408
v_mfma_f32_16x16x32_bf16 v[152:155], v[48:51], a[160:163], v[152:155]
v_mfma_f32_16x16x32_bf16 v[152:155], v[52:55], a[164:167], v[152:155]
ds_read_b64_tr_b16 v[44:45], v12 offset:24576
v_mfma_f32_16x16x32_bf16 v[152:155], v[56:59], a[168:171], v[152:155]
v_mfma_f32_16x16x32_bf16 v[152:155], v[60:63], a[172:175], v[152:155]
ds_read_b64_tr_b16 v[46:47], v12 offset:25600
v_mfma_f32_16x16x32_bf16 v[156:159], v[48:51], a[176:179], v[156:159]
v_add_u32 v12, 0x10000, v12
v_mfma_f32_16x16x32_bf16 v[156:159], v[52:55], a[180:183], v[156:159]
ds_read_b64_tr_b16 v[48:49], v13 offset:0
v_mfma_f32_16x16x32_bf16 v[156:159], v[56:59], a[184:187], v[156:159]
buffer_load_dwordx4 a[48:51], v1, s[4:7], s54 offen offset:0 sc1
v_mfma_f32_16x16x32_bf16 v[156:159], v[60:63], a[188:191], v[156:159]
s_waitcnt lgkmcnt(7)
ds_read_b64_tr_b16 v[50:51], v13 offset:1024
v_mfma_f32_16x16x32_bf16 v[160:163], v[32:35], a[128:131], v[160:163]
s_waitcnt lgkmcnt(6)
v_mfma_f32_16x16x32_bf16 v[160:163], v[36:39], a[132:135], v[160:163]
s_waitcnt lgkmcnt(4)
ds_read_b64_tr_b16 v[52:53], v13 offset:8192
v_mfma_f32_16x16x32_bf16 v[160:163], v[40:43], a[136:139], v[160:163]
s_waitcnt lgkmcnt(3)
v_mfma_f32_16x16x32_bf16 v[160:163], v[44:47], a[140:143], v[160:163]
ds_read_b64_tr_b16 v[54:55], v13 offset:9216
v_mfma_f32_16x16x32_bf16 v[164:167], v[32:35], a[144:147], v[164:167]
buffer_load_dwordx4 a[52:55], v1, s[4:7], s54 offen offset:1024 sc1
v_mfma_f32_16x16x32_bf16 v[164:167], v[36:39], a[148:151], v[164:167]
ds_read_b64_tr_b16 v[56:57], v13 offset:16384
v_mfma_f32_16x16x32_bf16 v[164:167], v[40:43], a[152:155], v[164:167]
v_mfma_f32_16x16x32_bf16 v[164:167], v[44:47], a[156:159], v[164:167]
ds_read_b64_tr_b16 v[58:59], v13 offset:17408
v_mfma_f32_16x16x32_bf16 v[168:171], v[32:35], a[160:163], v[168:171]
v_mfma_f32_16x16x32_bf16 v[168:171], v[36:39], a[164:167], v[168:171]
ds_read_b64_tr_b16 v[60:61], v13 offset:24576
v_mfma_f32_16x16x32_bf16 v[168:171], v[40:43], a[168:171], v[168:171]
buffer_load_dwordx4 a[56:59], v1, s[4:7], s54 offen offset:2048 sc1
v_mfma_f32_16x16x32_bf16 v[168:171], v[44:47], a[172:175], v[168:171]
ds_read_b64_tr_b16 v[62:63], v13 offset:25600
v_mfma_f32_16x16x32_bf16 v[172:175], v[32:35], a[176:179], v[172:175]
v_add_u32 v13, 0x10000, v13
v_mfma_f32_16x16x32_bf16 v[172:175], v[36:39], a[180:183], v[172:175]
ds_read_b64_tr_b16 v[32:33], v14 offset:0
v_mfma_f32_16x16x32_bf16 v[172:175], v[40:43], a[184:187], v[172:175]
v_mfma_f32_16x16x32_bf16 v[172:175], v[44:47], a[188:191], v[172:175]
s_waitcnt lgkmcnt(7)
ds_read_b64_tr_b16 v[34:35], v14 offset:1024
v_mfma_f32_16x16x32_bf16 v[176:179], v[48:51], a[128:131], v[176:179]
s_waitcnt lgkmcnt(6)
buffer_load_dwordx4 a[60:63], v1, s[4:7], s54 offen offset:3072 sc1
v_mfma_f32_16x16x32_bf16 v[176:179], v[52:55], a[132:135], v[176:179]
s_waitcnt lgkmcnt(4)
ds_read_b64_tr_b16 v[36:37], v14 offset:8192
v_mfma_f32_16x16x32_bf16 v[176:179], v[56:59], a[136:139], v[176:179]
s_waitcnt lgkmcnt(3)
v_mfma_f32_16x16x32_bf16 v[176:179], v[60:63], a[140:143], v[176:179]
ds_read_b64_tr_b16 v[38:39], v14 offset:9216
v_mfma_f32_16x16x32_bf16 v[180:183], v[48:51], a[144:147], v[180:183]
s_mov_b32 s54, 4194304
v_mfma_f32_16x16x32_bf16 v[180:183], v[52:55], a[148:151], v[180:183]
s_add_u32 m0, s67, 65536
ds_read_b64_tr_b16 v[40:41], v14 offset:16384
v_mfma_f32_16x16x32_bf16 v[180:183], v[56:59], a[152:155], v[180:183]
buffer_load_dwordx4 v6, s[24:27], s54 offen offset:0  lds
v_mfma_f32_16x16x32_bf16 v[180:183], v[60:63], a[156:159], v[180:183]
ds_read_b64_tr_b16 v[42:43], v14 offset:17408
v_mfma_f32_16x16x32_bf16 v[184:187], v[48:51], a[160:163], v[184:187]
v_mfma_f32_16x16x32_bf16 v[184:187], v[52:55], a[164:167], v[184:187]
ds_read_b64_tr_b16 v[44:45], v14 offset:24576
v_mfma_f32_16x16x32_bf16 v[184:187], v[56:59], a[168:171], v[184:187]
v_mfma_f32_16x16x32_bf16 v[184:187], v[60:63], a[172:175], v[184:187]
ds_read_b64_tr_b16 v[46:47], v14 offset:25600
v_mfma_f32_16x16x32_bf16 v[188:191], v[48:51], a[176:179], v[188:191]
v_add_u32 v14, 0x10000, v14
v_mfma_f32_16x16x32_bf16 v[188:191], v[52:55], a[180:183], v[188:191]
ds_read_b64_tr_b16 v[48:49], v15 offset:0
v_mfma_f32_16x16x32_bf16 v[188:191], v[56:59], a[184:187], v[188:191]
buffer_load_dwordx4 v7, s[24:27], s54 offen offset:1024  lds
v_mfma_f32_16x16x32_bf16 v[188:191], v[60:63], a[188:191], v[188:191]
s_waitcnt lgkmcnt(7)
ds_read_b64_tr_b16 v[50:51], v15 offset:1024
v_mfma_f32_16x16x32_bf16 v[192:195], v[32:35], a[128:131], v[192:195]
s_waitcnt lgkmcnt(6)
v_mfma_f32_16x16x32_bf16 v[192:195], v[36:39], a[132:135], v[192:195]
s_waitcnt lgkmcnt(4)
ds_read_b64_tr_b16 v[52:53], v15 offset:8192
v_mfma_f32_16x16x32_bf16 v[192:195], v[40:43], a[136:139], v[192:195]
s_waitcnt lgkmcnt(3)
v_mfma_f32_16x16x32_bf16 v[192:195], v[44:47], a[140:143], v[192:195]
ds_read_b64_tr_b16 v[54:55], v15 offset:9216
v_mfma_f32_16x16x32_bf16 v[196:199], v[32:35], a[144:147], v[196:199]
buffer_load_dwordx4 v8, s[24:27], s54 offen offset:2048  lds
v_mfma_f32_16x16x32_bf16 v[196:199], v[36:39], a[148:151], v[196:199]
ds_read_b64_tr_b16 v[56:57], v15 offset:16384
v_mfma_f32_16x16x32_bf16 v[196:199], v[40:43], a[152:155], v[196:199]
v_mfma_f32_16x16x32_bf16 v[196:199], v[44:47], a[156:159], v[196:199]
ds_read_b64_tr_b16 v[58:59], v15 offset:17408
v_mfma_f32_16x16x32_bf16 v[200:203], v[32:35], a[160:163], v[200:203]
v_mfma_f32_16x16x32_bf16 v[200:203], v[36:39], a[164:167], v[200:203]
ds_read_b64_tr_b16 v[60:61], v15 offset:24576
v_mfma_f32_16x16x32_bf16 v[200:203], v[40:43], a[168:171], v[200:203]
buffer_load_dwordx4 v9, s[24:27], s54 offen offset:3072  lds
v_mfma_f32_16x16x32_bf16 v[200:203], v[44:47], a[172:175], v[200:203]
s_mov_b32 s54, 4718592
ds_read_b64_tr_b16 v[62:63], v15 offset:25600
v_mfma_f32_16x16x32_bf16 v[204:207], v[32:35], a[176:179], v[204:207]
s_add_u32 m0, s67, 81920
v_add_u32 v15, 0x10000, v15
v_mfma_f32_16x16x32_bf16 v[204:207], v[36:39], a[180:183], v[204:207]
ds_read_b64_tr_b16 v[32:33], v16 offset:0
v_mfma_f32_16x16x32_bf16 v[204:207], v[40:43], a[184:187], v[204:207]
v_mfma_f32_16x16x32_bf16 v[204:207], v[44:47], a[188:191], v[204:207]
s_waitcnt lgkmcnt(7)
ds_read_b64_tr_b16 v[34:35], v16 offset:1024
v_mfma_f32_16x16x32_bf16 v[208:211], v[48:51], a[128:131], v[208:211]
s_waitcnt lgkmcnt(6)
buffer_load_dwordx4 v6, s[24:27], s54 offen offset:0  lds
v_mfma_f32_16x16x32_bf16 v[208:211], v[52:55], a[132:135], v[208:211]
s_waitcnt lgkmcnt(4)
ds_read_b64_tr_b16 v[36:37], v16 offset:8192
v_mfma_f32_16x16x32_bf16 v[208:211], v[56:59], a[136:139], v[208:211]
s_waitcnt lgkmcnt(3)
v_mfma_f32_16x16x32_bf16 v[208:211], v[60:63], a[140:143], v[208:211]
ds_read_b64_tr_b16 v[38:39], v16 offset:9216
v_mfma_f32_16x16x32_bf16 v[212:215], v[48:51], a[144:147], v[212:215]
v_mfma_f32_16x16x32_bf16 v[212:215], v[52:55], a[148:151], v[212:215]
ds_read_b64_tr_b16 v[40:41], v16 offset:16384
v_mfma_f32_16x16x32_bf16 v[212:215], v[56:59], a[152:155], v[212:215]
buffer_load_dwordx4 v7, s[24:27], s54 offen offset:1024  lds
v_mfma_f32_16x16x32_bf16 v[212:215], v[60:63], a[156:159], v[212:215]
ds_read_b64_tr_b16 v[42:43], v16 offset:17408
v_mfma_f32_16x16x32_bf16 v[216:219], v[48:51], a[160:163], v[216:219]
v_mfma_f32_16x16x32_bf16 v[216:219], v[52:55], a[164:167], v[216:219]
ds_read_b64_tr_b16 v[44:45], v16 offset:24576
v_mfma_f32_16x16x32_bf16 v[216:219], v[56:59], a[168:171], v[216:219]
v_mfma_f32_16x16x32_bf16 v[216:219], v[60:63], a[172:175], v[216:219]
ds_read_b64_tr_b16 v[46:47], v16 offset:25600
v_mfma_f32_16x16x32_bf16 v[220:223], v[48:51], a[176:179], v[220:223]
v_add_u32 v16, 0x10000, v16
v_mfma_f32_16x16x32_bf16 v[220:223], v[52:55], a[180:183], v[220:223]
ds_read_b64_tr_b16 v[48:49], v17 offset:0
v_mfma_f32_16x16x32_bf16 v[220:223], v[56:59], a[184:187], v[220:223]
buffer_load_dwordx4 v8, s[24:27], s54 offen offset:2048  lds
v_mfma_f32_16x16x32_bf16 v[220:223], v[60:63], a[188:191], v[220:223]
s_waitcnt lgkmcnt(7)
ds_read_b64_tr_b16 v[50:51], v17 offset:1024
v_mfma_f32_16x16x32_bf16 v[224:227], v[32:35], a[128:131], v[224:227]
s_waitcnt lgkmcnt(6)
v_mfma_f32_16x16x32_bf16 v[224:227], v[36:39], a[132:135], v[224:227]
s_waitcnt lgkmcnt(4)
ds_read_b64_tr_b16 v[52:53], v17 offset:8192
v_mfma_f32_16x16x32_bf16 v[224:227], v[40:43], a[136:139], v[224:227]
s_waitcnt lgkmcnt(3)
v_mfma_f32_16x16x32_bf16 v[224:227], v[44:47], a[140:143], v[224:227]
ds_read_b64_tr_b16 v[54:55], v17 offset:9216
v_mfma_f32_16x16x32_bf16 v[228:231], v[32:35], a[144:147], v[228:231]
buffer_load_dwordx4 v9, s[24:27], s54 offen offset:3072  lds
v_mfma_f32_16x16x32_bf16 v[228:231], v[36:39], a[148:151], v[228:231]
ds_read_b64_tr_b16 v[56:57], v17 offset:16384
v_mfma_f32_16x16x32_bf16 v[228:231], v[40:43], a[152:155], v[228:231]
v_mfma_f32_16x16x32_bf16 v[228:231], v[44:47], a[156:159], v[228:231]
ds_read_b64_tr_b16 v[58:59], v17 offset:17408
v_mfma_f32_16x16x32_bf16 v[232:235], v[32:35], a[160:163], v[232:235]
buffer_load_dword v31, v24, s[36:39], s22 offen
v_mfma_f32_16x16x32_bf16 v[232:235], v[36:39], a[164:167], v[232:235]
ds_read_b64_tr_b16 v[60:61], v17 offset:24576
v_mfma_f32_16x16x32_bf16 v[232:235], v[40:43], a[168:171], v[232:235]
v_mfma_f32_16x16x32_bf16 v[232:235], v[44:47], a[172:175], v[232:235]
ds_read_b64_tr_b16 v[62:63], v17 offset:25600
v_mfma_f32_16x16x32_bf16 v[236:239], v[32:35], a[176:179], v[236:239]
v_add_u32 v17, 0x10000, v17
v_mfma_f32_16x16x32_bf16 v[236:239], v[36:39], a[180:183], v[236:239]
v_mfma_f32_16x16x32_bf16 v[236:239], v[40:43], a[184:187], v[236:239]
v_mfma_f32_16x16x32_bf16 v[236:239], v[44:47], a[188:191], v[236:239]
s_waitcnt lgkmcnt(6)
v_mfma_f32_16x16x32_bf16 v[240:243], v[48:51], a[128:131], v[240:243]
s_waitcnt vmcnt(27)
s_waitcnt lgkmcnt(0)
s_barrier
v_mfma_f32_16x16x32_bf16 v[240:243], v[52:55], a[132:135], v[240:243]
s_and_b32 s12, s2, 7
ds_read_b64_tr_b16 v[32:33], v22 offset:0
v_mfma_f32_16x16x32_bf16 v[240:243], v[56:59], a[136:139], v[240:243]
s_lshr_b32 s14, s2, 5
ds_read_b64_tr_b16 v[34:35], v22 offset:1024
v_mfma_f32_16x16x32_bf16 v[240:243], v[60:63], a[140:143], v[240:243]
s_bfe_u32 s13, s2, 0x20003
ds_read_b64_tr_b16 v[36:37], v22 offset:4096
v_mfma_f32_16x16x32_bf16 v[244:247], v[48:51], a[144:147], v[244:247]
s_mul_i32 s51, s12, 7
ds_read_b64_tr_b16 v[38:39], v22 offset:5120
v_mfma_f32_16x16x32_bf16 v[244:247], v[52:55], a[148:151], v[244:247]
s_min_u32 s51, s51, 48
v_mfma_f32_16x16x32_bf16 v[244:247], v[56:59], a[152:155], v[244:247]
s_mul_i32 s52, s13, 320
ds_read_b64_tr_b16 v[40:41], v22 offset:8192
v_mfma_f32_16x16x32_bf16 v[244:247], v[60:63], a[156:159], v[244:247]
s_and_b32 s52, s52, -128
v_mfma_f32_16x16x32_bf16 v[248:251], v[48:51], a[160:163], v[248:251]
s_mul_i32 s15, s51, 40960
ds_read_b64_tr_b16 v[42:43], v22 offset:9216
v_mfma_f32_16x16x32_bf16 v[248:251], v[52:55], a[164:167], v[248:251]
s_add_u32 s15, s15, s52
v_mfma_f32_16x16x32_bf16 v[248:251], v[56:59], a[168:171], v[248:251]
s_mul_i32 s16, s12, 655360
ds_read_b64_tr_b16 v[44:45], v22 offset:12288
v_mfma_f32_16x16x32_bf16 v[248:251], v[60:63], a[172:175], v[248:251]
s_add_u32 s16, s16, s52
v_mfma_f32_16x16x32_bf16 v[252:255], v[48:51], a[176:179], v[252:255]
s_lshl_b32 s19, s14, 2
ds_read_b64_tr_b16 v[46:47], v22 offset:13312
v_mfma_f32_16x16x32_bf16 v[252:255], v[52:55], a[180:183], v[252:255]
s_add_u32 s19, s19, s50
ds_read_b64_tr_b16 v[48:49], v23 offset:0
v_mfma_f32_16x16x32_bf16 v[252:255], v[56:59], a[184:187], v[252:255]
s_lshl_b32 s19, s19, 1
v_mfma_f32_16x16x32_bf16 v[252:255], v[60:63], a[188:191], v[252:255]
s_waitcnt vmcnt(24) lgkmcnt(7)
s_mul_i32 s76, s19, 182
ds_read_b64_tr_b16 v[50:51], v23 offset:1024
v_mfma_f32_16x16x32_bf16 v[64:67], v[32:35], a[0:3], v[64:67]
s_waitcnt vmcnt(23) lgkmcnt(6)
s_sub_u32 s19, 126, s19
v_mfma_f32_16x16x32_bf16 v[64:67], v[36:39], a[4:7], v[64:67]
s_waitcnt vmcnt(22) lgkmcnt(4)
s_mul_i32 s78, s19, 182
ds_read_b64_tr_b16 v[52:53], v23 offset:4096
v_mfma_f32_16x16x32_bf16 v[64:67], v[40:43], a[8:11], v[64:67]
s_waitcnt vmcnt(21) lgkmcnt(3)
s_add_u32 s76, s76, s51
v_mfma_f32_16x16x32_bf16 v[64:67], v[44:47], a[12:15], v[64:67]
s_waitcnt vmcnt(20)
s_lshl_b32 s76, s76, 10
ds_read_b64_tr_b16 v[54:55], v23 offset:5120
v_mfma_f32_16x16x32_bf16 v[68:71], v[32:35], a[16:19], v[68:71]
s_waitcnt vmcnt(19)
s_lshr_b32 s3, s50, 1
v_mfma_f32_16x16x32_bf16 v[68:71], v[36:39], a[20:23], v[68:71]
s_waitcnt vmcnt(18)
s_lshl_b32 s57, s49, 1
ds_read_b64_tr_b16 v[56:57], v23 offset:8192
v_mfma_f32_16x16x32_bf16 v[68:71], v[40:43], a[24:27], v[68:71]
s_waitcnt vmcnt(17)
s_sub_u32 s59, 32, s57
v_mfma_f32_16x16x32_bf16 v[68:71], v[44:47], a[28:31], v[68:71]
s_waitcnt vmcnt(16)
s_sub_u32 s58, s59, s3
ds_read_b64_tr_b16 v[58:59], v23 offset:9216
v_mfma_f32_16x16x32_bf16 v[72:75], v[32:35], a[32:35], v[72:75]
s_waitcnt vmcnt(15)
s_add_u32 s57, s57, s3
v_mfma_f32_16x16x32_bf16 v[72:75], v[36:39], a[36:39], v[72:75]
s_waitcnt vmcnt(14)
s_add_u32 s57, s57, 1
ds_read_b64_tr_b16 v[60:61], v23 offset:12288
v_add_u32 v24, s67, v1
v_mfma_f32_16x16x32_bf16 v[72:75], v[40:43], a[40:43], v[72:75]
s_waitcnt vmcnt(13)
s_lshl_b32 s60, s48, 20
v_mfma_f32_16x16x32_bf16 v[72:75], v[44:47], a[44:47], v[72:75]
s_waitcnt vmcnt(12)
s_add_u32 s60, s60, 4202496
ds_read_b64_tr_b16 v[62:63], v23 offset:13312
v_mfma_f32_16x16x32_bf16 v[76:79], v[32:35], a[48:51], v[76:79]
s_waitcnt vmcnt(11)
s_lshl_b32 s61, s59, 14
v_mfma_f32_16x16x32_bf16 v[76:79], v[36:39], a[52:55], v[76:79]
s_waitcnt vmcnt(10)
s_add_u32 s61, s61, s60
ds_read_b64_tr_b16 v[32:33], v29 offset:0
v_mfma_f32_16x16x32_bf16 v[76:79], v[40:43], a[56:59], v[76:79]
s_waitcnt vmcnt(9)
s_mov_b32 s62, s67
v_mfma_f32_16x16x32_bf16 v[76:79], v[44:47], a[60:63], v[76:79]
s_waitcnt lgkmcnt(7)
s_mov_b32 s65, 0
ds_read_b64_tr_b16 v[34:35], v29 offset:1024
v_mfma_f32_16x16x32_bf16 v[80:83], v[48:51], a[0:3], v[80:83]
s_waitcnt lgkmcnt(6)
s_add_u32 s76, s76, 37879808
v_mfma_f32_16x16x32_bf16 v[80:83], v[52:55], a[4:7], v[80:83]
s_waitcnt lgkmcnt(4)
s_add_u32 s77, s76, 186368
ds_read_b64_tr_b16 v[36:37], v29 offset:4096
v_mfma_f32_16x16x32_bf16 v[80:83], v[56:59], a[8:11], v[80:83]
s_waitcnt lgkmcnt(3)
s_add_u32 s78, s78, s51
v_mfma_f32_16x16x32_bf16 v[80:83], v[60:63], a[12:15], v[80:83]
s_lshl_b32 s78, s78, 10
ds_read_b64_tr_b16 v[38:39], v29 offset:5120
v_mfma_f32_16x16x32_bf16 v[84:87], v[48:51], a[16:19], v[84:87]
s_add_u32 s78, s78, 37879808
v_mfma_f32_16x16x32_bf16 v[84:87], v[52:55], a[20:23], v[84:87]
s_add_u32 s79, s78, 186368
ds_read_b64_tr_b16 v[40:41], v29 offset:8192
v_lshrrev_b32 v2, 4, v1
v_mfma_f32_16x16x32_bf16 v[84:87], v[56:59], a[24:27], v[84:87]
v_add_u32 v2, 0, v2
v_mul_u32_u24 v3, 2731, v2
v_mfma_f32_16x16x32_bf16 v[84:87], v[60:63], a[28:31], v[84:87]
ds_read_b64_tr_b16 v[42:43], v29 offset:9216
v_lshrrev_b32 v3, 16, v3
v_mfma_f32_16x16x32_bf16 v[88:91], v[48:51], a[32:35], v[88:91]
v_mul_u32_u24 v4, 24, v3
v_sub_u32 v2, v2, v4
v_mfma_f32_16x16x32_bf16 v[88:91], v[52:55], a[36:39], v[88:91]
ds_read_b64_tr_b16 v[44:45], v29 offset:12288
v_and_b32 v4, 6, v3
v_mfma_f32_16x16x32_bf16 v[88:91], v[56:59], a[40:43], v[88:91]
v_xor_b32 v2, v2, v4
v_mul_u32_u24 v3, 1280, v3
v_mfma_f32_16x16x32_bf16 v[88:91], v[60:63], a[44:47], v[88:91]
ds_read_b64_tr_b16 v[46:47], v29 offset:13312
v_lshl_add_u32 v26, v2, 4, v3
v_mfma_f32_16x16x32_bf16 v[92:95], v[48:51], a[48:51], v[92:95]
v_lshrrev_b32 v2, 4, v1
v_add_u32 v2, 64, v2
v_mfma_f32_16x16x32_bf16 v[92:95], v[52:55], a[52:55], v[92:95]
ds_read_b64_tr_b16 v[48:49], v30 offset:0
v_mul_u32_u24 v3, 2731, v2
v_mfma_f32_16x16x32_bf16 v[92:95], v[56:59], a[56:59], v[92:95]
v_lshrrev_b32 v3, 16, v3
v_mul_u32_u24 v4, 24, v3
v_mfma_f32_16x16x32_bf16 v[92:95], v[60:63], a[60:63], v[92:95]
s_waitcnt lgkmcnt(7)
ds_read_b64_tr_b16 v[50:51], v30 offset:1024
v_sub_u32 v2, v2, v4
v_mfma_f32_16x16x32_bf16 v[96:99], v[32:35], a[0:3], v[96:99]
s_waitcnt lgkmcnt(6)
v_and_b32 v4, 6, v3
v_xor_b32 v2, v2, v4
v_mfma_f32_16x16x32_bf16 v[96:99], v[36:39], a[4:7], v[96:99]
s_waitcnt lgkmcnt(4)
ds_read_b64_tr_b16 v[52:53], v30 offset:4096
v_mul_u32_u24 v3, 1280, v3
v_mfma_f32_16x16x32_bf16 v[96:99], v[40:43], a[8:11], v[96:99]
s_waitcnt lgkmcnt(3)
v_lshl_add_u32 v27, v2, 4, v3
v_subrev_u32 v27, 1024, v27
v_mfma_f32_16x16x32_bf16 v[96:99], v[44:47], a[12:15], v[96:99]
ds_read_b64_tr_b16 v[54:55], v30 offset:5120
v_lshrrev_b32 v2, 4, v1
v_mfma_f32_16x16x32_bf16 v[100:103], v[32:35], a[16:19], v[100:103]
v_add_u32 v2, 128, v2
v_mul_u32_u24 v3, 2731, v2
v_mfma_f32_16x16x32_bf16 v[100:103], v[36:39], a[20:23], v[100:103]
ds_read_b64_tr_b16 v[56:57], v30 offset:8192
v_lshrrev_b32 v3, 16, v3
v_mfma_f32_16x16x32_bf16 v[100:103], v[40:43], a[24:27], v[100:103]
v_mul_u32_u24 v4, 24, v3
v_sub_u32 v2, v2, v4
v_mfma_f32_16x16x32_bf16 v[100:103], v[44:47], a[28:31], v[100:103]
ds_read_b64_tr_b16 v[58:59], v30 offset:9216
v_and_b32 v4, 6, v3
v_mfma_f32_16x16x32_bf16 v[104:107], v[32:35], a[32:35], v[104:107]
v_xor_b32 v2, v2, v4
v_mul_u32_u24 v3, 1280, v3
v_mfma_f32_16x16x32_bf16 v[104:107], v[36:39], a[36:39], v[104:107]
ds_read_b64_tr_b16 v[60:61], v30 offset:12288
v_lshl_add_u32 v28, v2, 4, v3
v_mfma_f32_16x16x32_bf16 v[104:107], v[40:43], a[40:43], v[104:107]
v_subrev_u32 v28, 2048, v28
v_lshrrev_b32 v4, 6, v1
v_mfma_f32_16x16x32_bf16 v[104:107], v[44:47], a[44:47], v[104:107]
ds_read_b64_tr_b16 v[62:63], v30 offset:13312
v_mul_u32_u24 v5, 384, v4
v_mfma_f32_16x16x32_bf16 v[108:111], v[32:35], a[48:51], v[108:111]
v_bfe_u32 v2, v1, 4, 2
v_lshl_add_u32 v5, v2, 3, v5
v_mfma_f32_16x16x32_bf16 v[108:111], v[36:39], a[52:55], v[108:111]
ds_read_b64_tr_b16 v[32:33], v10 offset:0
v_bfe_u32 v4, v4, 1, 2
v_mfma_f32_16x16x32_bf16 v[108:111], v[40:43], a[56:59], v[108:111]
s_and_b32 s19, s13, 1
v_mul_f32 v18, 0xbfb8aa3b, v64
v_mul_f32 v19, 0xbfb8aa3b, v65
v_mfma_f32_16x16x32_bf16 v[108:111], v[44:47], a[60:63], v[108:111]
s_waitcnt lgkmcnt(7)
s_lshl_b32 s19, s19, 1
ds_read_b64_tr_b16 v[34:35], v10 offset:1024
v_mul_f32 v20, 0xbfb8aa3b, v66
v_mfma_f32_16x16x32_bf16 v[112:115], v[48:51], a[0:3], v[112:115]
s_waitcnt lgkmcnt(6)
s_add_u32 s51, s19, 0
v_exp_f32 v18, v18
v_mfma_f32_16x16x32_bf16 v[112:115], v[52:55], a[4:7], v[112:115]
s_waitcnt lgkmcnt(4)
s_lshr_b32 s52, s51, 2
ds_read_b64_tr_b16 v[36:37], v10 offset:8192
v_add_f32 v18, 1.0, v18
v_mfma_f32_16x16x32_bf16 v[112:115], v[56:59], a[8:11], v[112:115]
s_waitcnt lgkmcnt(3)
s_lshl_b32 s52, s52, 7
v_rcp_f32 v18, v18
v_mfma_f32_16x16x32_bf16 v[112:115], v[60:63], a[12:15], v[112:115]
s_add_u32 s52, s52, 139264
ds_read_b64_tr_b16 v[38:39], v10 offset:9216
v_mul_f32 v64, v64, v18
v_mfma_f32_16x16x32_bf16 v[116:119], v[48:51], a[16:19], v[116:119]
s_and_b32 s51, s51, 3
v_xor_b32 v6, s51, v4
v_lshl_add_u32 v6, v6, 5, v5
v_mfma_f32_16x16x32_bf16 v[116:119], v[52:55], a[20:23], v[116:119]
ds_read_b64_tr_b16 v[40:41], v10 offset:16384
v_add_u32 v6, s52, v6
v_mfma_f32_16x16x32_bf16 v[116:119], v[56:59], a[24:27], v[116:119]
s_add_u32 s51, s19, 1
v_exp_f32 v19, v19
v_mfma_f32_16x16x32_bf16 v[116:119], v[60:63], a[28:31], v[116:119]
s_lshr_b32 s52, s51, 2
ds_read_b64_tr_b16 v[42:43], v10 offset:17408
v_add_f32 v19, 1.0, v19
v_mfma_f32_16x16x32_bf16 v[120:123], v[48:51], a[32:35], v[120:123]
s_lshl_b32 s52, s52, 7
v_rcp_f32 v19, v19
v_mfma_f32_16x16x32_bf16 v[120:123], v[52:55], a[36:39], v[120:123]
s_add_u32 s52, s52, 139264
ds_read_b64_tr_b16 v[44:45], v10 offset:24576
v_mul_f32 v65, v65, v19
v_mfma_f32_16x16x32_bf16 v[120:123], v[56:59], a[40:43], v[120:123]
s_and_b32 s51, s51, 3
v_xor_b32 v7, s51, v4
v_lshl_add_u32 v7, v7, 5, v5
v_mfma_f32_16x16x32_bf16 v[120:123], v[60:63], a[44:47], v[120:123]
ds_read_b64_tr_b16 v[46:47], v10 offset:25600
v_add_u32 v7, s52, v7
v_mfma_f32_16x16x32_bf16 v[124:127], v[48:51], a[48:51], v[124:127]
s_add_u32 s51, s19, 2
v_add_u32 v10, 0xffff8000, v10
v_mul_f32 v21, 0xbfb8aa3b, v67
v_mfma_f32_16x16x32_bf16 v[124:127], v[52:55], a[52:55], v[124:127]
s_lshr_b32 s52, s51, 2
ds_read_b64_tr_b16 v[48:49], v11 offset:0
v_mul_f32 v18, 0xbfb8aa3b, v80
v_mfma_f32_16x16x32_bf16 v[124:127], v[56:59], a[56:59], v[124:127]
s_lshl_b32 s52, s52, 7
v_exp_f32 v20, v20
v_mfma_f32_16x16x32_bf16 v[124:127], v[60:63], a[60:63], v[124:127]
s_waitcnt lgkmcnt(7)
s_add_u32 s52, s52, 139264
ds_read_b64_tr_b16 v[50:51], v11 offset:1024
v_add_f32 v20, 1.0, v20
v_mfma_f32_16x16x32_bf16 v[128:131], v[32:35], a[192:195], v[128:131]
s_waitcnt lgkmcnt(6)
s_and_b32 s51, s51, 3
v_xor_b32 v8, s51, v4
v_lshl_add_u32 v8, v8, 5, v5
v_mfma_f32_16x16x32_bf16 v[128:131], v[36:39], a[196:199], v[128:131]
s_waitcnt lgkmcnt(4)
ds_read_b64_tr_b16 v[52:53], v11 offset:8192
v_add_u32 v8, s52, v8
v_mfma_f32_16x16x32_bf16 v[128:131], v[40:43], a[200:203], v[128:131]
s_waitcnt lgkmcnt(3)
s_add_u32 s51, s19, 3
v_rcp_f32 v20, v20
v_mfma_f32_16x16x32_bf16 v[128:131], v[44:47], a[204:207], v[128:131]
s_lshr_b32 s52, s51, 2
ds_read_b64_tr_b16 v[54:55], v11 offset:9216
v_mul_f32 v66, v66, v20
v_mfma_f32_16x16x32_bf16 v[132:135], v[32:35], a[208:211], v[132:135]
s_lshl_b32 s52, s52, 7
v_exp_f32 v21, v21
v_mfma_f32_16x16x32_bf16 v[132:135], v[36:39], a[212:215], v[132:135]
s_add_u32 s52, s52, 139264
ds_read_b64_tr_b16 v[56:57], v11 offset:16384
v_add_f32 v21, 1.0, v21
v_mfma_f32_16x16x32_bf16 v[132:135], v[40:43], a[216:219], v[132:135]
s_and_b32 s51, s51, 3
v_xor_b32 v9, s51, v4
v_lshl_add_u32 v9, v9, 5, v5
v_mfma_f32_16x16x32_bf16 v[132:135], v[44:47], a[220:223], v[132:135]
ds_read_b64_tr_b16 v[58:59], v11 offset:17408
v_add_u32 v9, s52, v9
v_mfma_f32_16x16x32_bf16 v[136:139], v[32:35], a[224:227], v[136:139]
v_rcp_f32 v21, v21
v_mfma_f32_16x16x32_bf16 v[136:139], v[36:39], a[228:231], v[136:139]
ds_read_b64_tr_b16 v[60:61], v11 offset:24576
v_mul_f32 v67, v67, v21
v_mfma_f32_16x16x32_bf16 v[136:139], v[40:43], a[232:235], v[136:139]
v_exp_f32 v18, v18
v_mfma_f32_16x16x32_bf16 v[136:139], v[44:47], a[236:239], v[136:139]
ds_read_b64_tr_b16 v[62:63], v11 offset:25600
v_add_f32 v18, 1.0, v18
v_mfma_f32_16x16x32_bf16 v[140:143], v[32:35], a[240:243], v[140:143]
v_add_u32 v11, 0xffff8000, v11
v_mul_f32 v19, 0xbfb8aa3b, v81
v_mfma_f32_16x16x32_bf16 v[140:143], v[36:39], a[244:247], v[140:143]
ds_read_b64_tr_b16 v[32:33], v12 offset:0
v_mul_f32 v20, 0xbfb8aa3b, v82
v_mfma_f32_16x16x32_bf16 v[140:143], v[40:43], a[248:251], v[140:143]
v_rcp_f32 v18, v18
v_mfma_f32_16x16x32_bf16 v[140:143], v[44:47], a[252:255], v[140:143]
s_waitcnt lgkmcnt(7)
ds_read_b64_tr_b16 v[34:35], v12 offset:1024
v_mul_f32 v80, v80, v18
v_mfma_f32_16x16x32_bf16 v[144:147], v[48:51], a[192:195], v[144:147]
s_waitcnt lgkmcnt(6)
v_exp_f32 v19, v19
v_mfma_f32_16x16x32_bf16 v[144:147], v[52:55], a[196:199], v[144:147]
s_waitcnt lgkmcnt(4)
ds_read_b64_tr_b16 v[36:37], v12 offset:8192
v_add_f32 v19, 1.0, v19
v_mfma_f32_16x16x32_bf16 v[144:147], v[56:59], a[200:203], v[144:147]
s_waitcnt lgkmcnt(3)
v_rcp_f32 v19, v19
v_mfma_f32_16x16x32_bf16 v[144:147], v[60:63], a[204:207], v[144:147]
ds_read_b64_tr_b16 v[38:39], v12 offset:9216
v_mul_f32 v81, v81, v19
v_mfma_f32_16x16x32_bf16 v[148:151], v[48:51], a[208:211], v[148:151]
v_exp_f32 v20, v20
v_mfma_f32_16x16x32_bf16 v[148:151], v[52:55], a[212:215], v[148:151]
ds_read_b64_tr_b16 v[40:41], v12 offset:16384
v_add_f32 v20, 1.0, v20
v_mfma_f32_16x16x32_bf16 v[148:151], v[56:59], a[216:219], v[148:151]
v_rcp_f32 v20, v20
v_mfma_f32_16x16x32_bf16 v[148:151], v[60:63], a[220:223], v[148:151]
ds_read_b64_tr_b16 v[42:43], v12 offset:17408
v_mul_f32 v21, 0xbfb8aa3b, v83
v_mfma_f32_16x16x32_bf16 v[152:155], v[48:51], a[224:227], v[152:155]
v_exp_f32 v21, v21
v_mfma_f32_16x16x32_bf16 v[152:155], v[52:55], a[228:231], v[152:155]
ds_read_b64_tr_b16 v[44:45], v12 offset:24576
v_add_f32 v21, 1.0, v21
v_mfma_f32_16x16x32_bf16 v[152:155], v[56:59], a[232:235], v[152:155]
v_rcp_f32 v21, v21
v_mfma_f32_16x16x32_bf16 v[152:155], v[60:63], a[236:239], v[152:155]
ds_read_b64_tr_b16 v[46:47], v12 offset:25600
v_mul_f32 v18, 0xbfb8aa3b, v68
v_mfma_f32_16x16x32_bf16 v[156:159], v[48:51], a[240:243], v[156:159]
v_add_u32 v12, 0xffff8000, v12
v_mul_f32 v82, v82, v20
v_mfma_f32_16x16x32_bf16 v[156:159], v[52:55], a[244:247], v[156:159]
ds_read_b64_tr_b16 v[48:49], v13 offset:0
v_mul_f32 v83, v83, v21
v_mfma_f32_16x16x32_bf16 v[156:159], v[56:59], a[248:251], v[156:159]
v_exp_f32 v18, v18
v_mfma_f32_16x16x32_bf16 v[156:159], v[60:63], a[252:255], v[156:159]
s_waitcnt lgkmcnt(7)
ds_read_b64_tr_b16 v[50:51], v13 offset:1024
v_add_f32 v18, 1.0, v18
v_mfma_f32_16x16x32_bf16 v[160:163], v[32:35], a[192:195], v[160:163]
s_waitcnt lgkmcnt(6)
v_rcp_f32 v18, v18
v_mfma_f32_16x16x32_bf16 v[160:163], v[36:39], a[196:199], v[160:163]
s_waitcnt lgkmcnt(4)
ds_read_b64_tr_b16 v[52:53], v13 offset:8192
v_mul_f32 v19, 0xbfb8aa3b, v69
v_mfma_f32_16x16x32_bf16 v[160:163], v[40:43], a[200:203], v[160:163]
s_waitcnt lgkmcnt(3)
v_exp_f32 v19, v19
v_mfma_f32_16x16x32_bf16 v[160:163], v[44:47], a[204:207], v[160:163]
ds_read_b64_tr_b16 v[54:55], v13 offset:9216
v_add_f32 v19, 1.0, v19
v_mfma_f32_16x16x32_bf16 v[164:167], v[32:35], a[208:211], v[164:167]
v_rcp_f32 v19, v19
v_mfma_f32_16x16x32_bf16 v[164:167], v[36:39], a[212:215], v[164:167]
ds_read_b64_tr_b16 v[56:57], v13 offset:16384
v_mul_f32 v20, 0xbfb8aa3b, v70
v_mfma_f32_16x16x32_bf16 v[164:167], v[40:43], a[216:219], v[164:167]
v_exp_f32 v20, v20
v_mfma_f32_16x16x32_bf16 v[164:167], v[44:47], a[220:223], v[164:167]
ds_read_b64_tr_b16 v[58:59], v13 offset:17408
v_add_f32 v20, 1.0, v20
v_mfma_f32_16x16x32_bf16 v[168:171], v[32:35], a[224:227], v[168:171]
v_rcp_f32 v20, v20
v_mfma_f32_16x16x32_bf16 v[168:171], v[36:39], a[228:231], v[168:171]
ds_read_b64_tr_b16 v[60:61], v13 offset:24576
v_mul_f32 v21, 0xbfb8aa3b, v71
v_mfma_f32_16x16x32_bf16 v[168:171], v[40:43], a[232:235], v[168:171]
v_exp_f32 v21, v21
v_mfma_f32_16x16x32_bf16 v[168:171], v[44:47], a[236:239], v[168:171]
ds_read_b64_tr_b16 v[62:63], v13 offset:25600
v_add_f32 v21, 1.0, v21
v_mfma_f32_16x16x32_bf16 v[172:175], v[32:35], a[240:243], v[172:175]
v_add_u32 v13, 0xffff8000, v13
v_cvt_pk_bf16_f32 v2, v64, v65
v_mfma_f32_16x16x32_bf16 v[172:175], v[36:39], a[244:247], v[172:175]
ds_read_b64_tr_b16 v[32:33], v14 offset:0
v_cvt_pk_bf16_f32 v3, v66, v67
v_mfma_f32_16x16x32_bf16 v[172:175], v[40:43], a[248:251], v[172:175]
v_rcp_f32 v21, v21
v_mfma_f32_16x16x32_bf16 v[172:175], v[44:47], a[252:255], v[172:175]
s_waitcnt lgkmcnt(7)
ds_read_b64_tr_b16 v[34:35], v14 offset:1024
v_cvt_pk_bf16_f32 v4, v80, v81
v_mfma_f32_16x16x32_bf16 v[176:179], v[48:51], a[192:195], v[176:179]
s_waitcnt lgkmcnt(6)
v_cvt_pk_bf16_f32 v5, v82, v83
v_mul_f32 v68, v68, v18
v_mfma_f32_16x16x32_bf16 v[176:179], v[52:55], a[196:199], v[176:179]
s_waitcnt lgkmcnt(4)
s_add_u32 s55, s66, s80
ds_read_b64_tr_b16 v[36:37], v14 offset:8192
v_mul_f32 v18, 0xbfb8aa3b, v84
v_mfma_f32_16x16x32_bf16 v[176:179], v[56:59], a[200:203], v[176:179]
s_waitcnt lgkmcnt(3)
buffer_store_dwordx4 v[2:5], v1, s[4:7], s55 offen offset:0 sc1
v_mfma_f32_16x16x32_bf16 v[176:179], v[60:63], a[204:207], v[176:179]
ds_read_b64_tr_b16 v[38:39], v14 offset:9216
v_mul_f32 v69, v69, v19
v_mfma_f32_16x16x32_bf16 v[180:183], v[48:51], a[208:211], v[180:183]
v_exp_f32 v18, v18
v_mfma_f32_16x16x32_bf16 v[180:183], v[52:55], a[212:215], v[180:183]
ds_read_b64_tr_b16 v[40:41], v14 offset:16384
v_add_f32 v18, 1.0, v18
v_mfma_f32_16x16x32_bf16 v[180:183], v[56:59], a[216:219], v[180:183]
v_rcp_f32 v18, v18
v_mfma_f32_16x16x32_bf16 v[180:183], v[60:63], a[220:223], v[180:183]
ds_read_b64_tr_b16 v[42:43], v14 offset:17408
v_mul_f32 v19, 0xbfb8aa3b, v85
v_mfma_f32_16x16x32_bf16 v[184:187], v[48:51], a[224:227], v[184:187]
v_exp_f32 v19, v19
v_mfma_f32_16x16x32_bf16 v[184:187], v[52:55], a[228:231], v[184:187]
ds_read_b64_tr_b16 v[44:45], v14 offset:24576
v_add_f32 v19, 1.0, v19
v_mfma_f32_16x16x32_bf16 v[184:187], v[56:59], a[232:235], v[184:187]
v_rcp_f32 v19, v19
v_mfma_f32_16x16x32_bf16 v[184:187], v[60:63], a[236:239], v[184:187]
ds_read_b64_tr_b16 v[46:47], v14 offset:25600
v_mul_f32 v70, v70, v20
v_mfma_f32_16x16x32_bf16 v[188:191], v[48:51], a[240:243], v[188:191]
v_add_u32 v14, 0xffff8000, v14
v_mul_f32 v20, 0xbfb8aa3b, v86
v_mfma_f32_16x16x32_bf16 v[188:191], v[52:55], a[244:247], v[188:191]
ds_read_b64_tr_b16 v[48:49], v15 offset:0
v_mul_f32 v71, v71, v21
v_mfma_f32_16x16x32_bf16 v[188:191], v[56:59], a[248:251], v[188:191]
v_exp_f32 v20, v20
v_mfma_f32_16x16x32_bf16 v[188:191], v[60:63], a[252:255], v[188:191]
s_waitcnt lgkmcnt(7)
ds_read_b64_tr_b16 v[50:51], v15 offset:1024
v_add_f32 v20, 1.0, v20
v_mfma_f32_16x16x32_bf16 v[192:195], v[32:35], a[192:195], v[192:195]
s_waitcnt lgkmcnt(6)
s_lshl_b32 s1, s48, 8
v_rcp_f32 v20, v20
v_mfma_f32_16x16x32_bf16 v[192:195], v[36:39], a[196:199], v[192:195]
s_waitcnt lgkmcnt(4)
s_add_u32 s1, s1, 85983232
ds_read_b64_tr_b16 v[52:53], v15 offset:8192
v_lshl_add_u32 v23, s50, 10, v1
v_mfma_f32_16x16x32_bf16 v[192:195], v[40:43], a[200:203], v[192:195]
s_waitcnt lgkmcnt(3)
v_cmp_gt_u32 vcc, 16, v23
v_lshlrev_b32 v22, 4, v1
v_mfma_f32_16x16x32_bf16 v[192:195], v[44:47], a[204:207], v[192:195]
ds_read_b64_tr_b16 v[54:55], v15 offset:9216
v_mov_b32 v29, 2130706432
v_mfma_f32_16x16x32_bf16 v[196:199], v[32:35], a[208:211], v[196:199]
v_mov_b32 v23, 8
v_cndmask_b32 v22, v29, v22, vcc
v_mfma_f32_16x16x32_bf16 v[196:199], v[36:39], a[212:215], v[196:199]
ds_read_b64_tr_b16 v[56:57], v15 offset:16384
v_cndmask_b32 v23, 0, v23, vcc
v_mfma_f32_16x16x32_bf16 v[196:199], v[40:43], a[216:219], v[196:199]
buffer_load_dword v29, v22, s[4:7], s1 offen sc1
v_mfma_f32_16x16x32_bf16 v[196:199], v[44:47], a[220:223], v[196:199]
ds_read_b64_tr_b16 v[58:59], v15 offset:17408
v_mul_f32 v21, 0xbfb8aa3b, v87
v_mfma_f32_16x16x32_bf16 v[200:203], v[32:35], a[224:227], v[200:203]
v_exp_f32 v21, v21
v_mfma_f32_16x16x32_bf16 v[200:203], v[36:39], a[228:231], v[200:203]
ds_read_b64_tr_b16 v[60:61], v15 offset:24576
v_add_f32 v21, 1.0, v21
v_mfma_f32_16x16x32_bf16 v[200:203], v[40:43], a[232:235], v[200:203]
v_rcp_f32 v21, v21
v_mfma_f32_16x16x32_bf16 v[200:203], v[44:47], a[236:239], v[200:203]
ds_read_b64_tr_b16 v[62:63], v15 offset:25600
v_mul_f32 v84, v84, v18
v_mfma_f32_16x16x32_bf16 v[204:207], v[32:35], a[240:243], v[204:207]
v_add_u32 v15, 0xffff8000, v15
v_mul_f32 v18, 0xbfb8aa3b, v72
v_mfma_f32_16x16x32_bf16 v[204:207], v[36:39], a[244:247], v[204:207]
ds_read_b64_tr_b16 v[32:33], v16 offset:0
v_mul_f32 v85, v85, v19
v_mfma_f32_16x16x32_bf16 v[204:207], v[40:43], a[248:251], v[204:207]
v_exp_f32 v18, v18
v_mfma_f32_16x16x32_bf16 v[204:207], v[44:47], a[252:255], v[204:207]
s_waitcnt lgkmcnt(7)
ds_read_b64_tr_b16 v[34:35], v16 offset:1024
v_add_f32 v18, 1.0, v18
v_mfma_f32_16x16x32_bf16 v[208:211], v[48:51], a[192:195], v[208:211]
s_waitcnt lgkmcnt(6)
v_rcp_f32 v18, v18
v_mfma_f32_16x16x32_bf16 v[208:211], v[52:55], a[196:199], v[208:211]
s_waitcnt lgkmcnt(4)
ds_read_b64_tr_b16 v[36:37], v16 offset:8192
v_mul_f32 v19, 0xbfb8aa3b, v73
v_mfma_f32_16x16x32_bf16 v[208:211], v[56:59], a[200:203], v[208:211]
s_waitcnt lgkmcnt(3)
v_exp_f32 v19, v19
v_mfma_f32_16x16x32_bf16 v[208:211], v[60:63], a[204:207], v[208:211]
ds_read_b64_tr_b16 v[38:39], v16 offset:9216
v_add_f32 v19, 1.0, v19
v_mfma_f32_16x16x32_bf16 v[212:215], v[48:51], a[208:211], v[212:215]
v_rcp_f32 v19, v19
v_mfma_f32_16x16x32_bf16 v[212:215], v[52:55], a[212:215], v[212:215]
ds_read_b64_tr_b16 v[40:41], v16 offset:16384
v_mul_f32 v86, v86, v20
v_mfma_f32_16x16x32_bf16 v[212:215], v[56:59], a[216:219], v[212:215]
v_mul_f32 v20, 0xbfb8aa3b, v74
v_mul_f32 v87, v87, v21
v_mfma_f32_16x16x32_bf16 v[212:215], v[60:63], a[220:223], v[212:215]
ds_read_b64_tr_b16 v[42:43], v16 offset:17408
v_cvt_pk_bf16_f32 v2, v68, v69
v_mfma_f32_16x16x32_bf16 v[216:219], v[48:51], a[224:227], v[216:219]
v_exp_f32 v20, v20
v_mfma_f32_16x16x32_bf16 v[216:219], v[52:55], a[228:231], v[216:219]
ds_read_b64_tr_b16 v[44:45], v16 offset:24576
v_add_f32 v20, 1.0, v20
v_mfma_f32_16x16x32_bf16 v[216:219], v[56:59], a[232:235], v[216:219]
v_rcp_f32 v20, v20
v_mfma_f32_16x16x32_bf16 v[216:219], v[60:63], a[236:239], v[216:219]
ds_read_b64_tr_b16 v[46:47], v16 offset:25600
v_mul_f32 v21, 0xbfb8aa3b, v75
v_mfma_f32_16x16x32_bf16 v[220:223], v[48:51], a[240:243], v[220:223]
v_add_u32 v16, 0xffff8000, v16
v_cvt_pk_bf16_f32 v3, v70, v71
v_mfma_f32_16x16x32_bf16 v[220:223], v[52:55], a[244:247], v[220:223]
ds_read_b64_tr_b16 v[48:49], v17 offset:0
v_cvt_pk_bf16_f32 v4, v84, v85
v_mfma_f32_16x16x32_bf16 v[220:223], v[56:59], a[248:251], v[220:223]
v_exp_f32 v21, v21
v_mfma_f32_16x16x32_bf16 v[220:223], v[60:63], a[252:255], v[220:223]
s_waitcnt lgkmcnt(7)
ds_read_b64_tr_b16 v[50:51], v17 offset:1024
v_add_f32 v21, 1.0, v21
v_mfma_f32_16x16x32_bf16 v[224:227], v[32:35], a[192:195], v[224:227]
s_waitcnt lgkmcnt(6)
v_rcp_f32 v21, v21
v_mfma_f32_16x16x32_bf16 v[224:227], v[36:39], a[196:199], v[224:227]
s_waitcnt lgkmcnt(4)
ds_read_b64_tr_b16 v[52:53], v17 offset:8192
v_cvt_pk_bf16_f32 v5, v86, v87
v_mfma_f32_16x16x32_bf16 v[224:227], v[40:43], a[200:203], v[224:227]
s_waitcnt lgkmcnt(3)
s_add_u32 s55, s66, s81
buffer_store_dwordx4 v[2:5], v1, s[4:7], s55 offen offset:0 sc1
v_mfma_f32_16x16x32_bf16 v[224:227], v[44:47], a[204:207], v[224:227]
ds_read_b64_tr_b16 v[54:55], v17 offset:9216
v_mul_f32 v72, v72, v18
v_mfma_f32_16x16x32_bf16 v[228:231], v[32:35], a[208:211], v[228:231]
v_mul_f32 v18, 0xbfb8aa3b, v88
v_mul_f32 v73, v73, v19
v_mfma_f32_16x16x32_bf16 v[228:231], v[36:39], a[212:215], v[228:231]
ds_read_b64_tr_b16 v[56:57], v17 offset:16384
v_mul_f32 v74, v74, v20
v_mfma_f32_16x16x32_bf16 v[228:231], v[40:43], a[216:219], v[228:231]
v_exp_f32 v18, v18
v_mfma_f32_16x16x32_bf16 v[228:231], v[44:47], a[220:223], v[228:231]
ds_read_b64_tr_b16 v[58:59], v17 offset:17408
v_add_f32 v18, 1.0, v18
v_mfma_f32_16x16x32_bf16 v[232:235], v[32:35], a[224:227], v[232:235]
v_rcp_f32 v18, v18
v_mfma_f32_16x16x32_bf16 v[232:235], v[36:39], a[228:231], v[232:235]
ds_read_b64_tr_b16 v[60:61], v17 offset:24576
v_mul_f32 v19, 0xbfb8aa3b, v89
v_mfma_f32_16x16x32_bf16 v[232:235], v[40:43], a[232:235], v[232:235]
v_exp_f32 v19, v19
v_mfma_f32_16x16x32_bf16 v[232:235], v[44:47], a[236:239], v[232:235]
ds_read_b64_tr_b16 v[62:63], v17 offset:25600
v_add_f32 v19, 1.0, v19
v_mfma_f32_16x16x32_bf16 v[236:239], v[32:35], a[240:243], v[236:239]
v_add_u32 v17, 0xffff8000, v17
v_mul_f32 v75, v75, v21
v_mfma_f32_16x16x32_bf16 v[236:239], v[36:39], a[244:247], v[236:239]
v_rcp_f32 v19, v19
v_mfma_f32_16x16x32_bf16 v[236:239], v[40:43], a[248:251], v[236:239]
v_mul_f32 v20, 0xbfb8aa3b, v90
v_mul_f32 v21, 0xbfb8aa3b, v91
v_mfma_f32_16x16x32_bf16 v[236:239], v[44:47], a[252:255], v[236:239]
s_waitcnt vmcnt(1)
v_exp_f32 v20, v20
v_cmp_ge_u32 vcc, v29, v23
s_nop 3
s_cmp_eq_u64 vcc, -1
s_cbranch_scc0 L_spin_kvH
L_back_kvH:
s_waitcnt lgkmcnt(6)
v_mfma_f32_16x16x32_bf16 v[240:243], v[48:51], a[192:195], v[240:243]
s_waitcnt lgkmcnt(0)
s_barrier
v_exp_f32 v21, v21
v_mfma_f32_16x16x32_bf16 v[240:243], v[52:55], a[196:199], v[240:243]
ds_read_b64_tr_b16 v[32:33], v10 offset:0
v_add_f32 v20, 1.0, v20
v_mfma_f32_16x16x32_bf16 v[240:243], v[56:59], a[200:203], v[240:243]
ds_read_b64_tr_b16 v[34:35], v10 offset:1024
v_mul_f32 v88, v88, v18
v_mfma_f32_16x16x32_bf16 v[240:243], v[60:63], a[204:207], v[240:243]
ds_read_b64_tr_b16 v[36:37], v10 offset:8192
v_mul_f32 v89, v89, v19
v_mfma_f32_16x16x32_bf16 v[244:247], v[48:51], a[208:211], v[244:247]
ds_read_b64_tr_b16 v[38:39], v10 offset:9216
v_add_f32 v21, 1.0, v21
v_mfma_f32_16x16x32_bf16 v[244:247], v[52:55], a[212:215], v[244:247]
v_rcp_f32 v20, v20
v_mfma_f32_16x16x32_bf16 v[244:247], v[56:59], a[216:219], v[244:247]
ds_read_b64_tr_b16 v[40:41], v10 offset:16384
v_mul_f32 v90, v90, v20
v_mfma_f32_16x16x32_bf16 v[244:247], v[60:63], a[220:223], v[244:247]
v_rcp_f32 v21, v21
v_mfma_f32_16x16x32_bf16 v[248:251], v[48:51], a[224:227], v[248:251]
ds_read_b64_tr_b16 v[42:43], v10 offset:17408
v_mul_f32 v18, 0xbfb8aa3b, v76
v_mfma_f32_16x16x32_bf16 v[248:251], v[52:55], a[228:231], v[248:251]
v_exp_f32 v18, v18
v_mfma_f32_16x16x32_bf16 v[248:251], v[56:59], a[232:235], v[248:251]
ds_read_b64_tr_b16 v[44:45], v10 offset:24576
v_add_f32 v18, 1.0, v18
v_mfma_f32_16x16x32_bf16 v[248:251], v[60:63], a[236:239], v[248:251]
v_rcp_f32 v18, v18
v_mfma_f32_16x16x32_bf16 v[252:255], v[48:51], a[240:243], v[252:255]
ds_read_b64_tr_b16 v[46:47], v10 offset:25600
v_mul_f32 v19, 0xbfb8aa3b, v77
v_mfma_f32_16x16x32_bf16 v[252:255], v[52:55], a[244:247], v[252:255]
ds_read_b64_tr_b16 v[48:49], v11 offset:0
v_mul_f32 v91, v91, v21
v_mfma_f32_16x16x32_bf16 v[252:255], v[56:59], a[248:251], v[252:255]
v_exp_f32 v19, v19
v_mfma_f32_16x16x32_bf16 v[252:255], v[60:63], a[252:255], v[252:255]
s_waitcnt lgkmcnt(7)
ds_read_b64_tr_b16 v[50:51], v11 offset:1024
v_add_f32 v19, 1.0, v19
v_mfma_f32_16x16x32_bf16 v[128:131], v[32:35], a[0:3], v[128:131]
s_waitcnt lgkmcnt(6)
v_rcp_f32 v19, v19
v_mfma_f32_16x16x32_bf16 v[128:131], v[36:39], a[4:7], v[128:131]
s_waitcnt lgkmcnt(4)
ds_read_b64_tr_b16 v[52:53], v11 offset:8192
v_mul_f32 v20, 0xbfb8aa3b, v78
v_mfma_f32_16x16x32_bf16 v[128:131], v[40:43], a[8:11], v[128:131]
s_waitcnt lgkmcnt(3)
s_lshr_b32 s54, s67, 1
v_exp_f32 v20, v20
v_mfma_f32_16x16x32_bf16 v[128:131], v[44:47], a[12:15], v[128:131]
s_add_u32 m0, s54, 131072
ds_read_b64_tr_b16 v[54:55], v11 offset:9216
v_add_f32 v20, 1.0, v20
v_mfma_f32_16x16x32_bf16 v[132:135], v[32:35], a[16:19], v[132:135]
s_add_u32 s54, s54, s60
v_rcp_f32 v20, v20
v_mfma_f32_16x16x32_bf16 v[132:135], v[36:39], a[20:23], v[132:135]
s_sub_u32 s54, s54, 8192
ds_read_b64_tr_b16 v[56:57], v11 offset:16384
v_mul_f32 v21, 0xbfb8aa3b, v79
v_mfma_f32_16x16x32_bf16 v[132:135], v[40:43], a[24:27], v[132:135]
buffer_load_dwordx4 v1, s[4:7], s54 offen offset:0 sc1 lds
v_mfma_f32_16x16x32_bf16 v[132:135], v[44:47], a[28:31], v[132:135]
ds_read_b64_tr_b16 v[58:59], v11 offset:17408
v_cvt_pk_bf16_f32 v2, v72, v73
v_mfma_f32_16x16x32_bf16 v[136:139], v[32:35], a[32:35], v[136:139]
v_exp_f32 v21, v21
v_mfma_f32_16x16x32_bf16 v[136:139], v[36:39], a[36:39], v[136:139]
ds_read_b64_tr_b16 v[60:61], v11 offset:24576
v_add_f32 v21, 1.0, v21
v_mfma_f32_16x16x32_bf16 v[136:139], v[40:43], a[40:43], v[136:139]
buffer_load_dwordx4 v1, s[4:7], s54 offen offset:1024 sc1 lds
v_mfma_f32_16x16x32_bf16 v[136:139], v[44:47], a[44:47], v[136:139]
s_and_b32 m0, s62, 0x1ffff
ds_read_b64_tr_b16 v[62:63], v11 offset:25600
v_cvt_pk_bf16_f32 v3, v74, v75
v_mfma_f32_16x16x32_bf16 v[140:143], v[32:35], a[48:51], v[140:143]
v_rcp_f32 v21, v21
v_mfma_f32_16x16x32_bf16 v[140:143], v[36:39], a[52:55], v[140:143]
ds_read_b64_tr_b16 v[32:33], v12 offset:0
v_cvt_pk_bf16_f32 v4, v88, v89
v_mfma_f32_16x16x32_bf16 v[140:143], v[40:43], a[56:59], v[140:143]
buffer_load_dwordx4 v24, s[4:7], s60 offen offset:0 sc1  lds
v_mfma_f32_16x16x32_bf16 v[140:143], v[44:47], a[60:63], v[140:143]
s_waitcnt lgkmcnt(7)
ds_read_b64_tr_b16 v[34:35], v12 offset:1024
v_cvt_pk_bf16_f32 v5, v90, v91
v_mfma_f32_16x16x32_bf16 v[144:147], v[48:51], a[0:3], v[144:147]
s_waitcnt lgkmcnt(6)
s_add_u32 s55, s66, s82
buffer_store_dwordx4 v[2:5], v1, s[4:7], s55 offen offset:0 sc1
v_mfma_f32_16x16x32_bf16 v[144:147], v[52:55], a[4:7], v[144:147]
s_waitcnt lgkmcnt(4)
ds_read_b64_tr_b16 v[36:37], v12 offset:8192
v_mul_f32 v76, v76, v18
v_mfma_f32_16x16x32_bf16 v[144:147], v[56:59], a[8:11], v[144:147]
s_waitcnt lgkmcnt(3)
buffer_load_dwordx4 v24, s[4:7], s60 offen offset:1024 sc1  lds
v_mfma_f32_16x16x32_bf16 v[144:147], v[60:63], a[12:15], v[144:147]
ds_read_b64_tr_b16 v[38:39], v12 offset:9216
v_mul_f32 v18, 0xbfb8aa3b, v92
v_mfma_f32_16x16x32_bf16 v[148:151], v[48:51], a[16:19], v[148:151]
v_exp_f32 v18, v18
v_mfma_f32_16x16x32_bf16 v[148:151], v[52:55], a[20:23], v[148:151]
ds_read_b64_tr_b16 v[40:41], v12 offset:16384
v_add_f32 v18, 1.0, v18
v_mfma_f32_16x16x32_bf16 v[148:151], v[56:59], a[24:27], v[148:151]
buffer_load_dwordx4 v24, s[4:7], s60 offen offset:2048 sc1  lds
v_mfma_f32_16x16x32_bf16 v[148:151], v[60:63], a[28:31], v[148:151]
ds_read_b64_tr_b16 v[42:43], v12 offset:17408
v_mul_f32 v77, v77, v19
v_mfma_f32_16x16x32_bf16 v[152:155], v[48:51], a[32:35], v[152:155]
v_cvt_pk_bf16_f32 v128, v128, v129
v_cvt_pk_bf16_f32 v129, v130, v131
v_mfma_f32_16x16x32_bf16 v[152:155], v[52:55], a[36:39], v[152:155]
ds_read_b64_tr_b16 v[44:45], v12 offset:24576
v_cvt_pk_bf16_f32 v130, v144, v145
v_mfma_f32_16x16x32_bf16 v[152:155], v[56:59], a[40:43], v[152:155]
buffer_load_dwordx4 v24, s[4:7], s60 offen offset:3072 sc1  lds
v_mfma_f32_16x16x32_bf16 v[152:155], v[60:63], a[44:47], v[152:155]
s_add_u32 m0, m0, 16384
ds_read_b64_tr_b16 v[46:47], v12 offset:25600
v_cvt_pk_bf16_f32 v131, v146, v147
v_mfma_f32_16x16x32_bf16 v[156:159], v[48:51], a[48:51], v[156:159]
s_add_u32 s60, s60, 516096
v_cvt_pk_bf16_f32 v132, v132, v133
v_cvt_pk_bf16_f32 v133, v134, v135
v_mfma_f32_16x16x32_bf16 v[156:159], v[52:55], a[52:55], v[156:159]
ds_read_b64_tr_b16 v[48:49], v13 offset:0
v_cvt_pk_bf16_f32 v134, v148, v149
v_mfma_f32_16x16x32_bf16 v[156:159], v[56:59], a[56:59], v[156:159]
buffer_load_dwordx4 v24, s[4:7], s60 offen offset:0 sc1  lds
v_mfma_f32_16x16x32_bf16 v[156:159], v[60:63], a[60:63], v[156:159]
s_waitcnt lgkmcnt(7)
ds_read_b64_tr_b16 v[50:51], v13 offset:1024
v_cvt_pk_bf16_f32 v135, v150, v151
v_mfma_f32_16x16x32_bf16 v[160:163], v[32:35], a[0:3], v[160:163]
s_waitcnt lgkmcnt(6)
v_cvt_pk_bf16_f32 v136, v136, v137
v_cvt_pk_bf16_f32 v137, v138, v139
v_mfma_f32_16x16x32_bf16 v[160:163], v[36:39], a[4:7], v[160:163]
s_waitcnt lgkmcnt(4)
ds_read_b64_tr_b16 v[52:53], v13 offset:8192
v_cvt_pk_bf16_f32 v138, v152, v153
v_mfma_f32_16x16x32_bf16 v[160:163], v[40:43], a[8:11], v[160:163]
s_waitcnt lgkmcnt(3)
buffer_load_dwordx4 v24, s[4:7], s60 offen offset:1024 sc1  lds
v_mfma_f32_16x16x32_bf16 v[160:163], v[44:47], a[12:15], v[160:163]
ds_read_b64_tr_b16 v[54:55], v13 offset:9216
v_cvt_pk_bf16_f32 v139, v154, v155
v_mfma_f32_16x16x32_bf16 v[164:167], v[32:35], a[16:19], v[164:167]
v_cvt_pk_bf16_f32 v140, v140, v141
v_cvt_pk_bf16_f32 v141, v142, v143
v_mfma_f32_16x16x32_bf16 v[164:167], v[36:39], a[20:23], v[164:167]
ds_read_b64_tr_b16 v[56:57], v13 offset:16384
v_cvt_pk_bf16_f32 v142, v156, v157
v_mfma_f32_16x16x32_bf16 v[164:167], v[40:43], a[24:27], v[164:167]
buffer_load_dwordx4 v24, s[4:7], s60 offen offset:2048 sc1  lds
v_mfma_f32_16x16x32_bf16 v[164:167], v[44:47], a[28:31], v[164:167]
ds_read_b64_tr_b16 v[58:59], v13 offset:17408
v_cvt_pk_bf16_f32 v143, v158, v159
v_mfma_f32_16x16x32_bf16 v[168:171], v[32:35], a[32:35], v[168:171]
v_rcp_f32 v18, v18
v_mfma_f32_16x16x32_bf16 v[168:171], v[36:39], a[36:39], v[168:171]
ds_read_b64_tr_b16 v[60:61], v13 offset:24576
v_mul_f32 v19, 0xbfb8aa3b, v93
v_mfma_f32_16x16x32_bf16 v[168:171], v[40:43], a[40:43], v[168:171]
buffer_load_dwordx4 v24, s[4:7], s60 offen offset:3072 sc1  lds
v_mfma_f32_16x16x32_bf16 v[168:171], v[44:47], a[44:47], v[168:171]
s_sub_u32 s60, s60, 516096
ds_read_b64_tr_b16 v[62:63], v13 offset:25600
v_mul_f32 v78, v78, v20
v_mfma_f32_16x16x32_bf16 v[172:175], v[32:35], a[48:51], v[172:175]
s_add_u32 s60, s60, 16384
v_exp_f32 v19, v19
v_mfma_f32_16x16x32_bf16 v[172:175], v[36:39], a[52:55], v[172:175]
s_add_u32 s62, s62, 32768
ds_read_b64_tr_b16 v[32:33], v14 offset:0
v_add_f32 v19, 1.0, v19
v_mfma_f32_16x16x32_bf16 v[172:175], v[40:43], a[56:59], v[172:175]
s_and_b32 m0, s62, 0x1ffff
v_rcp_f32 v19, v19
v_mfma_f32_16x16x32_bf16 v[172:175], v[44:47], a[60:63], v[172:175]
s_waitcnt lgkmcnt(7)
ds_read_b64_tr_b16 v[34:35], v14 offset:1024
v_mul_f32 v20, 0xbfb8aa3b, v94
v_mfma_f32_16x16x32_bf16 v[176:179], v[48:51], a[0:3], v[176:179]
s_waitcnt lgkmcnt(6)
buffer_load_dwordx4 v24, s[4:7], s60 offen offset:0 sc1  lds
v_mfma_f32_16x16x32_bf16 v[176:179], v[52:55], a[4:7], v[176:179]
s_waitcnt lgkmcnt(4)
ds_read_b64_tr_b16 v[36:37], v14 offset:8192
v_mul_f32 v79, v79, v21
v_mfma_f32_16x16x32_bf16 v[176:179], v[56:59], a[8:11], v[176:179]
s_waitcnt lgkmcnt(3)
v_exp_f32 v20, v20
v_mfma_f32_16x16x32_bf16 v[176:179], v[60:63], a[12:15], v[176:179]
ds_read_b64_tr_b16 v[38:39], v14 offset:9216
v_add_f32 v20, 1.0, v20
v_mfma_f32_16x16x32_bf16 v[180:183], v[48:51], a[16:19], v[180:183]
buffer_load_dwordx4 v24, s[4:7], s60 offen offset:1024 sc1  lds
v_mfma_f32_16x16x32_bf16 v[180:183], v[52:55], a[20:23], v[180:183]
ds_read_b64_tr_b16 v[40:41], v14 offset:16384
v_mul_f32 v92, v92, v18
v_mfma_f32_16x16x32_bf16 v[180:183], v[56:59], a[24:27], v[180:183]
v_rcp_f32 v20, v20
v_mfma_f32_16x16x32_bf16 v[180:183], v[60:63], a[28:31], v[180:183]
ds_read_b64_tr_b16 v[42:43], v14 offset:17408
v_mul_f32 v21, 0xbfb8aa3b, v95
v_mfma_f32_16x16x32_bf16 v[184:187], v[48:51], a[32:35], v[184:187]
buffer_load_dwordx4 v24, s[4:7], s60 offen offset:2048 sc1  lds
v_mfma_f32_16x16x32_bf16 v[184:187], v[52:55], a[36:39], v[184:187]
ds_read_b64_tr_b16 v[44:45], v14 offset:24576
v_cvt_pk_bf16_f32 v160, v160, v161
v_mfma_f32_16x16x32_bf16 v[184:187], v[56:59], a[40:43], v[184:187]
v_cvt_pk_bf16_f32 v161, v162, v163
v_cvt_pk_bf16_f32 v162, v176, v177
v_mfma_f32_16x16x32_bf16 v[184:187], v[60:63], a[44:47], v[184:187]
ds_read_b64_tr_b16 v[46:47], v14 offset:25600
v_cvt_pk_bf16_f32 v163, v178, v179
v_mfma_f32_16x16x32_bf16 v[188:191], v[48:51], a[48:51], v[188:191]
buffer_load_dwordx4 v24, s[4:7], s60 offen offset:3072 sc1  lds
v_mfma_f32_16x16x32_bf16 v[188:191], v[52:55], a[52:55], v[188:191]
s_add_u32 m0, m0, 16384
ds_read_b64_tr_b16 v[48:49], v15 offset:0
v_cvt_pk_bf16_f32 v164, v164, v165
v_mfma_f32_16x16x32_bf16 v[188:191], v[56:59], a[56:59], v[188:191]
s_add_u32 s60, s60, 516096
v_cvt_pk_bf16_f32 v165, v166, v167
v_cvt_pk_bf16_f32 v166, v180, v181
v_mfma_f32_16x16x32_bf16 v[188:191], v[60:63], a[60:63], v[188:191]
s_waitcnt lgkmcnt(7)
ds_read_b64_tr_b16 v[50:51], v15 offset:1024
v_cvt_pk_bf16_f32 v167, v182, v183
v_mfma_f32_16x16x32_bf16 v[192:195], v[32:35], a[0:3], v[192:195]
s_waitcnt lgkmcnt(6)
buffer_load_dwordx4 v24, s[4:7], s60 offen offset:0 sc1  lds
v_mfma_f32_16x16x32_bf16 v[192:195], v[36:39], a[4:7], v[192:195]
s_waitcnt lgkmcnt(4)
ds_read_b64_tr_b16 v[52:53], v15 offset:8192
v_cvt_pk_bf16_f32 v168, v168, v169
v_mfma_f32_16x16x32_bf16 v[192:195], v[40:43], a[8:11], v[192:195]
s_waitcnt lgkmcnt(3)
v_cvt_pk_bf16_f32 v169, v170, v171
v_cvt_pk_bf16_f32 v170, v184, v185
v_mfma_f32_16x16x32_bf16 v[192:195], v[44:47], a[12:15], v[192:195]
ds_read_b64_tr_b16 v[54:55], v15 offset:9216
v_cvt_pk_bf16_f32 v171, v186, v187
v_mfma_f32_16x16x32_bf16 v[196:199], v[32:35], a[16:19], v[196:199]
buffer_load_dwordx4 v24, s[4:7], s60 offen offset:1024 sc1  lds
v_mfma_f32_16x16x32_bf16 v[196:199], v[36:39], a[20:23], v[196:199]
ds_read_b64_tr_b16 v[56:57], v15 offset:16384
v_cvt_pk_bf16_f32 v172, v172, v173
v_mfma_f32_16x16x32_bf16 v[196:199], v[40:43], a[24:27], v[196:199]
v_cvt_pk_bf16_f32 v173, v174, v175
v_cvt_pk_bf16_f32 v174, v188, v189
v_mfma_f32_16x16x32_bf16 v[196:199], v[44:47], a[28:31], v[196:199]
ds_read_b64_tr_b16 v[58:59], v15 offset:17408
v_cvt_pk_bf16_f32 v175, v190, v191
v_mfma_f32_16x16x32_bf16 v[200:203], v[32:35], a[32:35], v[200:203]
buffer_load_dwordx4 v24, s[4:7], s60 offen offset:2048 sc1  lds
v_mfma_f32_16x16x32_bf16 v[200:203], v[36:39], a[36:39], v[200:203]
ds_read_b64_tr_b16 v[60:61], v15 offset:24576
v_mul_f32 v93, v93, v19
v_mfma_f32_16x16x32_bf16 v[200:203], v[40:43], a[40:43], v[200:203]
v_exp_f32 v21, v21
v_mfma_f32_16x16x32_bf16 v[200:203], v[44:47], a[44:47], v[200:203]
ds_read_b64_tr_b16 v[62:63], v15 offset:25600
v_add_f32 v21, 1.0, v21
v_mfma_f32_16x16x32_bf16 v[204:207], v[32:35], a[48:51], v[204:207]
buffer_load_dwordx4 v24, s[4:7], s60 offen offset:3072 sc1  lds
v_mfma_f32_16x16x32_bf16 v[204:207], v[36:39], a[52:55], v[204:207]
s_sub_u32 s60, s60, 516096
ds_read_b64_tr_b16 v[32:33], v16 offset:0
v_mul_f32 v94, v94, v20
v_mfma_f32_16x16x32_bf16 v[204:207], v[40:43], a[56:59], v[204:207]
s_add_u32 s60, s60, 16384
v_rcp_f32 v21, v21
v_mfma_f32_16x16x32_bf16 v[204:207], v[44:47], a[60:63], v[204:207]
s_waitcnt lgkmcnt(7)
s_add_u32 s62, s62, 32768
ds_read_b64_tr_b16 v[34:35], v16 offset:1024
v_mul_f32 v18, 0xbfb8aa3b, v96
v_mfma_f32_16x16x32_bf16 v[208:211], v[48:51], a[0:3], v[208:211]
s_waitcnt lgkmcnt(6)
v_exp_f32 v18, v18
v_mfma_f32_16x16x32_bf16 v[208:211], v[52:55], a[4:7], v[208:211]
s_waitcnt lgkmcnt(4)
ds_read_b64_tr_b16 v[36:37], v16 offset:8192
v_add_f32 v18, 1.0, v18
v_mfma_f32_16x16x32_bf16 v[208:211], v[56:59], a[8:11], v[208:211]
s_waitcnt lgkmcnt(3)
v_rcp_f32 v18, v18
v_mfma_f32_16x16x32_bf16 v[208:211], v[60:63], a[12:15], v[208:211]
ds_read_b64_tr_b16 v[38:39], v16 offset:9216
v_mul_f32 v19, 0xbfb8aa3b, v97
v_mfma_f32_16x16x32_bf16 v[212:215], v[48:51], a[16:19], v[212:215]
v_exp_f32 v19, v19
v_mfma_f32_16x16x32_bf16 v[212:215], v[52:55], a[20:23], v[212:215]
ds_read_b64_tr_b16 v[40:41], v16 offset:16384
v_add_f32 v19, 1.0, v19
v_mfma_f32_16x16x32_bf16 v[212:215], v[56:59], a[24:27], v[212:215]
v_rcp_f32 v19, v19
v_mfma_f32_16x16x32_bf16 v[212:215], v[60:63], a[28:31], v[212:215]
ds_read_b64_tr_b16 v[42:43], v16 offset:17408
v_mul_f32 v20, 0xbfb8aa3b, v98
v_mfma_f32_16x16x32_bf16 v[216:219], v[48:51], a[32:35], v[216:219]
v_cvt_pk_bf16_f32 v192, v192, v193
v_cvt_pk_bf16_f32 v193, v194, v195
v_mfma_f32_16x16x32_bf16 v[216:219], v[52:55], a[36:39], v[216:219]
ds_read_b64_tr_b16 v[44:45], v16 offset:24576
v_cvt_pk_bf16_f32 v194, v208, v209
v_mfma_f32_16x16x32_bf16 v[216:219], v[56:59], a[40:43], v[216:219]
v_cvt_pk_bf16_f32 v195, v210, v211
v_mul_f32 v95, v95, v21
v_mfma_f32_16x16x32_bf16 v[216:219], v[60:63], a[44:47], v[216:219]
ds_read_b64_tr_b16 v[46:47], v16 offset:25600
v_cvt_pk_bf16_f32 v2, v76, v77
v_mfma_f32_16x16x32_bf16 v[220:223], v[48:51], a[48:51], v[220:223]
v_cvt_pk_bf16_f32 v196, v196, v197
v_cvt_pk_bf16_f32 v197, v198, v199
v_mfma_f32_16x16x32_bf16 v[220:223], v[52:55], a[52:55], v[220:223]
ds_read_b64_tr_b16 v[48:49], v17 offset:0
v_cvt_pk_bf16_f32 v198, v212, v213
v_mfma_f32_16x16x32_bf16 v[220:223], v[56:59], a[56:59], v[220:223]
v_cvt_pk_bf16_f32 v199, v214, v215
v_cvt_pk_bf16_f32 v3, v78, v79
v_mfma_f32_16x16x32_bf16 v[220:223], v[60:63], a[60:63], v[220:223]
s_waitcnt lgkmcnt(7)
ds_read_b64_tr_b16 v[50:51], v17 offset:1024
v_cvt_pk_bf16_f32 v4, v92, v93
v_mfma_f32_16x16x32_bf16 v[224:227], v[32:35], a[0:3], v[224:227]
s_waitcnt lgkmcnt(6)
v_cvt_pk_bf16_f32 v200, v200, v201
v_cvt_pk_bf16_f32 v201, v202, v203
v_mfma_f32_16x16x32_bf16 v[224:227], v[36:39], a[4:7], v[224:227]
s_waitcnt lgkmcnt(4)
ds_read_b64_tr_b16 v[52:53], v17 offset:8192
v_cvt_pk_bf16_f32 v202, v216, v217
v_mfma_f32_16x16x32_bf16 v[224:227], v[40:43], a[8:11], v[224:227]
s_waitcnt lgkmcnt(3)
v_cvt_pk_bf16_f32 v203, v218, v219
v_cvt_pk_bf16_f32 v5, v94, v95
v_mfma_f32_16x16x32_bf16 v[224:227], v[44:47], a[12:15], v[224:227]
s_add_u32 s55, s66, s83
ds_read_b64_tr_b16 v[54:55], v17 offset:9216
v_mul_f32 v96, v96, v18
v_mfma_f32_16x16x32_bf16 v[228:231], v[32:35], a[16:19], v[228:231]
v_cvt_pk_bf16_f32 v204, v204, v205
v_cvt_pk_bf16_f32 v205, v206, v207
v_mfma_f32_16x16x32_bf16 v[228:231], v[36:39], a[20:23], v[228:231]
ds_read_b64_tr_b16 v[56:57], v17 offset:16384
v_cvt_pk_bf16_f32 v206, v220, v221
v_mfma_f32_16x16x32_bf16 v[228:231], v[40:43], a[24:27], v[228:231]
v_cvt_pk_bf16_f32 v207, v222, v223
v_mul_f32 v97, v97, v19
v_mfma_f32_16x16x32_bf16 v[228:231], v[44:47], a[28:31], v[228:231]
ds_read_b64_tr_b16 v[58:59], v17 offset:17408
v_mul_f32 v21, 0xbfb8aa3b, v99
v_mfma_f32_16x16x32_bf16 v[232:235], v[32:35], a[32:35], v[232:235]
buffer_store_dwordx4 v[2:5], v1, s[4:7], s55 offen offset:0 sc1
v_mfma_f32_16x16x32_bf16 v[232:235], v[36:39], a[36:39], v[232:235]
ds_read_b64_tr_b16 v[60:61], v17 offset:24576
v_mul_f32 v18, 0xbfb8aa3b, v112
v_mfma_f32_16x16x32_bf16 v[232:235], v[40:43], a[40:43], v[232:235]
v_exp_f32 v20, v20
v_mfma_f32_16x16x32_bf16 v[232:235], v[44:47], a[44:47], v[232:235]
ds_read_b64_tr_b16 v[62:63], v17 offset:25600
v_add_f32 v20, 1.0, v20
v_mfma_f32_16x16x32_bf16 v[236:239], v[32:35], a[48:51], v[236:239]
v_rcp_f32 v20, v20
v_mfma_f32_16x16x32_bf16 v[236:239], v[36:39], a[52:55], v[236:239]
v_exp_f32 v21, v21
v_mfma_f32_16x16x32_bf16 v[236:239], v[40:43], a[56:59], v[236:239]
v_exp_f32 v18, v18
v_mfma_f32_16x16x32_bf16 v[236:239], v[44:47], a[60:63], v[236:239]
s_waitcnt lgkmcnt(6)
v_mov_b32 v10, v1
v_add_u32 v11, 131072, v1
v_mfma_f32_16x16x32_bf16 v[240:243], v[48:51], a[0:3], v[240:243]
s_waitcnt vmcnt(9)
s_waitcnt lgkmcnt(0)
s_barrier
v_add_f32 v21, 1.0, v21
v_add_f32 v18, 1.0, v18
v_mfma_f32_16x16x32_bf16 v[240:243], v[52:55], a[4:7], v[240:243]
ds_read_b128 a[96:99], v11 offset:0
v_mul_f32 v98, v98, v20
v_mfma_f32_16x16x32_bf16 v[240:243], v[56:59], a[8:11], v[240:243]
ds_read_b128 a[100:103], v11 offset:1024
v_mul_f32 v19, 0xbfb8aa3b, v113
v_mfma_f32_16x16x32_bf16 v[240:243], v[60:63], a[12:15], v[240:243]
ds_read_b128 a[104:107], v11 offset:2048
v_mul_f32 v20, 0xbfb8aa3b, v114
v_mfma_f32_16x16x32_bf16 v[244:247], v[48:51], a[16:19], v[244:247]
ds_read_b128 a[108:111], v11 offset:3072
v_mfma_f32_16x16x32_bf16 v[244:247], v[52:55], a[20:23], v[244:247]
ds_read_b128 a[112:115], v11 offset:4096
v_mfma_f32_16x16x32_bf16 v[244:247], v[56:59], a[24:27], v[244:247]
ds_read_b128 a[116:119], v11 offset:5120
v_mfma_f32_16x16x32_bf16 v[244:247], v[60:63], a[28:31], v[244:247]
ds_read_b128 a[120:123], v11 offset:6144
v_mfma_f32_16x16x32_bf16 v[248:251], v[48:51], a[32:35], v[248:251]
ds_read_b128 a[124:127], v11 offset:7168
v_cvt_pk_bf16_f32 v224, v224, v225
v_mfma_f32_16x16x32_bf16 v[248:251], v[52:55], a[36:39], v[248:251]
s_and_b32 m0, s62, 0x1ffff
v_cvt_pk_bf16_f32 v225, v226, v227
v_cvt_pk_bf16_f32 v226, v240, v241
v_mfma_f32_16x16x32_bf16 v[248:251], v[56:59], a[40:43], v[248:251]
ds_read_b128 a[64:67], v10 offset:0
v_cvt_pk_bf16_f32 v227, v242, v243
v_mfma_f32_16x16x32_bf16 v[248:251], v[60:63], a[44:47], v[248:251]
buffer_load_dwordx4 v24, s[4:7], s60 offen offset:0 sc1  lds
v_mfma_f32_16x16x32_bf16 v[252:255], v[48:51], a[48:51], v[252:255]
ds_read_b128 a[68:71], v10 offset:1024
v_cvt_pk_bf16_f32 v228, v228, v229
v_mfma_f32_16x16x32_bf16 v[252:255], v[52:55], a[52:55], v[252:255]
v_cvt_pk_bf16_f32 v229, v230, v231
v_cvt_pk_bf16_f32 v230, v244, v245
v_mfma_f32_16x16x32_bf16 v[252:255], v[56:59], a[56:59], v[252:255]
ds_read_b128 a[72:75], v10 offset:2048
v_cvt_pk_bf16_f32 v231, v246, v247
v_mfma_f32_16x16x32_bf16 v[252:255], v[60:63], a[60:63], v[252:255]
s_waitcnt lgkmcnt(10)
buffer_load_dwordx4 v24, s[4:7], s60 offen offset:1024 sc1  lds
v_mfma_f32_16x16x32_bf16 v[32:35], a[96:99], v[128:131], 0
s_waitcnt lgkmcnt(9)
ds_read_b128 a[76:79], v10 offset:3072
v_cvt_pk_bf16_f32 v232, v232, v233
v_mfma_f32_16x16x32_bf16 v[32:35], a[100:103], v[160:163], v[32:35]
s_waitcnt lgkmcnt(9)
v_cvt_pk_bf16_f32 v233, v234, v235
v_cvt_pk_bf16_f32 v234, v248, v249
v_mfma_f32_16x16x32_bf16 v[32:35], a[104:107], v[192:195], v[32:35]
s_waitcnt lgkmcnt(8)
ds_read_b128 a[80:83], v10 offset:4096
v_cvt_pk_bf16_f32 v235, v250, v251
v_mfma_f32_16x16x32_bf16 v[32:35], a[108:111], v[224:227], v[32:35]
s_waitcnt lgkmcnt(8)
buffer_load_dwordx4 v24, s[4:7], s60 offen offset:2048 sc1  lds
v_mfma_f32_16x16x32_bf16 v[48:51], a[112:115], v[128:131], 0
s_waitcnt lgkmcnt(7)
ds_read_b128 a[84:87], v10 offset:5120
v_cvt_pk_bf16_f32 v236, v236, v237
v_mfma_f32_16x16x32_bf16 v[48:51], a[116:119], v[160:163], v[48:51]
s_waitcnt lgkmcnt(7)
v_cvt_pk_bf16_f32 v237, v238, v239
v_cvt_pk_bf16_f32 v238, v252, v253
v_mfma_f32_16x16x32_bf16 v[48:51], a[120:123], v[192:195], v[48:51]
s_waitcnt lgkmcnt(6)
ds_read_b128 a[88:91], v10 offset:6144
v_cvt_pk_bf16_f32 v239, v254, v255
v_mfma_f32_16x16x32_bf16 v[48:51], a[124:127], v[224:227], v[48:51]
v_rcp_f32 v21, v21
v_mfma_f32_16x16x32_bf16 v[36:39], a[96:99], v[132:135], 0
ds_read_b128 a[92:95], v10 offset:7168
v_mul_f32 v99, v99, v21
v_mfma_f32_16x16x32_bf16 v[36:39], a[100:103], v[164:167], v[36:39]
v_rcp_f32 v18, v18
v_mfma_f32_16x16x32_bf16 v[36:39], a[104:107], v[196:199], v[36:39]
v_add_u32 v11, 0x8000, v1
v_mul_f32 v112, v112, v18
v_mfma_f32_16x16x32_bf16 v[36:39], a[108:111], v[228:231], v[36:39]
v_exp_f32 v19, v19
v_mfma_f32_16x16x32_bf16 v[52:55], a[112:115], v[132:135], 0
v_add_u32 v12, 516096, v24
v_add_f32 v19, 1.0, v19
v_mfma_f32_16x16x32_bf16 v[52:55], a[116:119], v[164:167], v[52:55]
v_rcp_f32 v19, v19
v_mfma_f32_16x16x32_bf16 v[52:55], a[120:123], v[196:199], v[52:55]
v_exp_f32 v20, v20
v_mfma_f32_16x16x32_bf16 v[52:55], a[124:127], v[228:231], v[52:55]
v_add_f32 v20, 1.0, v20
v_mul_f32 v21, 0xbfb8aa3b, v115
v_mfma_f32_16x16x32_bf16 v[40:43], a[96:99], v[136:139], 0
v_rcp_f32 v20, v20
v_mfma_f32_16x16x32_bf16 v[40:43], a[100:103], v[168:171], v[40:43]
v_exp_f32 v21, v21
v_mfma_f32_16x16x32_bf16 v[40:43], a[104:107], v[200:203], v[40:43]
v_add_f32 v21, 1.0, v21
v_mul_f32 v18, 0xbfb8aa3b, v100
v_mfma_f32_16x16x32_bf16 v[40:43], a[108:111], v[232:235], v[40:43]
v_rcp_f32 v21, v21
v_mfma_f32_16x16x32_bf16 v[56:59], a[112:115], v[136:139], 0
v_exp_f32 v18, v18
v_mfma_f32_16x16x32_bf16 v[56:59], a[116:119], v[168:171], v[56:59]
v_add_f32 v18, 1.0, v18
v_mul_f32 v113, v113, v19
s_add_u32 s3, s49, s50
s_cmp_eq_u32 s3, 0
s_cbranch_scc0 L_at_nmH
v_mov_b32 v216, 0xff800000
v_cndmask_b32 v32, v32, v216, s[68:69]
v_mov_b32 v48, v216
v_cndmask_b32 v52, v52, v216, s[68:69]
v_cndmask_b32 v33, v33, v216, s[70:71]
v_mov_b32 v49, v216
v_cndmask_b32 v53, v53, v216, s[70:71]
v_cndmask_b32 v34, v34, v216, s[72:73]
v_mov_b32 v50, v216
v_cndmask_b32 v54, v54, v216, s[72:73]
v_cndmask_b32 v35, v35, v216, s[74:75]
v_mov_b32 v51, v216
v_cndmask_b32 v55, v55, v216, s[74:75]
L_at_nmH:
v_mfma_f32_16x16x32_bf16 v[56:59], a[120:123], v[200:203], v[56:59]
v_max3_f32 v212, v32, v33, v34
v_max3_f32 v212, v212, v35, v48
v_mfma_f32_16x16x32_bf16 v[56:59], a[124:127], v[232:235], v[56:59]
v_max3_f32 v212, v212, v49, v50
v_max_f32 v212, v212, v51
v_mfma_f32_16x16x32_bf16 v[44:47], a[96:99], v[140:143], 0
v_max3_f32 v213, v36, v37, v38
v_max3_f32 v213, v213, v39, v52
v_mfma_f32_16x16x32_bf16 v[44:47], a[100:103], v[172:175], v[44:47]
v_max3_f32 v213, v213, v53, v54
v_max_f32 v213, v213, v55
v_mfma_f32_16x16x32_bf16 v[44:47], a[104:107], v[204:207], v[44:47]
v_rcp_f32 v18, v18
v_mfma_f32_16x16x32_bf16 v[44:47], a[108:111], v[236:239], v[44:47]
v_mul_f32 v19, 0xbfb8aa3b, v101
v_mul_f32 v114, v114, v20
v_mfma_f32_16x16x32_bf16 v[60:63], a[112:115], v[140:143], 0
v_max3_f32 v214, v40, v41, v42
v_max3_f32 v214, v214, v43, v56
v_mfma_f32_16x16x32_bf16 v[60:63], a[116:119], v[172:175], v[60:63]
v_max3_f32 v214, v214, v57, v58
v_max_f32 v214, v214, v59
v_mfma_f32_16x16x32_bf16 v[60:63], a[120:123], v[204:207], v[60:63]
v_exp_f32 v19, v19
v_mfma_f32_16x16x32_bf16 v[60:63], a[124:127], v[236:239], v[60:63]
v_add_f32 v19, 1.0, v19
v_mul_f32 v20, 0xbfb8aa3b, v102
s_mov_b32 s20, 0xbfb8aa3b
s_mov_b32 s21, 0xbfb8aa3b
v_mov_b32 v220, 0xff800000
v_exp_f32 v20, v20
v_mov_b32 v221, 0xff800000
v_add_f32 v20, 1.0, v20
v_mov_b32 v219, 0x53800000
v_rcp_f32 v19, v19
s_mov_b32 s56, 0
v_rcp_f32 v20, v20
s_mov_b32 s64, 0
v_mul_f32 v115, v115, v21
v_mov_b32 v208, 0
v_mul_f32 v100, v100, v18
v_mov_b32 v209, 0
v_mul_f32 v101, v101, v19
v_mov_b32 v210, 0
v_mul_f32 v102, v102, v20
v_mov_b32 v211, 0
v_mul_f32 v21, 0xbfb8aa3b, v103
v_max3_f32 v215, v44, v45, v46
v_exp_f32 v21, v21
v_max3_f32 v215, v215, v47, v60
v_add_f32 v21, 1.0, v21
v_max3_f32 v215, v215, v61, v62
v_rcp_f32 v21, v21
v_max_f32 v215, v215, v63
v_mul_f32 v103, v103, v21
v_mov_b32 v240, v212
v_cvt_pk_bf16_f32 v2, v96, v97
v_mov_b32 v241, v213
v_cvt_pk_bf16_f32 v3, v98, v99
v_mov_b32 v242, v214
v_cvt_pk_bf16_f32 v4, v112, v113
v_mov_b32 v243, v215
v_cvt_pk_bf16_f32 v5, v114, v115
v_permlane16_swap_b32 v212, v240
s_add_u32 s55, s66, s80
v_permlane16_swap_b32 v213, v241
buffer_store_dwordx4 v[2:5], v1, s[4:7], s55 offen offset:1024 sc1
v_permlane16_swap_b32 v214, v242
v_pk_mul_f32 v[18:19], v[116:117], s[20:21]
v_permlane16_swap_b32 v215, v243
v_pk_mul_f32 v[20:21], v[118:119], s[20:21]
v_max_f32 v212, v212, v240
v_exp_f32 v18, v18
v_max_f32 v213, v213, v241
v_exp_f32 v19, v19
v_max_f32 v214, v214, v242
v_exp_f32 v20, v20
v_max_f32 v215, v215, v243
v_exp_f32 v21, v21
v_mov_b32 v240, v212
v_pk_add_f32 v[18:19], v[18:19], 1.0 op_sel_hi:[1,0]
v_mov_b32 v241, v213
v_pk_add_f32 v[20:21], v[20:21], 1.0 op_sel_hi:[1,0]
v_mov_b32 v242, v214
v_rcp_f32 v18, v18
v_mov_b32 v243, v215
v_rcp_f32 v19, v19
v_permlane32_swap_b32 v212, v240
v_rcp_f32 v20, v20
v_permlane32_swap_b32 v213, v241
v_rcp_f32 v21, v21
v_permlane32_swap_b32 v214, v242
v_pk_mul_f32 v[116:117], v[116:117], v[18:19]
v_permlane32_swap_b32 v215, v243
v_pk_mul_f32 v[118:119], v[118:119], v[20:21]
v_max_f32 v212, v212, v240
v_cvt_pk_bf16_f32 v2, v100, v101
v_max_f32 v213, v213, v241
v_cvt_pk_bf16_f32 v3, v102, v103
v_max_f32 v214, v214, v242
v_cvt_pk_bf16_f32 v4, v116, v117
v_max_f32 v215, v215, v243
v_cvt_pk_bf16_f32 v5, v118, v119
v_sub_f32 v212, 0, v212
s_add_u32 s55, s66, s81
v_sub_f32 v213, 0, v213
buffer_store_dwordx4 v[2:5], v1, s[4:7], s55 offen offset:1024 sc1
v_sub_f32 v214, 0, v214
v_pk_mul_f32 v[18:19], v[104:105], s[20:21]
v_sub_f32 v215, 0, v215
v_pk_mul_f32 v[20:21], v[106:107], s[20:21]
v_pk_add_f32 v[32:33], v[32:33], v[212:213] op_sel:[0,0] op_sel_hi:[1,0]
v_exp_f32 v18, v18
v_pk_add_f32 v[34:35], v[34:35], v[212:213] op_sel:[0,0] op_sel_hi:[1,0]
v_exp_f32 v19, v19
v_pk_add_f32 v[36:37], v[36:37], v[212:213] op_sel:[0,1] op_sel_hi:[1,1]
v_exp_f32 v20, v20
v_pk_add_f32 v[38:39], v[38:39], v[212:213] op_sel:[0,1] op_sel_hi:[1,1]
v_exp_f32 v21, v21
v_pk_add_f32 v[40:41], v[40:41], v[214:215] op_sel:[0,0] op_sel_hi:[1,0]
v_pk_add_f32 v[18:19], v[18:19], 1.0 op_sel_hi:[1,0]
v_pk_add_f32 v[42:43], v[42:43], v[214:215] op_sel:[0,0] op_sel_hi:[1,0]
v_pk_add_f32 v[20:21], v[20:21], 1.0 op_sel_hi:[1,0]
v_pk_add_f32 v[44:45], v[44:45], v[214:215] op_sel:[0,1] op_sel_hi:[1,1]
v_rcp_f32 v18, v18
v_pk_add_f32 v[46:47], v[46:47], v[214:215] op_sel:[0,1] op_sel_hi:[1,1]
v_rcp_f32 v19, v19
v_pk_add_f32 v[48:49], v[48:49], v[212:213] op_sel:[0,0] op_sel_hi:[1,0]
v_rcp_f32 v20, v20
v_pk_add_f32 v[50:51], v[50:51], v[212:213] op_sel:[0,0] op_sel_hi:[1,0]
v_rcp_f32 v21, v21
v_pk_add_f32 v[52:53], v[52:53], v[212:213] op_sel:[0,1] op_sel_hi:[1,1]
v_pk_mul_f32 v[104:105], v[104:105], v[18:19]
v_pk_add_f32 v[54:55], v[54:55], v[212:213] op_sel:[0,1] op_sel_hi:[1,1]
v_pk_mul_f32 v[106:107], v[106:107], v[20:21]
v_pk_add_f32 v[56:57], v[56:57], v[214:215] op_sel:[0,0] op_sel_hi:[1,0]
v_pk_mul_f32 v[18:19], v[120:121], s[20:21]
v_pk_add_f32 v[58:59], v[58:59], v[214:215] op_sel:[0,0] op_sel_hi:[1,0]
v_pk_mul_f32 v[20:21], v[122:123], s[20:21]
v_pk_add_f32 v[60:61], v[60:61], v[214:215] op_sel:[0,1] op_sel_hi:[1,1]
v_exp_f32 v18, v18
v_pk_add_f32 v[62:63], v[62:63], v[214:215] op_sel:[0,1] op_sel_hi:[1,1]
v_exp_f32 v19, v19
v_pk_mov_b32 v[144:145], v[212:213], v[212:213] op_sel:[0,0]
v_exp_f32 v20, v20
v_pk_mov_b32 v[146:147], v[212:213], v[212:213] op_sel:[0,0]
v_exp_f32 v21, v21
v_pk_mov_b32 v[148:149], v[212:213], v[212:213] op_sel:[1,1]
v_pk_add_f32 v[18:19], v[18:19], 1.0 op_sel_hi:[1,0]
v_pk_mov_b32 v[150:151], v[212:213], v[212:213] op_sel:[1,1]
v_pk_add_f32 v[20:21], v[20:21], 1.0 op_sel_hi:[1,0]
v_pk_mov_b32 v[152:153], v[214:215], v[214:215] op_sel:[0,0]
v_rcp_f32 v18, v18
v_pk_mov_b32 v[154:155], v[214:215], v[214:215] op_sel:[0,0]
v_rcp_f32 v19, v19
v_pk_mov_b32 v[156:157], v[214:215], v[214:215] op_sel:[1,1]
v_rcp_f32 v20, v20
v_pk_mov_b32 v[158:159], v[214:215], v[214:215] op_sel:[1,1]
v_rcp_f32 v21, v21
v_pk_mov_b32 v[176:177], v[212:213], v[212:213] op_sel:[0,0]
v_pk_mul_f32 v[120:121], v[120:121], v[18:19]
v_pk_mov_b32 v[178:179], v[212:213], v[212:213] op_sel:[0,0]
v_pk_mul_f32 v[122:123], v[122:123], v[20:21]
v_pk_mov_b32 v[180:181], v[212:213], v[212:213] op_sel:[1,1]
v_cvt_pk_bf16_f32 v2, v104, v105
v_pk_mov_b32 v[182:183], v[212:213], v[212:213] op_sel:[1,1]
v_cvt_pk_bf16_f32 v3, v106, v107
v_pk_mov_b32 v[184:185], v[214:215], v[214:215] op_sel:[0,0]
v_cvt_pk_bf16_f32 v4, v120, v121
v_pk_mov_b32 v[186:187], v[214:215], v[214:215] op_sel:[0,0]
v_cvt_pk_bf16_f32 v5, v122, v123
v_pk_mov_b32 v[188:189], v[214:215], v[214:215] op_sel:[1,1]
s_add_u32 s55, s66, s82
v_pk_mov_b32 v[190:191], v[214:215], v[214:215] op_sel:[1,1]
buffer_store_dwordx4 v[2:5], v1, s[4:7], s55 offen offset:1024 sc1
v_pk_mul_f32 v[18:19], v[108:109], s[20:21]
v_pk_mul_f32 v[20:21], v[110:111], s[20:21]
v_exp_f32 v18, v18
v_exp_f32 v19, v19
v_exp_f32 v20, v20
v_exp_f32 v21, v21
v_pk_add_f32 v[18:19], v[18:19], 1.0 op_sel_hi:[1,0]
v_pk_add_f32 v[20:21], v[20:21], 1.0 op_sel_hi:[1,0]
v_rcp_f32 v18, v18
v_rcp_f32 v19, v19
v_rcp_f32 v20, v20
v_rcp_f32 v21, v21
v_pk_mul_f32 v[108:109], v[108:109], v[18:19]
v_pk_mul_f32 v[110:111], v[110:111], v[20:21]
v_pk_mul_f32 v[18:19], v[124:125], s[20:21]
v_pk_mul_f32 v[20:21], v[126:127], s[20:21]
v_exp_f32 v18, v18
v_exp_f32 v19, v19
v_exp_f32 v20, v20
v_exp_f32 v21, v21
v_pk_add_f32 v[18:19], v[18:19], 1.0 op_sel_hi:[1,0]
v_pk_add_f32 v[20:21], v[20:21], 1.0 op_sel_hi:[1,0]
v_rcp_f32 v18, v18
v_rcp_f32 v19, v19
v_rcp_f32 v20, v20
v_rcp_f32 v21, v21
v_pk_mul_f32 v[124:125], v[124:125], v[18:19]
v_pk_mul_f32 v[126:127], v[126:127], v[20:21]
v_cvt_pk_bf16_f32 v2, v108, v109
v_cvt_pk_bf16_f32 v3, v110, v111
v_cvt_pk_bf16_f32 v4, v124, v125
v_cvt_pk_bf16_f32 v5, v126, v127
s_add_u32 s55, s66, s83
buffer_store_dwordx4 v[2:5], v1, s[4:7], s55 offen offset:1024 sc1
v_pk_mov_b32 v[96:97], v[212:213], v[212:213] op_sel:[0,0]
v_pk_mov_b32 v[98:99], v[212:213], v[212:213] op_sel:[0,0]
v_pk_mov_b32 v[100:101], v[212:213], v[212:213] op_sel:[1,1]
v_pk_mov_b32 v[102:103], v[212:213], v[212:213] op_sel:[1,1]
v_pk_mov_b32 v[104:105], v[214:215], v[214:215] op_sel:[0,0]
v_pk_mov_b32 v[106:107], v[214:215], v[214:215] op_sel:[0,0]
v_pk_mov_b32 v[108:109], v[214:215], v[214:215] op_sel:[1,1]
v_pk_mov_b32 v[110:111], v[214:215], v[214:215] op_sel:[1,1]
v_pk_mov_b32 v[112:113], v[212:213], v[212:213] op_sel:[0,0]
v_pk_mov_b32 v[114:115], v[212:213], v[212:213] op_sel:[0,0]
v_pk_mov_b32 v[116:117], v[212:213], v[212:213] op_sel:[1,1]
v_pk_mov_b32 v[118:119], v[212:213], v[212:213] op_sel:[1,1]
v_pk_mov_b32 v[120:121], v[214:215], v[214:215] op_sel:[0,0]
v_pk_mov_b32 v[122:123], v[214:215], v[214:215] op_sel:[0,0]
v_pk_mov_b32 v[124:125], v[214:215], v[214:215] op_sel:[1,1]
v_pk_mov_b32 v[126:127], v[214:215], v[214:215] op_sel:[1,1]
v_exp_f32 v32, v32
v_exp_f32 v33, v33
v_exp_f32 v34, v34
v_exp_f32 v35, v35
v_add_f32 v208, v208, v32
v_add_f32 v208, v208, v33
v_cvt_pk_bf16_f32 v64, v32, v33
v_add_f32 v208, v208, v34
v_add_f32 v208, v208, v35
v_cvt_pk_bf16_f32 v65, v34, v35
v_exp_f32 v36, v36
v_exp_f32 v37, v37
v_exp_f32 v38, v38
v_exp_f32 v39, v39
v_add_f32 v209, v209, v36
v_add_f32 v209, v209, v37
v_cvt_pk_bf16_f32 v68, v36, v37
v_add_f32 v209, v209, v38
v_add_f32 v209, v209, v39
v_cvt_pk_bf16_f32 v69, v38, v39
v_exp_f32 v40, v40
v_exp_f32 v41, v41
v_exp_f32 v42, v42
v_exp_f32 v43, v43
v_add_f32 v210, v210, v40
v_add_f32 v210, v210, v41
v_cvt_pk_bf16_f32 v72, v40, v41
v_add_f32 v210, v210, v42
v_add_f32 v210, v210, v43
v_cvt_pk_bf16_f32 v73, v42, v43
v_exp_f32 v44, v44
v_exp_f32 v45, v45
v_exp_f32 v46, v46
v_exp_f32 v47, v47
v_add_f32 v211, v211, v44
v_add_f32 v211, v211, v45
v_cvt_pk_bf16_f32 v76, v44, v45
v_add_f32 v211, v211, v46
v_add_f32 v211, v211, v47
v_cvt_pk_bf16_f32 v77, v46, v47
v_exp_f32 v48, v48
v_exp_f32 v49, v49
v_exp_f32 v50, v50
v_exp_f32 v51, v51
v_add_f32 v208, v208, v48
v_add_f32 v208, v208, v49
v_cvt_pk_bf16_f32 v66, v48, v49
v_add_f32 v208, v208, v50
v_add_f32 v208, v208, v51
v_cvt_pk_bf16_f32 v67, v50, v51
v_exp_f32 v52, v52
v_exp_f32 v53, v53
v_exp_f32 v54, v54
v_exp_f32 v55, v55
v_add_f32 v209, v209, v52
v_add_f32 v209, v209, v53
v_cvt_pk_bf16_f32 v70, v52, v53
v_add_f32 v209, v209, v54
v_add_f32 v209, v209, v55
v_cvt_pk_bf16_f32 v71, v54, v55
s_branch L_afterB
L_varN:
s_waitcnt lgkmcnt(6)
v_mfma_f32_16x16x32_bf16 v[128:131], a[192:195], v[32:35], v[128:131]
s_waitcnt lgkmcnt(4)
s_add_u32 s54, s76, 0
buffer_load_dwordx4 a[8:11], v1, s[4:7], s54 offen offset:2048 sc1
v_mfma_f32_16x16x32_bf16 v[128:131], a[208:211], v[36:39], v[128:131]
s_waitcnt lgkmcnt(2)
ds_read_b64_tr_b16 v[48:49], v11 offset:0
v_mfma_f32_16x16x32_bf16 v[128:131], a[224:227], v[40:43], v[128:131]
s_waitcnt lgkmcnt(1)
ds_read_b64_tr_b16 v[50:51], v11 offset:1024
v_mfma_f32_16x16x32_bf16 v[128:131], a[240:243], v[44:47], v[128:131]
ds_read_b64_tr_b16 v[52:53], v11 offset:8192
v_mfma_f32_16x16x32_bf16 v[132:135], a[196:199], v[32:35], v[132:135]
ds_read_b64_tr_b16 v[54:55], v11 offset:9216
v_mfma_f32_16x16x32_bf16 v[132:135], a[212:215], v[36:39], v[132:135]
buffer_load_dwordx4 a[12:15], v1, s[4:7], s54 offen offset:3072 sc1
v_mfma_f32_16x16x32_bf16 v[132:135], a[228:231], v[40:43], v[132:135]
s_add_u32 s54, s77, 0
ds_read_b64_tr_b16 v[56:57], v11 offset:16384
v_mfma_f32_16x16x32_bf16 v[132:135], a[244:247], v[44:47], v[132:135]
v_mfma_f32_16x16x32_bf16 v[136:139], a[200:203], v[32:35], v[136:139]
ds_read_b64_tr_b16 v[58:59], v11 offset:17408
v_mfma_f32_16x16x32_bf16 v[136:139], a[216:219], v[36:39], v[136:139]
buffer_load_dwordx4 a[16:19], v1, s[4:7], s54 offen offset:0 sc1
v_mfma_f32_16x16x32_bf16 v[136:139], a[232:235], v[40:43], v[136:139]
ds_read_b64_tr_b16 v[60:61], v11 offset:24576
v_mfma_f32_16x16x32_bf16 v[136:139], a[248:251], v[44:47], v[136:139]
v_mfma_f32_16x16x32_bf16 v[140:143], a[204:207], v[32:35], v[140:143]
ds_read_b64_tr_b16 v[62:63], v11 offset:25600
v_mfma_f32_16x16x32_bf16 v[140:143], a[220:223], v[36:39], v[140:143]
ds_read_b64_tr_b16 v[32:33], v12 offset:0
v_add_u32 v11, 0x10000, v11
v_mfma_f32_16x16x32_bf16 v[140:143], a[236:239], v[40:43], v[140:143]
s_getreg_b32 s51, hwreg(HW_REG_XCC_ID, 0, 4)
buffer_load_dwordx4 a[20:23], v1, s[4:7], s54 offen offset:1024 sc1
v_mfma_f32_16x16x32_bf16 v[140:143], a[252:255], v[44:47], v[140:143]
s_waitcnt lgkmcnt(7)
s_mul_i32 s52, s51, s51
ds_read_b64_tr_b16 v[34:35], v12 offset:1024
v_mfma_f32_16x16x32_bf16 v[144:147], a[192:195], v[48:51], v[144:147]
s_waitcnt lgkmcnt(6)
s_lshl_b32 s52, s52, 10
v_mfma_f32_16x16x32_bf16 v[144:147], a[208:211], v[52:55], v[144:147]
s_waitcnt lgkmcnt(4)
s_lshl_b32 s51, s51, 4
ds_read_b64_tr_b16 v[36:37], v12 offset:8192
v_mfma_f32_16x16x32_bf16 v[144:147], a[224:227], v[56:59], v[144:147]
s_waitcnt lgkmcnt(3)
s_add_u32 s51, s51, s52
buffer_load_dwordx4 a[24:27], v1, s[4:7], s54 offen offset:2048 sc1
v_mfma_f32_16x16x32_bf16 v[144:147], a[240:243], v[60:63], v[144:147]
s_add_u32 s51, s51, 1
ds_read_b64_tr_b16 v[38:39], v12 offset:9216
v_mfma_f32_16x16x32_bf16 v[148:151], a[196:199], v[48:51], v[148:151]
s_waitcnt vmcnt(7)
s_lshl_b32 s51, s51, 3
v_xor_b32 v2, s51, v2
v_xor_b32 v3, s51, v3
v_mfma_f32_16x16x32_bf16 v[148:151], a[212:215], v[52:55], v[148:151]
ds_read_b64_tr_b16 v[40:41], v12 offset:16384
v_xor_b32 v4, s51, v4
v_mfma_f32_16x16x32_bf16 v[148:151], a[228:231], v[56:59], v[148:151]
buffer_load_dwordx4 a[28:31], v1, s[4:7], s54 offen offset:3072 sc1
v_mfma_f32_16x16x32_bf16 v[148:151], a[244:247], v[60:63], v[148:151]
s_add_u32 s54, s78, 0
ds_read_b64_tr_b16 v[42:43], v12 offset:17408
v_xor_b32 v5, s51, v5
v_mfma_f32_16x16x32_bf16 v[152:155], a[200:203], v[48:51], v[152:155]
v_or3_b32 v2, v2, v3, v4
v_or_b32 v2, v2, v5
v_mfma_f32_16x16x32_bf16 v[152:155], a[216:219], v[52:55], v[152:155]
s_nop 0
ds_read_b64_tr_b16 v[44:45], v12 offset:24576
v_readfirstlane_b32 s23, v2
v_mfma_f32_16x16x32_bf16 v[152:155], a[232:235], v[56:59], v[152:155]
buffer_load_dwordx4 a[32:35], v1, s[4:7], s54 offen offset:0 sc1
v_mfma_f32_16x16x32_bf16 v[152:155], a[248:251], v[60:63], v[152:155]
ds_read_b64_tr_b16 v[46:47], v12 offset:25600
v_mfma_f32_16x16x32_bf16 v[156:159], a[204:207], v[48:51], v[156:159]
v_add_u32 v12, 0x10000, v12
v_mfma_f32_16x16x32_bf16 v[156:159], a[220:223], v[52:55], v[156:159]
ds_read_b64_tr_b16 v[48:49], v13 offset:0
v_mfma_f32_16x16x32_bf16 v[156:159], a[236:239], v[56:59], v[156:159]
buffer_load_dwordx4 a[36:39], v1, s[4:7], s54 offen offset:1024 sc1
v_mfma_f32_16x16x32_bf16 v[156:159], a[252:255], v[60:63], v[156:159]
s_waitcnt lgkmcnt(7)
ds_read_b64_tr_b16 v[50:51], v13 offset:1024
v_mfma_f32_16x16x32_bf16 v[160:163], a[192:195], v[32:35], v[160:163]
s_waitcnt lgkmcnt(6)
v_mfma_f32_16x16x32_bf16 v[160:163], a[208:211], v[36:39], v[160:163]
s_waitcnt lgkmcnt(4)
ds_read_b64_tr_b16 v[52:53], v13 offset:8192
v_mfma_f32_16x16x32_bf16 v[160:163], a[224:227], v[40:43], v[160:163]
s_waitcnt lgkmcnt(3)
buffer_load_dwordx4 a[40:43], v1, s[4:7], s54 offen offset:2048 sc1
v_mfma_f32_16x16x32_bf16 v[160:163], a[240:243], v[44:47], v[160:163]
ds_read_b64_tr_b16 v[54:55], v13 offset:9216
v_mfma_f32_16x16x32_bf16 v[164:167], a[196:199], v[32:35], v[164:167]
v_cvt_pk_bf16_f32 v2, v128, v129
v_cvt_pk_bf16_f32 v3, v130, v131
v_mfma_f32_16x16x32_bf16 v[164:167], a[212:215], v[36:39], v[164:167]
ds_read_b64_tr_b16 v[56:57], v13 offset:16384
v_cvt_pk_bf16_f32 v4, v132, v133
v_mfma_f32_16x16x32_bf16 v[164:167], a[228:231], v[40:43], v[164:167]
buffer_load_dwordx4 a[44:47], v1, s[4:7], s54 offen offset:3072 sc1
v_mfma_f32_16x16x32_bf16 v[164:167], a[244:247], v[44:47], v[164:167]
s_add_u32 s54, s79, 0
ds_read_b64_tr_b16 v[58:59], v13 offset:17408
v_cvt_pk_bf16_f32 v5, v134, v135
v_mfma_f32_16x16x32_bf16 v[168:171], a[200:203], v[32:35], v[168:171]
s_mov_b32 s55, 524288
buffer_store_dwordx4 v[2:5], v24, s[4:7], s55 offen
v_mfma_f32_16x16x32_bf16 v[168:171], a[216:219], v[36:39], v[168:171]
ds_read_b64_tr_b16 v[60:61], v13 offset:24576
v_mfma_f32_16x16x32_bf16 v[168:171], a[232:235], v[40:43], v[168:171]
buffer_load_dwordx4 a[48:51], v1, s[4:7], s54 offen offset:0 sc1
v_mfma_f32_16x16x32_bf16 v[168:171], a[248:251], v[44:47], v[168:171]
ds_read_b64_tr_b16 v[62:63], v13 offset:25600
v_mfma_f32_16x16x32_bf16 v[172:175], a[204:207], v[32:35], v[172:175]
v_add_u32 v13, 0x10000, v13
v_mfma_f32_16x16x32_bf16 v[172:175], a[220:223], v[36:39], v[172:175]
ds_read_b64_tr_b16 v[32:33], v14 offset:0
v_mfma_f32_16x16x32_bf16 v[172:175], a[236:239], v[40:43], v[172:175]
buffer_load_dwordx4 a[52:55], v1, s[4:7], s54 offen offset:1024 sc1
v_mfma_f32_16x16x32_bf16 v[172:175], a[252:255], v[44:47], v[172:175]
s_waitcnt lgkmcnt(7)
ds_read_b64_tr_b16 v[34:35], v14 offset:1024
v_cvt_pk_bf16_f32 v18, v144, v145
v_mfma_f32_16x16x32_bf16 v[176:179], a[192:195], v[48:51], v[176:179]
s_waitcnt lgkmcnt(6)
v_cvt_pk_bf16_f32 v19, v146, v147
v_cvt_pk_bf16_f32 v20, v148, v149
v_mfma_f32_16x16x32_bf16 v[176:179], a[208:211], v[52:55], v[176:179]
s_waitcnt lgkmcnt(4)
ds_read_b64_tr_b16 v[36:37], v14 offset:8192
v_cvt_pk_bf16_f32 v21, v150, v151
v_mfma_f32_16x16x32_bf16 v[176:179], a[224:227], v[56:59], v[176:179]
s_waitcnt lgkmcnt(3)
s_mov_b32 s55, 525312
buffer_load_dwordx4 a[56:59], v1, s[4:7], s54 offen offset:2048 sc1
v_mfma_f32_16x16x32_bf16 v[176:179], a[240:243], v[60:63], v[176:179]
ds_read_b64_tr_b16 v[38:39], v14 offset:9216
v_mfma_f32_16x16x32_bf16 v[180:183], a[196:199], v[48:51], v[180:183]
buffer_store_dwordx4 v[18:21], v24, s[4:7], s55 offen
v_mfma_f32_16x16x32_bf16 v[180:183], a[212:215], v[52:55], v[180:183]
ds_read_b64_tr_b16 v[40:41], v14 offset:16384
v_mfma_f32_16x16x32_bf16 v[180:183], a[228:231], v[56:59], v[180:183]
buffer_load_dwordx4 a[60:63], v1, s[4:7], s54 offen offset:3072 sc1
v_mfma_f32_16x16x32_bf16 v[180:183], a[244:247], v[60:63], v[180:183]
s_mov_b32 s54, 1048576
ds_read_b64_tr_b16 v[42:43], v14 offset:17408
v_mfma_f32_16x16x32_bf16 v[184:187], a[200:203], v[48:51], v[184:187]
s_add_u32 m0, s67, 65536
v_mfma_f32_16x16x32_bf16 v[184:187], a[216:219], v[52:55], v[184:187]
ds_read_b64_tr_b16 v[44:45], v14 offset:24576
v_mfma_f32_16x16x32_bf16 v[184:187], a[232:235], v[56:59], v[184:187]
buffer_load_dwordx4 v6, s[24:27], s54 offen offset:0  lds
v_mfma_f32_16x16x32_bf16 v[184:187], a[248:251], v[60:63], v[184:187]
ds_read_b64_tr_b16 v[46:47], v14 offset:25600
v_cvt_pk_bf16_f32 v2, v136, v137
v_mfma_f32_16x16x32_bf16 v[188:191], a[204:207], v[48:51], v[188:191]
v_add_u32 v14, 0x10000, v14
v_cvt_pk_bf16_f32 v3, v138, v139
v_mfma_f32_16x16x32_bf16 v[188:191], a[220:223], v[52:55], v[188:191]
ds_read_b64_tr_b16 v[48:49], v15 offset:0
v_cvt_pk_bf16_f32 v4, v140, v141
v_mfma_f32_16x16x32_bf16 v[188:191], a[236:239], v[56:59], v[188:191]
buffer_load_dwordx4 v7, s[24:27], s54 offen offset:1024  lds
v_mfma_f32_16x16x32_bf16 v[188:191], a[252:255], v[60:63], v[188:191]
s_waitcnt lgkmcnt(7)
ds_read_b64_tr_b16 v[50:51], v15 offset:1024
v_cvt_pk_bf16_f32 v5, v142, v143
v_mfma_f32_16x16x32_bf16 v[192:195], a[192:195], v[32:35], v[192:195]
s_waitcnt lgkmcnt(6)
s_mov_b32 s55, 532480
buffer_store_dwordx4 v[2:5], v24, s[4:7], s55 offen
v_mfma_f32_16x16x32_bf16 v[192:195], a[208:211], v[36:39], v[192:195]
s_waitcnt lgkmcnt(4)
ds_read_b64_tr_b16 v[52:53], v15 offset:8192
v_mfma_f32_16x16x32_bf16 v[192:195], a[224:227], v[40:43], v[192:195]
s_waitcnt lgkmcnt(3)
buffer_load_dwordx4 v8, s[24:27], s54 offen offset:2048  lds
v_mfma_f32_16x16x32_bf16 v[192:195], a[240:243], v[44:47], v[192:195]
ds_read_b64_tr_b16 v[54:55], v15 offset:9216
v_mfma_f32_16x16x32_bf16 v[196:199], a[196:199], v[32:35], v[196:199]
v_mfma_f32_16x16x32_bf16 v[196:199], a[212:215], v[36:39], v[196:199]
ds_read_b64_tr_b16 v[56:57], v15 offset:16384
v_cvt_pk_bf16_f32 v18, v152, v153
v_mfma_f32_16x16x32_bf16 v[196:199], a[228:231], v[40:43], v[196:199]
buffer_load_dwordx4 v9, s[24:27], s54 offen offset:3072  lds
v_mfma_f32_16x16x32_bf16 v[196:199], a[244:247], v[44:47], v[196:199]
s_mov_b32 s54, 1572864
ds_read_b64_tr_b16 v[58:59], v15 offset:17408
v_cvt_pk_bf16_f32 v19, v154, v155
v_mfma_f32_16x16x32_bf16 v[200:203], a[200:203], v[32:35], v[200:203]
s_add_u32 m0, s67, 81920
v_cvt_pk_bf16_f32 v20, v156, v157
v_cvt_pk_bf16_f32 v21, v158, v159
v_mfma_f32_16x16x32_bf16 v[200:203], a[216:219], v[36:39], v[200:203]
s_mov_b32 s55, 533504
ds_read_b64_tr_b16 v[60:61], v15 offset:24576
v_mfma_f32_16x16x32_bf16 v[200:203], a[232:235], v[40:43], v[200:203]
buffer_load_dwordx4 v6, s[24:27], s54 offen offset:0  lds
v_mfma_f32_16x16x32_bf16 v[200:203], a[248:251], v[44:47], v[200:203]
ds_read_b64_tr_b16 v[62:63], v15 offset:25600
v_mfma_f32_16x16x32_bf16 v[204:207], a[204:207], v[32:35], v[204:207]
v_add_u32 v15, 0x10000, v15
v_mfma_f32_16x16x32_bf16 v[204:207], a[220:223], v[36:39], v[204:207]
ds_read_b64_tr_b16 v[32:33], v16 offset:0
v_mfma_f32_16x16x32_bf16 v[204:207], a[236:239], v[40:43], v[204:207]
buffer_load_dwordx4 v7, s[24:27], s54 offen offset:1024  lds
v_mfma_f32_16x16x32_bf16 v[204:207], a[252:255], v[44:47], v[204:207]
s_waitcnt lgkmcnt(7)
ds_read_b64_tr_b16 v[34:35], v16 offset:1024
v_mfma_f32_16x16x32_bf16 v[208:211], a[192:195], v[48:51], v[208:211]
s_waitcnt lgkmcnt(6)
buffer_store_dwordx4 v[18:21], v24, s[4:7], s55 offen
v_mfma_f32_16x16x32_bf16 v[208:211], a[208:211], v[52:55], v[208:211]
s_waitcnt lgkmcnt(4)
ds_read_b64_tr_b16 v[36:37], v16 offset:8192
v_cvt_pk_bf16_f32 v2, v160, v161
v_mfma_f32_16x16x32_bf16 v[208:211], a[224:227], v[56:59], v[208:211]
s_waitcnt lgkmcnt(3)
buffer_load_dwordx4 v8, s[24:27], s54 offen offset:2048  lds
v_mfma_f32_16x16x32_bf16 v[208:211], a[240:243], v[60:63], v[208:211]
ds_read_b64_tr_b16 v[38:39], v16 offset:9216
v_cvt_pk_bf16_f32 v3, v162, v163
v_mfma_f32_16x16x32_bf16 v[212:215], a[196:199], v[48:51], v[212:215]
v_cvt_pk_bf16_f32 v4, v164, v165
v_cvt_pk_bf16_f32 v5, v166, v167
v_mfma_f32_16x16x32_bf16 v[212:215], a[212:215], v[52:55], v[212:215]
s_mov_b32 s55, 526336
ds_read_b64_tr_b16 v[40:41], v16 offset:16384
v_mfma_f32_16x16x32_bf16 v[212:215], a[228:231], v[56:59], v[212:215]
buffer_load_dwordx4 v9, s[24:27], s54 offen offset:3072  lds
v_mfma_f32_16x16x32_bf16 v[212:215], a[244:247], v[60:63], v[212:215]
ds_read_b64_tr_b16 v[42:43], v16 offset:17408
v_mfma_f32_16x16x32_bf16 v[216:219], a[200:203], v[48:51], v[216:219]
buffer_store_dwordx4 v[2:5], v24, s[4:7], s55 offen
v_mfma_f32_16x16x32_bf16 v[216:219], a[216:219], v[52:55], v[216:219]
s_add_u32 s54, s76, 4096
ds_read_b64_tr_b16 v[44:45], v16 offset:24576
v_mfma_f32_16x16x32_bf16 v[216:219], a[232:235], v[56:59], v[216:219]
buffer_load_dwordx4 a[64:67], v1, s[4:7], s54 offen offset:0 sc1
v_mfma_f32_16x16x32_bf16 v[216:219], a[248:251], v[60:63], v[216:219]
ds_read_b64_tr_b16 v[46:47], v16 offset:25600
v_mfma_f32_16x16x32_bf16 v[220:223], a[204:207], v[48:51], v[220:223]
v_add_u32 v16, 0x10000, v16
v_cvt_pk_bf16_f32 v18, v176, v177
v_mfma_f32_16x16x32_bf16 v[220:223], a[220:223], v[52:55], v[220:223]
ds_read_b64_tr_b16 v[48:49], v17 offset:0
v_cvt_pk_bf16_f32 v19, v178, v179
v_mfma_f32_16x16x32_bf16 v[220:223], a[236:239], v[56:59], v[220:223]
v_cvt_pk_bf16_f32 v20, v180, v181
v_cvt_pk_bf16_f32 v21, v182, v183
v_mfma_f32_16x16x32_bf16 v[220:223], a[252:255], v[60:63], v[220:223]
s_waitcnt lgkmcnt(7)
s_mov_b32 s55, 527360
ds_read_b64_tr_b16 v[50:51], v17 offset:1024
v_mfma_f32_16x16x32_bf16 v[224:227], a[192:195], v[32:35], v[224:227]
s_waitcnt lgkmcnt(6)
buffer_load_dwordx4 a[68:71], v1, s[4:7], s54 offen offset:1024 sc1
v_mfma_f32_16x16x32_bf16 v[224:227], a[208:211], v[36:39], v[224:227]
s_waitcnt lgkmcnt(4)
ds_read_b64_tr_b16 v[52:53], v17 offset:8192
v_mfma_f32_16x16x32_bf16 v[224:227], a[224:227], v[40:43], v[224:227]
s_waitcnt lgkmcnt(3)
buffer_store_dwordx4 v[18:21], v24, s[4:7], s55 offen
v_mfma_f32_16x16x32_bf16 v[224:227], a[240:243], v[44:47], v[224:227]
ds_read_b64_tr_b16 v[54:55], v17 offset:9216
v_mfma_f32_16x16x32_bf16 v[228:231], a[196:199], v[32:35], v[228:231]
v_mfma_f32_16x16x32_bf16 v[228:231], a[212:215], v[36:39], v[228:231]
ds_read_b64_tr_b16 v[56:57], v17 offset:16384
v_mfma_f32_16x16x32_bf16 v[228:231], a[228:231], v[40:43], v[228:231]
buffer_load_dwordx4 a[72:75], v1, s[4:7], s54 offen offset:2048 sc1
v_mfma_f32_16x16x32_bf16 v[228:231], a[244:247], v[44:47], v[228:231]
ds_read_b64_tr_b16 v[58:59], v17 offset:17408
v_cvt_pk_bf16_f32 v2, v168, v169
v_mfma_f32_16x16x32_bf16 v[232:235], a[200:203], v[32:35], v[232:235]
v_cvt_pk_bf16_f32 v3, v170, v171
v_cvt_pk_bf16_f32 v4, v172, v173
v_mfma_f32_16x16x32_bf16 v[232:235], a[216:219], v[36:39], v[232:235]
ds_read_b64_tr_b16 v[60:61], v17 offset:24576
v_cvt_pk_bf16_f32 v5, v174, v175
v_mfma_f32_16x16x32_bf16 v[232:235], a[232:235], v[40:43], v[232:235]
s_mov_b32 s55, 534528
buffer_store_dwordx4 v[2:5], v24, s[4:7], s55 offen
v_mfma_f32_16x16x32_bf16 v[232:235], a[248:251], v[44:47], v[232:235]
ds_read_b64_tr_b16 v[62:63], v17 offset:25600
v_mfma_f32_16x16x32_bf16 v[236:239], a[204:207], v[32:35], v[236:239]
v_add_u32 v17, 0x10000, v17
v_mfma_f32_16x16x32_bf16 v[236:239], a[220:223], v[36:39], v[236:239]
buffer_load_dwordx4 a[76:79], v1, s[4:7], s54 offen offset:3072 sc1
v_mfma_f32_16x16x32_bf16 v[236:239], a[236:239], v[40:43], v[236:239]
s_add_u32 s54, s77, 4096
v_mfma_f32_16x16x32_bf16 v[236:239], a[252:255], v[44:47], v[236:239]
s_waitcnt lgkmcnt(6)
v_mfma_f32_16x16x32_bf16 v[240:243], a[192:195], v[48:51], v[240:243]
s_waitcnt lgkmcnt(0)
s_barrier
v_mfma_f32_16x16x32_bf16 v[240:243], a[208:211], v[52:55], v[240:243]
ds_read_b64_tr_b16 v[32:33], v10 offset:0
v_mfma_f32_16x16x32_bf16 v[240:243], a[224:227], v[56:59], v[240:243]
ds_read_b64_tr_b16 v[34:35], v10 offset:1024
v_cvt_pk_bf16_f32 v18, v184, v185
v_mfma_f32_16x16x32_bf16 v[240:243], a[240:243], v[60:63], v[240:243]
ds_read_b64_tr_b16 v[36:37], v10 offset:8192
v_cvt_pk_bf16_f32 v19, v186, v187
v_mfma_f32_16x16x32_bf16 v[244:247], a[196:199], v[48:51], v[244:247]
ds_read_b64_tr_b16 v[38:39], v10 offset:9216
v_cvt_pk_bf16_f32 v20, v188, v189
v_mfma_f32_16x16x32_bf16 v[244:247], a[212:215], v[52:55], v[244:247]
buffer_load_dwordx4 a[80:83], v1, s[4:7], s54 offen offset:0 sc1
v_mfma_f32_16x16x32_bf16 v[244:247], a[228:231], v[56:59], v[244:247]
ds_read_b64_tr_b16 v[40:41], v10 offset:16384
v_cvt_pk_bf16_f32 v21, v190, v191
v_mfma_f32_16x16x32_bf16 v[244:247], a[244:247], v[60:63], v[244:247]
s_mov_b32 s55, 535552
buffer_store_dwordx4 v[18:21], v24, s[4:7], s55 offen
v_mfma_f32_16x16x32_bf16 v[248:251], a[200:203], v[48:51], v[248:251]
ds_read_b64_tr_b16 v[42:43], v10 offset:17408
v_mfma_f32_16x16x32_bf16 v[248:251], a[216:219], v[52:55], v[248:251]
v_mfma_f32_16x16x32_bf16 v[248:251], a[232:235], v[56:59], v[248:251]
ds_read_b64_tr_b16 v[44:45], v10 offset:24576
v_mfma_f32_16x16x32_bf16 v[248:251], a[248:251], v[60:63], v[248:251]
buffer_load_dwordx4 a[84:87], v1, s[4:7], s54 offen offset:1024 sc1
v_mfma_f32_16x16x32_bf16 v[252:255], a[204:207], v[48:51], v[252:255]
ds_read_b64_tr_b16 v[46:47], v10 offset:25600
v_mfma_f32_16x16x32_bf16 v[252:255], a[220:223], v[52:55], v[252:255]
ds_read_b64_tr_b16 v[48:49], v11 offset:0
v_add_u32 v10, 0xffff8000, v10
v_mfma_f32_16x16x32_bf16 v[252:255], a[236:239], v[56:59], v[252:255]
v_cvt_pk_bf16_f32 v2, v192, v193
v_cvt_pk_bf16_f32 v3, v194, v195
v_mfma_f32_16x16x32_bf16 v[252:255], a[252:255], v[60:63], v[252:255]
s_waitcnt vmcnt(37) lgkmcnt(7)
ds_read_b64_tr_b16 v[50:51], v11 offset:1024
v_cvt_pk_bf16_f32 v4, v196, v197
v_mfma_f32_16x16x32_bf16 v[128:131], v[32:35], a[0:3], 0
s_waitcnt vmcnt(36) lgkmcnt(6)
buffer_load_dwordx4 a[88:91], v1, s[4:7], s54 offen offset:2048 sc1
v_mfma_f32_16x16x32_bf16 v[128:131], v[36:39], a[4:7], v[128:131]
s_waitcnt vmcnt(36) lgkmcnt(4)
ds_read_b64_tr_b16 v[52:53], v11 offset:8192
v_cvt_pk_bf16_f32 v5, v198, v199
v_mfma_f32_16x16x32_bf16 v[128:131], v[40:43], a[8:11], v[128:131]
s_waitcnt vmcnt(35) lgkmcnt(3)
s_mov_b32 s55, 528384
buffer_store_dwordx4 v[2:5], v24, s[4:7], s55 offen
v_mfma_f32_16x16x32_bf16 v[128:131], v[44:47], a[12:15], v[128:131]
s_waitcnt vmcnt(35)
ds_read_b64_tr_b16 v[54:55], v11 offset:9216
v_mfma_f32_16x16x32_bf16 v[132:135], v[32:35], a[16:19], 0
s_waitcnt vmcnt(34)
v_mfma_f32_16x16x32_bf16 v[132:135], v[36:39], a[20:23], v[132:135]
s_waitcnt vmcnt(33)
ds_read_b64_tr_b16 v[56:57], v11 offset:16384
v_mfma_f32_16x16x32_bf16 v[132:135], v[40:43], a[24:27], v[132:135]
s_waitcnt vmcnt(32)
buffer_load_dwordx4 a[92:95], v1, s[4:7], s54 offen offset:3072 sc1
v_mfma_f32_16x16x32_bf16 v[132:135], v[44:47], a[28:31], v[132:135]
s_waitcnt vmcnt(32)
s_add_u32 s54, s78, 4096
ds_read_b64_tr_b16 v[58:59], v11 offset:17408
v_mfma_f32_16x16x32_bf16 v[136:139], v[32:35], a[32:35], 0
s_waitcnt vmcnt(31)
v_cvt_pk_bf16_f32 v18, v208, v209
v_cvt_pk_bf16_f32 v19, v210, v211
v_mfma_f32_16x16x32_bf16 v[136:139], v[36:39], a[36:39], v[136:139]
s_waitcnt vmcnt(30)
ds_read_b64_tr_b16 v[60:61], v11 offset:24576
v_cvt_pk_bf16_f32 v20, v212, v213
v_mfma_f32_16x16x32_bf16 v[136:139], v[40:43], a[40:43], v[136:139]
s_waitcnt vmcnt(29)
v_cvt_pk_bf16_f32 v21, v214, v215
v_mfma_f32_16x16x32_bf16 v[136:139], v[44:47], a[44:47], v[136:139]
s_waitcnt vmcnt(27)
s_mov_b32 s55, 529408
ds_read_b64_tr_b16 v[62:63], v11 offset:25600
v_mfma_f32_16x16x32_bf16 v[140:143], v[32:35], a[48:51], 0
s_waitcnt vmcnt(26)
v_add_u32 v11, 0xffff8000, v11
v_mfma_f32_16x16x32_bf16 v[140:143], v[36:39], a[52:55], v[140:143]
s_waitcnt vmcnt(25)
ds_read_b64_tr_b16 v[32:33], v12 offset:0
v_mfma_f32_16x16x32_bf16 v[140:143], v[40:43], a[56:59], v[140:143]
s_waitcnt vmcnt(23)
buffer_load_dwordx4 a[96:99], v1, s[4:7], s54 offen offset:0 sc1
v_mfma_f32_16x16x32_bf16 v[140:143], v[44:47], a[60:63], v[140:143]
s_waitcnt lgkmcnt(7)
ds_read_b64_tr_b16 v[34:35], v12 offset:1024
v_mfma_f32_16x16x32_bf16 v[144:147], v[48:51], a[0:3], 0
s_waitcnt lgkmcnt(6)
buffer_store_dwordx4 v[18:21], v24, s[4:7], s55 offen
v_mfma_f32_16x16x32_bf16 v[144:147], v[52:55], a[4:7], v[144:147]
s_waitcnt lgkmcnt(4)
ds_read_b64_tr_b16 v[36:37], v12 offset:8192
v_mfma_f32_16x16x32_bf16 v[144:147], v[56:59], a[8:11], v[144:147]
s_waitcnt lgkmcnt(3)
v_mfma_f32_16x16x32_bf16 v[144:147], v[60:63], a[12:15], v[144:147]
ds_read_b64_tr_b16 v[38:39], v12 offset:9216
v_cvt_pk_bf16_f32 v2, v200, v201
v_mfma_f32_16x16x32_bf16 v[148:151], v[48:51], a[16:19], 0
buffer_load_dwordx4 a[100:103], v1, s[4:7], s54 offen offset:1024 sc1
v_mfma_f32_16x16x32_bf16 v[148:151], v[52:55], a[20:23], v[148:151]
ds_read_b64_tr_b16 v[40:41], v12 offset:16384
v_cvt_pk_bf16_f32 v3, v202, v203
v_mfma_f32_16x16x32_bf16 v[148:151], v[56:59], a[24:27], v[148:151]
v_cvt_pk_bf16_f32 v4, v204, v205
v_cvt_pk_bf16_f32 v5, v206, v207
v_mfma_f32_16x16x32_bf16 v[148:151], v[60:63], a[28:31], v[148:151]
s_mov_b32 s55, 536576
ds_read_b64_tr_b16 v[42:43], v12 offset:17408
v_mfma_f32_16x16x32_bf16 v[152:155], v[48:51], a[32:35], 0
buffer_store_dwordx4 v[2:5], v24, s[4:7], s55 offen
v_mfma_f32_16x16x32_bf16 v[152:155], v[52:55], a[36:39], v[152:155]
ds_read_b64_tr_b16 v[44:45], v12 offset:24576
v_mfma_f32_16x16x32_bf16 v[152:155], v[56:59], a[40:43], v[152:155]
buffer_load_dwordx4 a[104:107], v1, s[4:7], s54 offen offset:2048 sc1
v_mfma_f32_16x16x32_bf16 v[152:155], v[60:63], a[44:47], v[152:155]
ds_read_b64_tr_b16 v[46:47], v12 offset:25600
v_mfma_f32_16x16x32_bf16 v[156:159], v[48:51], a[48:51], 0
v_add_u32 v12, 0xffff8000, v12
v_mfma_f32_16x16x32_bf16 v[156:159], v[52:55], a[52:55], v[156:159]
ds_read_b64_tr_b16 v[48:49], v13 offset:0
v_mfma_f32_16x16x32_bf16 v[156:159], v[56:59], a[56:59], v[156:159]
v_cvt_pk_bf16_f32 v18, v216, v217
v_cvt_pk_bf16_f32 v19, v218, v219
v_mfma_f32_16x16x32_bf16 v[156:159], v[60:63], a[60:63], v[156:159]
s_waitcnt lgkmcnt(7)
ds_read_b64_tr_b16 v[50:51], v13 offset:1024
v_cvt_pk_bf16_f32 v20, v220, v221
v_mfma_f32_16x16x32_bf16 v[160:163], v[32:35], a[0:3], 0
s_waitcnt lgkmcnt(6)
buffer_load_dwordx4 a[108:111], v1, s[4:7], s54 offen offset:3072 sc1
v_mfma_f32_16x16x32_bf16 v[160:163], v[36:39], a[4:7], v[160:163]
s_waitcnt lgkmcnt(4)
s_add_u32 s54, s79, 4096
ds_read_b64_tr_b16 v[52:53], v13 offset:8192
v_cvt_pk_bf16_f32 v21, v222, v223
v_mfma_f32_16x16x32_bf16 v[160:163], v[40:43], a[8:11], v[160:163]
s_waitcnt lgkmcnt(3)
s_mov_b32 s55, 537600
buffer_store_dwordx4 v[18:21], v24, s[4:7], s55 offen
v_mfma_f32_16x16x32_bf16 v[160:163], v[44:47], a[12:15], v[160:163]
ds_read_b64_tr_b16 v[54:55], v13 offset:9216
v_mfma_f32_16x16x32_bf16 v[164:167], v[32:35], a[16:19], 0
v_mfma_f32_16x16x32_bf16 v[164:167], v[36:39], a[20:23], v[164:167]
ds_read_b64_tr_b16 v[56:57], v13 offset:16384
v_mfma_f32_16x16x32_bf16 v[164:167], v[40:43], a[24:27], v[164:167]
buffer_load_dwordx4 a[112:115], v1, s[4:7], s54 offen offset:0 sc1
v_mfma_f32_16x16x32_bf16 v[164:167], v[44:47], a[28:31], v[164:167]
ds_read_b64_tr_b16 v[58:59], v13 offset:17408
v_mfma_f32_16x16x32_bf16 v[168:171], v[32:35], a[32:35], 0
v_mfma_f32_16x16x32_bf16 v[168:171], v[36:39], a[36:39], v[168:171]
ds_read_b64_tr_b16 v[60:61], v13 offset:24576
v_cvt_pk_bf16_f32 v2, v224, v225
v_mfma_f32_16x16x32_bf16 v[168:171], v[40:43], a[40:43], v[168:171]
v_cvt_pk_bf16_f32 v3, v226, v227
v_cvt_pk_bf16_f32 v4, v228, v229
v_mfma_f32_16x16x32_bf16 v[168:171], v[44:47], a[44:47], v[168:171]
ds_read_b64_tr_b16 v[62:63], v13 offset:25600
v_cvt_pk_bf16_f32 v5, v230, v231
v_mfma_f32_16x16x32_bf16 v[172:175], v[32:35], a[48:51], 0
s_mov_b32 s55, 530432
v_add_u32 v13, 0xffff8000, v13
v_mfma_f32_16x16x32_bf16 v[172:175], v[36:39], a[52:55], v[172:175]
ds_read_b64_tr_b16 v[32:33], v14 offset:0
v_mfma_f32_16x16x32_bf16 v[172:175], v[40:43], a[56:59], v[172:175]
buffer_load_dwordx4 a[116:119], v1, s[4:7], s54 offen offset:1024 sc1
v_mfma_f32_16x16x32_bf16 v[172:175], v[44:47], a[60:63], v[172:175]
s_waitcnt lgkmcnt(7)
ds_read_b64_tr_b16 v[34:35], v14 offset:1024
v_mfma_f32_16x16x32_bf16 v[176:179], v[48:51], a[0:3], 0
s_waitcnt lgkmcnt(6)
buffer_store_dwordx4 v[2:5], v24, s[4:7], s55 offen
v_mfma_f32_16x16x32_bf16 v[176:179], v[52:55], a[4:7], v[176:179]
s_waitcnt lgkmcnt(4)
ds_read_b64_tr_b16 v[36:37], v14 offset:8192
v_mfma_f32_16x16x32_bf16 v[176:179], v[56:59], a[8:11], v[176:179]
s_waitcnt lgkmcnt(3)
v_mfma_f32_16x16x32_bf16 v[176:179], v[60:63], a[12:15], v[176:179]
ds_read_b64_tr_b16 v[38:39], v14 offset:9216
v_mfma_f32_16x16x32_bf16 v[180:183], v[48:51], a[16:19], 0
buffer_load_dwordx4 a[120:123], v1, s[4:7], s54 offen offset:2048 sc1
v_mfma_f32_16x16x32_bf16 v[180:183], v[52:55], a[20:23], v[180:183]
ds_read_b64_tr_b16 v[40:41], v14 offset:16384
v_cvt_pk_bf16_f32 v18, v240, v241
v_mfma_f32_16x16x32_bf16 v[180:183], v[56:59], a[24:27], v[180:183]
v_cvt_pk_bf16_f32 v19, v242, v243
v_cvt_pk_bf16_f32 v20, v244, v245
v_mfma_f32_16x16x32_bf16 v[180:183], v[60:63], a[28:31], v[180:183]
ds_read_b64_tr_b16 v[42:43], v14 offset:17408
v_cvt_pk_bf16_f32 v21, v246, v247
v_mfma_f32_16x16x32_bf16 v[184:187], v[48:51], a[32:35], 0
s_mov_b32 s55, 531456
buffer_store_dwordx4 v[18:21], v24, s[4:7], s55 offen
v_mfma_f32_16x16x32_bf16 v[184:187], v[52:55], a[36:39], v[184:187]
ds_read_b64_tr_b16 v[44:45], v14 offset:24576
v_mfma_f32_16x16x32_bf16 v[184:187], v[56:59], a[40:43], v[184:187]
buffer_load_dwordx4 a[124:127], v1, s[4:7], s54 offen offset:3072 sc1
v_mfma_f32_16x16x32_bf16 v[184:187], v[60:63], a[44:47], v[184:187]
ds_read_b64_tr_b16 v[46:47], v14 offset:25600
v_mfma_f32_16x16x32_bf16 v[188:191], v[48:51], a[48:51], 0
v_add_u32 v14, 0xffff8000, v14
v_mfma_f32_16x16x32_bf16 v[188:191], v[52:55], a[52:55], v[188:191]
ds_read_b64_tr_b16 v[48:49], v15 offset:0
v_mfma_f32_16x16x32_bf16 v[188:191], v[56:59], a[56:59], v[188:191]
s_mov_b32 s54, 2097152
v_mfma_f32_16x16x32_bf16 v[188:191], v[60:63], a[60:63], v[188:191]
s_waitcnt lgkmcnt(7)
s_add_u32 m0, s67, 32768
ds_read_b64_tr_b16 v[50:51], v15 offset:1024
v_cvt_pk_bf16_f32 v2, v232, v233
v_mfma_f32_16x16x32_bf16 v[192:195], v[32:35], a[0:3], 0
s_waitcnt lgkmcnt(6)
v_cvt_pk_bf16_f32 v3, v234, v235
v_cvt_pk_bf16_f32 v4, v236, v237
v_mfma_f32_16x16x32_bf16 v[192:195], v[36:39], a[4:7], v[192:195]
s_waitcnt lgkmcnt(4)
ds_read_b64_tr_b16 v[52:53], v15 offset:8192
v_cvt_pk_bf16_f32 v5, v238, v239
v_mfma_f32_16x16x32_bf16 v[192:195], v[40:43], a[8:11], v[192:195]
s_waitcnt lgkmcnt(3)
s_mov_b32 s55, 538624
buffer_store_dwordx4 v[2:5], v24, s[4:7], s55 offen
v_mfma_f32_16x16x32_bf16 v[192:195], v[44:47], a[12:15], v[192:195]
ds_read_b64_tr_b16 v[54:55], v15 offset:9216
v_mfma_f32_16x16x32_bf16 v[196:199], v[32:35], a[16:19], 0
buffer_load_dwordx4 v6, s[24:27], s54 offen offset:0  lds
v_mfma_f32_16x16x32_bf16 v[196:199], v[36:39], a[20:23], v[196:199]
ds_read_b64_tr_b16 v[56:57], v15 offset:16384
v_mfma_f32_16x16x32_bf16 v[196:199], v[40:43], a[24:27], v[196:199]
v_mfma_f32_16x16x32_bf16 v[196:199], v[44:47], a[28:31], v[196:199]
ds_read_b64_tr_b16 v[58:59], v15 offset:17408
v_mfma_f32_16x16x32_bf16 v[200:203], v[32:35], a[32:35], 0
v_mfma_f32_16x16x32_bf16 v[200:203], v[36:39], a[36:39], v[200:203]
ds_read_b64_tr_b16 v[60:61], v15 offset:24576
v_mfma_f32_16x16x32_bf16 v[200:203], v[40:43], a[40:43], v[200:203]
v_cvt_pk_bf16_f32 v18, v248, v249
v_cvt_pk_bf16_f32 v19, v250, v251
v_mfma_f32_16x16x32_bf16 v[200:203], v[44:47], a[44:47], v[200:203]
ds_read_b64_tr_b16 v[62:63], v15 offset:25600
v_cvt_pk_bf16_f32 v20, v252, v253
v_mfma_f32_16x16x32_bf16 v[204:207], v[32:35], a[48:51], 0
v_add_u32 v15, 0xffff8000, v15
v_cvt_pk_bf16_f32 v21, v254, v255
v_mfma_f32_16x16x32_bf16 v[204:207], v[36:39], a[52:55], v[204:207]
s_mov_b32 s55, 539648
ds_read_b64_tr_b16 v[32:33], v16 offset:0
v_mfma_f32_16x16x32_bf16 v[204:207], v[40:43], a[56:59], v[204:207]
buffer_store_dwordx4 v[18:21], v24, s[4:7], s55 offen
v_mfma_f32_16x16x32_bf16 v[204:207], v[44:47], a[60:63], v[204:207]
s_waitcnt lgkmcnt(7)
ds_read_b64_tr_b16 v[34:35], v16 offset:1024
v_mfma_f32_16x16x32_bf16 v[208:211], v[48:51], a[0:3], 0
s_waitcnt lgkmcnt(6)
buffer_load_dwordx4 v7, s[24:27], s54 offen offset:1024  lds
v_mfma_f32_16x16x32_bf16 v[208:211], v[52:55], a[4:7], v[208:211]
s_waitcnt lgkmcnt(4)
ds_read_b64_tr_b16 v[36:37], v16 offset:8192
v_mfma_f32_16x16x32_bf16 v[208:211], v[56:59], a[8:11], v[208:211]
s_waitcnt lgkmcnt(3)
v_mfma_f32_16x16x32_bf16 v[208:211], v[60:63], a[12:15], v[208:211]
ds_read_b64_tr_b16 v[38:39], v16 offset:9216
v_mfma_f32_16x16x32_bf16 v[212:215], v[48:51], a[16:19], 0
v_mfma_f32_16x16x32_bf16 v[212:215], v[52:55], a[20:23], v[212:215]
ds_read_b64_tr_b16 v[40:41], v16 offset:16384
v_mfma_f32_16x16x32_bf16 v[212:215], v[56:59], a[24:27], v[212:215]
buffer_load_dwordx4 v8, s[24:27], s54 offen offset:2048  lds
v_mfma_f32_16x16x32_bf16 v[212:215], v[60:63], a[28:31], v[212:215]
ds_read_b64_tr_b16 v[42:43], v16 offset:17408
v_mfma_f32_16x16x32_bf16 v[216:219], v[48:51], a[32:35], 0
v_mfma_f32_16x16x32_bf16 v[216:219], v[52:55], a[36:39], v[216:219]
ds_read_b64_tr_b16 v[44:45], v16 offset:24576
v_mfma_f32_16x16x32_bf16 v[216:219], v[56:59], a[40:43], v[216:219]
v_mfma_f32_16x16x32_bf16 v[216:219], v[60:63], a[44:47], v[216:219]
ds_read_b64_tr_b16 v[46:47], v16 offset:25600
v_mfma_f32_16x16x32_bf16 v[220:223], v[48:51], a[48:51], 0
v_add_u32 v16, 0xffff8000, v16
v_mfma_f32_16x16x32_bf16 v[220:223], v[52:55], a[52:55], v[220:223]
ds_read_b64_tr_b16 v[48:49], v17 offset:0
v_mfma_f32_16x16x32_bf16 v[220:223], v[56:59], a[56:59], v[220:223]
buffer_load_dwordx4 v9, s[24:27], s54 offen offset:3072  lds
v_mfma_f32_16x16x32_bf16 v[220:223], v[60:63], a[60:63], v[220:223]
s_waitcnt lgkmcnt(7)
s_mov_b32 s54, 2621440
ds_read_b64_tr_b16 v[50:51], v17 offset:1024
v_mfma_f32_16x16x32_bf16 v[224:227], v[32:35], a[0:3], 0
s_waitcnt lgkmcnt(6)
s_add_u32 m0, s67, 49152
v_mfma_f32_16x16x32_bf16 v[224:227], v[36:39], a[4:7], v[224:227]
s_waitcnt lgkmcnt(4)
ds_read_b64_tr_b16 v[52:53], v17 offset:8192
v_mfma_f32_16x16x32_bf16 v[224:227], v[40:43], a[8:11], v[224:227]
s_waitcnt lgkmcnt(3)
v_mfma_f32_16x16x32_bf16 v[224:227], v[44:47], a[12:15], v[224:227]
ds_read_b64_tr_b16 v[54:55], v17 offset:9216
v_mfma_f32_16x16x32_bf16 v[228:231], v[32:35], a[16:19], 0
buffer_load_dwordx4 v6, s[24:27], s54 offen offset:0  lds
v_mfma_f32_16x16x32_bf16 v[228:231], v[36:39], a[20:23], v[228:231]
ds_read_b64_tr_b16 v[56:57], v17 offset:16384
v_mfma_f32_16x16x32_bf16 v[228:231], v[40:43], a[24:27], v[228:231]
v_mfma_f32_16x16x32_bf16 v[228:231], v[44:47], a[28:31], v[228:231]
ds_read_b64_tr_b16 v[58:59], v17 offset:17408
v_mfma_f32_16x16x32_bf16 v[232:235], v[32:35], a[32:35], 0
v_mfma_f32_16x16x32_bf16 v[232:235], v[36:39], a[36:39], v[232:235]
ds_read_b64_tr_b16 v[60:61], v17 offset:24576
v_mfma_f32_16x16x32_bf16 v[232:235], v[40:43], a[40:43], v[232:235]
buffer_load_dwordx4 v7, s[24:27], s54 offen offset:1024  lds
v_mfma_f32_16x16x32_bf16 v[232:235], v[44:47], a[44:47], v[232:235]
ds_read_b64_tr_b16 v[62:63], v17 offset:25600
v_mfma_f32_16x16x32_bf16 v[236:239], v[32:35], a[48:51], 0
v_add_u32 v17, 0xffff8000, v17
v_mfma_f32_16x16x32_bf16 v[236:239], v[36:39], a[52:55], v[236:239]
v_mfma_f32_16x16x32_bf16 v[236:239], v[40:43], a[56:59], v[236:239]
v_mfma_f32_16x16x32_bf16 v[236:239], v[44:47], a[60:63], v[236:239]
s_waitcnt lgkmcnt(6)
buffer_load_dwordx4 v8, s[24:27], s54 offen offset:2048  lds
v_mfma_f32_16x16x32_bf16 v[240:243], v[48:51], a[0:3], 0
s_waitcnt vmcnt(35)
s_waitcnt lgkmcnt(0)
s_barrier
v_mfma_f32_16x16x32_bf16 v[240:243], v[52:55], a[4:7], v[240:243]
ds_read_b64_tr_b16 v[32:33], v10 offset:0
v_mfma_f32_16x16x32_bf16 v[240:243], v[56:59], a[8:11], v[240:243]
ds_read_b64_tr_b16 v[34:35], v10 offset:1024
v_mfma_f32_16x16x32_bf16 v[240:243], v[60:63], a[12:15], v[240:243]
ds_read_b64_tr_b16 v[36:37], v10 offset:8192
v_mfma_f32_16x16x32_bf16 v[244:247], v[48:51], a[16:19], 0
ds_read_b64_tr_b16 v[38:39], v10 offset:9216
v_mfma_f32_16x16x32_bf16 v[244:247], v[52:55], a[20:23], v[244:247]
buffer_load_dwordx4 v9, s[24:27], s54 offen offset:3072  lds
v_mfma_f32_16x16x32_bf16 v[244:247], v[56:59], a[24:27], v[244:247]
ds_read_b64_tr_b16 v[40:41], v10 offset:16384
v_mfma_f32_16x16x32_bf16 v[244:247], v[60:63], a[28:31], v[244:247]
v_mfma_f32_16x16x32_bf16 v[248:251], v[48:51], a[32:35], 0
ds_read_b64_tr_b16 v[42:43], v10 offset:17408
v_mfma_f32_16x16x32_bf16 v[248:251], v[52:55], a[36:39], v[248:251]
s_add_u32 s54, s76, 8192
buffer_load_dwordx4 a[128:131], v1, s[4:7], s54 offen offset:0 sc1
v_mfma_f32_16x16x32_bf16 v[248:251], v[56:59], a[40:43], v[248:251]
ds_read_b64_tr_b16 v[44:45], v10 offset:24576
v_mfma_f32_16x16x32_bf16 v[248:251], v[60:63], a[44:47], v[248:251]
v_mfma_f32_16x16x32_bf16 v[252:255], v[48:51], a[48:51], 0
ds_read_b64_tr_b16 v[46:47], v10 offset:25600
v_mfma_f32_16x16x32_bf16 v[252:255], v[52:55], a[52:55], v[252:255]
ds_read_b64_tr_b16 v[48:49], v11 offset:0
v_add_u32 v10, 0xffff8000, v10
v_mfma_f32_16x16x32_bf16 v[252:255], v[56:59], a[56:59], v[252:255]
buffer_load_dwordx4 a[132:135], v1, s[4:7], s54 offen offset:1024 sc1
v_mfma_f32_16x16x32_bf16 v[252:255], v[60:63], a[60:63], v[252:255]
s_waitcnt vmcnt(36) lgkmcnt(7)
ds_read_b64_tr_b16 v[50:51], v11 offset:1024
v_mfma_f32_16x16x32_bf16 v[128:131], v[32:35], a[64:67], v[128:131]
s_waitcnt vmcnt(35) lgkmcnt(6)
v_mfma_f32_16x16x32_bf16 v[128:131], v[36:39], a[68:71], v[128:131]
s_waitcnt vmcnt(33) lgkmcnt(4)
ds_read_b64_tr_b16 v[52:53], v11 offset:8192
v_mfma_f32_16x16x32_bf16 v[128:131], v[40:43], a[72:75], v[128:131]
s_waitcnt vmcnt(31) lgkmcnt(3)
buffer_load_dwordx4 a[136:139], v1, s[4:7], s54 offen offset:2048 sc1
v_mfma_f32_16x16x32_bf16 v[128:131], v[44:47], a[76:79], v[128:131]
s_waitcnt vmcnt(31)
ds_read_b64_tr_b16 v[54:55], v11 offset:9216
v_mfma_f32_16x16x32_bf16 v[132:135], v[32:35], a[80:83], v[132:135]
s_waitcnt vmcnt(29)
v_mfma_f32_16x16x32_bf16 v[132:135], v[36:39], a[84:87], v[132:135]
s_waitcnt vmcnt(28)
ds_read_b64_tr_b16 v[56:57], v11 offset:16384
v_mfma_f32_16x16x32_bf16 v[132:135], v[40:43], a[88:91], v[132:135]
s_waitcnt vmcnt(26)
buffer_load_dwordx4 a[140:143], v1, s[4:7], s54 offen offset:3072 sc1
v_mfma_f32_16x16x32_bf16 v[132:135], v[44:47], a[92:95], v[132:135]
s_waitcnt vmcnt(26)
s_add_u32 s54, s77, 8192
ds_read_b64_tr_b16 v[58:59], v11 offset:17408
v_mfma_f32_16x16x32_bf16 v[136:139], v[32:35], a[96:99], v[136:139]
s_waitcnt vmcnt(24)
v_lshrrev_b32 v2, 6, v1
v_and_b32 v2, 12, v2
v_mfma_f32_16x16x32_bf16 v[136:139], v[36:39], a[100:103], v[136:139]
s_waitcnt vmcnt(22)
ds_read_b64_tr_b16 v[60:61], v11 offset:24576
v_bfe_u32 v3, v1, 4, 4
v_mfma_f32_16x16x32_bf16 v[136:139], v[40:43], a[104:107], v[136:139]
s_waitcnt vmcnt(21)
buffer_load_dwordx4 a[144:147], v1, s[4:7], s54 offen offset:0 sc1
v_mfma_f32_16x16x32_bf16 v[136:139], v[44:47], a[108:111], v[136:139]
s_waitcnt vmcnt(20)
ds_read_b64_tr_b16 v[62:63], v11 offset:25600
v_add_u32 v4, 0, v2
v_mfma_f32_16x16x32_bf16 v[140:143], v[32:35], a[112:115], v[140:143]
s_waitcnt vmcnt(19)
v_add_u32 v11, 0xffff8000, v11
v_cmp_gt_u32 s[68:69], v4, v3
v_mfma_f32_16x16x32_bf16 v[140:143], v[36:39], a[116:119], v[140:143]
s_waitcnt vmcnt(17)
ds_read_b64_tr_b16 v[32:33], v12 offset:0
v_add_u32 v4, 1, v2
v_mfma_f32_16x16x32_bf16 v[140:143], v[40:43], a[120:123], v[140:143]
s_waitcnt vmcnt(15)
buffer_load_dwordx4 a[148:151], v1, s[4:7], s54 offen offset:1024 sc1
v_mfma_f32_16x16x32_bf16 v[140:143], v[44:47], a[124:127], v[140:143]
s_waitcnt lgkmcnt(7)
ds_read_b64_tr_b16 v[34:35], v12 offset:1024
v_cmp_gt_u32 s[70:71], v4, v3
v_mfma_f32_16x16x32_bf16 v[144:147], v[48:51], a[64:67], v[144:147]
s_waitcnt lgkmcnt(6)
v_add_u32 v4, 2, v2
v_cmp_gt_u32 s[72:73], v4, v3
v_mfma_f32_16x16x32_bf16 v[144:147], v[52:55], a[68:71], v[144:147]
s_waitcnt lgkmcnt(4)
ds_read_b64_tr_b16 v[36:37], v12 offset:8192
v_add_u32 v4, 3, v2
v_mfma_f32_16x16x32_bf16 v[144:147], v[56:59], a[72:75], v[144:147]
s_waitcnt lgkmcnt(3)
buffer_load_dwordx4 a[152:155], v1, s[4:7], s54 offen offset:2048 sc1
v_mfma_f32_16x16x32_bf16 v[144:147], v[60:63], a[76:79], v[144:147]
ds_read_b64_tr_b16 v[38:39], v12 offset:9216
v_cmp_gt_u32 s[74:75], v4, v3
v_mfma_f32_16x16x32_bf16 v[148:151], v[48:51], a[80:83], v[148:151]
v_mfma_f32_16x16x32_bf16 v[148:151], v[52:55], a[84:87], v[148:151]
ds_read_b64_tr_b16 v[40:41], v12 offset:16384
v_mfma_f32_16x16x32_bf16 v[148:151], v[56:59], a[88:91], v[148:151]
buffer_load_dwordx4 a[156:159], v1, s[4:7], s54 offen offset:3072 sc1
v_mfma_f32_16x16x32_bf16 v[148:151], v[60:63], a[92:95], v[148:151]
s_add_u32 s54, s78, 8192
ds_read_b64_tr_b16 v[42:43], v12 offset:17408
v_mfma_f32_16x16x32_bf16 v[152:155], v[48:51], a[96:99], v[152:155]
v_mfma_f32_16x16x32_bf16 v[152:155], v[52:55], a[100:103], v[152:155]
ds_read_b64_tr_b16 v[44:45], v12 offset:24576
v_mfma_f32_16x16x32_bf16 v[152:155], v[56:59], a[104:107], v[152:155]
buffer_load_dwordx4 a[160:163], v1, s[4:7], s54 offen offset:0 sc1
v_mfma_f32_16x16x32_bf16 v[152:155], v[60:63], a[108:111], v[152:155]
ds_read_b64_tr_b16 v[46:47], v12 offset:25600
v_mfma_f32_16x16x32_bf16 v[156:159], v[48:51], a[112:115], v[156:159]
v_add_u32 v12, 0xffff8000, v12
v_mfma_f32_16x16x32_bf16 v[156:159], v[52:55], a[116:119], v[156:159]
ds_read_b64_tr_b16 v[48:49], v13 offset:0
v_mfma_f32_16x16x32_bf16 v[156:159], v[56:59], a[120:123], v[156:159]
buffer_load_dwordx4 a[164:167], v1, s[4:7], s54 offen offset:1024 sc1
v_mfma_f32_16x16x32_bf16 v[156:159], v[60:63], a[124:127], v[156:159]
s_waitcnt lgkmcnt(7)
ds_read_b64_tr_b16 v[50:51], v13 offset:1024
v_mfma_f32_16x16x32_bf16 v[160:163], v[32:35], a[64:67], v[160:163]
s_waitcnt lgkmcnt(6)
v_mfma_f32_16x16x32_bf16 v[160:163], v[36:39], a[68:71], v[160:163]
s_waitcnt lgkmcnt(4)
ds_read_b64_tr_b16 v[52:53], v13 offset:8192
v_mfma_f32_16x16x32_bf16 v[160:163], v[40:43], a[72:75], v[160:163]
s_waitcnt lgkmcnt(3)
buffer_load_dwordx4 a[168:171], v1, s[4:7], s54 offen offset:2048 sc1
v_mfma_f32_16x16x32_bf16 v[160:163], v[44:47], a[76:79], v[160:163]
ds_read_b64_tr_b16 v[54:55], v13 offset:9216
v_mfma_f32_16x16x32_bf16 v[164:167], v[32:35], a[80:83], v[164:167]
v_mfma_f32_16x16x32_bf16 v[164:167], v[36:39], a[84:87], v[164:167]
ds_read_b64_tr_b16 v[56:57], v13 offset:16384
v_mfma_f32_16x16x32_bf16 v[164:167], v[40:43], a[88:91], v[164:167]
buffer_load_dwordx4 a[172:175], v1, s[4:7], s54 offen offset:3072 sc1
v_mfma_f32_16x16x32_bf16 v[164:167], v[44:47], a[92:95], v[164:167]
s_add_u32 s54, s79, 8192
ds_read_b64_tr_b16 v[58:59], v13 offset:17408
v_mfma_f32_16x16x32_bf16 v[168:171], v[32:35], a[96:99], v[168:171]
v_mfma_f32_16x16x32_bf16 v[168:171], v[36:39], a[100:103], v[168:171]
ds_read_b64_tr_b16 v[60:61], v13 offset:24576
v_mfma_f32_16x16x32_bf16 v[168:171], v[40:43], a[104:107], v[168:171]
buffer_load_dwordx4 a[176:179], v1, s[4:7], s54 offen offset:0 sc1
v_mfma_f32_16x16x32_bf16 v[168:171], v[44:47], a[108:111], v[168:171]
ds_read_b64_tr_b16 v[62:63], v13 offset:25600
v_mfma_f32_16x16x32_bf16 v[172:175], v[32:35], a[112:115], v[172:175]
v_add_u32 v13, 0xffff8000, v13
v_mfma_f32_16x16x32_bf16 v[172:175], v[36:39], a[116:119], v[172:175]
ds_read_b64_tr_b16 v[32:33], v14 offset:0
v_mfma_f32_16x16x32_bf16 v[172:175], v[40:43], a[120:123], v[172:175]
buffer_load_dwordx4 a[180:183], v1, s[4:7], s54 offen offset:1024 sc1
v_mfma_f32_16x16x32_bf16 v[172:175], v[44:47], a[124:127], v[172:175]
s_waitcnt lgkmcnt(7)
ds_read_b64_tr_b16 v[34:35], v14 offset:1024
v_mfma_f32_16x16x32_bf16 v[176:179], v[48:51], a[64:67], v[176:179]
s_waitcnt lgkmcnt(6)
v_mfma_f32_16x16x32_bf16 v[176:179], v[52:55], a[68:71], v[176:179]
s_waitcnt lgkmcnt(4)
ds_read_b64_tr_b16 v[36:37], v14 offset:8192
v_mfma_f32_16x16x32_bf16 v[176:179], v[56:59], a[72:75], v[176:179]
s_waitcnt lgkmcnt(3)
buffer_load_dwordx4 a[184:187], v1, s[4:7], s54 offen offset:2048 sc1
v_mfma_f32_16x16x32_bf16 v[176:179], v[60:63], a[76:79], v[176:179]
ds_read_b64_tr_b16 v[38:39], v14 offset:9216
v_mfma_f32_16x16x32_bf16 v[180:183], v[48:51], a[80:83], v[180:183]
v_mfma_f32_16x16x32_bf16 v[180:183], v[52:55], a[84:87], v[180:183]
ds_read_b64_tr_b16 v[40:41], v14 offset:16384
v_mfma_f32_16x16x32_bf16 v[180:183], v[56:59], a[88:91], v[180:183]
buffer_load_dwordx4 a[188:191], v1, s[4:7], s54 offen offset:3072 sc1
v_mfma_f32_16x16x32_bf16 v[180:183], v[60:63], a[92:95], v[180:183]
ds_read_b64_tr_b16 v[42:43], v14 offset:17408
v_mfma_f32_16x16x32_bf16 v[184:187], v[48:51], a[96:99], v[184:187]
v_mfma_f32_16x16x32_bf16 v[184:187], v[52:55], a[100:103], v[184:187]
s_mov_b32 s54, 3145728
ds_read_b64_tr_b16 v[44:45], v14 offset:24576
v_mfma_f32_16x16x32_bf16 v[184:187], v[56:59], a[104:107], v[184:187]
s_add_u32 m0, s67, 98304
v_mfma_f32_16x16x32_bf16 v[184:187], v[60:63], a[108:111], v[184:187]
ds_read_b64_tr_b16 v[46:47], v14 offset:25600
v_mfma_f32_16x16x32_bf16 v[188:191], v[48:51], a[112:115], v[188:191]
v_add_u32 v14, 0xffff8000, v14
v_mfma_f32_16x16x32_bf16 v[188:191], v[52:55], a[116:119], v[188:191]
ds_read_b64_tr_b16 v[48:49], v15 offset:0
v_mfma_f32_16x16x32_bf16 v[188:191], v[56:59], a[120:123], v[188:191]
buffer_load_dwordx4 v6, s[24:27], s54 offen offset:0  lds
v_mfma_f32_16x16x32_bf16 v[188:191], v[60:63], a[124:127], v[188:191]
s_waitcnt lgkmcnt(7)
ds_read_b64_tr_b16 v[50:51], v15 offset:1024
v_mfma_f32_16x16x32_bf16 v[192:195], v[32:35], a[64:67], v[192:195]
s_waitcnt lgkmcnt(6)
v_mfma_f32_16x16x32_bf16 v[192:195], v[36:39], a[68:71], v[192:195]
s_waitcnt lgkmcnt(4)
ds_read_b64_tr_b16 v[52:53], v15 offset:8192
v_mfma_f32_16x16x32_bf16 v[192:195], v[40:43], a[72:75], v[192:195]
s_waitcnt lgkmcnt(3)
v_mfma_f32_16x16x32_bf16 v[192:195], v[44:47], a[76:79], v[192:195]
ds_read_b64_tr_b16 v[54:55], v15 offset:9216
v_mfma_f32_16x16x32_bf16 v[196:199], v[32:35], a[80:83], v[196:199]
buffer_load_dwordx4 v7, s[24:27], s54 offen offset:1024  lds
v_mfma_f32_16x16x32_bf16 v[196:199], v[36:39], a[84:87], v[196:199]
ds_read_b64_tr_b16 v[56:57], v15 offset:16384
v_mfma_f32_16x16x32_bf16 v[196:199], v[40:43], a[88:91], v[196:199]
v_mfma_f32_16x16x32_bf16 v[196:199], v[44:47], a[92:95], v[196:199]
ds_read_b64_tr_b16 v[58:59], v15 offset:17408
v_mfma_f32_16x16x32_bf16 v[200:203], v[32:35], a[96:99], v[200:203]
v_mfma_f32_16x16x32_bf16 v[200:203], v[36:39], a[100:103], v[200:203]
ds_read_b64_tr_b16 v[60:61], v15 offset:24576
v_mfma_f32_16x16x32_bf16 v[200:203], v[40:43], a[104:107], v[200:203]
buffer_load_dwordx4 v8, s[24:27], s54 offen offset:2048  lds
v_mfma_f32_16x16x32_bf16 v[200:203], v[44:47], a[108:111], v[200:203]
ds_read_b64_tr_b16 v[62:63], v15 offset:25600
v_mfma_f32_16x16x32_bf16 v[204:207], v[32:35], a[112:115], v[204:207]
v_add_u32 v15, 0xffff8000, v15
v_mfma_f32_16x16x32_bf16 v[204:207], v[36:39], a[116:119], v[204:207]
ds_read_b64_tr_b16 v[32:33], v16 offset:0
v_mfma_f32_16x16x32_bf16 v[204:207], v[40:43], a[120:123], v[204:207]
v_mfma_f32_16x16x32_bf16 v[204:207], v[44:47], a[124:127], v[204:207]
s_waitcnt lgkmcnt(7)
ds_read_b64_tr_b16 v[34:35], v16 offset:1024
v_mfma_f32_16x16x32_bf16 v[208:211], v[48:51], a[64:67], v[208:211]
s_waitcnt lgkmcnt(6)
buffer_load_dwordx4 v9, s[24:27], s54 offen offset:3072  lds
v_mfma_f32_16x16x32_bf16 v[208:211], v[52:55], a[68:71], v[208:211]
s_waitcnt lgkmcnt(4)
s_mov_b32 s54, 3670016
ds_read_b64_tr_b16 v[36:37], v16 offset:8192
v_mfma_f32_16x16x32_bf16 v[208:211], v[56:59], a[72:75], v[208:211]
s_waitcnt lgkmcnt(3)
s_add_u32 m0, s67, 114688
v_mfma_f32_16x16x32_bf16 v[208:211], v[60:63], a[76:79], v[208:211]
ds_read_b64_tr_b16 v[38:39], v16 offset:9216
v_mfma_f32_16x16x32_bf16 v[212:215], v[48:51], a[80:83], v[212:215]
v_mfma_f32_16x16x32_bf16 v[212:215], v[52:55], a[84:87], v[212:215]
ds_read_b64_tr_b16 v[40:41], v16 offset:16384
v_mfma_f32_16x16x32_bf16 v[212:215], v[56:59], a[88:91], v[212:215]
buffer_load_dwordx4 v6, s[24:27], s54 offen offset:0  lds
v_mfma_f32_16x16x32_bf16 v[212:215], v[60:63], a[92:95], v[212:215]
ds_read_b64_tr_b16 v[42:43], v16 offset:17408
v_mfma_f32_16x16x32_bf16 v[216:219], v[48:51], a[96:99], v[216:219]
v_mfma_f32_16x16x32_bf16 v[216:219], v[52:55], a[100:103], v[216:219]
ds_read_b64_tr_b16 v[44:45], v16 offset:24576
v_mfma_f32_16x16x32_bf16 v[216:219], v[56:59], a[104:107], v[216:219]
v_mfma_f32_16x16x32_bf16 v[216:219], v[60:63], a[108:111], v[216:219]
ds_read_b64_tr_b16 v[46:47], v16 offset:25600
v_mfma_f32_16x16x32_bf16 v[220:223], v[48:51], a[112:115], v[220:223]
v_add_u32 v16, 0xffff8000, v16
v_mfma_f32_16x16x32_bf16 v[220:223], v[52:55], a[116:119], v[220:223]
ds_read_b64_tr_b16 v[48:49], v17 offset:0
v_mfma_f32_16x16x32_bf16 v[220:223], v[56:59], a[120:123], v[220:223]
buffer_load_dwordx4 v7, s[24:27], s54 offen offset:1024  lds
v_mfma_f32_16x16x32_bf16 v[220:223], v[60:63], a[124:127], v[220:223]
s_waitcnt lgkmcnt(7)
ds_read_b64_tr_b16 v[50:51], v17 offset:1024
v_mfma_f32_16x16x32_bf16 v[224:227], v[32:35], a[64:67], v[224:227]
s_waitcnt lgkmcnt(6)
v_mfma_f32_16x16x32_bf16 v[224:227], v[36:39], a[68:71], v[224:227]
s_waitcnt lgkmcnt(4)
ds_read_b64_tr_b16 v[52:53], v17 offset:8192
v_mfma_f32_16x16x32_bf16 v[224:227], v[40:43], a[72:75], v[224:227]
s_waitcnt lgkmcnt(3)
v_mfma_f32_16x16x32_bf16 v[224:227], v[44:47], a[76:79], v[224:227]
ds_read_b64_tr_b16 v[54:55], v17 offset:9216
v_mfma_f32_16x16x32_bf16 v[228:231], v[32:35], a[80:83], v[228:231]
buffer_load_dwordx4 v8, s[24:27], s54 offen offset:2048  lds
v_mfma_f32_16x16x32_bf16 v[228:231], v[36:39], a[84:87], v[228:231]
ds_read_b64_tr_b16 v[56:57], v17 offset:16384
v_mfma_f32_16x16x32_bf16 v[228:231], v[40:43], a[88:91], v[228:231]
v_mfma_f32_16x16x32_bf16 v[228:231], v[44:47], a[92:95], v[228:231]
ds_read_b64_tr_b16 v[58:59], v17 offset:17408
v_mfma_f32_16x16x32_bf16 v[232:235], v[32:35], a[96:99], v[232:235]
v_mfma_f32_16x16x32_bf16 v[232:235], v[36:39], a[100:103], v[232:235]
ds_read_b64_tr_b16 v[60:61], v17 offset:24576
v_mfma_f32_16x16x32_bf16 v[232:235], v[40:43], a[104:107], v[232:235]
buffer_load_dwordx4 v9, s[24:27], s54 offen offset:3072  lds
v_mfma_f32_16x16x32_bf16 v[232:235], v[44:47], a[108:111], v[232:235]
ds_read_b64_tr_b16 v[62:63], v17 offset:25600
v_mfma_f32_16x16x32_bf16 v[236:239], v[32:35], a[112:115], v[236:239]
v_add_u32 v17, 0xffff8000, v17
v_mfma_f32_16x16x32_bf16 v[236:239], v[36:39], a[116:119], v[236:239]
v_mfma_f32_16x16x32_bf16 v[236:239], v[40:43], a[120:123], v[236:239]
s_add_u32 s54, s76, 12288
buffer_load_dwordx4 a[192:195], v1, s[4:7], s54 offen offset:0 sc1
v_mfma_f32_16x16x32_bf16 v[236:239], v[44:47], a[124:127], v[236:239]
s_waitcnt lgkmcnt(6)
v_mfma_f32_16x16x32_bf16 v[240:243], v[48:51], a[64:67], v[240:243]
s_waitcnt vmcnt(25)
s_waitcnt lgkmcnt(0)
s_barrier
v_mfma_f32_16x16x32_bf16 v[240:243], v[52:55], a[68:71], v[240:243]
ds_read_b64_tr_b16 v[32:33], v10 offset:0
v_mfma_f32_16x16x32_bf16 v[240:243], v[56:59], a[72:75], v[240:243]
ds_read_b64_tr_b16 v[34:35], v10 offset:1024
v_mfma_f32_16x16x32_bf16 v[240:243], v[60:63], a[76:79], v[240:243]
ds_read_b64_tr_b16 v[36:37], v10 offset:8192
s_cmp_eq_u32 s50, 0
s_cselect_b32 s3, s23, 0
s_cmp_eq_u32 s3, 0
s_cbranch_scc1 L_samedieN
buffer_wbl2 sc1
s_waitcnt vmcnt(0)
L_samedieN:
v_mfma_f32_16x16x32_bf16 v[244:247], v[48:51], a[80:83], v[244:247]
s_lshl_b32 s53, s48, 8
ds_read_b64_tr_b16 v[38:39], v10 offset:9216
v_mfma_f32_16x16x32_bf16 v[244:247], v[52:55], a[84:87], v[244:247]
s_add_u32 s53, s53, 85983232
buffer_load_dwordx4 a[196:199], v1, s[4:7], s54 offen offset:1024 sc1
v_mfma_f32_16x16x32_bf16 v[244:247], v[56:59], a[88:91], v[244:247]
ds_read_b64_tr_b16 v[40:41], v10 offset:16384
v_mov_b32 v31, 1
v_mfma_f32_16x16x32_bf16 v[244:247], v[60:63], a[92:95], v[244:247]
buffer_atomic_add v31, v0, s[4:7], s53 offen sc1
v_mfma_f32_16x16x32_bf16 v[248:251], v[48:51], a[96:99], v[248:251]
ds_read_b64_tr_b16 v[42:43], v10 offset:17408
v_mfma_f32_16x16x32_bf16 v[248:251], v[52:55], a[100:103], v[248:251]
buffer_load_dwordx4 a[200:203], v1, s[4:7], s54 offen offset:2048 sc1
v_mfma_f32_16x16x32_bf16 v[248:251], v[56:59], a[104:107], v[248:251]
ds_read_b64_tr_b16 v[44:45], v10 offset:24576
v_mfma_f32_16x16x32_bf16 v[248:251], v[60:63], a[108:111], v[248:251]
v_mfma_f32_16x16x32_bf16 v[252:255], v[48:51], a[112:115], v[252:255]
ds_read_b64_tr_b16 v[46:47], v10 offset:25600
v_mfma_f32_16x16x32_bf16 v[252:255], v[52:55], a[116:119], v[252:255]
ds_read_b64_tr_b16 v[48:49], v11 offset:0
v_add_u32 v10, 0x10000, v10
v_mfma_f32_16x16x32_bf16 v[252:255], v[56:59], a[120:123], v[252:255]
buffer_load_dwordx4 a[204:207], v1, s[4:7], s54 offen offset:3072 sc1
v_mfma_f32_16x16x32_bf16 v[252:255], v[60:63], a[124:127], v[252:255]
s_waitcnt vmcnt(28) lgkmcnt(7)
s_add_u32 s54, s77, 12288
ds_read_b64_tr_b16 v[50:51], v11 offset:1024
v_mfma_f32_16x16x32_bf16 v[128:131], v[32:35], a[128:131], v[128:131]
s_waitcnt vmcnt(27) lgkmcnt(6)
v_mfma_f32_16x16x32_bf16 v[128:131], v[36:39], a[132:135], v[128:131]
s_waitcnt vmcnt(26) lgkmcnt(4)
ds_read_b64_tr_b16 v[52:53], v11 offset:8192
v_mfma_f32_16x16x32_bf16 v[128:131], v[40:43], a[136:139], v[128:131]
s_waitcnt vmcnt(25) lgkmcnt(3)
buffer_load_dwordx4 a[208:211], v1, s[4:7], s54 offen offset:0 sc1
v_mfma_f32_16x16x32_bf16 v[128:131], v[44:47], a[140:143], v[128:131]
s_waitcnt vmcnt(25)
ds_read_b64_tr_b16 v[54:55], v11 offset:9216
v_mfma_f32_16x16x32_bf16 v[132:135], v[32:35], a[144:147], v[132:135]
s_waitcnt vmcnt(24)
v_mfma_f32_16x16x32_bf16 v[132:135], v[36:39], a[148:151], v[132:135]
s_waitcnt vmcnt(23)
ds_read_b64_tr_b16 v[56:57], v11 offset:16384
v_mfma_f32_16x16x32_bf16 v[132:135], v[40:43], a[152:155], v[132:135]
s_waitcnt vmcnt(22)
buffer_load_dwordx4 a[212:215], v1, s[4:7], s54 offen offset:1024 sc1
v_mfma_f32_16x16x32_bf16 v[132:135], v[44:47], a[156:159], v[132:135]
s_waitcnt vmcnt(22)
ds_read_b64_tr_b16 v[58:59], v11 offset:17408
v_mfma_f32_16x16x32_bf16 v[136:139], v[32:35], a[160:163], v[136:139]
s_waitcnt vmcnt(21)
v_mfma_f32_16x16x32_bf16 v[136:139], v[36:39], a[164:167], v[136:139]
s_waitcnt vmcnt(20)
ds_read_b64_tr_b16 v[60:61], v11 offset:24576
v_mfma_f32_16x16x32_bf16 v[136:139], v[40:43], a[168:171], v[136:139]
s_waitcnt vmcnt(19)
buffer_load_dwordx4 a[216:219], v1, s[4:7], s54 offen offset:2048 sc1
v_mfma_f32_16x16x32_bf16 v[136:139], v[44:47], a[172:175], v[136:139]
s_waitcnt vmcnt(19)
ds_read_b64_tr_b16 v[62:63], v11 offset:25600
v_mfma_f32_16x16x32_bf16 v[140:143], v[32:35], a[176:179], v[140:143]
s_waitcnt vmcnt(18)
v_add_u32 v11, 0x10000, v11
v_mfma_f32_16x16x32_bf16 v[140:143], v[36:39], a[180:183], v[140:143]
s_waitcnt vmcnt(17)
ds_read_b64_tr_b16 v[32:33], v12 offset:0
v_mfma_f32_16x16x32_bf16 v[140:143], v[40:43], a[184:187], v[140:143]
s_waitcnt vmcnt(16)
buffer_load_dwordx4 a[220:223], v1, s[4:7], s54 offen offset:3072 sc1
v_mfma_f32_16x16x32_bf16 v[140:143], v[44:47], a[188:191], v[140:143]
s_waitcnt lgkmcnt(7)
s_add_u32 s54, s78, 12288
ds_read_b64_tr_b16 v[34:35], v12 offset:1024
v_mfma_f32_16x16x32_bf16 v[144:147], v[48:51], a[128:131], v[144:147]
s_waitcnt lgkmcnt(6)
v_mfma_f32_16x16x32_bf16 v[144:147], v[52:55], a[132:135], v[144:147]
s_waitcnt lgkmcnt(4)
ds_read_b64_tr_b16 v[36:37], v12 offset:8192
v_mfma_f32_16x16x32_bf16 v[144:147], v[56:59], a[136:139], v[144:147]
s_waitcnt lgkmcnt(3)
buffer_load_dwordx4 a[224:227], v1, s[4:7], s54 offen offset:0 sc1
v_mfma_f32_16x16x32_bf16 v[144:147], v[60:63], a[140:143], v[144:147]
ds_read_b64_tr_b16 v[38:39], v12 offset:9216
v_mfma_f32_16x16x32_bf16 v[148:151], v[48:51], a[144:147], v[148:151]
v_mfma_f32_16x16x32_bf16 v[148:151], v[52:55], a[148:151], v[148:151]
ds_read_b64_tr_b16 v[40:41], v12 offset:16384
v_mfma_f32_16x16x32_bf16 v[148:151], v[56:59], a[152:155], v[148:151]
buffer_load_dwordx4 a[228:231], v1, s[4:7], s54 offen offset:1024 sc1
v_mfma_f32_16x16x32_bf16 v[148:151], v[60:63], a[156:159], v[148:151]
ds_read_b64_tr_b16 v[42:43], v12 offset:17408
v_mfma_f32_16x16x32_bf16 v[152:155], v[48:51], a[160:163], v[152:155]
v_mfma_f32_16x16x32_bf16 v[152:155], v[52:55], a[164:167], v[152:155]
ds_read_b64_tr_b16 v[44:45], v12 offset:24576
v_mfma_f32_16x16x32_bf16 v[152:155], v[56:59], a[168:171], v[152:155]
buffer_load_dwordx4 a[232:235], v1, s[4:7], s54 offen offset:2048 sc1
v_mfma_f32_16x16x32_bf16 v[152:155], v[60:63], a[172:175], v[152:155]
ds_read_b64_tr_b16 v[46:47], v12 offset:25600
v_mfma_f32_16x16x32_bf16 v[156:159], v[48:51], a[176:179], v[156:159]
v_add_u32 v12, 0x10000, v12
v_mfma_f32_16x16x32_bf16 v[156:159], v[52:55], a[180:183], v[156:159]
ds_read_b64_tr_b16 v[48:49], v13 offset:0
v_mfma_f32_16x16x32_bf16 v[156:159], v[56:59], a[184:187], v[156:159]
buffer_load_dwordx4 a[236:239], v1, s[4:7], s54 offen offset:3072 sc1
v_mfma_f32_16x16x32_bf16 v[156:159], v[60:63], a[188:191], v[156:159]
s_waitcnt lgkmcnt(7)
s_add_u32 s54, s79, 12288
ds_read_b64_tr_b16 v[50:51], v13 offset:1024
v_mfma_f32_16x16x32_bf16 v[160:163], v[32:35], a[128:131], v[160:163]
s_waitcnt lgkmcnt(6)
v_mfma_f32_16x16x32_bf16 v[160:163], v[36:39], a[132:135], v[160:163]
s_waitcnt lgkmcnt(4)
ds_read_b64_tr_b16 v[52:53], v13 offset:8192
v_mfma_f32_16x16x32_bf16 v[160:163], v[40:43], a[136:139], v[160:163]
s_waitcnt lgkmcnt(3)
buffer_load_dwordx4 a[240:243], v1, s[4:7], s54 offen offset:0 sc1
v_mfma_f32_16x16x32_bf16 v[160:163], v[44:47], a[140:143], v[160:163]
ds_read_b64_tr_b16 v[54:55], v13 offset:9216
v_mfma_f32_16x16x32_bf16 v[164:167], v[32:35], a[144:147], v[164:167]
v_mfma_f32_16x16x32_bf16 v[164:167], v[36:39], a[148:151], v[164:167]
ds_read_b64_tr_b16 v[56:57], v13 offset:16384
v_mfma_f32_16x16x32_bf16 v[164:167], v[40:43], a[152:155], v[164:167]
buffer_load_dwordx4 a[244:247], v1, s[4:7], s54 offen offset:1024 sc1
v_mfma_f32_16x16x32_bf16 v[164:167], v[44:47], a[156:159], v[164:167]
ds_read_b64_tr_b16 v[58:59], v13 offset:17408
v_mfma_f32_16x16x32_bf16 v[168:171], v[32:35], a[160:163], v[168:171]
v_mfma_f32_16x16x32_bf16 v[168:171], v[36:39], a[164:167], v[168:171]
ds_read_b64_tr_b16 v[60:61], v13 offset:24576
v_mfma_f32_16x16x32_bf16 v[168:171], v[40:43], a[168:171], v[168:171]
buffer_load_dwordx4 a[248:251], v1, s[4:7], s54 offen offset:2048 sc1
v_mfma_f32_16x16x32_bf16 v[168:171], v[44:47], a[172:175], v[168:171]
ds_read_b64_tr_b16 v[62:63], v13 offset:25600
v_mfma_f32_16x16x32_bf16 v[172:175], v[32:35], a[176:179], v[172:175]
v_add_u32 v13, 0x10000, v13
v_mfma_f32_16x16x32_bf16 v[172:175], v[36:39], a[180:183], v[172:175]
ds_read_b64_tr_b16 v[32:33], v14 offset:0
v_mfma_f32_16x16x32_bf16 v[172:175], v[40:43], a[184:187], v[172:175]
buffer_load_dwordx4 a[252:255], v1, s[4:7], s54 offen offset:3072 sc1
v_mfma_f32_16x16x32_bf16 v[172:175], v[44:47], a[188:191], v[172:175]
s_waitcnt lgkmcnt(7)
ds_read_b64_tr_b16 v[34:35], v14 offset:1024
v_mfma_f32_16x16x32_bf16 v[176:179], v[48:51], a[128:131], v[176:179]
s_waitcnt lgkmcnt(6)
v_mfma_f32_16x16x32_bf16 v[176:179], v[52:55], a[132:135], v[176:179]
s_waitcnt lgkmcnt(4)
s_lshl_b32 s57, s2, 2
ds_read_b64_tr_b16 v[36:37], v14 offset:8192
v_mfma_f32_16x16x32_bf16 v[176:179], v[56:59], a[136:139], v[176:179]
s_waitcnt lgkmcnt(3)
s_add_u32 s57, s57, s50
v_mfma_f32_16x16x32_bf16 v[176:179], v[60:63], a[140:143], v[176:179]
s_mul_i32 s22, s57, 2176
ds_read_b64_tr_b16 v[38:39], v14 offset:9216
v_mfma_f32_16x16x32_bf16 v[180:183], v[48:51], a[144:147], v[180:183]
s_mul_i32 s57, s57, 5120
v_cmp_gt_u32 vcc, 320, v1
v_lshlrev_b32 v24, 3, v1
v_mfma_f32_16x16x32_bf16 v[180:183], v[52:55], a[148:151], v[180:183]
ds_read_b64_tr_b16 v[40:41], v14 offset:16384
v_mov_b32 v31, 2130706432
v_mfma_f32_16x16x32_bf16 v[180:183], v[56:59], a[152:155], v[180:183]
v_cndmask_b32 v24, v31, v24, vcc
v_mfma_f32_16x16x32_bf16 v[180:183], v[60:63], a[156:159], v[180:183]
ds_read_b64_tr_b16 v[42:43], v14 offset:17408
v_mfma_f32_16x16x32_bf16 v[184:187], v[48:51], a[160:163], v[184:187]
buffer_load_dword v31, v24, s[32:35], s57 offen
v_mfma_f32_16x16x32_bf16 v[184:187], v[52:55], a[164:167], v[184:187]
ds_read_b64_tr_b16 v[44:45], v14 offset:24576
v_mfma_f32_16x16x32_bf16 v[184:187], v[56:59], a[168:171], v[184:187]
v_mfma_f32_16x16x32_bf16 v[184:187], v[60:63], a[172:175], v[184:187]
ds_read_b64_tr_b16 v[46:47], v14 offset:25600
v_mfma_f32_16x16x32_bf16 v[188:191], v[48:51], a[176:179], v[188:191]
v_add_u32 v14, 0x10000, v14
v_mfma_f32_16x16x32_bf16 v[188:191], v[52:55], a[180:183], v[188:191]
ds_read_b64_tr_b16 v[48:49], v15 offset:0
v_mfma_f32_16x16x32_bf16 v[188:191], v[56:59], a[184:187], v[188:191]
v_mfma_f32_16x16x32_bf16 v[188:191], v[60:63], a[188:191], v[188:191]
s_waitcnt lgkmcnt(7)
ds_read_b64_tr_b16 v[50:51], v15 offset:1024
v_mfma_f32_16x16x32_bf16 v[192:195], v[32:35], a[128:131], v[192:195]
s_waitcnt lgkmcnt(6)
buffer_load_dword v31, v24, s[32:35], s57 offen offset:2560
v_mfma_f32_16x16x32_bf16 v[192:195], v[36:39], a[132:135], v[192:195]
s_waitcnt lgkmcnt(4)
ds_read_b64_tr_b16 v[52:53], v15 offset:8192
v_mfma_f32_16x16x32_bf16 v[192:195], v[40:43], a[136:139], v[192:195]
s_waitcnt lgkmcnt(3)
v_mfma_f32_16x16x32_bf16 v[192:195], v[44:47], a[140:143], v[192:195]
ds_read_b64_tr_b16 v[54:55], v15 offset:9216
v_mfma_f32_16x16x32_bf16 v[196:199], v[32:35], a[144:147], v[196:199]
v_mfma_f32_16x16x32_bf16 v[196:199], v[36:39], a[148:151], v[196:199]
ds_read_b64_tr_b16 v[56:57], v15 offset:16384
v_mfma_f32_16x16x32_bf16 v[196:199], v[40:43], a[152:155], v[196:199]
v_mfma_f32_16x16x32_bf16 v[196:199], v[44:47], a[156:159], v[196:199]
s_mov_b32 s54, 4194304
ds_read_b64_tr_b16 v[58:59], v15 offset:17408
v_mfma_f32_16x16x32_bf16 v[200:203], v[32:35], a[160:163], v[200:203]
s_add_u32 m0, s67, 65536
v_mfma_f32_16x16x32_bf16 v[200:203], v[36:39], a[164:167], v[200:203]
ds_read_b64_tr_b16 v[60:61], v15 offset:24576
v_mfma_f32_16x16x32_bf16 v[200:203], v[40:43], a[168:171], v[200:203]
buffer_load_dwordx4 v6, s[24:27], s54 offen offset:0  lds
v_mfma_f32_16x16x32_bf16 v[200:203], v[44:47], a[172:175], v[200:203]
ds_read_b64_tr_b16 v[62:63], v15 offset:25600
v_mfma_f32_16x16x32_bf16 v[204:207], v[32:35], a[176:179], v[204:207]
v_add_u32 v15, 0x10000, v15
v_mfma_f32_16x16x32_bf16 v[204:207], v[36:39], a[180:183], v[204:207]
ds_read_b64_tr_b16 v[32:33], v16 offset:0
v_mfma_f32_16x16x32_bf16 v[204:207], v[40:43], a[184:187], v[204:207]
v_mfma_f32_16x16x32_bf16 v[204:207], v[44:47], a[188:191], v[204:207]
s_waitcnt lgkmcnt(7)
ds_read_b64_tr_b16 v[34:35], v16 offset:1024
v_mfma_f32_16x16x32_bf16 v[208:211], v[48:51], a[128:131], v[208:211]
s_waitcnt lgkmcnt(6)
buffer_load_dwordx4 v7, s[24:27], s54 offen offset:1024  lds
v_mfma_f32_16x16x32_bf16 v[208:211], v[52:55], a[132:135], v[208:211]
s_waitcnt lgkmcnt(4)
ds_read_b64_tr_b16 v[36:37], v16 offset:8192
v_mfma_f32_16x16x32_bf16 v[208:211], v[56:59], a[136:139], v[208:211]
s_waitcnt lgkmcnt(3)
v_mfma_f32_16x16x32_bf16 v[208:211], v[60:63], a[140:143], v[208:211]
ds_read_b64_tr_b16 v[38:39], v16 offset:9216
v_mfma_f32_16x16x32_bf16 v[212:215], v[48:51], a[144:147], v[212:215]
v_mfma_f32_16x16x32_bf16 v[212:215], v[52:55], a[148:151], v[212:215]
ds_read_b64_tr_b16 v[40:41], v16 offset:16384
v_mfma_f32_16x16x32_bf16 v[212:215], v[56:59], a[152:155], v[212:215]
buffer_load_dwordx4 v8, s[24:27], s54 offen offset:2048  lds
v_mfma_f32_16x16x32_bf16 v[212:215], v[60:63], a[156:159], v[212:215]
ds_read_b64_tr_b16 v[42:43], v16 offset:17408
v_mfma_f32_16x16x32_bf16 v[216:219], v[48:51], a[160:163], v[216:219]
v_mfma_f32_16x16x32_bf16 v[216:219], v[52:55], a[164:167], v[216:219]
ds_read_b64_tr_b16 v[44:45], v16 offset:24576
v_mfma_f32_16x16x32_bf16 v[216:219], v[56:59], a[168:171], v[216:219]
v_mfma_f32_16x16x32_bf16 v[216:219], v[60:63], a[172:175], v[216:219]
ds_read_b64_tr_b16 v[46:47], v16 offset:25600
v_mfma_f32_16x16x32_bf16 v[220:223], v[48:51], a[176:179], v[220:223]
v_add_u32 v16, 0x10000, v16
v_mfma_f32_16x16x32_bf16 v[220:223], v[52:55], a[180:183], v[220:223]
ds_read_b64_tr_b16 v[48:49], v17 offset:0
v_mfma_f32_16x16x32_bf16 v[220:223], v[56:59], a[184:187], v[220:223]
buffer_load_dwordx4 v9, s[24:27], s54 offen offset:3072  lds
v_mfma_f32_16x16x32_bf16 v[220:223], v[60:63], a[188:191], v[220:223]
s_waitcnt lgkmcnt(7)
s_mov_b32 s54, 4718592
ds_read_b64_tr_b16 v[50:51], v17 offset:1024
v_mfma_f32_16x16x32_bf16 v[224:227], v[32:35], a[128:131], v[224:227]
s_waitcnt lgkmcnt(6)
s_add_u32 m0, s67, 81920
v_mfma_f32_16x16x32_bf16 v[224:227], v[36:39], a[132:135], v[224:227]
s_waitcnt lgkmcnt(4)
ds_read_b64_tr_b16 v[52:53], v17 offset:8192
v_mfma_f32_16x16x32_bf16 v[224:227], v[40:43], a[136:139], v[224:227]
s_waitcnt lgkmcnt(3)
v_mfma_f32_16x16x32_bf16 v[224:227], v[44:47], a[140:143], v[224:227]
ds_read_b64_tr_b16 v[54:55], v17 offset:9216
v_mfma_f32_16x16x32_bf16 v[228:231], v[32:35], a[144:147], v[228:231]
buffer_load_dwordx4 v6, s[24:27], s54 offen offset:0  lds
v_mfma_f32_16x16x32_bf16 v[228:231], v[36:39], a[148:151], v[228:231]
ds_read_b64_tr_b16 v[56:57], v17 offset:16384
v_mfma_f32_16x16x32_bf16 v[228:231], v[40:43], a[152:155], v[228:231]
v_mfma_f32_16x16x32_bf16 v[228:231], v[44:47], a[156:159], v[228:231]
ds_read_b64_tr_b16 v[58:59], v17 offset:17408
v_mfma_f32_16x16x32_bf16 v[232:235], v[32:35], a[160:163], v[232:235]
v_mfma_f32_16x16x32_bf16 v[232:235], v[36:39], a[164:167], v[232:235]
ds_read_b64_tr_b16 v[60:61], v17 offset:24576
v_mfma_f32_16x16x32_bf16 v[232:235], v[40:43], a[168:171], v[232:235]
buffer_load_dwordx4 v7, s[24:27], s54 offen offset:1024  lds
v_mfma_f32_16x16x32_bf16 v[232:235], v[44:47], a[172:175], v[232:235]
ds_read_b64_tr_b16 v[62:63], v17 offset:25600
v_mfma_f32_16x16x32_bf16 v[236:239], v[32:35], a[176:179], v[236:239]
v_add_u32 v17, 0x10000, v17
v_mfma_f32_16x16x32_bf16 v[236:239], v[36:39], a[180:183], v[236:239]
v_mfma_f32_16x16x32_bf16 v[236:239], v[40:43], a[184:187], v[236:239]
v_mfma_f32_16x16x32_bf16 v[236:239], v[44:47], a[188:191], v[236:239]
s_waitcnt lgkmcnt(6)
buffer_load_dwordx4 v8, s[24:27], s54 offen offset:2048  lds
v_mfma_f32_16x16x32_bf16 v[240:243], v[48:51], a[128:131], v[240:243]
s_waitcnt vmcnt(26)
s_waitcnt lgkmcnt(0)
s_barrier
v_mfma_f32_16x16x32_bf16 v[240:243], v[52:55], a[132:135], v[240:243]
ds_read_b64_tr_b16 v[32:33], v10 offset:0
v_mfma_f32_16x16x32_bf16 v[240:243], v[56:59], a[136:139], v[240:243]
ds_read_b64_tr_b16 v[34:35], v10 offset:1024
v_mfma_f32_16x16x32_bf16 v[240:243], v[60:63], a[140:143], v[240:243]
ds_read_b64_tr_b16 v[36:37], v10 offset:8192
v_mfma_f32_16x16x32_bf16 v[244:247], v[48:51], a[144:147], v[244:247]
ds_read_b64_tr_b16 v[38:39], v10 offset:9216
v_mfma_f32_16x16x32_bf16 v[244:247], v[52:55], a[148:151], v[244:247]
buffer_load_dwordx4 v9, s[24:27], s54 offen offset:3072  lds
v_mfma_f32_16x16x32_bf16 v[244:247], v[56:59], a[152:155], v[244:247]
ds_read_b64_tr_b16 v[40:41], v10 offset:16384
v_mfma_f32_16x16x32_bf16 v[244:247], v[60:63], a[156:159], v[244:247]
v_mfma_f32_16x16x32_bf16 v[248:251], v[48:51], a[160:163], v[248:251]
ds_read_b64_tr_b16 v[42:43], v10 offset:17408
v_mfma_f32_16x16x32_bf16 v[248:251], v[52:55], a[164:167], v[248:251]
s_add_u32 s54, s76, 16384
buffer_load_dwordx4 a[0:3], v1, s[4:7], s54 offen offset:0 sc1
v_mfma_f32_16x16x32_bf16 v[248:251], v[56:59], a[168:171], v[248:251]
ds_read_b64_tr_b16 v[44:45], v10 offset:24576
v_mfma_f32_16x16x32_bf16 v[248:251], v[60:63], a[172:175], v[248:251]
v_mfma_f32_16x16x32_bf16 v[252:255], v[48:51], a[176:179], v[252:255]
ds_read_b64_tr_b16 v[46:47], v10 offset:25600
v_mfma_f32_16x16x32_bf16 v[252:255], v[52:55], a[180:183], v[252:255]
ds_read_b64_tr_b16 v[48:49], v11 offset:0
v_add_u32 v10, 0xffff8000, v10
v_mfma_f32_16x16x32_bf16 v[252:255], v[56:59], a[184:187], v[252:255]
buffer_load_dwordx4 a[4:7], v1, s[4:7], s54 offen offset:1024 sc1
v_mfma_f32_16x16x32_bf16 v[252:255], v[60:63], a[188:191], v[252:255]
s_waitcnt vmcnt(28) lgkmcnt(7)
ds_read_b64_tr_b16 v[50:51], v11 offset:1024
v_mfma_f32_16x16x32_bf16 v[128:131], v[32:35], a[192:195], v[128:131]
s_waitcnt vmcnt(27) lgkmcnt(6)
v_mfma_f32_16x16x32_bf16 v[128:131], v[36:39], a[196:199], v[128:131]
s_waitcnt vmcnt(25) lgkmcnt(4)
ds_read_b64_tr_b16 v[52:53], v11 offset:8192
v_mfma_f32_16x16x32_bf16 v[128:131], v[40:43], a[200:203], v[128:131]
s_waitcnt vmcnt(24) lgkmcnt(3)
buffer_load_dwordx4 a[8:11], v1, s[4:7], s54 offen offset:2048 sc1
v_mfma_f32_16x16x32_bf16 v[128:131], v[44:47], a[204:207], v[128:131]
s_waitcnt vmcnt(24)
ds_read_b64_tr_b16 v[54:55], v11 offset:9216
v_mfma_f32_16x16x32_bf16 v[132:135], v[32:35], a[208:211], v[132:135]
s_waitcnt vmcnt(23)
v_mfma_f32_16x16x32_bf16 v[132:135], v[36:39], a[212:215], v[132:135]
s_waitcnt vmcnt(22)
ds_read_b64_tr_b16 v[56:57], v11 offset:16384
v_mfma_f32_16x16x32_bf16 v[132:135], v[40:43], a[216:219], v[132:135]
s_waitcnt vmcnt(21)
buffer_load_dwordx4 a[12:15], v1, s[4:7], s54 offen offset:3072 sc1
v_mfma_f32_16x16x32_bf16 v[132:135], v[44:47], a[220:223], v[132:135]
s_waitcnt vmcnt(21)
s_add_u32 s54, s77, 16384
ds_read_b64_tr_b16 v[58:59], v11 offset:17408
v_mfma_f32_16x16x32_bf16 v[136:139], v[32:35], a[224:227], v[136:139]
s_waitcnt vmcnt(20)
v_mfma_f32_16x16x32_bf16 v[136:139], v[36:39], a[228:231], v[136:139]
s_waitcnt vmcnt(19)
ds_read_b64_tr_b16 v[60:61], v11 offset:24576
v_mfma_f32_16x16x32_bf16 v[136:139], v[40:43], a[232:235], v[136:139]
s_waitcnt vmcnt(18)
buffer_load_dwordx4 a[16:19], v1, s[4:7], s54 offen offset:0 sc1
v_mfma_f32_16x16x32_bf16 v[136:139], v[44:47], a[236:239], v[136:139]
s_waitcnt vmcnt(18)
ds_read_b64_tr_b16 v[62:63], v11 offset:25600
v_mfma_f32_16x16x32_bf16 v[140:143], v[32:35], a[240:243], v[140:143]
s_waitcnt vmcnt(17)
v_add_u32 v11, 0xffff8000, v11
v_mfma_f32_16x16x32_bf16 v[140:143], v[36:39], a[244:247], v[140:143]
s_waitcnt vmcnt(16)
ds_read_b64_tr_b16 v[32:33], v12 offset:0
v_mfma_f32_16x16x32_bf16 v[140:143], v[40:43], a[248:251], v[140:143]
s_waitcnt vmcnt(15)
buffer_load_dwordx4 a[20:23], v1, s[4:7], s54 offen offset:1024 sc1
v_mfma_f32_16x16x32_bf16 v[140:143], v[44:47], a[252:255], v[140:143]
s_waitcnt lgkmcnt(7)
ds_read_b64_tr_b16 v[34:35], v12 offset:1024
v_mfma_f32_16x16x32_bf16 v[144:147], v[48:51], a[192:195], v[144:147]
s_waitcnt lgkmcnt(6)
v_mfma_f32_16x16x32_bf16 v[144:147], v[52:55], a[196:199], v[144:147]
s_waitcnt lgkmcnt(4)
ds_read_b64_tr_b16 v[36:37], v12 offset:8192
v_mfma_f32_16x16x32_bf16 v[144:147], v[56:59], a[200:203], v[144:147]
s_waitcnt lgkmcnt(3)
buffer_load_dwordx4 a[24:27], v1, s[4:7], s54 offen offset:2048 sc1
v_mfma_f32_16x16x32_bf16 v[144:147], v[60:63], a[204:207], v[144:147]
ds_read_b64_tr_b16 v[38:39], v12 offset:9216
v_mfma_f32_16x16x32_bf16 v[148:151], v[48:51], a[208:211], v[148:151]
v_mfma_f32_16x16x32_bf16 v[148:151], v[52:55], a[212:215], v[148:151]
ds_read_b64_tr_b16 v[40:41], v12 offset:16384
v_mfma_f32_16x16x32_bf16 v[148:151], v[56:59], a[216:219], v[148:151]
buffer_load_dwordx4 a[28:31], v1, s[4:7], s54 offen offset:3072 sc1
v_mfma_f32_16x16x32_bf16 v[148:151], v[60:63], a[220:223], v[148:151]
s_add_u32 s54, s78, 16384
ds_read_b64_tr_b16 v[42:43], v12 offset:17408
v_mfma_f32_16x16x32_bf16 v[152:155], v[48:51], a[224:227], v[152:155]
v_mfma_f32_16x16x32_bf16 v[152:155], v[52:55], a[228:231], v[152:155]
ds_read_b64_tr_b16 v[44:45], v12 offset:24576
v_mfma_f32_16x16x32_bf16 v[152:155], v[56:59], a[232:235], v[152:155]
buffer_load_dwordx4 a[32:35], v1, s[4:7], s54 offen offset:0 sc1
v_mfma_f32_16x16x32_bf16 v[152:155], v[60:63], a[236:239], v[152:155]
ds_read_b64_tr_b16 v[46:47], v12 offset:25600
v_mfma_f32_16x16x32_bf16 v[156:159], v[48:51], a[240:243], v[156:159]
v_add_u32 v12, 0xffff8000, v12
v_mfma_f32_16x16x32_bf16 v[156:159], v[52:55], a[244:247], v[156:159]
ds_read_b64_tr_b16 v[48:49], v13 offset:0
v_mfma_f32_16x16x32_bf16 v[156:159], v[56:59], a[248:251], v[156:159]
buffer_load_dwordx4 a[36:39], v1, s[4:7], s54 offen offset:1024 sc1
v_mfma_f32_16x16x32_bf16 v[156:159], v[60:63], a[252:255], v[156:159]
s_waitcnt lgkmcnt(7)
ds_read_b64_tr_b16 v[50:51], v13 offset:1024
v_mfma_f32_16x16x32_bf16 v[160:163], v[32:35], a[192:195], v[160:163]
s_waitcnt lgkmcnt(6)
v_mfma_f32_16x16x32_bf16 v[160:163], v[36:39], a[196:199], v[160:163]
s_waitcnt lgkmcnt(4)
ds_read_b64_tr_b16 v[52:53], v13 offset:8192
v_mfma_f32_16x16x32_bf16 v[160:163], v[40:43], a[200:203], v[160:163]
s_waitcnt lgkmcnt(3)
buffer_load_dwordx4 a[40:43], v1, s[4:7], s54 offen offset:2048 sc1
v_mfma_f32_16x16x32_bf16 v[160:163], v[44:47], a[204:207], v[160:163]
ds_read_b64_tr_b16 v[54:55], v13 offset:9216
v_mfma_f32_16x16x32_bf16 v[164:167], v[32:35], a[208:211], v[164:167]
v_mfma_f32_16x16x32_bf16 v[164:167], v[36:39], a[212:215], v[164:167]
ds_read_b64_tr_b16 v[56:57], v13 offset:16384
v_mfma_f32_16x16x32_bf16 v[164:167], v[40:43], a[216:219], v[164:167]
buffer_load_dwordx4 a[44:47], v1, s[4:7], s54 offen offset:3072 sc1
v_mfma_f32_16x16x32_bf16 v[164:167], v[44:47], a[220:223], v[164:167]
s_add_u32 s54, s79, 16384
ds_read_b64_tr_b16 v[58:59], v13 offset:17408
v_mfma_f32_16x16x32_bf16 v[168:171], v[32:35], a[224:227], v[168:171]
v_mfma_f32_16x16x32_bf16 v[168:171], v[36:39], a[228:231], v[168:171]
ds_read_b64_tr_b16 v[60:61], v13 offset:24576
v_mfma_f32_16x16x32_bf16 v[168:171], v[40:43], a[232:235], v[168:171]
buffer_load_dwordx4 a[48:51], v1, s[4:7], s54 offen offset:0 sc1
v_mfma_f32_16x16x32_bf16 v[168:171], v[44:47], a[236:239], v[168:171]
ds_read_b64_tr_b16 v[62:63], v13 offset:25600
v_mfma_f32_16x16x32_bf16 v[172:175], v[32:35], a[240:243], v[172:175]
v_add_u32 v13, 0xffff8000, v13
v_mfma_f32_16x16x32_bf16 v[172:175], v[36:39], a[244:247], v[172:175]
ds_read_b64_tr_b16 v[32:33], v14 offset:0
v_mfma_f32_16x16x32_bf16 v[172:175], v[40:43], a[248:251], v[172:175]
buffer_load_dwordx4 a[52:55], v1, s[4:7], s54 offen offset:1024 sc1
v_mfma_f32_16x16x32_bf16 v[172:175], v[44:47], a[252:255], v[172:175]
s_waitcnt lgkmcnt(7)
ds_read_b64_tr_b16 v[34:35], v14 offset:1024
v_mfma_f32_16x16x32_bf16 v[176:179], v[48:51], a[192:195], v[176:179]
s_waitcnt lgkmcnt(6)
v_mfma_f32_16x16x32_bf16 v[176:179], v[52:55], a[196:199], v[176:179]
s_waitcnt lgkmcnt(4)
ds_read_b64_tr_b16 v[36:37], v14 offset:8192
v_mfma_f32_16x16x32_bf16 v[176:179], v[56:59], a[200:203], v[176:179]
s_waitcnt lgkmcnt(3)
buffer_load_dwordx4 a[56:59], v1, s[4:7], s54 offen offset:2048 sc1
v_mfma_f32_16x16x32_bf16 v[176:179], v[60:63], a[204:207], v[176:179]
ds_read_b64_tr_b16 v[38:39], v14 offset:9216
v_mfma_f32_16x16x32_bf16 v[180:183], v[48:51], a[208:211], v[180:183]
v_mfma_f32_16x16x32_bf16 v[180:183], v[52:55], a[212:215], v[180:183]
ds_read_b64_tr_b16 v[40:41], v14 offset:16384
v_mfma_f32_16x16x32_bf16 v[180:183], v[56:59], a[216:219], v[180:183]
buffer_load_dwordx4 a[60:63], v1, s[4:7], s54 offen offset:3072 sc1
v_mfma_f32_16x16x32_bf16 v[180:183], v[60:63], a[220:223], v[180:183]
ds_read_b64_tr_b16 v[42:43], v14 offset:17408
v_mfma_f32_16x16x32_bf16 v[184:187], v[48:51], a[224:227], v[184:187]
v_mfma_f32_16x16x32_bf16 v[184:187], v[52:55], a[228:231], v[184:187]
ds_read_b64_tr_b16 v[44:45], v14 offset:24576
v_mfma_f32_16x16x32_bf16 v[184:187], v[56:59], a[232:235], v[184:187]
buffer_load_dword v31, v24, s[36:39], s22 offen
v_mfma_f32_16x16x32_bf16 v[184:187], v[60:63], a[236:239], v[184:187]
ds_read_b64_tr_b16 v[46:47], v14 offset:25600
v_mfma_f32_16x16x32_bf16 v[188:191], v[48:51], a[240:243], v[188:191]
v_add_u32 v14, 0xffff8000, v14
v_mfma_f32_16x16x32_bf16 v[188:191], v[52:55], a[244:247], v[188:191]
ds_read_b64_tr_b16 v[48:49], v15 offset:0
v_mfma_f32_16x16x32_bf16 v[188:191], v[56:59], a[248:251], v[188:191]
v_mfma_f32_16x16x32_bf16 v[188:191], v[60:63], a[252:255], v[188:191]
s_waitcnt lgkmcnt(7)
ds_read_b64_tr_b16 v[50:51], v15 offset:1024
v_mfma_f32_16x16x32_bf16 v[192:195], v[32:35], a[192:195], v[192:195]
s_waitcnt lgkmcnt(6)
s_lshl_b32 s1, s48, 8
v_mfma_f32_16x16x32_bf16 v[192:195], v[36:39], a[196:199], v[192:195]
s_waitcnt lgkmcnt(4)
s_add_u32 s1, s1, 85983232
ds_read_b64_tr_b16 v[52:53], v15 offset:8192
v_lshl_add_u32 v19, s50, 10, v1
v_mfma_f32_16x16x32_bf16 v[192:195], v[40:43], a[200:203], v[192:195]
s_waitcnt lgkmcnt(3)
s_lshr_b32 s3, s50, 1
v_cmp_gt_u32 vcc, 16, v19
v_lshlrev_b32 v18, 4, v1
v_mfma_f32_16x16x32_bf16 v[192:195], v[44:47], a[204:207], v[192:195]
s_lshl_b32 s57, s49, 1
ds_read_b64_tr_b16 v[54:55], v15 offset:9216
v_mov_b32 v20, 2130706432
v_mfma_f32_16x16x32_bf16 v[196:199], v[32:35], a[208:211], v[196:199]
s_sub_u32 s59, 32, s57
v_mov_b32 v19, 8
v_cndmask_b32 v18, v20, v18, vcc
v_mfma_f32_16x16x32_bf16 v[196:199], v[36:39], a[212:215], v[196:199]
s_sub_u32 s58, s59, s3
ds_read_b64_tr_b16 v[56:57], v15 offset:16384
v_cndmask_b32 v19, 0, v19, vcc
v_mfma_f32_16x16x32_bf16 v[196:199], v[40:43], a[216:219], v[196:199]
s_add_u32 s57, s57, s3
buffer_load_dword v20, v18, s[4:7], s1 offen sc1
v_mfma_f32_16x16x32_bf16 v[196:199], v[44:47], a[220:223], v[196:199]
s_add_u32 s57, s57, 1
ds_read_b64_tr_b16 v[58:59], v15 offset:17408
v_add_u32 v24, s67, v1
v_mfma_f32_16x16x32_bf16 v[200:203], v[32:35], a[224:227], v[200:203]
s_lshl_b32 s60, s48, 20
v_mfma_f32_16x16x32_bf16 v[200:203], v[36:39], a[228:231], v[200:203]
s_add_u32 s60, s60, 4202496
ds_read_b64_tr_b16 v[60:61], v15 offset:24576
v_mfma_f32_16x16x32_bf16 v[200:203], v[40:43], a[232:235], v[200:203]
s_lshl_b32 s61, s59, 14
v_mfma_f32_16x16x32_bf16 v[200:203], v[44:47], a[236:239], v[200:203]
s_add_u32 s61, s61, s60
ds_read_b64_tr_b16 v[62:63], v15 offset:25600
v_mfma_f32_16x16x32_bf16 v[204:207], v[32:35], a[240:243], v[204:207]
s_mov_b32 s62, s67
v_add_u32 v15, 0xffff8000, v15
v_mfma_f32_16x16x32_bf16 v[204:207], v[36:39], a[244:247], v[204:207]
s_mov_b32 s65, 0
ds_read_b64_tr_b16 v[32:33], v16 offset:0
v_mfma_f32_16x16x32_bf16 v[204:207], v[40:43], a[248:251], v[204:207]
s_and_b32 s12, s2, 7
v_mfma_f32_16x16x32_bf16 v[204:207], v[44:47], a[252:255], v[204:207]
s_waitcnt lgkmcnt(7)
s_lshr_b32 s14, s2, 5
ds_read_b64_tr_b16 v[34:35], v16 offset:1024
v_mfma_f32_16x16x32_bf16 v[208:211], v[48:51], a[192:195], v[208:211]
s_waitcnt lgkmcnt(6)
s_bfe_u32 s13, s2, 0x20003
v_mfma_f32_16x16x32_bf16 v[208:211], v[52:55], a[196:199], v[208:211]
s_waitcnt lgkmcnt(4)
s_mul_i32 s51, s12, 7
ds_read_b64_tr_b16 v[36:37], v16 offset:8192
v_mfma_f32_16x16x32_bf16 v[208:211], v[56:59], a[200:203], v[208:211]
s_waitcnt lgkmcnt(3)
s_min_u32 s51, s51, 48
v_mfma_f32_16x16x32_bf16 v[208:211], v[60:63], a[204:207], v[208:211]
s_mul_i32 s52, s13, 320
ds_read_b64_tr_b16 v[38:39], v16 offset:9216
v_mfma_f32_16x16x32_bf16 v[212:215], v[48:51], a[208:211], v[212:215]
s_and_b32 s52, s52, -128
v_mfma_f32_16x16x32_bf16 v[212:215], v[52:55], a[212:215], v[212:215]
s_mul_i32 s15, s51, 40960
ds_read_b64_tr_b16 v[40:41], v16 offset:16384
v_mfma_f32_16x16x32_bf16 v[212:215], v[56:59], a[216:219], v[212:215]
s_add_u32 s15, s15, s52
v_mfma_f32_16x16x32_bf16 v[212:215], v[60:63], a[220:223], v[212:215]
s_mul_i32 s16, s12, 655360
ds_read_b64_tr_b16 v[42:43], v16 offset:17408
v_mfma_f32_16x16x32_bf16 v[216:219], v[48:51], a[224:227], v[216:219]
s_add_u32 s16, s16, s52
v_mfma_f32_16x16x32_bf16 v[216:219], v[52:55], a[228:231], v[216:219]
s_lshl_b32 s19, s14, 2
ds_read_b64_tr_b16 v[44:45], v16 offset:24576
v_mfma_f32_16x16x32_bf16 v[216:219], v[56:59], a[232:235], v[216:219]
s_add_u32 s19, s19, s50
v_mfma_f32_16x16x32_bf16 v[216:219], v[60:63], a[236:239], v[216:219]
s_lshl_b32 s19, s19, 1
ds_read_b64_tr_b16 v[46:47], v16 offset:25600
v_mfma_f32_16x16x32_bf16 v[220:223], v[48:51], a[240:243], v[220:223]
s_mul_i32 s76, s19, 182
v_add_u32 v16, 0xffff8000, v16
v_mfma_f32_16x16x32_bf16 v[220:223], v[52:55], a[244:247], v[220:223]
s_sub_u32 s19, 126, s19
ds_read_b64_tr_b16 v[48:49], v17 offset:0
v_mfma_f32_16x16x32_bf16 v[220:223], v[56:59], a[248:251], v[220:223]
s_mul_i32 s78, s19, 182
v_mfma_f32_16x16x32_bf16 v[220:223], v[60:63], a[252:255], v[220:223]
s_waitcnt lgkmcnt(7)
s_add_u32 s76, s76, s51
ds_read_b64_tr_b16 v[50:51], v17 offset:1024
v_mfma_f32_16x16x32_bf16 v[224:227], v[32:35], a[192:195], v[224:227]
s_waitcnt lgkmcnt(6)
s_lshl_b32 s76, s76, 10
v_mfma_f32_16x16x32_bf16 v[224:227], v[36:39], a[196:199], v[224:227]
s_waitcnt lgkmcnt(4)
s_add_u32 s76, s76, 37879808
ds_read_b64_tr_b16 v[52:53], v17 offset:8192
v_mfma_f32_16x16x32_bf16 v[224:227], v[40:43], a[200:203], v[224:227]
s_waitcnt lgkmcnt(3)
s_add_u32 s77, s76, 186368
v_mfma_f32_16x16x32_bf16 v[224:227], v[44:47], a[204:207], v[224:227]
s_add_u32 s78, s78, s51
ds_read_b64_tr_b16 v[54:55], v17 offset:9216
v_mfma_f32_16x16x32_bf16 v[228:231], v[32:35], a[208:211], v[228:231]
s_lshl_b32 s78, s78, 10
v_mfma_f32_16x16x32_bf16 v[228:231], v[36:39], a[212:215], v[228:231]
s_add_u32 s78, s78, 37879808
ds_read_b64_tr_b16 v[56:57], v17 offset:16384
v_mfma_f32_16x16x32_bf16 v[228:231], v[40:43], a[216:219], v[228:231]
s_add_u32 s79, s78, 186368
v_lshrrev_b32 v2, 4, v1
v_add_u32 v2, 0, v2
v_mfma_f32_16x16x32_bf16 v[228:231], v[44:47], a[220:223], v[228:231]
ds_read_b64_tr_b16 v[58:59], v17 offset:17408
v_mul_u32_u24 v3, 2731, v2
v_mfma_f32_16x16x32_bf16 v[232:235], v[32:35], a[224:227], v[232:235]
v_lshrrev_b32 v3, 16, v3
v_mul_u32_u24 v4, 24, v3
v_mfma_f32_16x16x32_bf16 v[232:235], v[36:39], a[228:231], v[232:235]
ds_read_b64_tr_b16 v[60:61], v17 offset:24576
v_sub_u32 v2, v2, v4
v_mfma_f32_16x16x32_bf16 v[232:235], v[40:43], a[232:235], v[232:235]
v_and_b32 v4, 6, v3
v_xor_b32 v2, v2, v4
v_mfma_f32_16x16x32_bf16 v[232:235], v[44:47], a[236:239], v[232:235]
ds_read_b64_tr_b16 v[62:63], v17 offset:25600
v_mul_u32_u24 v3, 1280, v3
v_mfma_f32_16x16x32_bf16 v[236:239], v[32:35], a[240:243], v[236:239]
v_add_u32 v17, 0xffff8000, v17
v_lshl_add_u32 v26, v2, 4, v3
v_mfma_f32_16x16x32_bf16 v[236:239], v[36:39], a[244:247], v[236:239]
v_lshrrev_b32 v2, 4, v1
v_add_u32 v2, 64, v2
v_mfma_f32_16x16x32_bf16 v[236:239], v[40:43], a[248:251], v[236:239]
v_mul_u32_u24 v3, 2731, v2
v_lshrrev_b32 v3, 16, v3
v_mfma_f32_16x16x32_bf16 v[236:239], v[44:47], a[252:255], v[236:239]
s_waitcnt vmcnt(0)
v_mul_u32_u24 v4, 24, v3
v_sub_u32 v2, v2, v4
v_cmp_ge_u32 vcc, v20, v19
s_nop 3
s_cmp_eq_u64 vcc, -1
s_cbranch_scc0 L_spin_kvN
L_back_kvN:
s_waitcnt lgkmcnt(6)
v_mfma_f32_16x16x32_bf16 v[240:243], v[48:51], a[192:195], v[240:243]
s_waitcnt lgkmcnt(0)
s_barrier
v_and_b32 v4, 6, v3
v_xor_b32 v2, v2, v4
v_mfma_f32_16x16x32_bf16 v[240:243], v[52:55], a[196:199], v[240:243]
ds_read_b64_tr_b16 v[32:33], v10 offset:0
v_mul_u32_u24 v3, 1280, v3
v_mfma_f32_16x16x32_bf16 v[240:243], v[56:59], a[200:203], v[240:243]
ds_read_b64_tr_b16 v[34:35], v10 offset:1024
v_lshl_add_u32 v27, v2, 4, v3
v_mfma_f32_16x16x32_bf16 v[240:243], v[60:63], a[204:207], v[240:243]
ds_read_b64_tr_b16 v[36:37], v10 offset:8192
v_subrev_u32 v27, 1024, v27
v_mfma_f32_16x16x32_bf16 v[244:247], v[48:51], a[208:211], v[244:247]
ds_read_b64_tr_b16 v[38:39], v10 offset:9216
v_lshrrev_b32 v2, 4, v1
v_mfma_f32_16x16x32_bf16 v[244:247], v[52:55], a[212:215], v[244:247]
v_add_u32 v2, 128, v2
v_mul_u32_u24 v3, 2731, v2
v_mfma_f32_16x16x32_bf16 v[244:247], v[56:59], a[216:219], v[244:247]
ds_read_b64_tr_b16 v[40:41], v10 offset:16384
v_lshrrev_b32 v3, 16, v3
v_mfma_f32_16x16x32_bf16 v[244:247], v[60:63], a[220:223], v[244:247]
v_mul_u32_u24 v4, 24, v3
v_sub_u32 v2, v2, v4
v_mfma_f32_16x16x32_bf16 v[248:251], v[48:51], a[224:227], v[248:251]
ds_read_b64_tr_b16 v[42:43], v10 offset:17408
v_and_b32 v4, 6, v3
v_mfma_f32_16x16x32_bf16 v[248:251], v[52:55], a[228:231], v[248:251]
v_xor_b32 v2, v2, v4
v_mul_u32_u24 v3, 1280, v3
v_mfma_f32_16x16x32_bf16 v[248:251], v[56:59], a[232:235], v[248:251]
ds_read_b64_tr_b16 v[44:45], v10 offset:24576
v_lshl_add_u32 v28, v2, 4, v3
v_mfma_f32_16x16x32_bf16 v[248:251], v[60:63], a[236:239], v[248:251]
v_subrev_u32 v28, 2048, v28
v_lshrrev_b32 v4, 6, v1
v_mfma_f32_16x16x32_bf16 v[252:255], v[48:51], a[240:243], v[252:255]
ds_read_b64_tr_b16 v[46:47], v10 offset:25600
v_mul_u32_u24 v5, 384, v4
v_mfma_f32_16x16x32_bf16 v[252:255], v[52:55], a[244:247], v[252:255]
ds_read_b64_tr_b16 v[48:49], v11 offset:0
v_bfe_u32 v2, v1, 4, 2
v_mfma_f32_16x16x32_bf16 v[252:255], v[56:59], a[248:251], v[252:255]
v_lshl_add_u32 v5, v2, 3, v5
v_bfe_u32 v4, v4, 1, 2
v_mfma_f32_16x16x32_bf16 v[252:255], v[60:63], a[252:255], v[252:255]
s_waitcnt lgkmcnt(7)
s_and_b32 s19, s13, 1
ds_read_b64_tr_b16 v[50:51], v11 offset:1024
v_mfma_f32_16x16x32_bf16 v[128:131], v[32:35], a[0:3], v[128:131]
s_waitcnt lgkmcnt(6)
s_lshl_b32 s19, s19, 1
v_mfma_f32_16x16x32_bf16 v[128:131], v[36:39], a[4:7], v[128:131]
s_waitcnt lgkmcnt(4)
s_add_u32 s51, s19, 0
ds_read_b64_tr_b16 v[52:53], v11 offset:8192
v_mfma_f32_16x16x32_bf16 v[128:131], v[40:43], a[8:11], v[128:131]
s_waitcnt lgkmcnt(3)
s_lshr_b32 s52, s51, 2
v_mfma_f32_16x16x32_bf16 v[128:131], v[44:47], a[12:15], v[128:131]
s_lshl_b32 s52, s52, 7
ds_read_b64_tr_b16 v[54:55], v11 offset:9216
v_mfma_f32_16x16x32_bf16 v[132:135], v[32:35], a[16:19], v[132:135]
s_add_u32 s52, s52, 139264
v_mfma_f32_16x16x32_bf16 v[132:135], v[36:39], a[20:23], v[132:135]
s_and_b32 s51, s51, 3
ds_read_b64_tr_b16 v[56:57], v11 offset:16384
v_xor_b32 v6, s51, v4
v_mfma_f32_16x16x32_bf16 v[132:135], v[40:43], a[24:27], v[132:135]
s_lshr_b32 s54, s67, 1
v_lshl_add_u32 v6, v6, 5, v5
v_add_u32 v6, s52, v6
v_mfma_f32_16x16x32_bf16 v[132:135], v[44:47], a[28:31], v[132:135]
s_add_u32 s51, s19, 1
ds_read_b64_tr_b16 v[58:59], v11 offset:17408
v_mfma_f32_16x16x32_bf16 v[136:139], v[32:35], a[32:35], v[136:139]
s_lshr_b32 s52, s51, 2
v_mfma_f32_16x16x32_bf16 v[136:139], v[36:39], a[36:39], v[136:139]
s_lshl_b32 s52, s52, 7
ds_read_b64_tr_b16 v[60:61], v11 offset:24576
v_mfma_f32_16x16x32_bf16 v[136:139], v[40:43], a[40:43], v[136:139]
s_add_u32 s52, s52, 139264
v_mfma_f32_16x16x32_bf16 v[136:139], v[44:47], a[44:47], v[136:139]
s_and_b32 s51, s51, 3
ds_read_b64_tr_b16 v[62:63], v11 offset:25600
v_xor_b32 v7, s51, v4
v_mfma_f32_16x16x32_bf16 v[140:143], v[32:35], a[48:51], v[140:143]
s_add_u32 m0, s54, 131072
v_lshl_add_u32 v7, v7, 5, v5
v_add_u32 v7, s52, v7
v_mfma_f32_16x16x32_bf16 v[140:143], v[36:39], a[52:55], v[140:143]
s_add_u32 s51, s19, 2
ds_read_b64_tr_b16 v[32:33], v12 offset:0
v_mfma_f32_16x16x32_bf16 v[140:143], v[40:43], a[56:59], v[140:143]
s_lshr_b32 s52, s51, 2
v_mfma_f32_16x16x32_bf16 v[140:143], v[44:47], a[60:63], v[140:143]
s_waitcnt lgkmcnt(7)
s_lshl_b32 s52, s52, 7
ds_read_b64_tr_b16 v[34:35], v12 offset:1024
v_mfma_f32_16x16x32_bf16 v[144:147], v[48:51], a[0:3], v[144:147]
s_waitcnt lgkmcnt(6)
s_add_u32 s52, s52, 139264
v_mfma_f32_16x16x32_bf16 v[144:147], v[52:55], a[4:7], v[144:147]
s_waitcnt lgkmcnt(4)
s_and_b32 s51, s51, 3
ds_read_b64_tr_b16 v[36:37], v12 offset:8192
v_xor_b32 v8, s51, v4
v_mfma_f32_16x16x32_bf16 v[144:147], v[56:59], a[8:11], v[144:147]
s_waitcnt lgkmcnt(3)
s_add_u32 s54, s54, s60
v_lshl_add_u32 v8, v8, 5, v5
v_add_u32 v8, s52, v8
v_mfma_f32_16x16x32_bf16 v[144:147], v[60:63], a[12:15], v[144:147]
s_add_u32 s51, s19, 3
ds_read_b64_tr_b16 v[38:39], v12 offset:9216
v_mfma_f32_16x16x32_bf16 v[148:151], v[48:51], a[16:19], v[148:151]
s_lshr_b32 s52, s51, 2
v_mfma_f32_16x16x32_bf16 v[148:151], v[52:55], a[20:23], v[148:151]
s_lshl_b32 s52, s52, 7
ds_read_b64_tr_b16 v[40:41], v12 offset:16384
v_mfma_f32_16x16x32_bf16 v[148:151], v[56:59], a[24:27], v[148:151]
s_add_u32 s52, s52, 139264
v_mfma_f32_16x16x32_bf16 v[148:151], v[60:63], a[28:31], v[148:151]
s_and_b32 s51, s51, 3
ds_read_b64_tr_b16 v[42:43], v12 offset:17408
v_xor_b32 v9, s51, v4
v_mfma_f32_16x16x32_bf16 v[152:155], v[48:51], a[32:35], v[152:155]
s_sub_u32 s54, s54, 8192
v_lshl_add_u32 v9, v9, 5, v5
v_add_u32 v9, s52, v9
v_mfma_f32_16x16x32_bf16 v[152:155], v[52:55], a[36:39], v[152:155]
ds_read_b64_tr_b16 v[44:45], v12 offset:24576
v_cvt_pk_bf16_f32 v128, v128, v129
v_mfma_f32_16x16x32_bf16 v[152:155], v[56:59], a[40:43], v[152:155]
buffer_load_dwordx4 v1, s[4:7], s54 offen offset:0 sc1 lds
v_mfma_f32_16x16x32_bf16 v[152:155], v[60:63], a[44:47], v[152:155]
ds_read_b64_tr_b16 v[46:47], v12 offset:25600
v_cvt_pk_bf16_f32 v129, v130, v131
v_mfma_f32_16x16x32_bf16 v[156:159], v[48:51], a[48:51], v[156:159]
v_cvt_pk_bf16_f32 v130, v144, v145
v_cvt_pk_bf16_f32 v131, v146, v147
v_mfma_f32_16x16x32_bf16 v[156:159], v[52:55], a[52:55], v[156:159]
ds_read_b64_tr_b16 v[48:49], v13 offset:0
v_cvt_pk_bf16_f32 v132, v132, v133
v_mfma_f32_16x16x32_bf16 v[156:159], v[56:59], a[56:59], v[156:159]
buffer_load_dwordx4 v1, s[4:7], s54 offen offset:1024 sc1 lds
v_mfma_f32_16x16x32_bf16 v[156:159], v[60:63], a[60:63], v[156:159]
s_waitcnt lgkmcnt(7)
s_and_b32 m0, s62, 0x1ffff
ds_read_b64_tr_b16 v[50:51], v13 offset:1024
v_cvt_pk_bf16_f32 v133, v134, v135
v_mfma_f32_16x16x32_bf16 v[160:163], v[32:35], a[0:3], v[160:163]
s_waitcnt lgkmcnt(6)
v_cvt_pk_bf16_f32 v134, v148, v149
v_cvt_pk_bf16_f32 v135, v150, v151
v_mfma_f32_16x16x32_bf16 v[160:163], v[36:39], a[4:7], v[160:163]
s_waitcnt lgkmcnt(4)
ds_read_b64_tr_b16 v[52:53], v13 offset:8192
v_cvt_pk_bf16_f32 v136, v136, v137
v_mfma_f32_16x16x32_bf16 v[160:163], v[40:43], a[8:11], v[160:163]
s_waitcnt lgkmcnt(3)
buffer_load_dwordx4 v24, s[4:7], s60 offen offset:0 sc1  lds
v_mfma_f32_16x16x32_bf16 v[160:163], v[44:47], a[12:15], v[160:163]
ds_read_b64_tr_b16 v[54:55], v13 offset:9216
v_cvt_pk_bf16_f32 v137, v138, v139
v_mfma_f32_16x16x32_bf16 v[164:167], v[32:35], a[16:19], v[164:167]
v_cvt_pk_bf16_f32 v138, v152, v153
v_cvt_pk_bf16_f32 v139, v154, v155
v_mfma_f32_16x16x32_bf16 v[164:167], v[36:39], a[20:23], v[164:167]
ds_read_b64_tr_b16 v[56:57], v13 offset:16384
v_cvt_pk_bf16_f32 v140, v140, v141
v_mfma_f32_16x16x32_bf16 v[164:167], v[40:43], a[24:27], v[164:167]
buffer_load_dwordx4 v24, s[4:7], s60 offen offset:1024 sc1  lds
v_mfma_f32_16x16x32_bf16 v[164:167], v[44:47], a[28:31], v[164:167]
ds_read_b64_tr_b16 v[58:59], v13 offset:17408
v_cvt_pk_bf16_f32 v141, v142, v143
v_mfma_f32_16x16x32_bf16 v[168:171], v[32:35], a[32:35], v[168:171]
v_cvt_pk_bf16_f32 v142, v156, v157
v_cvt_pk_bf16_f32 v143, v158, v159
v_mfma_f32_16x16x32_bf16 v[168:171], v[36:39], a[36:39], v[168:171]
ds_read_b64_tr_b16 v[60:61], v13 offset:24576
v_mfma_f32_16x16x32_bf16 v[168:171], v[40:43], a[40:43], v[168:171]
buffer_load_dwordx4 v24, s[4:7], s60 offen offset:2048 sc1  lds
v_mfma_f32_16x16x32_bf16 v[168:171], v[44:47], a[44:47], v[168:171]
ds_read_b64_tr_b16 v[62:63], v13 offset:25600
v_mfma_f32_16x16x32_bf16 v[172:175], v[32:35], a[48:51], v[172:175]
v_mfma_f32_16x16x32_bf16 v[172:175], v[36:39], a[52:55], v[172:175]
ds_read_b64_tr_b16 v[32:33], v14 offset:0
v_mfma_f32_16x16x32_bf16 v[172:175], v[40:43], a[56:59], v[172:175]
buffer_load_dwordx4 v24, s[4:7], s60 offen offset:3072 sc1  lds
v_mfma_f32_16x16x32_bf16 v[172:175], v[44:47], a[60:63], v[172:175]
s_waitcnt lgkmcnt(7)
s_add_u32 m0, m0, 16384
ds_read_b64_tr_b16 v[34:35], v14 offset:1024
v_mfma_f32_16x16x32_bf16 v[176:179], v[48:51], a[0:3], v[176:179]
s_waitcnt lgkmcnt(6)
s_add_u32 s60, s60, 516096
v_mfma_f32_16x16x32_bf16 v[176:179], v[52:55], a[4:7], v[176:179]
s_waitcnt lgkmcnt(4)
ds_read_b64_tr_b16 v[36:37], v14 offset:8192
v_mfma_f32_16x16x32_bf16 v[176:179], v[56:59], a[8:11], v[176:179]
s_waitcnt lgkmcnt(3)
buffer_load_dwordx4 v24, s[4:7], s60 offen offset:0 sc1  lds
v_mfma_f32_16x16x32_bf16 v[176:179], v[60:63], a[12:15], v[176:179]
ds_read_b64_tr_b16 v[38:39], v14 offset:9216
v_mfma_f32_16x16x32_bf16 v[180:183], v[48:51], a[16:19], v[180:183]
v_mfma_f32_16x16x32_bf16 v[180:183], v[52:55], a[20:23], v[180:183]
ds_read_b64_tr_b16 v[40:41], v14 offset:16384
v_mfma_f32_16x16x32_bf16 v[180:183], v[56:59], a[24:27], v[180:183]
buffer_load_dwordx4 v24, s[4:7], s60 offen offset:1024 sc1  lds
v_mfma_f32_16x16x32_bf16 v[180:183], v[60:63], a[28:31], v[180:183]
ds_read_b64_tr_b16 v[42:43], v14 offset:17408
v_mfma_f32_16x16x32_bf16 v[184:187], v[48:51], a[32:35], v[184:187]
v_cvt_pk_bf16_f32 v160, v160, v161
v_cvt_pk_bf16_f32 v161, v162, v163
v_mfma_f32_16x16x32_bf16 v[184:187], v[52:55], a[36:39], v[184:187]
ds_read_b64_tr_b16 v[44:45], v14 offset:24576
v_cvt_pk_bf16_f32 v162, v176, v177
v_mfma_f32_16x16x32_bf16 v[184:187], v[56:59], a[40:43], v[184:187]
buffer_load_dwordx4 v24, s[4:7], s60 offen offset:2048 sc1  lds
v_mfma_f32_16x16x32_bf16 v[184:187], v[60:63], a[44:47], v[184:187]
ds_read_b64_tr_b16 v[46:47], v14 offset:25600
v_cvt_pk_bf16_f32 v163, v178, v179
v_mfma_f32_16x16x32_bf16 v[188:191], v[48:51], a[48:51], v[188:191]
v_cvt_pk_bf16_f32 v164, v164, v165
v_cvt_pk_bf16_f32 v165, v166, v167
v_mfma_f32_16x16x32_bf16 v[188:191], v[52:55], a[52:55], v[188:191]
ds_read_b64_tr_b16 v[48:49], v15 offset:0
v_cvt_pk_bf16_f32 v166, v180, v181
v_mfma_f32_16x16x32_bf16 v[188:191], v[56:59], a[56:59], v[188:191]
buffer_load_dwordx4 v24, s[4:7], s60 offen offset:3072 sc1  lds
v_mfma_f32_16x16x32_bf16 v[188:191], v[60:63], a[60:63], v[188:191]
s_waitcnt lgkmcnt(7)
s_sub_u32 s60, s60, 516096
ds_read_b64_tr_b16 v[50:51], v15 offset:1024
v_cvt_pk_bf16_f32 v167, v182, v183
v_mfma_f32_16x16x32_bf16 v[192:195], v[32:35], a[0:3], v[192:195]
s_waitcnt lgkmcnt(6)
s_add_u32 s60, s60, 16384
v_cvt_pk_bf16_f32 v168, v168, v169
v_cvt_pk_bf16_f32 v169, v170, v171
v_mfma_f32_16x16x32_bf16 v[192:195], v[36:39], a[4:7], v[192:195]
s_waitcnt lgkmcnt(4)
s_add_u32 s62, s62, 32768
ds_read_b64_tr_b16 v[52:53], v15 offset:8192
v_cvt_pk_bf16_f32 v170, v184, v185
v_mfma_f32_16x16x32_bf16 v[192:195], v[40:43], a[8:11], v[192:195]
s_waitcnt lgkmcnt(3)
s_and_b32 m0, s62, 0x1ffff
v_cvt_pk_bf16_f32 v171, v186, v187
v_mfma_f32_16x16x32_bf16 v[192:195], v[44:47], a[12:15], v[192:195]
ds_read_b64_tr_b16 v[54:55], v15 offset:9216
v_mfma_f32_16x16x32_bf16 v[196:199], v[32:35], a[16:19], v[196:199]
buffer_load_dwordx4 v24, s[4:7], s60 offen offset:0 sc1  lds
v_mfma_f32_16x16x32_bf16 v[196:199], v[36:39], a[20:23], v[196:199]
ds_read_b64_tr_b16 v[56:57], v15 offset:16384
v_cvt_pk_bf16_f32 v172, v172, v173
v_mfma_f32_16x16x32_bf16 v[196:199], v[40:43], a[24:27], v[196:199]
v_cvt_pk_bf16_f32 v173, v174, v175
v_cvt_pk_bf16_f32 v174, v188, v189
v_mfma_f32_16x16x32_bf16 v[196:199], v[44:47], a[28:31], v[196:199]
ds_read_b64_tr_b16 v[58:59], v15 offset:17408
v_cvt_pk_bf16_f32 v175, v190, v191
v_mfma_f32_16x16x32_bf16 v[200:203], v[32:35], a[32:35], v[200:203]
buffer_load_dwordx4 v24, s[4:7], s60 offen offset:1024 sc1  lds
v_mfma_f32_16x16x32_bf16 v[200:203], v[36:39], a[36:39], v[200:203]
ds_read_b64_tr_b16 v[60:61], v15 offset:24576
v_mfma_f32_16x16x32_bf16 v[200:203], v[40:43], a[40:43], v[200:203]
v_mfma_f32_16x16x32_bf16 v[200:203], v[44:47], a[44:47], v[200:203]
ds_read_b64_tr_b16 v[62:63], v15 offset:25600
v_mfma_f32_16x16x32_bf16 v[204:207], v[32:35], a[48:51], v[204:207]
buffer_load_dwordx4 v24, s[4:7], s60 offen offset:2048 sc1  lds
v_mfma_f32_16x16x32_bf16 v[204:207], v[36:39], a[52:55], v[204:207]
ds_read_b64_tr_b16 v[32:33], v16 offset:0
v_mfma_f32_16x16x32_bf16 v[204:207], v[40:43], a[56:59], v[204:207]
v_mfma_f32_16x16x32_bf16 v[204:207], v[44:47], a[60:63], v[204:207]
s_waitcnt lgkmcnt(7)
ds_read_b64_tr_b16 v[34:35], v16 offset:1024
v_mfma_f32_16x16x32_bf16 v[208:211], v[48:51], a[0:3], v[208:211]
s_waitcnt lgkmcnt(6)
buffer_load_dwordx4 v24, s[4:7], s60 offen offset:3072 sc1  lds
v_mfma_f32_16x16x32_bf16 v[208:211], v[52:55], a[4:7], v[208:211]
s_waitcnt lgkmcnt(4)
s_add_u32 m0, m0, 16384
ds_read_b64_tr_b16 v[36:37], v16 offset:8192
v_mfma_f32_16x16x32_bf16 v[208:211], v[56:59], a[8:11], v[208:211]
s_waitcnt lgkmcnt(3)
s_add_u32 s60, s60, 516096
v_mfma_f32_16x16x32_bf16 v[208:211], v[60:63], a[12:15], v[208:211]
ds_read_b64_tr_b16 v[38:39], v16 offset:9216
v_mfma_f32_16x16x32_bf16 v[212:215], v[48:51], a[16:19], v[212:215]
buffer_load_dwordx4 v24, s[4:7], s60 offen offset:0 sc1  lds
v_mfma_f32_16x16x32_bf16 v[212:215], v[52:55], a[20:23], v[212:215]
ds_read_b64_tr_b16 v[40:41], v16 offset:16384
v_mfma_f32_16x16x32_bf16 v[212:215], v[56:59], a[24:27], v[212:215]
v_mfma_f32_16x16x32_bf16 v[212:215], v[60:63], a[28:31], v[212:215]
ds_read_b64_tr_b16 v[42:43], v16 offset:17408
v_mfma_f32_16x16x32_bf16 v[216:219], v[48:51], a[32:35], v[216:219]
buffer_load_dwordx4 v24, s[4:7], s60 offen offset:1024 sc1  lds
v_mfma_f32_16x16x32_bf16 v[216:219], v[52:55], a[36:39], v[216:219]
ds_read_b64_tr_b16 v[44:45], v16 offset:24576
v_cvt_pk_bf16_f32 v192, v192, v193
v_mfma_f32_16x16x32_bf16 v[216:219], v[56:59], a[40:43], v[216:219]
v_cvt_pk_bf16_f32 v193, v194, v195
v_cvt_pk_bf16_f32 v194, v208, v209
v_mfma_f32_16x16x32_bf16 v[216:219], v[60:63], a[44:47], v[216:219]
ds_read_b64_tr_b16 v[46:47], v16 offset:25600
v_cvt_pk_bf16_f32 v195, v210, v211
v_mfma_f32_16x16x32_bf16 v[220:223], v[48:51], a[48:51], v[220:223]
buffer_load_dwordx4 v24, s[4:7], s60 offen offset:2048 sc1  lds
v_mfma_f32_16x16x32_bf16 v[220:223], v[52:55], a[52:55], v[220:223]
ds_read_b64_tr_b16 v[48:49], v17 offset:0
v_cvt_pk_bf16_f32 v196, v196, v197
v_mfma_f32_16x16x32_bf16 v[220:223], v[56:59], a[56:59], v[220:223]
v_cvt_pk_bf16_f32 v197, v198, v199
v_cvt_pk_bf16_f32 v198, v212, v213
v_mfma_f32_16x16x32_bf16 v[220:223], v[60:63], a[60:63], v[220:223]
s_waitcnt lgkmcnt(7)
ds_read_b64_tr_b16 v[50:51], v17 offset:1024
v_cvt_pk_bf16_f32 v199, v214, v215
v_mfma_f32_16x16x32_bf16 v[224:227], v[32:35], a[0:3], v[224:227]
s_waitcnt lgkmcnt(6)
buffer_load_dwordx4 v24, s[4:7], s60 offen offset:3072 sc1  lds
v_mfma_f32_16x16x32_bf16 v[224:227], v[36:39], a[4:7], v[224:227]
s_waitcnt lgkmcnt(4)
s_sub_u32 s60, s60, 516096
ds_read_b64_tr_b16 v[52:53], v17 offset:8192
v_cvt_pk_bf16_f32 v200, v200, v201
v_mfma_f32_16x16x32_bf16 v[224:227], v[40:43], a[8:11], v[224:227]
s_waitcnt lgkmcnt(3)
s_add_u32 s60, s60, 16384
v_cvt_pk_bf16_f32 v201, v202, v203
v_cvt_pk_bf16_f32 v202, v216, v217
v_mfma_f32_16x16x32_bf16 v[224:227], v[44:47], a[12:15], v[224:227]
s_add_u32 s62, s62, 32768
ds_read_b64_tr_b16 v[54:55], v17 offset:9216
v_cvt_pk_bf16_f32 v203, v218, v219
v_mfma_f32_16x16x32_bf16 v[228:231], v[32:35], a[16:19], v[228:231]
v_cvt_pk_bf16_f32 v204, v204, v205
v_cvt_pk_bf16_f32 v205, v206, v207
v_mfma_f32_16x16x32_bf16 v[228:231], v[36:39], a[20:23], v[228:231]
ds_read_b64_tr_b16 v[56:57], v17 offset:16384
v_cvt_pk_bf16_f32 v206, v220, v221
v_mfma_f32_16x16x32_bf16 v[228:231], v[40:43], a[24:27], v[228:231]
v_cvt_pk_bf16_f32 v207, v222, v223
v_mfma_f32_16x16x32_bf16 v[228:231], v[44:47], a[28:31], v[228:231]
ds_read_b64_tr_b16 v[58:59], v17 offset:17408
v_mfma_f32_16x16x32_bf16 v[232:235], v[32:35], a[32:35], v[232:235]
v_mfma_f32_16x16x32_bf16 v[232:235], v[36:39], a[36:39], v[232:235]
ds_read_b64_tr_b16 v[60:61], v17 offset:24576
v_mfma_f32_16x16x32_bf16 v[232:235], v[40:43], a[40:43], v[232:235]
v_mfma_f32_16x16x32_bf16 v[232:235], v[44:47], a[44:47], v[232:235]
ds_read_b64_tr_b16 v[62:63], v17 offset:25600
v_mfma_f32_16x16x32_bf16 v[236:239], v[32:35], a[48:51], v[236:239]
v_mfma_f32_16x16x32_bf16 v[236:239], v[36:39], a[52:55], v[236:239]
v_mfma_f32_16x16x32_bf16 v[236:239], v[40:43], a[56:59], v[236:239]
v_mfma_f32_16x16x32_bf16 v[236:239], v[44:47], a[60:63], v[236:239]
s_waitcnt lgkmcnt(6)
v_mov_b32 v10, v1
v_add_u32 v11, 131072, v1
v_mfma_f32_16x16x32_bf16 v[240:243], v[48:51], a[0:3], v[240:243]
s_waitcnt vmcnt(8)
s_waitcnt lgkmcnt(0)
s_barrier
v_mfma_f32_16x16x32_bf16 v[240:243], v[52:55], a[4:7], v[240:243]
ds_read_b128 a[96:99], v11 offset:0
v_mfma_f32_16x16x32_bf16 v[240:243], v[56:59], a[8:11], v[240:243]
ds_read_b128 a[100:103], v11 offset:1024
v_mfma_f32_16x16x32_bf16 v[240:243], v[60:63], a[12:15], v[240:243]
ds_read_b128 a[104:107], v11 offset:2048
v_mfma_f32_16x16x32_bf16 v[244:247], v[48:51], a[16:19], v[244:247]
ds_read_b128 a[108:111], v11 offset:3072
v_mfma_f32_16x16x32_bf16 v[244:247], v[52:55], a[20:23], v[244:247]
ds_read_b128 a[112:115], v11 offset:4096
v_mfma_f32_16x16x32_bf16 v[244:247], v[56:59], a[24:27], v[244:247]
ds_read_b128 a[116:119], v11 offset:5120
v_mfma_f32_16x16x32_bf16 v[244:247], v[60:63], a[28:31], v[244:247]
ds_read_b128 a[120:123], v11 offset:6144
v_mfma_f32_16x16x32_bf16 v[248:251], v[48:51], a[32:35], v[248:251]
ds_read_b128 a[124:127], v11 offset:7168
v_cvt_pk_bf16_f32 v224, v224, v225
v_mfma_f32_16x16x32_bf16 v[248:251], v[52:55], a[36:39], v[248:251]
s_and_b32 m0, s62, 0x1ffff
v_cvt_pk_bf16_f32 v225, v226, v227
v_cvt_pk_bf16_f32 v226, v240, v241
v_mfma_f32_16x16x32_bf16 v[248:251], v[56:59], a[40:43], v[248:251]
ds_read_b128 a[64:67], v10 offset:0
v_cvt_pk_bf16_f32 v227, v242, v243
v_mfma_f32_16x16x32_bf16 v[248:251], v[60:63], a[44:47], v[248:251]
buffer_load_dwordx4 v24, s[4:7], s60 offen offset:0 sc1  lds
v_mfma_f32_16x16x32_bf16 v[252:255], v[48:51], a[48:51], v[252:255]
ds_read_b128 a[68:71], v10 offset:1024
v_cvt_pk_bf16_f32 v228, v228, v229
v_mfma_f32_16x16x32_bf16 v[252:255], v[52:55], a[52:55], v[252:255]
v_cvt_pk_bf16_f32 v229, v230, v231
v_cvt_pk_bf16_f32 v230, v244, v245
v_mfma_f32_16x16x32_bf16 v[252:255], v[56:59], a[56:59], v[252:255]
ds_read_b128 a[72:75], v10 offset:2048
v_cvt_pk_bf16_f32 v231, v246, v247
v_mfma_f32_16x16x32_bf16 v[252:255], v[60:63], a[60:63], v[252:255]
s_waitcnt lgkmcnt(10)
buffer_load_dwordx4 v24, s[4:7], s60 offen offset:1024 sc1  lds
v_mfma_f32_16x16x32_bf16 v[32:35], a[96:99], v[128:131], 0
s_waitcnt lgkmcnt(9)
ds_read_b128 a[76:79], v10 offset:3072
v_cvt_pk_bf16_f32 v232, v232, v233
v_mfma_f32_16x16x32_bf16 v[32:35], a[100:103], v[160:163], v[32:35]
s_waitcnt lgkmcnt(9)
v_cvt_pk_bf16_f32 v233, v234, v235
v_cvt_pk_bf16_f32 v234, v248, v249
v_mfma_f32_16x16x32_bf16 v[32:35], a[104:107], v[192:195], v[32:35]
s_waitcnt lgkmcnt(8)
ds_read_b128 a[80:83], v10 offset:4096
v_cvt_pk_bf16_f32 v235, v250, v251
v_mfma_f32_16x16x32_bf16 v[32:35], a[108:111], v[224:227], v[32:35]
s_waitcnt lgkmcnt(8)
buffer_load_dwordx4 v24, s[4:7], s60 offen offset:2048 sc1  lds
v_mfma_f32_16x16x32_bf16 v[48:51], a[112:115], v[128:131], 0
s_waitcnt lgkmcnt(7)
ds_read_b128 a[84:87], v10 offset:5120
v_cvt_pk_bf16_f32 v236, v236, v237
v_mfma_f32_16x16x32_bf16 v[48:51], a[116:119], v[160:163], v[48:51]
s_waitcnt lgkmcnt(7)
v_cvt_pk_bf16_f32 v237, v238, v239
v_cvt_pk_bf16_f32 v238, v252, v253
v_mfma_f32_16x16x32_bf16 v[48:51], a[120:123], v[192:195], v[48:51]
s_waitcnt lgkmcnt(6)
ds_read_b128 a[88:91], v10 offset:6144
v_cvt_pk_bf16_f32 v239, v254, v255
v_mfma_f32_16x16x32_bf16 v[48:51], a[124:127], v[224:227], v[48:51]
v_mfma_f32_16x16x32_bf16 v[36:39], a[96:99], v[132:135], 0
ds_read_b128 a[92:95], v10 offset:7168
v_mfma_f32_16x16x32_bf16 v[36:39], a[100:103], v[164:167], v[36:39]
v_mfma_f32_16x16x32_bf16 v[36:39], a[104:107], v[196:199], v[36:39]
v_add_u32 v11, 0x8000, v1
v_mfma_f32_16x16x32_bf16 v[36:39], a[108:111], v[228:231], v[36:39]
v_mfma_f32_16x16x32_bf16 v[52:55], a[112:115], v[132:135], 0
v_add_u32 v12, 516096, v24
v_mfma_f32_16x16x32_bf16 v[52:55], a[116:119], v[164:167], v[52:55]
v_mfma_f32_16x16x32_bf16 v[52:55], a[120:123], v[196:199], v[52:55]
v_mfma_f32_16x16x32_bf16 v[52:55], a[124:127], v[228:231], v[52:55]
v_mfma_f32_16x16x32_bf16 v[40:43], a[96:99], v[136:139], 0
v_mfma_f32_16x16x32_bf16 v[40:43], a[100:103], v[168:171], v[40:43]
v_mfma_f32_16x16x32_bf16 v[40:43], a[104:107], v[200:203], v[40:43]
v_mfma_f32_16x16x32_bf16 v[40:43], a[108:111], v[232:235], v[40:43]
v_mfma_f32_16x16x32_bf16 v[56:59], a[112:115], v[136:139], 0
v_mfma_f32_16x16x32_bf16 v[56:59], a[116:119], v[168:171], v[56:59]
s_add_u32 s3, s49, s50
s_cmp_eq_u32 s3, 0
s_cbranch_scc0 L_at_nmN
v_mov_b32 v216, 0xff800000
v_cndmask_b32 v32, v32, v216, s[68:69]
v_mov_b32 v48, v216
v_cndmask_b32 v52, v52, v216, s[68:69]
v_cndmask_b32 v33, v33, v216, s[70:71]
v_mov_b32 v49, v216
v_cndmask_b32 v53, v53, v216, s[70:71]
v_cndmask_b32 v34, v34, v216, s[72:73]
v_mov_b32 v50, v216
v_cndmask_b32 v54, v54, v216, s[72:73]
v_cndmask_b32 v35, v35, v216, s[74:75]
v_mov_b32 v51, v216
v_cndmask_b32 v55, v55, v216, s[74:75]
L_at_nmN:
v_mfma_f32_16x16x32_bf16 v[56:59], a[120:123], v[200:203], v[56:59]
v_max3_f32 v212, v32, v33, v34
v_max3_f32 v212, v212, v35, v48
v_mfma_f32_16x16x32_bf16 v[56:59], a[124:127], v[232:235], v[56:59]
v_max3_f32 v212, v212, v49, v50
v_max_f32 v212, v212, v51
v_mfma_f32_16x16x32_bf16 v[44:47], a[96:99], v[140:143], 0
v_max3_f32 v213, v36, v37, v38
v_max3_f32 v213, v213, v39, v52
v_mfma_f32_16x16x32_bf16 v[44:47], a[100:103], v[172:175], v[44:47]
v_max3_f32 v213, v213, v53, v54
v_max_f32 v213, v213, v55
v_mfma_f32_16x16x32_bf16 v[44:47], a[104:107], v[204:207], v[44:47]
v_mfma_f32_16x16x32_bf16 v[44:47], a[108:111], v[236:239], v[44:47]
v_mfma_f32_16x16x32_bf16 v[60:63], a[112:115], v[140:143], 0
v_max3_f32 v214, v40, v41, v42
v_max3_f32 v214, v214, v43, v56
v_mfma_f32_16x16x32_bf16 v[60:63], a[116:119], v[172:175], v[60:63]
v_max3_f32 v214, v214, v57, v58
v_max_f32 v214, v214, v59
v_mfma_f32_16x16x32_bf16 v[60:63], a[120:123], v[204:207], v[60:63]
v_mfma_f32_16x16x32_bf16 v[60:63], a[124:127], v[236:239], v[60:63]
v_mov_b32 v220, 0xff800000
v_mov_b32 v221, 0xff800000
v_mov_b32 v219, 0x53800000
s_mov_b32 s56, 0
s_mov_b32 s64, 0
v_mov_b32 v208, 0
v_mov_b32 v209, 0
v_mov_b32 v210, 0
v_mov_b32 v211, 0
v_max3_f32 v215, v44, v45, v46
v_max3_f32 v215, v215, v47, v60
v_max3_f32 v215, v215, v61, v62
v_max_f32 v215, v215, v63
v_mov_b32 v240, v212
v_mov_b32 v241, v213
v_mov_b32 v242, v214
v_mov_b32 v243, v215
v_permlane16_swap_b32 v212, v240
v_permlane16_swap_b32 v213, v241
v_permlane16_swap_b32 v214, v242
v_permlane16_swap_b32 v215, v243
v_max_f32 v212, v212, v240
v_max_f32 v213, v213, v241
v_max_f32 v214, v214, v242
v_max_f32 v215, v215, v243
v_mov_b32 v240, v212
v_mov_b32 v241, v213
v_mov_b32 v242, v214
v_mov_b32 v243, v215
v_permlane32_swap_b32 v212, v240
v_permlane32_swap_b32 v213, v241
v_permlane32_swap_b32 v214, v242
v_permlane32_swap_b32 v215, v243
v_max_f32 v212, v212, v240
v_max_f32 v213, v213, v241
v_max_f32 v214, v214, v242
v_max_f32 v215, v215, v243
v_sub_f32 v212, 0, v212
v_sub_f32 v213, 0, v213
v_sub_f32 v214, 0, v214
v_sub_f32 v215, 0, v215
v_pk_add_f32 v[32:33], v[32:33], v[212:213] op_sel:[0,0] op_sel_hi:[1,0]
v_pk_add_f32 v[34:35], v[34:35], v[212:213] op_sel:[0,0] op_sel_hi:[1,0]
v_pk_add_f32 v[36:37], v[36:37], v[212:213] op_sel:[0,1] op_sel_hi:[1,1]
v_pk_add_f32 v[38:39], v[38:39], v[212:213] op_sel:[0,1] op_sel_hi:[1,1]
v_pk_add_f32 v[40:41], v[40:41], v[214:215] op_sel:[0,0] op_sel_hi:[1,0]
v_pk_add_f32 v[42:43], v[42:43], v[214:215] op_sel:[0,0] op_sel_hi:[1,0]
v_pk_add_f32 v[44:45], v[44:45], v[214:215] op_sel:[0,1] op_sel_hi:[1,1]
v_pk_add_f32 v[46:47], v[46:47], v[214:215] op_sel:[0,1] op_sel_hi:[1,1]
v_pk_add_f32 v[48:49], v[48:49], v[212:213] op_sel:[0,0] op_sel_hi:[1,0]
v_pk_add_f32 v[50:51], v[50:51], v[212:213] op_sel:[0,0] op_sel_hi:[1,0]
v_pk_add_f32 v[52:53], v[52:53], v[212:213] op_sel:[0,1] op_sel_hi:[1,1]
v_pk_add_f32 v[54:55], v[54:55], v[212:213] op_sel:[0,1] op_sel_hi:[1,1]
v_pk_add_f32 v[56:57], v[56:57], v[214:215] op_sel:[0,0] op_sel_hi:[1,0]
v_pk_add_f32 v[58:59], v[58:59], v[214:215] op_sel:[0,0] op_sel_hi:[1,0]
v_pk_add_f32 v[60:61], v[60:61], v[214:215] op_sel:[0,1] op_sel_hi:[1,1]
v_pk_add_f32 v[62:63], v[62:63], v[214:215] op_sel:[0,1] op_sel_hi:[1,1]
v_pk_mov_b32 v[144:145], v[212:213], v[212:213] op_sel:[0,0]
v_pk_mov_b32 v[146:147], v[212:213], v[212:213] op_sel:[0,0]
v_pk_mov_b32 v[148:149], v[212:213], v[212:213] op_sel:[1,1]
v_pk_mov_b32 v[150:151], v[212:213], v[212:213] op_sel:[1,1]
v_pk_mov_b32 v[152:153], v[214:215], v[214:215] op_sel:[0,0]
v_pk_mov_b32 v[154:155], v[214:215], v[214:215] op_sel:[0,0]
v_pk_mov_b32 v[156:157], v[214:215], v[214:215] op_sel:[1,1]
v_pk_mov_b32 v[158:159], v[214:215], v[214:215] op_sel:[1,1]
v_pk_mov_b32 v[176:177], v[212:213], v[212:213] op_sel:[0,0]
v_pk_mov_b32 v[178:179], v[212:213], v[212:213] op_sel:[0,0]
v_pk_mov_b32 v[180:181], v[212:213], v[212:213] op_sel:[1,1]
v_pk_mov_b32 v[182:183], v[212:213], v[212:213] op_sel:[1,1]
v_pk_mov_b32 v[184:185], v[214:215], v[214:215] op_sel:[0,0]
v_pk_mov_b32 v[186:187], v[214:215], v[214:215] op_sel:[0,0]
v_pk_mov_b32 v[188:189], v[214:215], v[214:215] op_sel:[1,1]
v_pk_mov_b32 v[190:191], v[214:215], v[214:215] op_sel:[1,1]
v_pk_mov_b32 v[96:97], v[212:213], v[212:213] op_sel:[0,0]
v_pk_mov_b32 v[98:99], v[212:213], v[212:213] op_sel:[0,0]
v_pk_mov_b32 v[100:101], v[212:213], v[212:213] op_sel:[1,1]
v_pk_mov_b32 v[102:103], v[212:213], v[212:213] op_sel:[1,1]
v_pk_mov_b32 v[104:105], v[214:215], v[214:215] op_sel:[0,0]
v_pk_mov_b32 v[106:107], v[214:215], v[214:215] op_sel:[0,0]
v_pk_mov_b32 v[108:109], v[214:215], v[214:215] op_sel:[1,1]
v_pk_mov_b32 v[110:111], v[214:215], v[214:215] op_sel:[1,1]
v_pk_mov_b32 v[112:113], v[212:213], v[212:213] op_sel:[0,0]
v_pk_mov_b32 v[114:115], v[212:213], v[212:213] op_sel:[0,0]
v_pk_mov_b32 v[116:117], v[212:213], v[212:213] op_sel:[1,1]
v_pk_mov_b32 v[118:119], v[212:213], v[212:213] op_sel:[1,1]
v_pk_mov_b32 v[120:121], v[214:215], v[214:215] op_sel:[0,0]
v_pk_mov_b32 v[122:123], v[214:215], v[214:215] op_sel:[0,0]
v_pk_mov_b32 v[124:125], v[214:215], v[214:215] op_sel:[1,1]
v_pk_mov_b32 v[126:127], v[214:215], v[214:215] op_sel:[1,1]
v_exp_f32 v32, v32
v_exp_f32 v33, v33
v_exp_f32 v34, v34
v_exp_f32 v35, v35
v_add_f32 v208, v208, v32
v_add_f32 v208, v208, v33
v_cvt_pk_bf16_f32 v64, v32, v33
v_add_f32 v208, v208, v34
v_add_f32 v208, v208, v35
v_cvt_pk_bf16_f32 v65, v34, v35
v_exp_f32 v36, v36
v_exp_f32 v37, v37
v_exp_f32 v38, v38
v_exp_f32 v39, v39
v_add_f32 v209, v209, v36
v_add_f32 v209, v209, v37
v_cvt_pk_bf16_f32 v68, v36, v37
v_add_f32 v209, v209, v38
v_add_f32 v209, v209, v39
v_cvt_pk_bf16_f32 v69, v38, v39
v_exp_f32 v40, v40
v_exp_f32 v41, v41
v_exp_f32 v42, v42
v_exp_f32 v43, v43
v_add_f32 v210, v210, v40
v_add_f32 v210, v210, v41
v_cvt_pk_bf16_f32 v72, v40, v41
v_add_f32 v210, v210, v42
v_add_f32 v210, v210, v43
v_cvt_pk_bf16_f32 v73, v42, v43
v_exp_f32 v44, v44
v_exp_f32 v45, v45
v_exp_f32 v46, v46
v_exp_f32 v47, v47
v_add_f32 v211, v211, v44
v_add_f32 v211, v211, v45
v_cvt_pk_bf16_f32 v76, v44, v45
v_add_f32 v211, v211, v46
v_add_f32 v211, v211, v47
v_cvt_pk_bf16_f32 v77, v46, v47
v_exp_f32 v48, v48
v_exp_f32 v49, v49
v_exp_f32 v50, v50
v_exp_f32 v51, v51
v_add_f32 v208, v208, v48
v_add_f32 v208, v208, v49
v_cvt_pk_bf16_f32 v66, v48, v49
v_add_f32 v208, v208, v50
v_add_f32 v208, v208, v51
v_cvt_pk_bf16_f32 v67, v50, v51
v_exp_f32 v52, v52
v_exp_f32 v53, v53
v_exp_f32 v54, v54
v_exp_f32 v55, v55
v_add_f32 v209, v209, v52
v_add_f32 v209, v209, v53
v_cvt_pk_bf16_f32 v70, v52, v53
v_add_f32 v209, v209, v54
v_add_f32 v209, v209, v55
v_cvt_pk_bf16_f32 v71, v54, v55
L_afterB:
L_at_disp:
s_cmp_eq_u32 s56, 2
s_cbranch_scc0 L_at_d0
s_cmp_eq_u32 s65, 0
s_cbranch_scc0 L_at_d0
s_lshl_b32 s53, s49, 8
s_add_u32 s53, s53, 85991424
v_mov_b32 v216, 1
buffer_atomic_add v216, v0, s[4:7], s53 offen sc1
L_at_d0:
s_add_u32 s3, s56, 2
s_cmp_eq_u32 s3, s58
s_cbranch_scc0 L_at_d1
s_mov_b32 s1, 85991424
v_cmp_gt_u32 vcc, 128, v1
v_lshlrev_b32 v22, 4, v1
s_waitcnt vmcnt(8)
v_mov_b32 v25, 2130706432
v_mov_b32 v23, 32
v_cndmask_b32 v22, v25, v22, vcc
v_cndmask_b32 v23, 0, v23, vcc
buffer_load_dword v25, v22, s[4:7], s1 offen sc1
s_bitcmp1_b32 s50, 0
s_cbranch_scc0 L_mk1a
v_cndmask_b32 v104, v214, v220, s[68:69]
v_cndmask_b32 v124, v215, v220, s[68:69]
v_cndmask_b32 v105, v214, v220, s[70:71]
v_cndmask_b32 v125, v215, v220, s[70:71]
v_cndmask_b32 v106, v214, v220, s[72:73]
v_cndmask_b32 v126, v215, v220, s[72:73]
v_cndmask_b32 v107, v214, v220, s[74:75]
v_cndmask_b32 v127, v215, v220, s[74:75]
v_pk_mov_b32 v[120:121], v[220:221], v[220:221]
v_pk_mov_b32 v[122:123], v[220:221], v[220:221]
L_mk1a:
L_at_d1:
s_cmp_ge_u32 s56, s57
s_cbranch_scc1 L_at_dB
s_add_u32 s3, s56, 2
s_cmp_eq_u32 s3, s57
s_cbranch_scc0 L_at_d2
s_bitcmp1_b32 s50, 0
s_cbranch_scc1 L_mk2a
v_cndmask_b32 v96, v212, v220, s[68:69]
v_cndmask_b32 v116, v213, v220, s[68:69]
v_cndmask_b32 v97, v212, v220, s[70:71]
v_cndmask_b32 v117, v213, v220, s[70:71]
v_cndmask_b32 v98, v212, v220, s[72:73]
v_cndmask_b32 v118, v213, v220, s[72:73]
v_cndmask_b32 v99, v212, v220, s[74:75]
v_cndmask_b32 v119, v213, v220, s[74:75]
v_pk_mov_b32 v[112:113], v[220:221], v[220:221]
v_pk_mov_b32 v[114:115], v[220:221], v[220:221]
L_mk2a:
L_at_d2:
s_add_u32 s63, s56, 1
s_cmp_eq_u32 s63, s57
s_cbranch_scc0 L_at_d3
s_cmp_lg_u32 s56, 0
s_cbranch_scc1 L_at_mx
s_bitcmp1_b32 s50, 0
s_cbranch_scc0 L_mk3a
v_cndmask_b32 v144, v212, v220, s[68:69]
v_cndmask_b32 v180, v213, v220, s[68:69]
v_cndmask_b32 v145, v212, v220, s[70:71]
v_cndmask_b32 v181, v213, v220, s[70:71]
v_cndmask_b32 v146, v212, v220, s[72:73]
v_cndmask_b32 v182, v213, v220, s[72:73]
v_cndmask_b32 v147, v212, v220, s[74:75]
v_cndmask_b32 v183, v213, v220, s[74:75]
v_pk_mov_b32 v[176:177], v[220:221], v[220:221]
v_pk_mov_b32 v[178:179], v[220:221], v[220:221]
s_branch L_mk3b
L_mk3a:
v_pk_mov_b32 v[144:145], v[220:221], v[220:221]
v_pk_mov_b32 v[146:147], v[220:221], v[220:221]
v_pk_mov_b32 v[148:149], v[220:221], v[220:221]
v_pk_mov_b32 v[150:151], v[220:221], v[220:221]
v_pk_mov_b32 v[176:177], v[220:221], v[220:221]
v_pk_mov_b32 v[178:179], v[220:221], v[220:221]
v_pk_mov_b32 v[180:181], v[220:221], v[220:221]
v_pk_mov_b32 v[182:183], v[220:221], v[220:221]
L_mk3b:
v_pk_mov_b32 v[96:97], v[220:221], v[220:221]
v_pk_mov_b32 v[98:99], v[220:221], v[220:221]
v_pk_mov_b32 v[100:101], v[220:221], v[220:221]
v_pk_mov_b32 v[102:103], v[220:221], v[220:221]
v_pk_mov_b32 v[112:113], v[220:221], v[220:221]
v_pk_mov_b32 v[114:115], v[220:221], v[220:221]
v_pk_mov_b32 v[116:117], v[220:221], v[220:221]
v_pk_mov_b32 v[118:119], v[220:221], v[220:221]
L_at_d3:
s_sub_u32 s3, s57, 2
s_max_i32 s63, s63, s3
s_cmp_lt_u32 s56, 2
s_cselect_b32 s3, 2, 64
s_min_u32 s63, s63, s3
s_cmp_lg_u32 s56, 0
s_cbranch_scc1 L_at_dual
s_waitcnt lgkmcnt(7)
v_mfma_f32_16x16x32_bf16 v[32:35], a[64:67], v[128:131], v[144:147]
s_waitcnt lgkmcnt(6)
v_exp_f32 v56, v56
v_mfma_f32_16x16x32_bf16 v[32:35], a[68:71], v[160:163], v[32:35]
s_waitcnt lgkmcnt(4)
ds_read_b128 a[96:99], v10 offset:16384
v_add_f32 v210, v210, v56
v_mfma_f32_16x16x32_bf16 v[32:35], a[72:75], v[192:195], v[32:35]
buffer_load_dwordx4 v24, s[4:7], s60 offen offset:3072 sc1  lds
v_exp_f32 v57, v57
v_mfma_f32_16x16x32_bf16 v[32:35], a[76:79], v[224:227], v[32:35]
s_add_u32 m0, m0, 16384
v_add_f32 v210, v210, v57
v_cvt_pk_bf16_f32 v74, v56, v57
v_mfma_f32_16x16x32_bf16 v[36:39], a[64:67], v[132:135], v[148:151]
v_exp_f32 v58, v58
v_mfma_f32_16x16x32_bf16 v[36:39], a[68:71], v[164:167], v[36:39]
ds_read_b128 a[100:103], v10 offset:17408
v_add_f32 v210, v210, v58
v_mfma_f32_16x16x32_bf16 v[36:39], a[72:75], v[196:199], v[36:39]
v_exp_f32 v59, v59
v_mfma_f32_16x16x32_bf16 v[36:39], a[76:79], v[228:231], v[36:39]
v_add_f32 v210, v210, v59
v_cvt_pk_bf16_f32 v75, v58, v59
v_mfma_f32_16x16x32_bf16 v[40:43], a[64:67], v[136:139], v[152:155]
v_exp_f32 v60, v60
v_mfma_f32_16x16x32_bf16 v[40:43], a[68:71], v[168:171], v[40:43]
ds_read_b128 a[104:107], v10 offset:18432
v_add_f32 v211, v211, v60
v_mfma_f32_16x16x32_bf16 v[40:43], a[72:75], v[200:203], v[40:43]
v_exp_f32 v61, v61
v_mfma_f32_16x16x32_bf16 v[40:43], a[76:79], v[232:235], v[40:43]
v_add_f32 v211, v211, v61
v_cvt_pk_bf16_f32 v78, v60, v61
v_mfma_f32_16x16x32_bf16 v[44:47], a[64:67], v[140:143], v[156:159]
buffer_load_dwordx4 v12, s[4:7], s60 offen offset:0 sc1  lds
v_exp_f32 v62, v62
v_mfma_f32_16x16x32_bf16 v[44:47], a[68:71], v[172:175], v[44:47]
ds_read_b128 a[108:111], v10 offset:19456
v_add_f32 v211, v211, v62
v_mfma_f32_16x16x32_bf16 v[44:47], a[72:75], v[204:207], v[44:47]
v_exp_f32 v63, v63
v_mfma_f32_16x16x32_bf16 v[44:47], a[76:79], v[236:239], v[44:47]
s_waitcnt lgkmcnt(6)
v_add_f32 v211, v211, v63
v_cvt_pk_bf16_f32 v79, v62, v63
v_mfma_f32_16x16x32_bf16 v[48:51], a[80:83], v[128:131], v[176:179]
v_exp_f32 v32, v32
v_mfma_f32_16x16x32_bf16 v[48:51], a[84:87], v[160:163], v[48:51]
s_waitcnt lgkmcnt(4)
ds_read_b128 a[112:115], v10 offset:20480
v_add_f32 v208, v208, v32
v_mfma_f32_16x16x32_bf16 v[48:51], a[88:91], v[192:195], v[48:51]
v_exp_f32 v33, v33
v_mfma_f32_16x16x32_bf16 v[48:51], a[92:95], v[224:227], v[48:51]
v_add_f32 v208, v208, v33
v_cvt_pk_bf16_f32 v80, v32, v33
v_mfma_f32_16x16x32_bf16 v[52:55], a[80:83], v[132:135], v[180:183]
v_exp_f32 v34, v34
v_mfma_f32_16x16x32_bf16 v[52:55], a[84:87], v[164:167], v[52:55]
ds_read_b128 a[116:119], v10 offset:21504
v_add_f32 v208, v208, v34
v_mfma_f32_16x16x32_bf16 v[52:55], a[88:91], v[196:199], v[52:55]
buffer_load_dwordx4 v12, s[4:7], s60 offen offset:1024 sc1  lds
v_exp_f32 v35, v35
v_mfma_f32_16x16x32_bf16 v[52:55], a[92:95], v[228:231], v[52:55]
v_add_f32 v208, v208, v35
v_cvt_pk_bf16_f32 v81, v34, v35
v_mfma_f32_16x16x32_bf16 v[56:59], a[80:83], v[136:139], v[184:187]
v_exp_f32 v36, v36
v_mfma_f32_16x16x32_bf16 v[56:59], a[84:87], v[168:171], v[56:59]
ds_read_b128 a[120:123], v10 offset:22528
v_add_f32 v209, v209, v36
v_mfma_f32_16x16x32_bf16 v[56:59], a[88:91], v[200:203], v[56:59]
v_exp_f32 v37, v37
v_mfma_f32_16x16x32_bf16 v[56:59], a[92:95], v[232:235], v[56:59]
v_add_f32 v209, v209, v37
v_cvt_pk_bf16_f32 v84, v36, v37
v_mfma_f32_16x16x32_bf16 v[60:63], a[80:83], v[140:143], v[188:191]
v_exp_f32 v38, v38
v_mfma_f32_16x16x32_bf16 v[60:63], a[84:87], v[172:175], v[60:63]
ds_read_b128 a[124:127], v10 offset:23552
v_add_f32 v209, v209, v38
v_mfma_f32_16x16x32_bf16 v[60:63], a[88:91], v[204:207], v[60:63]
v_exp_f32 v39, v39
v_mfma_f32_16x16x32_bf16 v[60:63], a[92:95], v[236:239], v[60:63]
s_waitcnt lgkmcnt(6)
v_add_f32 v209, v209, v39
v_cvt_pk_bf16_f32 v85, v38, v39
v_mfma_f32_16x16x32_bf16 a[128:131], a[96:99], v[64:67], 0
buffer_load_dwordx4 v12, s[4:7], s60 offen offset:2048 sc1  lds
v_exp_f32 v40, v40
v_mfma_f32_16x16x32_bf16 a[132:135], a[96:99], v[68:71], 0
ds_read_b128 a[64:67], v10 offset:8192
v_add_f32 v210, v210, v40
v_mfma_f32_16x16x32_bf16 a[136:139], a[96:99], v[72:75], 0
v_exp_f32 v41, v41
v_mfma_f32_16x16x32_bf16 a[140:143], a[96:99], v[76:79], 0
v_add_f32 v210, v210, v41
v_cvt_pk_bf16_f32 v88, v40, v41
v_mfma_f32_16x16x32_bf16 a[144:147], a[100:103], v[64:67], 0
v_exp_f32 v42, v42
v_mfma_f32_16x16x32_bf16 a[148:151], a[100:103], v[68:71], 0
ds_read_b128 a[68:71], v10 offset:9216
v_add_f32 v210, v210, v42
v_mfma_f32_16x16x32_bf16 a[152:155], a[100:103], v[72:75], 0
v_exp_f32 v43, v43
v_mfma_f32_16x16x32_bf16 a[156:159], a[100:103], v[76:79], 0
s_waitcnt lgkmcnt(6)
v_add_f32 v210, v210, v43
v_cvt_pk_bf16_f32 v89, v42, v43
v_mfma_f32_16x16x32_bf16 a[160:163], a[104:107], v[64:67], 0
v_exp_f32 v44, v44
v_mfma_f32_16x16x32_bf16 a[164:167], a[104:107], v[68:71], 0
ds_read_b128 a[72:75], v10 offset:10240
v_add_f32 v211, v211, v44
v_mfma_f32_16x16x32_bf16 a[168:171], a[104:107], v[72:75], 0
buffer_load_dwordx4 v12, s[4:7], s60 offen offset:3072 sc1  lds
v_exp_f32 v45, v45
v_mfma_f32_16x16x32_bf16 a[172:175], a[104:107], v[76:79], 0
s_add_u32 s60, s60, 16384
v_add_f32 v211, v211, v45
v_cvt_pk_bf16_f32 v92, v44, v45
v_mfma_f32_16x16x32_bf16 a[176:179], a[108:111], v[64:67], 0
s_add_u32 s62, s62, 32768
v_exp_f32 v46, v46
v_mfma_f32_16x16x32_bf16 a[180:183], a[108:111], v[68:71], 0
s_cmp_lt_u32 s60, s61
ds_read_b128 a[76:79], v10 offset:11264
v_add_f32 v211, v211, v46
v_mfma_f32_16x16x32_bf16 a[184:187], a[108:111], v[72:75], 0
s_cselect_b32 s60, s60, 2130706432
v_exp_f32 v47, v47
v_mfma_f32_16x16x32_bf16 a[188:191], a[108:111], v[76:79], 0
s_waitcnt lgkmcnt(6)
v_add_f32 v211, v211, v47
v_cvt_pk_bf16_f32 v93, v46, v47
v_mfma_f32_16x16x32_bf16 a[192:195], a[112:115], v[64:67], 0
s_and_b32 m0, s62, 0x1ffff
v_exp_f32 v48, v48
v_mfma_f32_16x16x32_bf16 a[196:199], a[112:115], v[68:71], 0
ds_read_b128 a[80:83], v10 offset:12288
v_add_f32 v208, v208, v48
v_mfma_f32_16x16x32_bf16 a[200:203], a[112:115], v[72:75], 0
v_exp_f32 v49, v49
v_mfma_f32_16x16x32_bf16 a[204:207], a[112:115], v[76:79], 0
v_add_f32 v208, v208, v49
v_cvt_pk_bf16_f32 v82, v48, v49
v_mfma_f32_16x16x32_bf16 a[208:211], a[116:119], v[64:67], 0
v_exp_f32 v50, v50
v_mfma_f32_16x16x32_bf16 a[212:215], a[116:119], v[68:71], 0
ds_read_b128 a[84:87], v10 offset:13312
v_add_f32 v208, v208, v50
v_mfma_f32_16x16x32_bf16 a[216:219], a[116:119], v[72:75], 0
v_exp_f32 v51, v51
v_mfma_f32_16x16x32_bf16 a[220:223], a[116:119], v[76:79], 0
s_waitcnt lgkmcnt(6)
v_add_f32 v208, v208, v51
v_cvt_pk_bf16_f32 v83, v50, v51
v_mfma_f32_16x16x32_bf16 a[224:227], a[120:123], v[64:67], 0
v_exp_f32 v52, v52
v_mfma_f32_16x16x32_bf16 a[228:231], a[120:123], v[68:71], 0
ds_read_b128 a[88:91], v10 offset:14336
v_add_f32 v209, v209, v52
v_mfma_f32_16x16x32_bf16 a[232:235], a[120:123], v[72:75], 0
v_exp_f32 v53, v53
v_mfma_f32_16x16x32_bf16 a[236:239], a[120:123], v[76:79], 0
v_add_f32 v209, v209, v53
v_cvt_pk_bf16_f32 v86, v52, v53
v_mfma_f32_16x16x32_bf16 a[240:243], a[124:127], v[64:67], 0
v_exp_f32 v54, v54
v_mfma_f32_16x16x32_bf16 a[244:247], a[124:127], v[68:71], 0
ds_read_b128 a[92:95], v10 offset:15360
v_add_f32 v209, v209, v54
v_mfma_f32_16x16x32_bf16 a[248:251], a[124:127], v[72:75], 0
v_exp_f32 v55, v55
v_mfma_f32_16x16x32_bf16 a[252:255], a[124:127], v[76:79], 0
s_waitcnt lgkmcnt(6)
v_add_f32 v209, v209, v55
v_cvt_pk_bf16_f32 v87, v54, v55
v_mfma_f32_16x16x32_bf16 v[32:35], a[64:67], v[128:131], v[96:99]
v_exp_f32 v56, v56
v_mfma_f32_16x16x32_bf16 v[32:35], a[68:71], v[160:163], v[32:35]
s_waitcnt lgkmcnt(4)
ds_read_b128 a[96:99], v10 offset:24576
v_add_f32 v210, v210, v56
v_mfma_f32_16x16x32_bf16 v[32:35], a[72:75], v[192:195], v[32:35]
v_exp_f32 v57, v57
v_mfma_f32_16x16x32_bf16 v[32:35], a[76:79], v[224:227], v[32:35]
v_add_f32 v210, v210, v57
v_cvt_pk_bf16_f32 v90, v56, v57
v_mfma_f32_16x16x32_bf16 v[36:39], a[64:67], v[132:135], v[100:103]
v_exp_f32 v58, v58
v_mfma_f32_16x16x32_bf16 v[36:39], a[68:71], v[164:167], v[36:39]
ds_read_b128 a[100:103], v10 offset:25600
v_add_f32 v210, v210, v58
v_mfma_f32_16x16x32_bf16 v[36:39], a[72:75], v[196:199], v[36:39]
v_exp_f32 v59, v59
v_mfma_f32_16x16x32_bf16 v[36:39], a[76:79], v[228:231], v[36:39]
v_add_f32 v210, v210, v59
v_cvt_pk_bf16_f32 v91, v58, v59
v_mfma_f32_16x16x32_bf16 v[40:43], a[64:67], v[136:139], v[104:107]
v_exp_f32 v60, v60
v_mfma_f32_16x16x32_bf16 v[40:43], a[68:71], v[168:171], v[40:43]
ds_read_b128 a[104:107], v10 offset:26624
v_add_f32 v211, v211, v60
v_mfma_f32_16x16x32_bf16 v[40:43], a[72:75], v[200:203], v[40:43]
v_exp_f32 v61, v61
v_mfma_f32_16x16x32_bf16 v[40:43], a[76:79], v[232:235], v[40:43]
v_add_f32 v211, v211, v61
v_cvt_pk_bf16_f32 v94, v60, v61
v_mfma_f32_16x16x32_bf16 v[44:47], a[64:67], v[140:143], v[108:111]
v_exp_f32 v62, v62
v_mfma_f32_16x16x32_bf16 v[44:47], a[68:71], v[172:175], v[44:47]
ds_read_b128 a[108:111], v10 offset:27648
v_add_f32 v211, v211, v62
v_mfma_f32_16x16x32_bf16 v[44:47], a[72:75], v[204:207], v[44:47]
v_exp_f32 v63, v63
v_mfma_f32_16x16x32_bf16 v[44:47], a[76:79], v[236:239], v[44:47]
s_waitcnt lgkmcnt(6)
v_add_f32 v211, v211, v63
v_cvt_pk_bf16_f32 v95, v62, v63
v_mfma_f32_16x16x32_bf16 v[48:51], a[80:83], v[128:131], v[112:115]
v_exp_f32 v32, v32
v_mfma_f32_16x16x32_bf16 v[48:51], a[84:87], v[160:163], v[48:51]
s_waitcnt lgkmcnt(4)
ds_read_b128 a[112:115], v10 offset:28672
v_add_f32 v208, v208, v32
v_mfma_f32_16x16x32_bf16 v[48:51], a[88:91], v[192:195], v[48:51]
v_exp_f32 v33, v33
v_mfma_f32_16x16x32_bf16 v[48:51], a[92:95], v[224:227], v[48:51]
v_add_f32 v208, v208, v33
v_cvt_pk_bf16_f32 v64, v32, v33
v_mfma_f32_16x16x32_bf16 v[52:55], a[80:83], v[132:135], v[116:119]
v_exp_f32 v34, v34
v_mfma_f32_16x16x32_bf16 v[52:55], a[84:87], v[164:167], v[52:55]
ds_read_b128 a[116:119], v10 offset:29696
v_add_f32 v208, v208, v34
v_mfma_f32_16x16x32_bf16 v[52:55], a[88:91], v[196:199], v[52:55]
v_exp_f32 v35, v35
v_mfma_f32_16x16x32_bf16 v[52:55], a[92:95], v[228:231], v[52:55]
v_add_f32 v208, v208, v35
v_cvt_pk_bf16_f32 v65, v34, v35
v_mfma_f32_16x16x32_bf16 v[56:59], a[80:83], v[136:139], v[120:123]
v_exp_f32 v36, v36
v_mfma_f32_16x16x32_bf16 v[56:59], a[84:87], v[168:171], v[56:59]
ds_read_b128 a[120:123], v10 offset:30720
v_add_f32 v209, v209, v36
v_mfma_f32_16x16x32_bf16 v[56:59], a[88:91], v[200:203], v[56:59]
v_exp_f32 v37, v37
v_mfma_f32_16x16x32_bf16 v[56:59], a[92:95], v[232:235], v[56:59]
v_add_f32 v209, v209, v37
v_cvt_pk_bf16_f32 v68, v36, v37
v_mfma_f32_16x16x32_bf16 v[60:63], a[80:83], v[140:143], v[124:127]
v_exp_f32 v38, v38
v_mfma_f32_16x16x32_bf16 v[60:63], a[84:87], v[172:175], v[60:63]
ds_read_b128 a[124:127], v10 offset:31744
v_add_f32 v209, v209, v38
v_mfma_f32_16x16x32_bf16 v[60:63], a[88:91], v[204:207], v[60:63]
v_exp_f32 v39, v39
v_mfma_f32_16x16x32_bf16 v[60:63], a[92:95], v[236:239], v[60:63]
s_waitcnt lgkmcnt(6)
v_add_f32 v209, v209, v39
v_cvt_pk_bf16_f32 v69, v38, v39
v_mfma_f32_16x16x32_bf16 a[128:131], a[96:99], v[80:83], a[128:131]
s_waitcnt vmcnt(8)
s_barrier
v_exp_f32 v40, v40
v_mfma_f32_16x16x32_bf16 a[132:135], a[96:99], v[84:87], a[132:135]
ds_read_b128 a[64:67], v11 offset:0
v_add_f32 v210, v210, v40
v_mfma_f32_16x16x32_bf16 a[136:139], a[96:99], v[88:91], a[136:139]
buffer_load_dwordx4 v24, s[4:7], s60 offen offset:0 sc1  lds
v_exp_f32 v41, v41
v_mfma_f32_16x16x32_bf16 a[140:143], a[96:99], v[92:95], a[140:143]
v_add_f32 v210, v210, v41
v_cvt_pk_bf16_f32 v72, v40, v41
v_mfma_f32_16x16x32_bf16 a[144:147], a[100:103], v[80:83], a[144:147]
v_exp_f32 v42, v42
v_mfma_f32_16x16x32_bf16 a[148:151], a[100:103], v[84:87], a[148:151]
ds_read_b128 a[68:71], v11 offset:1024
v_add_f32 v210, v210, v42
v_mfma_f32_16x16x32_bf16 a[152:155], a[100:103], v[88:91], a[152:155]
v_exp_f32 v43, v43
v_mfma_f32_16x16x32_bf16 a[156:159], a[100:103], v[92:95], a[156:159]
s_waitcnt lgkmcnt(6)
v_add_f32 v210, v210, v43
v_cvt_pk_bf16_f32 v73, v42, v43
v_mfma_f32_16x16x32_bf16 a[160:163], a[104:107], v[80:83], a[160:163]
v_exp_f32 v44, v44
v_mfma_f32_16x16x32_bf16 a[164:167], a[104:107], v[84:87], a[164:167]
ds_read_b128 a[72:75], v11 offset:2048
v_add_f32 v211, v211, v44
v_mfma_f32_16x16x32_bf16 a[168:171], a[104:107], v[88:91], a[168:171]
v_exp_f32 v45, v45
v_mfma_f32_16x16x32_bf16 a[172:175], a[104:107], v[92:95], a[172:175]
v_add_f32 v211, v211, v45
v_cvt_pk_bf16_f32 v76, v44, v45
v_mfma_f32_16x16x32_bf16 a[176:179], a[108:111], v[80:83], a[176:179]
buffer_load_dwordx4 v24, s[4:7], s60 offen offset:1024 sc1  lds
v_exp_f32 v46, v46
v_mfma_f32_16x16x32_bf16 a[180:183], a[108:111], v[84:87], a[180:183]
ds_read_b128 a[76:79], v11 offset:3072
v_add_f32 v211, v211, v46
v_mfma_f32_16x16x32_bf16 a[184:187], a[108:111], v[88:91], a[184:187]
v_exp_f32 v47, v47
v_mfma_f32_16x16x32_bf16 a[188:191], a[108:111], v[92:95], a[188:191]
s_waitcnt lgkmcnt(6)
v_add_f32 v211, v211, v47
v_cvt_pk_bf16_f32 v77, v46, v47
v_mfma_f32_16x16x32_bf16 a[192:195], a[112:115], v[80:83], a[192:195]
v_exp_f32 v48, v48
v_mfma_f32_16x16x32_bf16 a[196:199], a[112:115], v[84:87], a[196:199]
ds_read_b128 a[80:83], v11 offset:4096
v_add_f32 v208, v208, v48
v_mfma_f32_16x16x32_bf16 a[200:203], a[112:115], v[88:91], a[200:203]
v_exp_f32 v49, v49
v_mfma_f32_16x16x32_bf16 a[204:207], a[112:115], v[92:95], a[204:207]
v_add_f32 v208, v208, v49
v_cvt_pk_bf16_f32 v66, v48, v49
v_mfma_f32_16x16x32_bf16 a[208:211], a[116:119], v[80:83], a[208:211]
v_exp_f32 v50, v50
v_mfma_f32_16x16x32_bf16 a[212:215], a[116:119], v[84:87], a[212:215]
ds_read_b128 a[84:87], v11 offset:5120
v_add_f32 v208, v208, v50
v_mfma_f32_16x16x32_bf16 a[216:219], a[116:119], v[88:91], a[216:219]
buffer_load_dwordx4 v24, s[4:7], s60 offen offset:2048 sc1  lds
v_exp_f32 v51, v51
v_mfma_f32_16x16x32_bf16 a[220:223], a[116:119], v[92:95], a[220:223]
s_waitcnt lgkmcnt(6)
v_add_f32 v208, v208, v51
v_cvt_pk_bf16_f32 v67, v50, v51
v_mfma_f32_16x16x32_bf16 a[224:227], a[120:123], v[80:83], a[224:227]
v_exp_f32 v52, v52
v_mfma_f32_16x16x32_bf16 a[228:231], a[120:123], v[84:87], a[228:231]
ds_read_b128 a[88:91], v11 offset:6144
v_add_f32 v209, v209, v52
v_mfma_f32_16x16x32_bf16 a[232:235], a[120:123], v[88:91], a[232:235]
v_exp_f32 v53, v53
v_mfma_f32_16x16x32_bf16 a[236:239], a[120:123], v[92:95], a[236:239]
v_add_f32 v209, v209, v53
v_cvt_pk_bf16_f32 v70, v52, v53
v_mfma_f32_16x16x32_bf16 a[240:243], a[124:127], v[80:83], a[240:243]
s_add_u32 s56, s56, 1
v_exp_f32 v54, v54
v_mfma_f32_16x16x32_bf16 a[244:247], a[124:127], v[84:87], a[244:247]
s_cmp_lg_u32 s56, s63
ds_read_b128 a[92:95], v11 offset:7168
v_add_f32 v209, v209, v54
v_mfma_f32_16x16x32_bf16 a[248:251], a[124:127], v[88:91], a[248:251]
v_exp_f32 v55, v55
v_mfma_f32_16x16x32_bf16 a[252:255], a[124:127], v[92:95], a[252:255]
s_waitcnt lgkmcnt(6)
v_add_f32 v209, v209, v55
v_cvt_pk_bf16_f32 v71, v54, v55
v_mov_b32 v10, v11
v_add_u32 v11, 0x8000, v11
v_and_b32 v11, 0x1ffff, v11
s_cbranch_scc0 L_at_disp
.p2align 5
L_at_dual:
v_mfma_f32_16x16x32_bf16 v[32:35], a[64:67], v[128:131], v[144:147]
v_exp_f32 v56, v56
v_mfma_f32_16x16x32_bf16 v[32:35], a[68:71], v[160:163], v[32:35]
s_waitcnt lgkmcnt(4)
ds_read_b128 a[96:99], v10 offset:16384
v_add_f32 v210, v210, v56
v_mfma_f32_16x16x32_bf16 v[32:35], a[72:75], v[192:195], v[32:35]
buffer_load_dwordx4 v24, s[4:7], s60 offen offset:3072 sc1  lds
v_exp_f32 v57, v57
v_mfma_f32_16x16x32_bf16 v[32:35], a[76:79], v[224:227], v[32:35]
s_add_u32 m0, m0, 16384
v_add_f32 v210, v210, v57
v_cvt_pk_bf16_f32 v74, v56, v57
v_mfma_f32_16x16x32_bf16 v[36:39], a[64:67], v[132:135], v[148:151]
v_exp_f32 v58, v58
v_mfma_f32_16x16x32_bf16 v[36:39], a[68:71], v[164:167], v[36:39]
ds_read_b128 a[100:103], v10 offset:17408
v_add_f32 v210, v210, v58
v_mfma_f32_16x16x32_bf16 v[36:39], a[72:75], v[196:199], v[36:39]
v_exp_f32 v59, v59
v_mfma_f32_16x16x32_bf16 v[36:39], a[76:79], v[228:231], v[36:39]
v_add_f32 v210, v210, v59
v_cvt_pk_bf16_f32 v75, v58, v59
v_mfma_f32_16x16x32_bf16 v[40:43], a[64:67], v[136:139], v[152:155]
v_exp_f32 v60, v60
v_mfma_f32_16x16x32_bf16 v[40:43], a[68:71], v[168:171], v[40:43]
ds_read_b128 a[104:107], v10 offset:18432
v_add_f32 v211, v211, v60
v_mfma_f32_16x16x32_bf16 v[40:43], a[72:75], v[200:203], v[40:43]
v_exp_f32 v61, v61
v_mfma_f32_16x16x32_bf16 v[40:43], a[76:79], v[232:235], v[40:43]
v_add_f32 v211, v211, v61
v_cvt_pk_bf16_f32 v78, v60, v61
v_mfma_f32_16x16x32_bf16 v[44:47], a[64:67], v[140:143], v[156:159]
buffer_load_dwordx4 v12, s[4:7], s60 offen offset:0 sc1  lds
v_exp_f32 v62, v62
v_mfma_f32_16x16x32_bf16 v[44:47], a[68:71], v[172:175], v[44:47]
ds_read_b128 a[108:111], v10 offset:19456
v_add_f32 v211, v211, v62
v_mfma_f32_16x16x32_bf16 v[44:47], a[72:75], v[204:207], v[44:47]
v_exp_f32 v63, v63
v_mfma_f32_16x16x32_bf16 v[44:47], a[76:79], v[236:239], v[44:47]
s_waitcnt lgkmcnt(6)
v_add_f32 v211, v211, v63
v_cvt_pk_bf16_f32 v79, v62, v63
v_mfma_f32_16x16x32_bf16 v[48:51], a[80:83], v[128:131], v[176:179]
v_exp_f32 v32, v32
v_mfma_f32_16x16x32_bf16 v[48:51], a[84:87], v[160:163], v[48:51]
s_waitcnt lgkmcnt(4)
ds_read_b128 a[112:115], v10 offset:20480
v_add_f32 v208, v208, v32
v_mfma_f32_16x16x32_bf16 v[48:51], a[88:91], v[192:195], v[48:51]
v_exp_f32 v33, v33
v_mfma_f32_16x16x32_bf16 v[48:51], a[92:95], v[224:227], v[48:51]
v_add_f32 v208, v208, v33
v_cvt_pk_bf16_f32 v80, v32, v33
v_mfma_f32_16x16x32_bf16 v[52:55], a[80:83], v[132:135], v[180:183]
v_exp_f32 v34, v34
v_mfma_f32_16x16x32_bf16 v[52:55], a[84:87], v[164:167], v[52:55]
ds_read_b128 a[116:119], v10 offset:21504
v_add_f32 v208, v208, v34
v_mfma_f32_16x16x32_bf16 v[52:55], a[88:91], v[196:199], v[52:55]
buffer_load_dwordx4 v12, s[4:7], s60 offen offset:1024 sc1  lds
v_exp_f32 v35, v35
v_mfma_f32_16x16x32_bf16 v[52:55], a[92:95], v[228:231], v[52:55]
v_add_f32 v208, v208, v35
v_cvt_pk_bf16_f32 v81, v34, v35
v_mfma_f32_16x16x32_bf16 v[56:59], a[80:83], v[136:139], v[184:187]
v_exp_f32 v36, v36
v_mfma_f32_16x16x32_bf16 v[56:59], a[84:87], v[168:171], v[56:59]
ds_read_b128 a[120:123], v10 offset:22528
v_add_f32 v209, v209, v36
v_mfma_f32_16x16x32_bf16 v[56:59], a[88:91], v[200:203], v[56:59]
v_exp_f32 v37, v37
v_mfma_f32_16x16x32_bf16 v[56:59], a[92:95], v[232:235], v[56:59]
v_add_f32 v209, v209, v37
v_cvt_pk_bf16_f32 v84, v36, v37
v_mfma_f32_16x16x32_bf16 v[60:63], a[80:83], v[140:143], v[188:191]
v_exp_f32 v38, v38
v_mfma_f32_16x16x32_bf16 v[60:63], a[84:87], v[172:175], v[60:63]
ds_read_b128 a[124:127], v10 offset:23552
v_add_f32 v209, v209, v38
v_mfma_f32_16x16x32_bf16 v[60:63], a[88:91], v[204:207], v[60:63]
v_exp_f32 v39, v39
v_mfma_f32_16x16x32_bf16 v[60:63], a[92:95], v[236:239], v[60:63]
s_waitcnt lgkmcnt(6)
v_add_f32 v209, v209, v39
v_cvt_pk_bf16_f32 v85, v38, v39
v_mfma_f32_16x16x32_bf16 a[128:131], a[96:99], v[64:67], a[128:131]
buffer_load_dwordx4 v12, s[4:7], s60 offen offset:2048 sc1  lds
v_exp_f32 v40, v40
v_mfma_f32_16x16x32_bf16 a[132:135], a[96:99], v[68:71], a[132:135]
ds_read_b128 a[64:67], v10 offset:8192
v_add_f32 v210, v210, v40
v_mfma_f32_16x16x32_bf16 a[136:139], a[96:99], v[72:75], a[136:139]
v_exp_f32 v41, v41
v_mfma_f32_16x16x32_bf16 a[140:143], a[96:99], v[76:79], a[140:143]
v_add_f32 v210, v210, v41
v_cvt_pk_bf16_f32 v88, v40, v41
v_mfma_f32_16x16x32_bf16 a[144:147], a[100:103], v[64:67], a[144:147]
v_exp_f32 v42, v42
v_mfma_f32_16x16x32_bf16 a[148:151], a[100:103], v[68:71], a[148:151]
ds_read_b128 a[68:71], v10 offset:9216
v_add_f32 v210, v210, v42
v_mfma_f32_16x16x32_bf16 a[152:155], a[100:103], v[72:75], a[152:155]
v_exp_f32 v43, v43
v_mfma_f32_16x16x32_bf16 a[156:159], a[100:103], v[76:79], a[156:159]
s_waitcnt lgkmcnt(6)
v_add_f32 v210, v210, v43
v_cvt_pk_bf16_f32 v89, v42, v43
v_mfma_f32_16x16x32_bf16 a[160:163], a[104:107], v[64:67], a[160:163]
v_exp_f32 v44, v44
v_mfma_f32_16x16x32_bf16 a[164:167], a[104:107], v[68:71], a[164:167]
ds_read_b128 a[72:75], v10 offset:10240
v_add_f32 v211, v211, v44
v_mfma_f32_16x16x32_bf16 a[168:171], a[104:107], v[72:75], a[168:171]
buffer_load_dwordx4 v12, s[4:7], s60 offen offset:3072 sc1  lds
v_exp_f32 v45, v45
v_mfma_f32_16x16x32_bf16 a[172:175], a[104:107], v[76:79], a[172:175]
s_add_u32 s60, s60, 16384
v_add_f32 v211, v211, v45
v_cvt_pk_bf16_f32 v92, v44, v45
v_mfma_f32_16x16x32_bf16 a[176:179], a[108:111], v[64:67], a[176:179]
s_add_u32 s62, s62, 32768
v_exp_f32 v46, v46
v_mfma_f32_16x16x32_bf16 a[180:183], a[108:111], v[68:71], a[180:183]
s_cmp_lt_u32 s60, s61
ds_read_b128 a[76:79], v10 offset:11264
v_add_f32 v211, v211, v46
v_mfma_f32_16x16x32_bf16 a[184:187], a[108:111], v[72:75], a[184:187]
s_cselect_b32 s60, s60, 2130706432
v_exp_f32 v47, v47
v_mfma_f32_16x16x32_bf16 a[188:191], a[108:111], v[76:79], a[188:191]
s_waitcnt lgkmcnt(6)
v_add_f32 v211, v211, v47
v_cvt_pk_bf16_f32 v93, v46, v47
v_mfma_f32_16x16x32_bf16 a[192:195], a[112:115], v[64:67], a[192:195]
s_and_b32 m0, s62, 0x1ffff
v_exp_f32 v48, v48
v_mfma_f32_16x16x32_bf16 a[196:199], a[112:115], v[68:71], a[196:199]
ds_read_b128 a[80:83], v10 offset:12288
v_add_f32 v208, v208, v48
v_mfma_f32_16x16x32_bf16 a[200:203], a[112:115], v[72:75], a[200:203]
v_exp_f32 v49, v49
v_mfma_f32_16x16x32_bf16 a[204:207], a[112:115], v[76:79], a[204:207]
v_add_f32 v208, v208, v49
v_cvt_pk_bf16_f32 v82, v48, v49
v_mfma_f32_16x16x32_bf16 a[208:211], a[116:119], v[64:67], a[208:211]
v_exp_f32 v50, v50
v_mfma_f32_16x16x32_bf16 a[212:215], a[116:119], v[68:71], a[212:215]
ds_read_b128 a[84:87], v10 offset:13312
v_add_f32 v208, v208, v50
v_mfma_f32_16x16x32_bf16 a[216:219], a[116:119], v[72:75], a[216:219]
v_exp_f32 v51, v51
v_mfma_f32_16x16x32_bf16 a[220:223], a[116:119], v[76:79], a[220:223]
s_waitcnt lgkmcnt(6)
v_add_f32 v208, v208, v51
v_cvt_pk_bf16_f32 v83, v50, v51
v_mfma_f32_16x16x32_bf16 a[224:227], a[120:123], v[64:67], a[224:227]
v_exp_f32 v52, v52
v_mfma_f32_16x16x32_bf16 a[228:231], a[120:123], v[68:71], a[228:231]
ds_read_b128 a[88:91], v10 offset:14336
v_add_f32 v209, v209, v52
v_mfma_f32_16x16x32_bf16 a[232:235], a[120:123], v[72:75], a[232:235]
v_exp_f32 v53, v53
v_mfma_f32_16x16x32_bf16 a[236:239], a[120:123], v[76:79], a[236:239]
v_add_f32 v209, v209, v53
v_cvt_pk_bf16_f32 v86, v52, v53
v_mfma_f32_16x16x32_bf16 a[240:243], a[124:127], v[64:67], a[240:243]
v_exp_f32 v54, v54
v_mfma_f32_16x16x32_bf16 a[244:247], a[124:127], v[68:71], a[244:247]
ds_read_b128 a[92:95], v10 offset:15360
v_add_f32 v209, v209, v54
v_mfma_f32_16x16x32_bf16 a[248:251], a[124:127], v[72:75], a[248:251]
v_exp_f32 v55, v55
v_mfma_f32_16x16x32_bf16 a[252:255], a[124:127], v[76:79], a[252:255]
s_waitcnt lgkmcnt(6)
v_add_f32 v209, v209, v55
v_cvt_pk_bf16_f32 v87, v54, v55
v_mfma_f32_16x16x32_bf16 v[32:35], a[64:67], v[128:131], v[96:99]
v_exp_f32 v56, v56
v_mfma_f32_16x16x32_bf16 v[32:35], a[68:71], v[160:163], v[32:35]
s_waitcnt lgkmcnt(4)
ds_read_b128 a[96:99], v10 offset:24576
v_add_f32 v210, v210, v56
v_mfma_f32_16x16x32_bf16 v[32:35], a[72:75], v[192:195], v[32:35]
v_exp_f32 v57, v57
v_mfma_f32_16x16x32_bf16 v[32:35], a[76:79], v[224:227], v[32:35]
v_add_f32 v210, v210, v57
v_cvt_pk_bf16_f32 v90, v56, v57
v_mfma_f32_16x16x32_bf16 v[36:39], a[64:67], v[132:135], v[100:103]
v_exp_f32 v58, v58
v_mfma_f32_16x16x32_bf16 v[36:39], a[68:71], v[164:167], v[36:39]
ds_read_b128 a[100:103], v10 offset:25600
v_add_f32 v210, v210, v58
v_mfma_f32_16x16x32_bf16 v[36:39], a[72:75], v[196:199], v[36:39]
v_exp_f32 v59, v59
v_mfma_f32_16x16x32_bf16 v[36:39], a[76:79], v[228:231], v[36:39]
v_add_f32 v210, v210, v59
v_cvt_pk_bf16_f32 v91, v58, v59
v_mfma_f32_16x16x32_bf16 v[40:43], a[64:67], v[136:139], v[104:107]
v_exp_f32 v60, v60
v_mfma_f32_16x16x32_bf16 v[40:43], a[68:71], v[168:171], v[40:43]
ds_read_b128 a[104:107], v10 offset:26624
v_add_f32 v211, v211, v60
v_mfma_f32_16x16x32_bf16 v[40:43], a[72:75], v[200:203], v[40:43]
v_exp_f32 v61, v61
v_mfma_f32_16x16x32_bf16 v[40:43], a[76:79], v[232:235], v[40:43]
v_add_f32 v211, v211, v61
v_cvt_pk_bf16_f32 v94, v60, v61
v_mfma_f32_16x16x32_bf16 v[44:47], a[64:67], v[140:143], v[108:111]
v_exp_f32 v62, v62
v_mfma_f32_16x16x32_bf16 v[44:47], a[68:71], v[172:175], v[44:47]
ds_read_b128 a[108:111], v10 offset:27648
v_add_f32 v211, v211, v62
v_mfma_f32_16x16x32_bf16 v[44:47], a[72:75], v[204:207], v[44:47]
v_exp_f32 v63, v63
v_mfma_f32_16x16x32_bf16 v[44:47], a[76:79], v[236:239], v[44:47]
s_waitcnt lgkmcnt(6)
v_add_f32 v211, v211, v63
v_cvt_pk_bf16_f32 v95, v62, v63
v_mfma_f32_16x16x32_bf16 v[48:51], a[80:83], v[128:131], v[112:115]
v_exp_f32 v32, v32
v_mfma_f32_16x16x32_bf16 v[48:51], a[84:87], v[160:163], v[48:51]
s_waitcnt lgkmcnt(4)
ds_read_b128 a[112:115], v10 offset:28672
v_add_f32 v208, v208, v32
v_mfma_f32_16x16x32_bf16 v[48:51], a[88:91], v[192:195], v[48:51]
v_exp_f32 v33, v33
v_mfma_f32_16x16x32_bf16 v[48:51], a[92:95], v[224:227], v[48:51]
v_add_f32 v208, v208, v33
v_cvt_pk_bf16_f32 v64, v32, v33
v_mfma_f32_16x16x32_bf16 v[52:55], a[80:83], v[132:135], v[116:119]
v_exp_f32 v34, v34
v_mfma_f32_16x16x32_bf16 v[52:55], a[84:87], v[164:167], v[52:55]
ds_read_b128 a[116:119], v10 offset:29696
v_add_f32 v208, v208, v34
v_mfma_f32_16x16x32_bf16 v[52:55], a[88:91], v[196:199], v[52:55]
v_exp_f32 v35, v35
v_mfma_f32_16x16x32_bf16 v[52:55], a[92:95], v[228:231], v[52:55]
v_add_f32 v208, v208, v35
v_cvt_pk_bf16_f32 v65, v34, v35
v_mfma_f32_16x16x32_bf16 v[56:59], a[80:83], v[136:139], v[120:123]
v_exp_f32 v36, v36
v_mfma_f32_16x16x32_bf16 v[56:59], a[84:87], v[168:171], v[56:59]
ds_read_b128 a[120:123], v10 offset:30720
v_add_f32 v209, v209, v36
v_mfma_f32_16x16x32_bf16 v[56:59], a[88:91], v[200:203], v[56:59]
v_exp_f32 v37, v37
v_mfma_f32_16x16x32_bf16 v[56:59], a[92:95], v[232:235], v[56:59]
v_add_f32 v209, v209, v37
v_cvt_pk_bf16_f32 v68, v36, v37
v_mfma_f32_16x16x32_bf16 v[60:63], a[80:83], v[140:143], v[124:127]
v_exp_f32 v38, v38
v_mfma_f32_16x16x32_bf16 v[60:63], a[84:87], v[172:175], v[60:63]
ds_read_b128 a[124:127], v10 offset:31744
v_add_f32 v209, v209, v38
v_mfma_f32_16x16x32_bf16 v[60:63], a[88:91], v[204:207], v[60:63]
v_exp_f32 v39, v39
v_mfma_f32_16x16x32_bf16 v[60:63], a[92:95], v[236:239], v[60:63]
s_waitcnt lgkmcnt(6)
v_add_f32 v209, v209, v39
v_cvt_pk_bf16_f32 v69, v38, v39
v_mfma_f32_16x16x32_bf16 a[128:131], a[96:99], v[80:83], a[128:131]
s_waitcnt vmcnt(8)
s_barrier
v_exp_f32 v40, v40
v_mfma_f32_16x16x32_bf16 a[132:135], a[96:99], v[84:87], a[132:135]
ds_read_b128 a[64:67], v11 offset:0
v_add_f32 v210, v210, v40
v_mfma_f32_16x16x32_bf16 a[136:139], a[96:99], v[88:91], a[136:139]
buffer_load_dwordx4 v24, s[4:7], s60 offen offset:0 sc1  lds
v_exp_f32 v41, v41
v_mfma_f32_16x16x32_bf16 a[140:143], a[96:99], v[92:95], a[140:143]
v_add_f32 v210, v210, v41
v_cvt_pk_bf16_f32 v72, v40, v41
v_mfma_f32_16x16x32_bf16 a[144:147], a[100:103], v[80:83], a[144:147]
v_exp_f32 v42, v42
v_mfma_f32_16x16x32_bf16 a[148:151], a[100:103], v[84:87], a[148:151]
ds_read_b128 a[68:71], v11 offset:1024
v_add_f32 v210, v210, v42
v_mfma_f32_16x16x32_bf16 a[152:155], a[100:103], v[88:91], a[152:155]
v_exp_f32 v43, v43
v_mfma_f32_16x16x32_bf16 a[156:159], a[100:103], v[92:95], a[156:159]
s_waitcnt lgkmcnt(6)
v_add_f32 v210, v210, v43
v_cvt_pk_bf16_f32 v73, v42, v43
v_mfma_f32_16x16x32_bf16 a[160:163], a[104:107], v[80:83], a[160:163]
v_exp_f32 v44, v44
v_mfma_f32_16x16x32_bf16 a[164:167], a[104:107], v[84:87], a[164:167]
ds_read_b128 a[72:75], v11 offset:2048
v_add_f32 v211, v211, v44
v_mfma_f32_16x16x32_bf16 a[168:171], a[104:107], v[88:91], a[168:171]
v_exp_f32 v45, v45
v_mfma_f32_16x16x32_bf16 a[172:175], a[104:107], v[92:95], a[172:175]
v_add_f32 v211, v211, v45
v_cvt_pk_bf16_f32 v76, v44, v45
v_mfma_f32_16x16x32_bf16 a[176:179], a[108:111], v[80:83], a[176:179]
buffer_load_dwordx4 v24, s[4:7], s60 offen offset:1024 sc1  lds
v_exp_f32 v46, v46
v_mfma_f32_16x16x32_bf16 a[180:183], a[108:111], v[84:87], a[180:183]
ds_read_b128 a[76:79], v11 offset:3072
v_add_f32 v211, v211, v46
v_mfma_f32_16x16x32_bf16 a[184:187], a[108:111], v[88:91], a[184:187]
v_exp_f32 v47, v47
v_mfma_f32_16x16x32_bf16 a[188:191], a[108:111], v[92:95], a[188:191]
s_waitcnt lgkmcnt(6)
v_add_f32 v211, v211, v47
v_cvt_pk_bf16_f32 v77, v46, v47
v_mfma_f32_16x16x32_bf16 a[192:195], a[112:115], v[80:83], a[192:195]
v_exp_f32 v48, v48
v_mfma_f32_16x16x32_bf16 a[196:199], a[112:115], v[84:87], a[196:199]
ds_read_b128 a[80:83], v11 offset:4096
v_add_f32 v208, v208, v48
v_mfma_f32_16x16x32_bf16 a[200:203], a[112:115], v[88:91], a[200:203]
v_exp_f32 v49, v49
v_mfma_f32_16x16x32_bf16 a[204:207], a[112:115], v[92:95], a[204:207]
v_add_f32 v208, v208, v49
v_cvt_pk_bf16_f32 v66, v48, v49
v_mfma_f32_16x16x32_bf16 a[208:211], a[116:119], v[80:83], a[208:211]
v_exp_f32 v50, v50
v_mfma_f32_16x16x32_bf16 a[212:215], a[116:119], v[84:87], a[212:215]
ds_read_b128 a[84:87], v11 offset:5120
v_add_f32 v208, v208, v50
v_mfma_f32_16x16x32_bf16 a[216:219], a[116:119], v[88:91], a[216:219]
buffer_load_dwordx4 v24, s[4:7], s60 offen offset:2048 sc1  lds
v_exp_f32 v51, v51
v_mfma_f32_16x16x32_bf16 a[220:223], a[116:119], v[92:95], a[220:223]
s_waitcnt lgkmcnt(6)
v_add_f32 v208, v208, v51
v_cvt_pk_bf16_f32 v67, v50, v51
v_mfma_f32_16x16x32_bf16 a[224:227], a[120:123], v[80:83], a[224:227]
v_exp_f32 v52, v52
v_mfma_f32_16x16x32_bf16 a[228:231], a[120:123], v[84:87], a[228:231]
ds_read_b128 a[88:91], v11 offset:6144
v_add_f32 v209, v209, v52
v_mfma_f32_16x16x32_bf16 a[232:235], a[120:123], v[88:91], a[232:235]
v_exp_f32 v53, v53
v_mfma_f32_16x16x32_bf16 a[236:239], a[120:123], v[92:95], a[236:239]
v_add_f32 v209, v209, v53
v_cvt_pk_bf16_f32 v70, v52, v53
v_mfma_f32_16x16x32_bf16 a[240:243], a[124:127], v[80:83], a[240:243]
s_add_u32 s56, s56, 1
v_exp_f32 v54, v54
v_mfma_f32_16x16x32_bf16 a[244:247], a[124:127], v[84:87], a[244:247]
s_cmp_lg_u32 s56, s63
ds_read_b128 a[92:95], v11 offset:7168
v_add_f32 v209, v209, v54
v_mfma_f32_16x16x32_bf16 a[248:251], a[124:127], v[88:91], a[248:251]
v_exp_f32 v55, v55
v_mfma_f32_16x16x32_bf16 a[252:255], a[124:127], v[92:95], a[252:255]
s_waitcnt lgkmcnt(6)
v_add_f32 v209, v209, v55
v_cvt_pk_bf16_f32 v71, v54, v55
v_mov_b32 v10, v11
v_add_u32 v11, 0x8000, v11
v_and_b32 v11, 0x1ffff, v11
s_cbranch_scc1 L_at_dual
s_branch L_at_disp
L_at_mx:
s_bitcmp1_b32 s50, 0
s_cbranch_scc0 L_at_m0
v_cndmask_b32 v144, v212, v220, s[68:69]
v_cndmask_b32 v180, v213, v220, s[68:69]
v_cndmask_b32 v145, v212, v220, s[70:71]
v_cndmask_b32 v181, v213, v220, s[70:71]
v_cndmask_b32 v146, v212, v220, s[72:73]
v_cndmask_b32 v182, v213, v220, s[72:73]
v_cndmask_b32 v147, v212, v220, s[74:75]
v_cndmask_b32 v183, v213, v220, s[74:75]
v_pk_mov_b32 v[176:177], v[220:221], v[220:221]
v_pk_mov_b32 v[178:179], v[220:221], v[220:221]
v_mfma_f32_16x16x32_bf16 v[40:43], a[64:67], v[136:139], v[152:155]
v_exp_f32 v56, v56
v_mfma_f32_16x16x32_bf16 v[40:43], a[68:71], v[168:171], v[40:43]
s_waitcnt lgkmcnt(4)
ds_read_b128 a[96:99], v10 offset:16384
v_add_f32 v210, v210, v56
v_mfma_f32_16x16x32_bf16 v[40:43], a[72:75], v[200:203], v[40:43]
buffer_load_dwordx4 v24, s[4:7], s60 offen offset:3072 sc1  lds
v_exp_f32 v57, v57
v_mfma_f32_16x16x32_bf16 v[40:43], a[76:79], v[232:235], v[40:43]
s_add_u32 m0, m0, 16384
v_add_f32 v210, v210, v57
v_cvt_pk_bf16_f32 v74, v56, v57
v_mfma_f32_16x16x32_bf16 v[44:47], a[64:67], v[140:143], v[156:159]
v_exp_f32 v58, v58
v_mfma_f32_16x16x32_bf16 v[44:47], a[68:71], v[172:175], v[44:47]
ds_read_b128 a[100:103], v10 offset:17408
v_add_f32 v210, v210, v58
v_mfma_f32_16x16x32_bf16 v[44:47], a[72:75], v[204:207], v[44:47]
v_exp_f32 v59, v59
v_mfma_f32_16x16x32_bf16 v[44:47], a[76:79], v[236:239], v[44:47]
v_add_f32 v210, v210, v59
v_cvt_pk_bf16_f32 v75, v58, v59
v_mfma_f32_16x16x32_bf16 v[32:35], a[64:67], v[128:131], v[144:147]
v_exp_f32 v60, v60
v_mfma_f32_16x16x32_bf16 v[32:35], a[68:71], v[160:163], v[32:35]
ds_read_b128 a[104:107], v10 offset:18432
v_add_f32 v211, v211, v60
v_mfma_f32_16x16x32_bf16 v[32:35], a[72:75], v[192:195], v[32:35]
buffer_load_dwordx4 v12, s[4:7], s60 offen offset:0 sc1  lds
v_exp_f32 v61, v61
v_mfma_f32_16x16x32_bf16 v[32:35], a[76:79], v[224:227], v[32:35]
v_add_f32 v211, v211, v61
v_cvt_pk_bf16_f32 v78, v60, v61
v_mfma_f32_16x16x32_bf16 v[36:39], a[64:67], v[132:135], v[148:151]
v_exp_f32 v62, v62
v_mfma_f32_16x16x32_bf16 v[36:39], a[68:71], v[164:167], v[36:39]
ds_read_b128 a[108:111], v10 offset:19456
v_add_f32 v211, v211, v62
v_mfma_f32_16x16x32_bf16 v[36:39], a[72:75], v[196:199], v[36:39]
v_exp_f32 v63, v63
v_mfma_f32_16x16x32_bf16 v[36:39], a[76:79], v[228:231], v[36:39]
s_waitcnt lgkmcnt(6)
v_add_f32 v211, v211, v63
v_cvt_pk_bf16_f32 v79, v62, v63
v_mfma_f32_16x16x32_bf16 v[56:59], a[80:83], v[136:139], v[184:187]
v_exp_f32 v40, v40
v_mfma_f32_16x16x32_bf16 v[56:59], a[84:87], v[168:171], v[56:59]
s_waitcnt lgkmcnt(4)
ds_read_b128 a[112:115], v10 offset:20480
v_add_f32 v210, v210, v40
v_mfma_f32_16x16x32_bf16 v[56:59], a[88:91], v[200:203], v[56:59]
buffer_load_dwordx4 v12, s[4:7], s60 offen offset:1024 sc1  lds
v_exp_f32 v41, v41
v_mfma_f32_16x16x32_bf16 v[56:59], a[92:95], v[232:235], v[56:59]
v_add_f32 v210, v210, v41
v_cvt_pk_bf16_f32 v88, v40, v41
v_mfma_f32_16x16x32_bf16 v[60:63], a[80:83], v[140:143], v[188:191]
v_exp_f32 v42, v42
v_mfma_f32_16x16x32_bf16 v[60:63], a[84:87], v[172:175], v[60:63]
ds_read_b128 a[116:119], v10 offset:21504
v_add_f32 v210, v210, v42
v_mfma_f32_16x16x32_bf16 v[60:63], a[88:91], v[204:207], v[60:63]
v_exp_f32 v43, v43
v_mfma_f32_16x16x32_bf16 v[60:63], a[92:95], v[236:239], v[60:63]
v_add_f32 v210, v210, v43
v_cvt_pk_bf16_f32 v89, v42, v43
v_mfma_f32_16x16x32_bf16 v[48:51], a[80:83], v[128:131], v[176:179]
v_exp_f32 v44, v44
v_mfma_f32_16x16x32_bf16 v[48:51], a[84:87], v[160:163], v[48:51]
ds_read_b128 a[120:123], v10 offset:22528
v_add_f32 v211, v211, v44
v_mfma_f32_16x16x32_bf16 v[48:51], a[88:91], v[192:195], v[48:51]
buffer_load_dwordx4 v12, s[4:7], s60 offen offset:2048 sc1  lds
v_exp_f32 v45, v45
v_mfma_f32_16x16x32_bf16 v[48:51], a[92:95], v[224:227], v[48:51]
v_add_f32 v211, v211, v45
v_cvt_pk_bf16_f32 v92, v44, v45
v_mfma_f32_16x16x32_bf16 v[52:55], a[80:83], v[132:135], v[180:183]
v_exp_f32 v46, v46
v_mfma_f32_16x16x32_bf16 v[52:55], a[84:87], v[164:167], v[52:55]
ds_read_b128 a[124:127], v10 offset:23552
v_add_f32 v211, v211, v46
v_mfma_f32_16x16x32_bf16 v[52:55], a[88:91], v[196:199], v[52:55]
v_exp_f32 v47, v47
v_mfma_f32_16x16x32_bf16 v[52:55], a[92:95], v[228:231], v[52:55]
s_waitcnt lgkmcnt(6)
v_add_f32 v211, v211, v47
v_cvt_pk_bf16_f32 v93, v46, v47
v_mfma_f32_16x16x32_bf16 a[136:139], a[96:99], v[72:75], a[136:139]
v_exp_f32 v32, v32
v_mfma_f32_16x16x32_bf16 a[140:143], a[96:99], v[76:79], a[140:143]
ds_read_b128 a[64:67], v10 offset:8192
v_add_f32 v208, v208, v32
v_mfma_f32_16x16x32_bf16 a[128:131], a[96:99], v[64:67], a[128:131]
buffer_load_dwordx4 v12, s[4:7], s60 offen offset:3072 sc1  lds
v_exp_f32 v33, v33
v_mfma_f32_16x16x32_bf16 a[132:135], a[96:99], v[68:71], a[132:135]
s_add_u32 s60, s60, 16384
v_add_f32 v208, v208, v33
v_cvt_pk_bf16_f32 v80, v32, v33
v_mfma_f32_16x16x32_bf16 a[152:155], a[100:103], v[72:75], a[152:155]
s_add_u32 s62, s62, 32768
v_exp_f32 v34, v34
v_mfma_f32_16x16x32_bf16 a[156:159], a[100:103], v[76:79], a[156:159]
s_cmp_lt_u32 s60, s61
ds_read_b128 a[68:71], v10 offset:9216
v_add_f32 v208, v208, v34
v_mfma_f32_16x16x32_bf16 a[144:147], a[100:103], v[64:67], a[144:147]
s_cselect_b32 s60, s60, 2130706432
v_exp_f32 v35, v35
v_mfma_f32_16x16x32_bf16 a[148:151], a[100:103], v[68:71], a[148:151]
s_waitcnt lgkmcnt(6)
v_add_f32 v208, v208, v35
v_cvt_pk_bf16_f32 v81, v34, v35
v_mfma_f32_16x16x32_bf16 a[168:171], a[104:107], v[72:75], a[168:171]
s_and_b32 m0, s62, 0x1ffff
v_exp_f32 v36, v36
v_mfma_f32_16x16x32_bf16 a[172:175], a[104:107], v[76:79], a[172:175]
s_add_u32 s56, s56, 1
ds_read_b128 a[72:75], v10 offset:10240
v_add_f32 v209, v209, v36
v_mfma_f32_16x16x32_bf16 a[160:163], a[104:107], v[64:67], a[160:163]
v_exp_f32 v37, v37
v_mfma_f32_16x16x32_bf16 a[164:167], a[104:107], v[68:71], a[164:167]
v_add_f32 v209, v209, v37
v_cvt_pk_bf16_f32 v84, v36, v37
v_mfma_f32_16x16x32_bf16 a[184:187], a[108:111], v[72:75], a[184:187]
v_exp_f32 v38, v38
v_mfma_f32_16x16x32_bf16 a[188:191], a[108:111], v[76:79], a[188:191]
ds_read_b128 a[76:79], v10 offset:11264
v_add_f32 v209, v209, v38
v_mfma_f32_16x16x32_bf16 a[176:179], a[108:111], v[64:67], a[176:179]
v_exp_f32 v39, v39
v_mfma_f32_16x16x32_bf16 a[180:183], a[108:111], v[68:71], a[180:183]
s_waitcnt lgkmcnt(6)
v_add_f32 v209, v209, v39
v_cvt_pk_bf16_f32 v85, v38, v39
v_mfma_f32_16x16x32_bf16 a[200:203], a[112:115], v[72:75], a[200:203]
v_exp_f32 v56, v56
v_mfma_f32_16x16x32_bf16 a[204:207], a[112:115], v[76:79], a[204:207]
ds_read_b128 a[80:83], v10 offset:12288
v_add_f32 v210, v210, v56
v_mfma_f32_16x16x32_bf16 a[192:195], a[112:115], v[64:67], a[192:195]
v_exp_f32 v57, v57
v_mfma_f32_16x16x32_bf16 a[196:199], a[112:115], v[68:71], a[196:199]
v_add_f32 v210, v210, v57
v_cvt_pk_bf16_f32 v90, v56, v57
v_mfma_f32_16x16x32_bf16 a[216:219], a[116:119], v[72:75], a[216:219]
v_exp_f32 v58, v58
v_mfma_f32_16x16x32_bf16 a[220:223], a[116:119], v[76:79], a[220:223]
ds_read_b128 a[84:87], v10 offset:13312
v_add_f32 v210, v210, v58
v_mfma_f32_16x16x32_bf16 a[208:211], a[116:119], v[64:67], a[208:211]
v_exp_f32 v59, v59
v_mfma_f32_16x16x32_bf16 a[212:215], a[116:119], v[68:71], a[212:215]
s_waitcnt lgkmcnt(6)
v_add_f32 v210, v210, v59
v_cvt_pk_bf16_f32 v91, v58, v59
v_mfma_f32_16x16x32_bf16 a[232:235], a[120:123], v[72:75], a[232:235]
v_exp_f32 v60, v60
v_mfma_f32_16x16x32_bf16 a[236:239], a[120:123], v[76:79], a[236:239]
ds_read_b128 a[88:91], v10 offset:14336
v_add_f32 v211, v211, v60
v_mfma_f32_16x16x32_bf16 a[224:227], a[120:123], v[64:67], a[224:227]
v_exp_f32 v61, v61
v_mfma_f32_16x16x32_bf16 a[228:231], a[120:123], v[68:71], a[228:231]
v_add_f32 v211, v211, v61
v_cvt_pk_bf16_f32 v94, v60, v61
v_mfma_f32_16x16x32_bf16 a[248:251], a[124:127], v[72:75], a[248:251]
v_exp_f32 v62, v62
v_mfma_f32_16x16x32_bf16 a[252:255], a[124:127], v[76:79], a[252:255]
ds_read_b128 a[92:95], v10 offset:15360
v_add_f32 v211, v211, v62
v_mfma_f32_16x16x32_bf16 a[240:243], a[124:127], v[64:67], a[240:243]
v_exp_f32 v63, v63
v_mfma_f32_16x16x32_bf16 a[244:247], a[124:127], v[68:71], a[244:247]
s_waitcnt lgkmcnt(6)
v_add_f32 v211, v211, v63
v_cvt_pk_bf16_f32 v95, v62, v63
v_mfma_f32_16x16x32_bf16 v[40:43], a[64:67], v[136:139], v[104:107]
v_exp_f32 v48, v48
v_mfma_f32_16x16x32_bf16 v[40:43], a[68:71], v[168:171], v[40:43]
s_waitcnt lgkmcnt(4)
ds_read_b128 a[96:99], v10 offset:24576
v_add_f32 v208, v208, v48
v_mfma_f32_16x16x32_bf16 v[40:43], a[72:75], v[200:203], v[40:43]
v_exp_f32 v49, v49
v_mfma_f32_16x16x32_bf16 v[40:43], a[76:79], v[232:235], v[40:43]
ds_read_b128 a[100:103], v10 offset:25600
v_add_f32 v208, v208, v49
v_cvt_pk_bf16_f32 v82, v48, v49
v_mfma_f32_16x16x32_bf16 v[44:47], a[64:67], v[140:143], v[108:111]
v_exp_f32 v50, v50
v_mfma_f32_16x16x32_bf16 v[44:47], a[68:71], v[172:175], v[44:47]
ds_read_b128 a[104:107], v10 offset:26624
v_add_f32 v208, v208, v50
v_mfma_f32_16x16x32_bf16 v[44:47], a[72:75], v[204:207], v[44:47]
v_exp_f32 v51, v51
v_mfma_f32_16x16x32_bf16 v[44:47], a[76:79], v[236:239], v[44:47]
s_waitcnt lgkmcnt(5)
ds_read_b128 a[108:111], v10 offset:27648
v_add_f32 v208, v208, v51
v_cvt_pk_bf16_f32 v83, v50, v51
v_mfma_f32_16x16x32_bf16 v[56:59], a[80:83], v[136:139], v[120:123]
v_exp_f32 v52, v52
v_mfma_f32_16x16x32_bf16 v[56:59], a[84:87], v[168:171], v[56:59]
s_waitcnt lgkmcnt(4)
ds_read_b128 a[112:115], v10 offset:28672
v_add_f32 v209, v209, v52
v_mfma_f32_16x16x32_bf16 v[56:59], a[88:91], v[200:203], v[56:59]
v_exp_f32 v53, v53
v_mfma_f32_16x16x32_bf16 v[56:59], a[92:95], v[232:235], v[56:59]
ds_read_b128 a[116:119], v10 offset:29696
v_add_f32 v209, v209, v53
v_cvt_pk_bf16_f32 v86, v52, v53
v_mfma_f32_16x16x32_bf16 v[60:63], a[80:83], v[140:143], v[124:127]
v_exp_f32 v54, v54
v_mfma_f32_16x16x32_bf16 v[60:63], a[84:87], v[172:175], v[60:63]
ds_read_b128 a[120:123], v10 offset:30720
v_add_f32 v209, v209, v54
v_mfma_f32_16x16x32_bf16 v[60:63], a[88:91], v[204:207], v[60:63]
v_exp_f32 v55, v55
v_mfma_f32_16x16x32_bf16 v[60:63], a[92:95], v[236:239], v[60:63]
s_waitcnt lgkmcnt(5)
ds_read_b128 a[124:127], v10 offset:31744
v_add_f32 v209, v209, v55
v_cvt_pk_bf16_f32 v87, v54, v55
v_mfma_f32_16x16x32_bf16 a[136:139], a[96:99], v[88:91], a[136:139]
s_waitcnt vmcnt(8)
s_barrier
v_exp_f32 v40, v40
v_mfma_f32_16x16x32_bf16 a[140:143], a[96:99], v[92:95], a[140:143]
ds_read_b128 a[64:67], v11 offset:0
v_add_f32 v210, v210, v40
v_mfma_f32_16x16x32_bf16 a[128:131], a[96:99], v[80:83], a[128:131]
buffer_load_dwordx4 v24, s[4:7], s60 offen offset:0 sc1  lds
v_exp_f32 v41, v41
v_mfma_f32_16x16x32_bf16 a[132:135], a[96:99], v[84:87], a[132:135]
v_add_f32 v210, v210, v41
v_cvt_pk_bf16_f32 v72, v40, v41
v_mfma_f32_16x16x32_bf16 a[152:155], a[100:103], v[88:91], a[152:155]
v_exp_f32 v42, v42
v_mfma_f32_16x16x32_bf16 a[156:159], a[100:103], v[92:95], a[156:159]
ds_read_b128 a[68:71], v11 offset:1024
v_add_f32 v210, v210, v42
v_mfma_f32_16x16x32_bf16 a[144:147], a[100:103], v[80:83], a[144:147]
v_exp_f32 v43, v43
v_mfma_f32_16x16x32_bf16 a[148:151], a[100:103], v[84:87], a[148:151]
s_waitcnt lgkmcnt(6)
v_add_f32 v210, v210, v43
v_cvt_pk_bf16_f32 v73, v42, v43
v_mfma_f32_16x16x32_bf16 a[168:171], a[104:107], v[88:91], a[168:171]
v_exp_f32 v44, v44
v_mfma_f32_16x16x32_bf16 a[172:175], a[104:107], v[92:95], a[172:175]
ds_read_b128 a[72:75], v11 offset:2048
v_add_f32 v211, v211, v44
v_mfma_f32_16x16x32_bf16 a[160:163], a[104:107], v[80:83], a[160:163]
buffer_load_dwordx4 v24, s[4:7], s60 offen offset:1024 sc1  lds
v_exp_f32 v45, v45
v_mfma_f32_16x16x32_bf16 a[164:167], a[104:107], v[84:87], a[164:167]
v_add_f32 v211, v211, v45
v_cvt_pk_bf16_f32 v76, v44, v45
v_mfma_f32_16x16x32_bf16 a[184:187], a[108:111], v[88:91], a[184:187]
v_exp_f32 v46, v46
v_mfma_f32_16x16x32_bf16 a[188:191], a[108:111], v[92:95], a[188:191]
ds_read_b128 a[76:79], v11 offset:3072
v_add_f32 v211, v211, v46
v_mfma_f32_16x16x32_bf16 a[176:179], a[108:111], v[80:83], a[176:179]
v_exp_f32 v47, v47
v_mfma_f32_16x16x32_bf16 a[180:183], a[108:111], v[84:87], a[180:183]
s_waitcnt lgkmcnt(6)
v_add_f32 v211, v211, v47
v_cvt_pk_bf16_f32 v77, v46, v47
v_mfma_f32_16x16x32_bf16 a[200:203], a[112:115], v[88:91], a[200:203]
v_exp_f32 v56, v56
v_mfma_f32_16x16x32_bf16 a[204:207], a[112:115], v[92:95], a[204:207]
ds_read_b128 a[80:83], v11 offset:4096
v_add_f32 v210, v210, v56
v_mfma_f32_16x16x32_bf16 a[192:195], a[112:115], v[80:83], a[192:195]
buffer_load_dwordx4 v24, s[4:7], s60 offen offset:2048 sc1  lds
v_exp_f32 v57, v57
v_mfma_f32_16x16x32_bf16 a[196:199], a[112:115], v[84:87], a[196:199]
v_add_f32 v210, v210, v57
v_cvt_pk_bf16_f32 v74, v56, v57
v_mfma_f32_16x16x32_bf16 a[216:219], a[116:119], v[88:91], a[216:219]
v_exp_f32 v58, v58
v_mfma_f32_16x16x32_bf16 a[220:223], a[116:119], v[92:95], a[220:223]
ds_read_b128 a[84:87], v11 offset:5120
v_add_f32 v210, v210, v58
v_mfma_f32_16x16x32_bf16 a[208:211], a[116:119], v[80:83], a[208:211]
v_exp_f32 v59, v59
v_mfma_f32_16x16x32_bf16 a[212:215], a[116:119], v[84:87], a[212:215]
s_waitcnt lgkmcnt(6)
v_add_f32 v210, v210, v59
v_cvt_pk_bf16_f32 v75, v58, v59
v_mfma_f32_16x16x32_bf16 a[232:235], a[120:123], v[88:91], a[232:235]
v_mfma_f32_16x16x32_bf16 a[236:239], a[120:123], v[92:95], a[236:239]
ds_read_b128 a[88:91], v11 offset:6144
v_mfma_f32_16x16x32_bf16 a[224:227], a[120:123], v[80:83], a[224:227]
v_mfma_f32_16x16x32_bf16 a[228:231], a[120:123], v[84:87], a[228:231]
v_mfma_f32_16x16x32_bf16 a[248:251], a[124:127], v[88:91], a[248:251]
v_mfma_f32_16x16x32_bf16 a[252:255], a[124:127], v[92:95], a[252:255]
ds_read_b128 a[92:95], v11 offset:7168
v_mfma_f32_16x16x32_bf16 a[240:243], a[124:127], v[80:83], a[240:243]
v_mfma_f32_16x16x32_bf16 a[244:247], a[124:127], v[84:87], a[244:247]
s_waitcnt lgkmcnt(6)
v_mov_b32 v10, v11
v_add_u32 v11, 0x8000, v11
v_and_b32 v11, 0x1ffff, v11
s_branch L_at_disp
L_at_m0:
v_exp_f32 v56, v56
v_exp_f32 v57, v57
v_exp_f32 v58, v58
v_exp_f32 v59, v59
v_add_f32 v210, v210, v56
v_add_f32 v210, v210, v57
v_cvt_pk_bf16_f32 v74, v56, v57
v_add_f32 v210, v210, v58
v_add_f32 v210, v210, v59
v_cvt_pk_bf16_f32 v75, v58, v59
v_mfma_f32_16x16x32_bf16 v[40:43], a[64:67], v[136:139], v[152:155]
v_exp_f32 v60, v60
v_mfma_f32_16x16x32_bf16 v[40:43], a[68:71], v[168:171], v[40:43]
s_waitcnt lgkmcnt(4)
ds_read_b128 a[96:99], v10 offset:16384
v_add_f32 v211, v211, v60
v_mfma_f32_16x16x32_bf16 v[40:43], a[72:75], v[200:203], v[40:43]
buffer_load_dwordx4 v24, s[4:7], s60 offen offset:3072 sc1  lds
v_exp_f32 v61, v61
v_mfma_f32_16x16x32_bf16 v[40:43], a[76:79], v[232:235], v[40:43]
s_add_u32 m0, m0, 16384
ds_read_b128 a[100:103], v10 offset:17408
v_add_f32 v211, v211, v61
v_cvt_pk_bf16_f32 v78, v60, v61
v_mfma_f32_16x16x32_bf16 v[44:47], a[64:67], v[140:143], v[156:159]
v_exp_f32 v62, v62
v_mfma_f32_16x16x32_bf16 v[44:47], a[68:71], v[172:175], v[44:47]
ds_read_b128 a[104:107], v10 offset:18432
v_add_f32 v211, v211, v62
v_mfma_f32_16x16x32_bf16 v[44:47], a[72:75], v[204:207], v[44:47]
v_exp_f32 v63, v63
v_mfma_f32_16x16x32_bf16 v[44:47], a[76:79], v[236:239], v[44:47]
s_waitcnt lgkmcnt(5)
ds_read_b128 a[108:111], v10 offset:19456
v_add_f32 v211, v211, v63
v_cvt_pk_bf16_f32 v79, v62, v63
v_mfma_f32_16x16x32_bf16 v[56:59], a[80:83], v[136:139], v[184:187]
v_exp_f32 v40, v40
v_mfma_f32_16x16x32_bf16 v[56:59], a[84:87], v[168:171], v[56:59]
s_waitcnt lgkmcnt(4)
ds_read_b128 a[112:115], v10 offset:20480
v_add_f32 v210, v210, v40
v_mfma_f32_16x16x32_bf16 v[56:59], a[88:91], v[200:203], v[56:59]
buffer_load_dwordx4 v12, s[4:7], s60 offen offset:0 sc1  lds
v_exp_f32 v41, v41
v_mfma_f32_16x16x32_bf16 v[56:59], a[92:95], v[232:235], v[56:59]
ds_read_b128 a[116:119], v10 offset:21504
v_add_f32 v210, v210, v41
v_cvt_pk_bf16_f32 v88, v40, v41
v_mfma_f32_16x16x32_bf16 v[60:63], a[80:83], v[140:143], v[188:191]
v_exp_f32 v42, v42
v_mfma_f32_16x16x32_bf16 v[60:63], a[84:87], v[172:175], v[60:63]
ds_read_b128 a[120:123], v10 offset:22528
v_add_f32 v210, v210, v42
v_mfma_f32_16x16x32_bf16 v[60:63], a[88:91], v[204:207], v[60:63]
v_exp_f32 v43, v43
v_mfma_f32_16x16x32_bf16 v[60:63], a[92:95], v[236:239], v[60:63]
s_waitcnt lgkmcnt(5)
ds_read_b128 a[124:127], v10 offset:23552
v_add_f32 v210, v210, v43
v_cvt_pk_bf16_f32 v89, v42, v43
v_mfma_f32_16x16x32_bf16 a[136:139], a[96:99], v[72:75], a[136:139]
v_exp_f32 v44, v44
v_mfma_f32_16x16x32_bf16 a[140:143], a[96:99], v[76:79], a[140:143]
ds_read_b128 a[64:67], v10 offset:8192
v_add_f32 v211, v211, v44
v_mfma_f32_16x16x32_bf16 a[128:131], a[96:99], v[64:67], a[128:131]
buffer_load_dwordx4 v12, s[4:7], s60 offen offset:1024 sc1  lds
v_exp_f32 v45, v45
v_mfma_f32_16x16x32_bf16 a[132:135], a[96:99], v[68:71], a[132:135]
v_add_f32 v211, v211, v45
v_cvt_pk_bf16_f32 v92, v44, v45
v_mfma_f32_16x16x32_bf16 a[152:155], a[100:103], v[72:75], a[152:155]
v_exp_f32 v46, v46
v_mfma_f32_16x16x32_bf16 a[156:159], a[100:103], v[76:79], a[156:159]
ds_read_b128 a[68:71], v10 offset:9216
v_add_f32 v211, v211, v46
v_mfma_f32_16x16x32_bf16 a[144:147], a[100:103], v[64:67], a[144:147]
v_exp_f32 v47, v47
v_mfma_f32_16x16x32_bf16 a[148:151], a[100:103], v[68:71], a[148:151]
s_waitcnt lgkmcnt(6)
v_add_f32 v211, v211, v47
v_cvt_pk_bf16_f32 v93, v46, v47
v_mfma_f32_16x16x32_bf16 a[168:171], a[104:107], v[72:75], a[168:171]
v_exp_f32 v56, v56
v_mfma_f32_16x16x32_bf16 a[172:175], a[104:107], v[76:79], a[172:175]
ds_read_b128 a[72:75], v10 offset:10240
v_add_f32 v210, v210, v56
v_mfma_f32_16x16x32_bf16 a[160:163], a[104:107], v[64:67], a[160:163]
buffer_load_dwordx4 v12, s[4:7], s60 offen offset:2048 sc1  lds
v_exp_f32 v57, v57
v_mfma_f32_16x16x32_bf16 a[164:167], a[104:107], v[68:71], a[164:167]
v_add_f32 v210, v210, v57
v_cvt_pk_bf16_f32 v90, v56, v57
v_mfma_f32_16x16x32_bf16 a[184:187], a[108:111], v[72:75], a[184:187]
v_exp_f32 v58, v58
v_mfma_f32_16x16x32_bf16 a[188:191], a[108:111], v[76:79], a[188:191]
ds_read_b128 a[76:79], v10 offset:11264
v_add_f32 v210, v210, v58
v_mfma_f32_16x16x32_bf16 a[176:179], a[108:111], v[64:67], a[176:179]
v_exp_f32 v59, v59
v_mfma_f32_16x16x32_bf16 a[180:183], a[108:111], v[68:71], a[180:183]
s_waitcnt lgkmcnt(6)
v_add_f32 v210, v210, v59
v_cvt_pk_bf16_f32 v91, v58, v59
v_mfma_f32_16x16x32_bf16 a[200:203], a[112:115], v[72:75], a[200:203]
v_exp_f32 v60, v60
v_mfma_f32_16x16x32_bf16 a[204:207], a[112:115], v[76:79], a[204:207]
ds_read_b128 a[80:83], v10 offset:12288
v_add_f32 v211, v211, v60
v_mfma_f32_16x16x32_bf16 a[192:195], a[112:115], v[64:67], a[192:195]
buffer_load_dwordx4 v12, s[4:7], s60 offen offset:3072 sc1  lds
v_exp_f32 v61, v61
v_mfma_f32_16x16x32_bf16 a[196:199], a[112:115], v[68:71], a[196:199]
s_add_u32 s60, s60, 16384
v_add_f32 v211, v211, v61
v_cvt_pk_bf16_f32 v94, v60, v61
v_mfma_f32_16x16x32_bf16 a[216:219], a[116:119], v[72:75], a[216:219]
s_add_u32 s62, s62, 32768
v_exp_f32 v62, v62
v_mfma_f32_16x16x32_bf16 a[220:223], a[116:119], v[76:79], a[220:223]
s_cmp_lt_u32 s60, s61
ds_read_b128 a[84:87], v10 offset:13312
v_add_f32 v211, v211, v62
v_mfma_f32_16x16x32_bf16 a[208:211], a[116:119], v[64:67], a[208:211]
s_cselect_b32 s60, s60, 2130706432
v_exp_f32 v63, v63
v_mfma_f32_16x16x32_bf16 a[212:215], a[116:119], v[68:71], a[212:215]
s_waitcnt lgkmcnt(6)
v_add_f32 v211, v211, v63
v_cvt_pk_bf16_f32 v95, v62, v63
v_mfma_f32_16x16x32_bf16 a[232:235], a[120:123], v[72:75], a[232:235]
s_and_b32 m0, s62, 0x1ffff
v_mfma_f32_16x16x32_bf16 a[236:239], a[120:123], v[76:79], a[236:239]
s_add_u32 s56, s56, 1
ds_read_b128 a[88:91], v10 offset:14336
v_mfma_f32_16x16x32_bf16 a[224:227], a[120:123], v[64:67], a[224:227]
v_mfma_f32_16x16x32_bf16 a[228:231], a[120:123], v[68:71], a[228:231]
v_mfma_f32_16x16x32_bf16 a[248:251], a[124:127], v[72:75], a[248:251]
v_mfma_f32_16x16x32_bf16 a[252:255], a[124:127], v[76:79], a[252:255]
ds_read_b128 a[92:95], v10 offset:15360
v_mfma_f32_16x16x32_bf16 a[240:243], a[124:127], v[64:67], a[240:243]
v_mfma_f32_16x16x32_bf16 a[244:247], a[124:127], v[68:71], a[244:247]
s_waitcnt lgkmcnt(6)
v_mfma_f32_16x16x32_bf16 v[40:43], a[64:67], v[136:139], v[104:107]
v_mfma_f32_16x16x32_bf16 v[40:43], a[68:71], v[168:171], v[40:43]
s_waitcnt lgkmcnt(4)
ds_read_b128 a[96:99], v10 offset:24576
v_mfma_f32_16x16x32_bf16 v[40:43], a[72:75], v[200:203], v[40:43]
v_mfma_f32_16x16x32_bf16 v[40:43], a[76:79], v[232:235], v[40:43]
ds_read_b128 a[100:103], v10 offset:25600
v_mfma_f32_16x16x32_bf16 v[44:47], a[64:67], v[140:143], v[108:111]
v_mfma_f32_16x16x32_bf16 v[44:47], a[68:71], v[172:175], v[44:47]
ds_read_b128 a[104:107], v10 offset:26624
v_mfma_f32_16x16x32_bf16 v[44:47], a[72:75], v[204:207], v[44:47]
v_mfma_f32_16x16x32_bf16 v[44:47], a[76:79], v[236:239], v[44:47]
s_waitcnt lgkmcnt(5)
ds_read_b128 a[108:111], v10 offset:27648
v_mfma_f32_16x16x32_bf16 v[56:59], a[80:83], v[136:139], v[120:123]
v_exp_f32 v40, v40
v_mfma_f32_16x16x32_bf16 v[56:59], a[84:87], v[168:171], v[56:59]
s_waitcnt lgkmcnt(4)
ds_read_b128 a[112:115], v10 offset:28672
v_add_f32 v210, v210, v40
v_mfma_f32_16x16x32_bf16 v[56:59], a[88:91], v[200:203], v[56:59]
v_exp_f32 v41, v41
v_mfma_f32_16x16x32_bf16 v[56:59], a[92:95], v[232:235], v[56:59]
ds_read_b128 a[116:119], v10 offset:29696
v_add_f32 v210, v210, v41
v_cvt_pk_bf16_f32 v72, v40, v41
v_mfma_f32_16x16x32_bf16 v[60:63], a[80:83], v[140:143], v[124:127]
v_exp_f32 v42, v42
v_mfma_f32_16x16x32_bf16 v[60:63], a[84:87], v[172:175], v[60:63]
ds_read_b128 a[120:123], v10 offset:30720
v_add_f32 v210, v210, v42
v_mfma_f32_16x16x32_bf16 v[60:63], a[88:91], v[204:207], v[60:63]
v_exp_f32 v43, v43
v_mfma_f32_16x16x32_bf16 v[60:63], a[92:95], v[236:239], v[60:63]
s_waitcnt lgkmcnt(5)
ds_read_b128 a[124:127], v10 offset:31744
v_add_f32 v210, v210, v43
v_cvt_pk_bf16_f32 v73, v42, v43
v_mfma_f32_16x16x32_bf16 a[136:139], a[96:99], v[88:91], a[136:139]
s_waitcnt vmcnt(8)
s_barrier
v_exp_f32 v44, v44
v_mfma_f32_16x16x32_bf16 a[140:143], a[96:99], v[92:95], a[140:143]
ds_read_b128 a[64:67], v11 offset:0
v_add_f32 v211, v211, v44
v_mfma_f32_16x16x32_bf16 a[152:155], a[100:103], v[88:91], a[152:155]
buffer_load_dwordx4 v24, s[4:7], s60 offen offset:0 sc1  lds
v_exp_f32 v45, v45
v_mfma_f32_16x16x32_bf16 a[156:159], a[100:103], v[92:95], a[156:159]
s_waitcnt lgkmcnt(5)
ds_read_b128 a[68:71], v11 offset:1024
v_add_f32 v211, v211, v45
v_cvt_pk_bf16_f32 v76, v44, v45
v_mfma_f32_16x16x32_bf16 a[168:171], a[104:107], v[88:91], a[168:171]
v_exp_f32 v46, v46
v_mfma_f32_16x16x32_bf16 a[172:175], a[104:107], v[92:95], a[172:175]
ds_read_b128 a[72:75], v11 offset:2048
v_add_f32 v211, v211, v46
v_mfma_f32_16x16x32_bf16 a[184:187], a[108:111], v[88:91], a[184:187]
buffer_load_dwordx4 v24, s[4:7], s60 offen offset:1024 sc1  lds
v_exp_f32 v47, v47
v_mfma_f32_16x16x32_bf16 a[188:191], a[108:111], v[92:95], a[188:191]
s_waitcnt lgkmcnt(5)
ds_read_b128 a[76:79], v11 offset:3072
v_add_f32 v211, v211, v47
v_cvt_pk_bf16_f32 v77, v46, v47
v_mfma_f32_16x16x32_bf16 a[200:203], a[112:115], v[88:91], a[200:203]
v_exp_f32 v56, v56
v_mfma_f32_16x16x32_bf16 a[204:207], a[112:115], v[92:95], a[204:207]
ds_read_b128 a[80:83], v11 offset:4096
v_add_f32 v210, v210, v56
v_mfma_f32_16x16x32_bf16 a[216:219], a[116:119], v[88:91], a[216:219]
buffer_load_dwordx4 v24, s[4:7], s60 offen offset:2048 sc1  lds
v_exp_f32 v57, v57
v_mfma_f32_16x16x32_bf16 a[220:223], a[116:119], v[92:95], a[220:223]
s_waitcnt lgkmcnt(5)
ds_read_b128 a[84:87], v11 offset:5120
v_add_f32 v210, v210, v57
v_cvt_pk_bf16_f32 v74, v56, v57
v_mfma_f32_16x16x32_bf16 a[232:235], a[120:123], v[88:91], a[232:235]
v_exp_f32 v58, v58
v_mfma_f32_16x16x32_bf16 a[236:239], a[120:123], v[92:95], a[236:239]
ds_read_b128 a[88:91], v11 offset:6144
v_add_f32 v210, v210, v58
v_mfma_f32_16x16x32_bf16 a[248:251], a[124:127], v[88:91], a[248:251]
v_exp_f32 v59, v59
v_mfma_f32_16x16x32_bf16 a[252:255], a[124:127], v[92:95], a[252:255]
s_waitcnt lgkmcnt(5)
ds_read_b128 a[92:95], v11 offset:7168
v_add_f32 v210, v210, v59
v_cvt_pk_bf16_f32 v75, v58, v59
v_mov_b32 v10, v11
v_add_u32 v11, 0x8000, v11
v_and_b32 v11, 0x1ffff, v11
s_branch L_at_disp
L_at_dB:
s_cmp_eq_u32 s56, s57
s_cbranch_scc0 L_at_dB2
s_cmp_eq_u32 s57, 1
s_cbranch_scc0 L_at_tr1
v_exp_f32 v56, v56
v_exp_f32 v57, v57
v_exp_f32 v58, v58
v_exp_f32 v59, v59
v_add_f32 v210, v210, v56
v_add_f32 v210, v210, v57
v_cvt_pk_bf16_f32 v74, v56, v57
v_add_f32 v210, v210, v58
v_add_f32 v210, v210, v59
v_cvt_pk_bf16_f32 v75, v58, v59
L_at_tr1:
s_cmp_lt_u32 s50, 2
s_cbranch_scc0 L_at_tre
v_mov_b32 v216, v208
v_mov_b32 v217, v209
s_nop 0
v_permlane16_swap_b32 v208, v216
v_permlane16_swap_b32 v209, v217
v_add_f32 v208, v208, v216
v_add_f32 v209, v209, v217
v_mov_b32 v216, v208
v_mov_b32 v217, v209
s_nop 0
v_permlane32_swap_b32 v208, v216
v_permlane32_swap_b32 v209, v217
v_add_f32 v208, v208, v216
v_add_f32 v209, v209, v217
v_max_f32 v218, v208, v209
v_cmp_nle_f32 vcc, v218, v219
v_rcp_f32 v216, v208
v_rcp_f32 v217, v209
s_nop 1
s_or_b32 s3, vcc_lo, vcc_hi
s_or_b32 s64, s64, s3
s_lshl_b32 s52, s48, 12
s_add_u32 s52, s52, s80
v_accvgpr_read_b32 v240, a128
v_accvgpr_read_b32 v241, a129
v_accvgpr_read_b32 v242, a130
v_accvgpr_read_b32 v243, a131
v_accvgpr_read_b32 v244, a144
v_accvgpr_read_b32 v245, a145
v_accvgpr_read_b32 v246, a146
v_accvgpr_read_b32 v247, a147
v_pk_mul_f32 v[240:241], v[240:241], v[216:217] op_sel:[0,0] op_sel_hi:[1,0]
v_pk_mul_f32 v[242:243], v[242:243], v[216:217] op_sel:[0,0] op_sel_hi:[1,0]
v_pk_mul_f32 v[244:245], v[244:245], v[216:217] op_sel:[0,0] op_sel_hi:[1,0]
v_pk_mul_f32 v[246:247], v[246:247], v[216:217] op_sel:[0,0] op_sel_hi:[1,0]
v_cvt_pk_bf16_f32 v240, v240, v241
v_cvt_pk_bf16_f32 v241, v242, v243
v_cvt_pk_bf16_f32 v242, v244, v245
v_cvt_pk_bf16_f32 v243, v246, v247
buffer_store_dwordx4 v[240:243], v1, s[4:7], s52 offen offset:0 sc1
v_accvgpr_read_b32 v248, a160
v_accvgpr_read_b32 v249, a161
v_accvgpr_read_b32 v250, a162
v_accvgpr_read_b32 v251, a163
v_accvgpr_read_b32 v252, a176
v_accvgpr_read_b32 v253, a177
v_accvgpr_read_b32 v254, a178
v_accvgpr_read_b32 v255, a179
v_pk_mul_f32 v[248:249], v[248:249], v[216:217] op_sel:[0,0] op_sel_hi:[1,0]
v_pk_mul_f32 v[250:251], v[250:251], v[216:217] op_sel:[0,0] op_sel_hi:[1,0]
v_pk_mul_f32 v[252:253], v[252:253], v[216:217] op_sel:[0,0] op_sel_hi:[1,0]
v_pk_mul_f32 v[254:255], v[254:255], v[216:217] op_sel:[0,0] op_sel_hi:[1,0]
v_cvt_pk_bf16_f32 v248, v248, v249
v_cvt_pk_bf16_f32 v249, v250, v251
v_cvt_pk_bf16_f32 v250, v252, v253
v_cvt_pk_bf16_f32 v251, v254, v255
buffer_store_dwordx4 v[248:251], v1, s[4:7], s52 offen offset:1024 sc1
v_accvgpr_read_b32 v240, a192
v_accvgpr_read_b32 v241, a193
v_accvgpr_read_b32 v242, a194
v_accvgpr_read_b32 v243, a195
v_accvgpr_read_b32 v244, a208
v_accvgpr_read_b32 v245, a209
v_accvgpr_read_b32 v246, a210
v_accvgpr_read_b32 v247, a211
v_pk_mul_f32 v[240:241], v[240:241], v[216:217] op_sel:[0,0] op_sel_hi:[1,0]
v_pk_mul_f32 v[242:243], v[242:243], v[216:217] op_sel:[0,0] op_sel_hi:[1,0]
v_pk_mul_f32 v[244:245], v[244:245], v[216:217] op_sel:[0,0] op_sel_hi:[1,0]
v_pk_mul_f32 v[246:247], v[246:247], v[216:217] op_sel:[0,0] op_sel_hi:[1,0]
v_cvt_pk_bf16_f32 v240, v240, v241
v_cvt_pk_bf16_f32 v241, v242, v243
v_cvt_pk_bf16_f32 v242, v244, v245
v_cvt_pk_bf16_f32 v243, v246, v247
buffer_store_dwordx4 v[240:243], v1, s[4:7], s52 offen offset:2048 sc1
v_accvgpr_read_b32 v248, a224
v_accvgpr_read_b32 v249, a225
v_accvgpr_read_b32 v250, a226
v_accvgpr_read_b32 v251, a227
v_accvgpr_read_b32 v252, a240
v_accvgpr_read_b32 v253, a241
v_accvgpr_read_b32 v254, a242
v_accvgpr_read_b32 v255, a243
v_pk_mul_f32 v[248:249], v[248:249], v[216:217] op_sel:[0,0] op_sel_hi:[1,0]
v_pk_mul_f32 v[250:251], v[250:251], v[216:217] op_sel:[0,0] op_sel_hi:[1,0]
v_pk_mul_f32 v[252:253], v[252:253], v[216:217] op_sel:[0,0] op_sel_hi:[1,0]
v_pk_mul_f32 v[254:255], v[254:255], v[216:217] op_sel:[0,0] op_sel_hi:[1,0]
v_cvt_pk_bf16_f32 v248, v248, v249
v_cvt_pk_bf16_f32 v249, v250, v251
v_cvt_pk_bf16_f32 v250, v252, v253
v_cvt_pk_bf16_f32 v251, v254, v255
buffer_store_dwordx4 v[248:251], v1, s[4:7], s52 offen offset:3072 sc1
s_lshl_b32 s52, s48, 12
s_add_u32 s52, s52, s81
v_accvgpr_read_b32 v240, a132
v_accvgpr_read_b32 v241, a133
v_accvgpr_read_b32 v242, a134
v_accvgpr_read_b32 v243, a135
v_accvgpr_read_b32 v244, a148
v_accvgpr_read_b32 v245, a149
v_accvgpr_read_b32 v246, a150
v_accvgpr_read_b32 v247, a151
v_pk_mul_f32 v[240:241], v[240:241], v[216:217] op_sel:[0,1] op_sel_hi:[1,1]
v_pk_mul_f32 v[242:243], v[242:243], v[216:217] op_sel:[0,1] op_sel_hi:[1,1]
v_pk_mul_f32 v[244:245], v[244:245], v[216:217] op_sel:[0,1] op_sel_hi:[1,1]
v_pk_mul_f32 v[246:247], v[246:247], v[216:217] op_sel:[0,1] op_sel_hi:[1,1]
v_cvt_pk_bf16_f32 v240, v240, v241
v_cvt_pk_bf16_f32 v241, v242, v243
v_cvt_pk_bf16_f32 v242, v244, v245
v_cvt_pk_bf16_f32 v243, v246, v247
buffer_store_dwordx4 v[240:243], v1, s[4:7], s52 offen offset:0 sc1
v_accvgpr_read_b32 v248, a164
v_accvgpr_read_b32 v249, a165
v_accvgpr_read_b32 v250, a166
v_accvgpr_read_b32 v251, a167
v_accvgpr_read_b32 v252, a180
v_accvgpr_read_b32 v253, a181
v_accvgpr_read_b32 v254, a182
v_accvgpr_read_b32 v255, a183
v_pk_mul_f32 v[248:249], v[248:249], v[216:217] op_sel:[0,1] op_sel_hi:[1,1]
v_pk_mul_f32 v[250:251], v[250:251], v[216:217] op_sel:[0,1] op_sel_hi:[1,1]
v_pk_mul_f32 v[252:253], v[252:253], v[216:217] op_sel:[0,1] op_sel_hi:[1,1]
v_pk_mul_f32 v[254:255], v[254:255], v[216:217] op_sel:[0,1] op_sel_hi:[1,1]
v_cvt_pk_bf16_f32 v248, v248, v249
v_cvt_pk_bf16_f32 v249, v250, v251
v_cvt_pk_bf16_f32 v250, v252, v253
v_cvt_pk_bf16_f32 v251, v254, v255
buffer_store_dwordx4 v[248:251], v1, s[4:7], s52 offen offset:1024 sc1
v_accvgpr_read_b32 v240, a196
v_accvgpr_read_b32 v241, a197
v_accvgpr_read_b32 v242, a198
v_accvgpr_read_b32 v243, a199
v_accvgpr_read_b32 v244, a212
v_accvgpr_read_b32 v245, a213
v_accvgpr_read_b32 v246, a214
v_accvgpr_read_b32 v247, a215
v_pk_mul_f32 v[240:241], v[240:241], v[216:217] op_sel:[0,1] op_sel_hi:[1,1]
v_pk_mul_f32 v[242:243], v[242:243], v[216:217] op_sel:[0,1] op_sel_hi:[1,1]
v_pk_mul_f32 v[244:245], v[244:245], v[216:217] op_sel:[0,1] op_sel_hi:[1,1]
v_pk_mul_f32 v[246:247], v[246:247], v[216:217] op_sel:[0,1] op_sel_hi:[1,1]
v_cvt_pk_bf16_f32 v240, v240, v241
v_cvt_pk_bf16_f32 v241, v242, v243
v_cvt_pk_bf16_f32 v242, v244, v245
v_cvt_pk_bf16_f32 v243, v246, v247
buffer_store_dwordx4 v[240:243], v1, s[4:7], s52 offen offset:2048 sc1
v_accvgpr_read_b32 v248, a228
v_accvgpr_read_b32 v249, a229
v_accvgpr_read_b32 v250, a230
v_accvgpr_read_b32 v251, a231
v_accvgpr_read_b32 v252, a244
v_accvgpr_read_b32 v253, a245
v_accvgpr_read_b32 v254, a246
v_accvgpr_read_b32 v255, a247
v_pk_mul_f32 v[248:249], v[248:249], v[216:217] op_sel:[0,1] op_sel_hi:[1,1]
v_pk_mul_f32 v[250:251], v[250:251], v[216:217] op_sel:[0,1] op_sel_hi:[1,1]
v_pk_mul_f32 v[252:253], v[252:253], v[216:217] op_sel:[0,1] op_sel_hi:[1,1]
v_pk_mul_f32 v[254:255], v[254:255], v[216:217] op_sel:[0,1] op_sel_hi:[1,1]
v_cvt_pk_bf16_f32 v248, v248, v249
v_cvt_pk_bf16_f32 v249, v250, v251
v_cvt_pk_bf16_f32 v250, v252, v253
v_cvt_pk_bf16_f32 v251, v254, v255
buffer_store_dwordx4 v[248:251], v1, s[4:7], s52 offen offset:3072 sc1
L_at_tre:
L_at_dB2:
s_add_u32 s63, s56, 1
s_cmp_eq_u32 s63, s58
s_cbranch_scc1 L_at_last
s_sub_u32 s3, s58, 2
s_max_u32 s63, s63, s3
s_cmp_lt_u32 s56, 2
s_cselect_b32 s3, 2, 64
s_min_u32 s63, s63, s3
.p2align 5
L_at_single:
v_mfma_f32_16x16x32_bf16 v[40:43], a[64:67], v[136:139], v[152:155]
v_exp_f32 v60, v60
v_mfma_f32_16x16x32_bf16 v[40:43], a[68:71], v[168:171], v[40:43]
s_waitcnt lgkmcnt(4)
ds_read_b128 a[96:99], v10 offset:16384
v_add_f32 v211, v211, v60
v_mfma_f32_16x16x32_bf16 v[40:43], a[72:75], v[200:203], v[40:43]
buffer_load_dwordx4 v24, s[4:7], s60 offen offset:3072 sc1  lds
v_exp_f32 v61, v61
v_mfma_f32_16x16x32_bf16 v[40:43], a[76:79], v[232:235], v[40:43]
s_add_u32 m0, m0, 16384
ds_read_b128 a[100:103], v10 offset:17408
v_add_f32 v211, v211, v61
v_cvt_pk_bf16_f32 v78, v60, v61
v_mfma_f32_16x16x32_bf16 v[44:47], a[64:67], v[140:143], v[156:159]
v_exp_f32 v62, v62
v_mfma_f32_16x16x32_bf16 v[44:47], a[68:71], v[172:175], v[44:47]
ds_read_b128 a[104:107], v10 offset:18432
v_add_f32 v211, v211, v62
v_mfma_f32_16x16x32_bf16 v[44:47], a[72:75], v[204:207], v[44:47]
buffer_load_dwordx4 v12, s[4:7], s60 offen offset:0 sc1  lds
v_exp_f32 v63, v63
v_mfma_f32_16x16x32_bf16 v[44:47], a[76:79], v[236:239], v[44:47]
s_waitcnt lgkmcnt(5)
ds_read_b128 a[108:111], v10 offset:19456
v_add_f32 v211, v211, v63
v_cvt_pk_bf16_f32 v79, v62, v63
v_mfma_f32_16x16x32_bf16 v[56:59], a[80:83], v[136:139], v[184:187]
v_exp_f32 v40, v40
v_mfma_f32_16x16x32_bf16 v[56:59], a[84:87], v[168:171], v[56:59]
s_waitcnt lgkmcnt(4)
ds_read_b128 a[112:115], v10 offset:20480
v_add_f32 v210, v210, v40
v_mfma_f32_16x16x32_bf16 v[56:59], a[88:91], v[200:203], v[56:59]
buffer_load_dwordx4 v12, s[4:7], s60 offen offset:1024 sc1  lds
v_exp_f32 v41, v41
v_mfma_f32_16x16x32_bf16 v[56:59], a[92:95], v[232:235], v[56:59]
ds_read_b128 a[116:119], v10 offset:21504
v_add_f32 v210, v210, v41
v_cvt_pk_bf16_f32 v88, v40, v41
v_mfma_f32_16x16x32_bf16 v[60:63], a[80:83], v[140:143], v[188:191]
v_exp_f32 v42, v42
v_mfma_f32_16x16x32_bf16 v[60:63], a[84:87], v[172:175], v[60:63]
ds_read_b128 a[120:123], v10 offset:22528
v_add_f32 v210, v210, v42
v_mfma_f32_16x16x32_bf16 v[60:63], a[88:91], v[204:207], v[60:63]
buffer_load_dwordx4 v12, s[4:7], s60 offen offset:2048 sc1  lds
v_exp_f32 v43, v43
v_mfma_f32_16x16x32_bf16 v[60:63], a[92:95], v[236:239], v[60:63]
s_waitcnt lgkmcnt(5)
ds_read_b128 a[124:127], v10 offset:23552
v_add_f32 v210, v210, v43
v_cvt_pk_bf16_f32 v89, v42, v43
v_mfma_f32_16x16x32_bf16 a[136:139], a[96:99], v[72:75], a[136:139]
v_exp_f32 v44, v44
v_mfma_f32_16x16x32_bf16 a[140:143], a[96:99], v[76:79], a[140:143]
ds_read_b128 a[64:67], v10 offset:8192
v_add_f32 v211, v211, v44
v_mfma_f32_16x16x32_bf16 a[152:155], a[100:103], v[72:75], a[152:155]
buffer_load_dwordx4 v12, s[4:7], s60 offen offset:3072 sc1  lds
v_exp_f32 v45, v45
v_mfma_f32_16x16x32_bf16 a[156:159], a[100:103], v[76:79], a[156:159]
s_waitcnt lgkmcnt(5)
ds_read_b128 a[68:71], v10 offset:9216
v_add_f32 v211, v211, v45
v_cvt_pk_bf16_f32 v92, v44, v45
v_mfma_f32_16x16x32_bf16 a[168:171], a[104:107], v[72:75], a[168:171]
s_add_u32 s60, s60, 16384
v_exp_f32 v46, v46
v_mfma_f32_16x16x32_bf16 a[172:175], a[104:107], v[76:79], a[172:175]
s_add_u32 s62, s62, 32768
ds_read_b128 a[72:75], v10 offset:10240
v_add_f32 v211, v211, v46
v_mfma_f32_16x16x32_bf16 a[184:187], a[108:111], v[72:75], a[184:187]
s_cmp_lt_u32 s60, s61
v_exp_f32 v47, v47
v_mfma_f32_16x16x32_bf16 a[188:191], a[108:111], v[76:79], a[188:191]
s_waitcnt lgkmcnt(5)
ds_read_b128 a[76:79], v10 offset:11264
v_add_f32 v211, v211, v47
v_cvt_pk_bf16_f32 v93, v46, v47
v_mfma_f32_16x16x32_bf16 a[200:203], a[112:115], v[72:75], a[200:203]
s_cselect_b32 s60, s60, 2130706432
v_exp_f32 v56, v56
v_mfma_f32_16x16x32_bf16 a[204:207], a[112:115], v[76:79], a[204:207]
s_and_b32 m0, s62, 0x1ffff
ds_read_b128 a[80:83], v10 offset:12288
v_add_f32 v210, v210, v56
v_mfma_f32_16x16x32_bf16 a[216:219], a[116:119], v[72:75], a[216:219]
v_exp_f32 v57, v57
v_mfma_f32_16x16x32_bf16 a[220:223], a[116:119], v[76:79], a[220:223]
s_waitcnt lgkmcnt(5)
ds_read_b128 a[84:87], v10 offset:13312
v_add_f32 v210, v210, v57
v_cvt_pk_bf16_f32 v90, v56, v57
v_mfma_f32_16x16x32_bf16 a[232:235], a[120:123], v[72:75], a[232:235]
v_exp_f32 v58, v58
v_mfma_f32_16x16x32_bf16 a[236:239], a[120:123], v[76:79], a[236:239]
ds_read_b128 a[88:91], v10 offset:14336
v_add_f32 v210, v210, v58
v_mfma_f32_16x16x32_bf16 a[248:251], a[124:127], v[72:75], a[248:251]
v_exp_f32 v59, v59
v_mfma_f32_16x16x32_bf16 a[252:255], a[124:127], v[76:79], a[252:255]
s_waitcnt lgkmcnt(5)
ds_read_b128 a[92:95], v10 offset:15360
v_add_f32 v210, v210, v59
v_cvt_pk_bf16_f32 v91, v58, v59
v_mfma_f32_16x16x32_bf16 v[40:43], a[64:67], v[136:139], v[104:107]
v_exp_f32 v60, v60
v_mfma_f32_16x16x32_bf16 v[40:43], a[68:71], v[168:171], v[40:43]
s_waitcnt lgkmcnt(4)
ds_read_b128 a[96:99], v10 offset:24576
v_add_f32 v211, v211, v60
v_mfma_f32_16x16x32_bf16 v[40:43], a[72:75], v[200:203], v[40:43]
v_exp_f32 v61, v61
v_mfma_f32_16x16x32_bf16 v[40:43], a[76:79], v[232:235], v[40:43]
ds_read_b128 a[100:103], v10 offset:25600
v_add_f32 v211, v211, v61
v_cvt_pk_bf16_f32 v94, v60, v61
v_mfma_f32_16x16x32_bf16 v[44:47], a[64:67], v[140:143], v[108:111]
v_exp_f32 v62, v62
v_mfma_f32_16x16x32_bf16 v[44:47], a[68:71], v[172:175], v[44:47]
ds_read_b128 a[104:107], v10 offset:26624
v_add_f32 v211, v211, v62
v_mfma_f32_16x16x32_bf16 v[44:47], a[72:75], v[204:207], v[44:47]
v_exp_f32 v63, v63
v_mfma_f32_16x16x32_bf16 v[44:47], a[76:79], v[236:239], v[44:47]
s_waitcnt lgkmcnt(5)
ds_read_b128 a[108:111], v10 offset:27648
v_add_f32 v211, v211, v63
v_cvt_pk_bf16_f32 v95, v62, v63
v_mfma_f32_16x16x32_bf16 v[56:59], a[80:83], v[136:139], v[120:123]
v_exp_f32 v40, v40
v_mfma_f32_16x16x32_bf16 v[56:59], a[84:87], v[168:171], v[56:59]
s_waitcnt lgkmcnt(4)
ds_read_b128 a[112:115], v10 offset:28672
v_add_f32 v210, v210, v40
v_mfma_f32_16x16x32_bf16 v[56:59], a[88:91], v[200:203], v[56:59]
v_exp_f32 v41, v41
v_mfma_f32_16x16x32_bf16 v[56:59], a[92:95], v[232:235], v[56:59]
ds_read_b128 a[116:119], v10 offset:29696
v_add_f32 v210, v210, v41
v_cvt_pk_bf16_f32 v72, v40, v41
v_mfma_f32_16x16x32_bf16 v[60:63], a[80:83], v[140:143], v[124:127]
v_exp_f32 v42, v42
v_mfma_f32_16x16x32_bf16 v[60:63], a[84:87], v[172:175], v[60:63]
ds_read_b128 a[120:123], v10 offset:30720
v_add_f32 v210, v210, v42
v_mfma_f32_16x16x32_bf16 v[60:63], a[88:91], v[204:207], v[60:63]
v_exp_f32 v43, v43
v_mfma_f32_16x16x32_bf16 v[60:63], a[92:95], v[236:239], v[60:63]
s_waitcnt lgkmcnt(5)
ds_read_b128 a[124:127], v10 offset:31744
v_add_f32 v210, v210, v43
v_cvt_pk_bf16_f32 v73, v42, v43
v_mfma_f32_16x16x32_bf16 a[136:139], a[96:99], v[88:91], a[136:139]
s_waitcnt vmcnt(8)
s_barrier
v_exp_f32 v44, v44
v_mfma_f32_16x16x32_bf16 a[140:143], a[96:99], v[92:95], a[140:143]
ds_read_b128 a[64:67], v11 offset:0
v_add_f32 v211, v211, v44
v_mfma_f32_16x16x32_bf16 a[152:155], a[100:103], v[88:91], a[152:155]
buffer_load_dwordx4 v24, s[4:7], s60 offen offset:0 sc1  lds
v_exp_f32 v45, v45
v_mfma_f32_16x16x32_bf16 a[156:159], a[100:103], v[92:95], a[156:159]
s_waitcnt lgkmcnt(5)
ds_read_b128 a[68:71], v11 offset:1024
v_add_f32 v211, v211, v45
v_cvt_pk_bf16_f32 v76, v44, v45
v_mfma_f32_16x16x32_bf16 a[168:171], a[104:107], v[88:91], a[168:171]
v_exp_f32 v46, v46
v_mfma_f32_16x16x32_bf16 a[172:175], a[104:107], v[92:95], a[172:175]
ds_read_b128 a[72:75], v11 offset:2048
v_add_f32 v211, v211, v46
v_mfma_f32_16x16x32_bf16 a[184:187], a[108:111], v[88:91], a[184:187]
buffer_load_dwordx4 v24, s[4:7], s60 offen offset:1024 sc1  lds
v_exp_f32 v47, v47
v_mfma_f32_16x16x32_bf16 a[188:191], a[108:111], v[92:95], a[188:191]
s_waitcnt lgkmcnt(5)
ds_read_b128 a[76:79], v11 offset:3072
v_add_f32 v211, v211, v47
v_cvt_pk_bf16_f32 v77, v46, v47
v_mfma_f32_16x16x32_bf16 a[200:203], a[112:115], v[88:91], a[200:203]
v_exp_f32 v56, v56
v_mfma_f32_16x16x32_bf16 a[204:207], a[112:115], v[92:95], a[204:207]
ds_read_b128 a[80:83], v11 offset:4096
v_add_f32 v210, v210, v56
v_mfma_f32_16x16x32_bf16 a[216:219], a[116:119], v[88:91], a[216:219]
buffer_load_dwordx4 v24, s[4:7], s60 offen offset:2048 sc1  lds
v_exp_f32 v57, v57
v_mfma_f32_16x16x32_bf16 a[220:223], a[116:119], v[92:95], a[220:223]
s_waitcnt lgkmcnt(5)
ds_read_b128 a[84:87], v11 offset:5120
v_add_f32 v210, v210, v57
v_cvt_pk_bf16_f32 v74, v56, v57
v_mfma_f32_16x16x32_bf16 a[232:235], a[120:123], v[88:91], a[232:235]
s_add_u32 s56, s56, 1
v_exp_f32 v58, v58
v_mfma_f32_16x16x32_bf16 a[236:239], a[120:123], v[92:95], a[236:239]
s_cmp_lg_u32 s56, s63
ds_read_b128 a[88:91], v11 offset:6144
v_add_f32 v210, v210, v58
v_mfma_f32_16x16x32_bf16 a[248:251], a[124:127], v[88:91], a[248:251]
v_exp_f32 v59, v59
v_mfma_f32_16x16x32_bf16 a[252:255], a[124:127], v[92:95], a[252:255]
s_waitcnt lgkmcnt(5)
ds_read_b128 a[92:95], v11 offset:7168
v_add_f32 v210, v210, v59
v_cvt_pk_bf16_f32 v75, v58, v59
v_mov_b32 v10, v11
v_add_u32 v11, 0x8000, v11
v_and_b32 v11, 0x1ffff, v11
s_cbranch_scc1 L_at_single
s_branch L_at_disp
L_at_last:
s_bitcmp1_b32 s50, 0
s_cbranch_scc1 L_mk4a
v_cndmask_b32 v152, v214, v220, s[68:69]
v_cndmask_b32 v188, v215, v220, s[68:69]
v_cndmask_b32 v153, v214, v220, s[70:71]
v_cndmask_b32 v189, v215, v220, s[70:71]
v_cndmask_b32 v154, v214, v220, s[72:73]
v_cndmask_b32 v190, v215, v220, s[72:73]
v_cndmask_b32 v155, v214, v220, s[74:75]
v_cndmask_b32 v191, v215, v220, s[74:75]
v_pk_mov_b32 v[184:185], v[220:221], v[220:221]
v_pk_mov_b32 v[186:187], v[220:221], v[220:221]
s_branch L_mk4b
L_mk4a:
v_pk_mov_b32 v[152:153], v[220:221], v[220:221]
v_pk_mov_b32 v[154:155], v[220:221], v[220:221]
v_pk_mov_b32 v[156:157], v[220:221], v[220:221]
v_pk_mov_b32 v[158:159], v[220:221], v[220:221]
v_pk_mov_b32 v[184:185], v[220:221], v[220:221]
v_pk_mov_b32 v[186:187], v[220:221], v[220:221]
v_pk_mov_b32 v[188:189], v[220:221], v[220:221]
v_pk_mov_b32 v[190:191], v[220:221], v[220:221]
L_mk4b:
s_waitcnt vmcnt(8)
v_cmp_ge_u32 vcc, v25, v23
s_nop 3
s_cmp_eq_u64 vcc, -1
s_cbranch_scc0 L_spin_pre
L_back_pre:
v_mfma_f32_16x16x32_bf16 v[40:43], a[64:67], v[136:139], v[152:155]
v_exp_f32 v60, v60
v_mfma_f32_16x16x32_bf16 v[40:43], a[68:71], v[168:171], v[40:43]
s_waitcnt lgkmcnt(4)
s_mul_i32 s54, s50, 20480
ds_read_b128 a[96:99], v10 offset:16384
v_add_f32 v211, v211, v60
v_mfma_f32_16x16x32_bf16 v[40:43], a[72:75], v[200:203], v[40:43]
s_add_u32 s54, s54, s15
s_mul_i32 s3, s50, 6144
s_add_u32 m0, s3, 139264
v_exp_f32 v61, v61
v_mfma_f32_16x16x32_bf16 v[40:43], a[76:79], v[232:235], v[40:43]
s_add_u32 s54, s54, 0
ds_read_b128 a[100:103], v10 offset:17408
v_add_f32 v211, v211, v61
v_cvt_pk_bf16_f32 v78, v60, v61
v_mfma_f32_16x16x32_bf16 v[44:47], a[64:67], v[140:143], v[156:159]
buffer_load_dwordx4 v26, s[36:39], s54 offen offset:0  lds
v_exp_f32 v62, v62
v_mfma_f32_16x16x32_bf16 v[44:47], a[68:71], v[172:175], v[44:47]
ds_read_b128 a[104:107], v10 offset:18432
v_add_f32 v211, v211, v62
v_mfma_f32_16x16x32_bf16 v[44:47], a[72:75], v[204:207], v[44:47]
buffer_load_dwordx4 v27, s[36:39], s54 offen offset:1024  lds
v_exp_f32 v63, v63
v_mfma_f32_16x16x32_bf16 v[44:47], a[76:79], v[236:239], v[44:47]
s_waitcnt lgkmcnt(5)
ds_read_b128 a[108:111], v10 offset:19456
v_add_f32 v211, v211, v63
v_cvt_pk_bf16_f32 v79, v62, v63
v_mfma_f32_16x16x32_bf16 v[56:59], a[80:83], v[136:139], v[184:187]
buffer_load_dwordx4 v28, s[36:39], s54 offen offset:2048  lds
v_exp_f32 v40, v40
v_mfma_f32_16x16x32_bf16 v[56:59], a[84:87], v[168:171], v[56:59]
s_waitcnt lgkmcnt(4)
ds_read_b128 a[112:115], v10 offset:20480
v_add_f32 v210, v210, v40
v_mfma_f32_16x16x32_bf16 v[56:59], a[88:91], v[200:203], v[56:59]
s_add_u32 m0, s3, 142336
v_exp_f32 v41, v41
v_mfma_f32_16x16x32_bf16 v[56:59], a[92:95], v[232:235], v[56:59]
s_add_u32 s54, s54, 10240
ds_read_b128 a[116:119], v10 offset:21504
v_add_f32 v210, v210, v41
v_cvt_pk_bf16_f32 v88, v40, v41
v_mfma_f32_16x16x32_bf16 v[60:63], a[80:83], v[140:143], v[188:191]
buffer_load_dwordx4 v26, s[36:39], s54 offen offset:0  lds
v_exp_f32 v42, v42
v_mfma_f32_16x16x32_bf16 v[60:63], a[84:87], v[172:175], v[60:63]
ds_read_b128 a[120:123], v10 offset:22528
v_add_f32 v210, v210, v42
v_mfma_f32_16x16x32_bf16 v[60:63], a[88:91], v[204:207], v[60:63]
buffer_load_dwordx4 v27, s[36:39], s54 offen offset:1024  lds
v_exp_f32 v43, v43
v_mfma_f32_16x16x32_bf16 v[60:63], a[92:95], v[236:239], v[60:63]
s_waitcnt lgkmcnt(5)
ds_read_b128 a[124:127], v10 offset:23552
v_add_f32 v210, v210, v43
v_cvt_pk_bf16_f32 v89, v42, v43
v_mfma_f32_16x16x32_bf16 a[136:139], a[96:99], v[72:75], a[136:139]
buffer_load_dwordx4 v28, s[36:39], s54 offen offset:2048  lds
v_exp_f32 v44, v44
v_mfma_f32_16x16x32_bf16 a[140:143], a[96:99], v[76:79], a[140:143]
ds_read_b128 a[64:67], v10 offset:24576
v_add_f32 v211, v211, v44
v_mfma_f32_16x16x32_bf16 a[152:155], a[100:103], v[72:75], a[152:155]
s_add_u32 s55, s76, 0
buffer_load_dwordx4 a[0:3], v1, s[4:7], s55 offen offset:0 sc1
v_exp_f32 v45, v45
v_mfma_f32_16x16x32_bf16 a[156:159], a[100:103], v[76:79], a[156:159]
s_waitcnt lgkmcnt(5)
ds_read_b128 a[68:71], v10 offset:25600
v_add_f32 v211, v211, v45
v_cvt_pk_bf16_f32 v92, v44, v45
v_mfma_f32_16x16x32_bf16 a[168:171], a[104:107], v[72:75], a[168:171]
buffer_load_dwordx4 a[4:7], v1, s[4:7], s55 offen offset:1024 sc1
v_exp_f32 v46, v46
v_mfma_f32_16x16x32_bf16 a[172:175], a[104:107], v[76:79], a[172:175]
ds_read_b128 a[72:75], v10 offset:26624
v_add_f32 v211, v211, v46
v_mfma_f32_16x16x32_bf16 a[184:187], a[108:111], v[72:75], a[184:187]
s_add_u32 s55, s77, 0
buffer_load_dwordx4 a[16:19], v1, s[4:7], s55 offen offset:0 sc1
v_exp_f32 v47, v47
v_mfma_f32_16x16x32_bf16 a[188:191], a[108:111], v[76:79], a[188:191]
s_waitcnt lgkmcnt(5)
ds_read_b128 a[76:79], v10 offset:27648
v_add_f32 v211, v211, v47
v_cvt_pk_bf16_f32 v93, v46, v47
v_mfma_f32_16x16x32_bf16 a[200:203], a[112:115], v[72:75], a[200:203]
buffer_load_dwordx4 a[20:23], v1, s[4:7], s55 offen offset:1024 sc1
v_exp_f32 v56, v56
v_mfma_f32_16x16x32_bf16 a[204:207], a[112:115], v[76:79], a[204:207]
ds_read_b128 a[80:83], v10 offset:28672
v_add_f32 v210, v210, v56
v_mfma_f32_16x16x32_bf16 a[216:219], a[116:119], v[72:75], a[216:219]
s_add_u32 s55, s78, 0
buffer_load_dwordx4 a[32:35], v1, s[4:7], s55 offen offset:0 sc1
v_exp_f32 v57, v57
v_mfma_f32_16x16x32_bf16 a[220:223], a[116:119], v[76:79], a[220:223]
s_waitcnt lgkmcnt(5)
ds_read_b128 a[84:87], v10 offset:29696
v_add_f32 v210, v210, v57
v_cvt_pk_bf16_f32 v90, v56, v57
v_mfma_f32_16x16x32_bf16 a[232:235], a[120:123], v[72:75], a[232:235]
buffer_load_dwordx4 a[36:39], v1, s[4:7], s55 offen offset:1024 sc1
v_exp_f32 v58, v58
v_mfma_f32_16x16x32_bf16 a[236:239], a[120:123], v[76:79], a[236:239]
ds_read_b128 a[88:91], v10 offset:30720
v_add_f32 v210, v210, v58
v_mfma_f32_16x16x32_bf16 a[248:251], a[124:127], v[72:75], a[248:251]
s_add_u32 s55, s79, 0
buffer_load_dwordx4 a[48:51], v1, s[4:7], s55 offen offset:0 sc1
v_exp_f32 v59, v59
v_mfma_f32_16x16x32_bf16 a[252:255], a[124:127], v[76:79], a[252:255]
ds_read_b128 a[92:95], v10 offset:31744
buffer_load_dwordx4 a[52:55], v1, s[4:7], s55 offen offset:1024 sc1
v_add_f32 v210, v210, v59
v_cvt_pk_bf16_f32 v91, v58, v59
s_cmp_ge_u32 s50, 2
s_cbranch_scc0 L_at_nobar
s_waitcnt vmcnt(14)
s_barrier
L_at_nobar:
v_exp_f32 v60, v60
v_exp_f32 v61, v61
v_exp_f32 v62, v62
v_exp_f32 v63, v63
v_add_f32 v211, v211, v60
v_add_f32 v211, v211, v61
v_cvt_pk_bf16_f32 v94, v60, v61
v_add_f32 v211, v211, v62
v_add_f32 v211, v211, v63
v_cvt_pk_bf16_f32 v95, v62, v63
s_waitcnt lgkmcnt(7)
v_mfma_f32_16x16x32_bf16 a[136:139], a[64:67], v[88:91], a[136:139]
s_add_u32 s55, s78, 2048
buffer_load_dwordx4 a[96:99], v1, s[4:7], s55 offen offset:0 sc1
v_mfma_f32_16x16x32_bf16 a[140:143], a[64:67], v[92:95], a[140:143]
s_waitcnt lgkmcnt(6)
v_mov_b32 v222, v210
v_mov_b32 v223, v211
v_mfma_f32_16x16x32_bf16 a[152:155], a[68:71], v[88:91], a[152:155]
v_permlane16_swap_b32 v210, v222
v_permlane16_swap_b32 v211, v223
v_mfma_f32_16x16x32_bf16 a[156:159], a[68:71], v[92:95], a[156:159]
s_waitcnt lgkmcnt(5)
buffer_load_dwordx4 a[100:103], v1, s[4:7], s55 offen offset:1024 sc1
v_mfma_f32_16x16x32_bf16 a[168:171], a[72:75], v[88:91], a[168:171]
s_add_u32 s55, s79, 2048
v_add_f32 v210, v210, v222
v_add_f32 v211, v211, v223
v_mfma_f32_16x16x32_bf16 a[172:175], a[72:75], v[92:95], a[172:175]
s_waitcnt lgkmcnt(4)
v_mov_b32 v222, v210
v_mov_b32 v223, v211
v_mfma_f32_16x16x32_bf16 a[184:187], a[76:79], v[88:91], a[184:187]
buffer_load_dwordx4 a[112:115], v1, s[4:7], s55 offen offset:0 sc1
v_mfma_f32_16x16x32_bf16 a[188:191], a[76:79], v[92:95], a[188:191]
s_waitcnt lgkmcnt(3)
v_permlane32_swap_b32 v210, v222
v_permlane32_swap_b32 v211, v223
v_mfma_f32_16x16x32_bf16 a[200:203], a[80:83], v[88:91], a[200:203]
v_add_f32 v210, v210, v222
v_add_f32 v211, v211, v223
v_mfma_f32_16x16x32_bf16 a[204:207], a[80:83], v[92:95], a[204:207]
s_waitcnt lgkmcnt(2)
buffer_load_dwordx4 a[116:119], v1, s[4:7], s55 offen offset:1024 sc1
v_mfma_f32_16x16x32_bf16 a[216:219], a[84:87], v[88:91], a[216:219]
v_max_f32 v218, v210, v211
v_cmp_nle_f32 vcc, v218, v219
v_mfma_f32_16x16x32_bf16 a[220:223], a[84:87], v[92:95], a[220:223]
s_waitcnt lgkmcnt(1)
v_rcp_f32 v222, v210
v_mfma_f32_16x16x32_bf16 a[232:235], a[88:91], v[88:91], a[232:235]
v_rcp_f32 v223, v211
v_mfma_f32_16x16x32_bf16 a[236:239], a[88:91], v[92:95], a[236:239]
s_waitcnt lgkmcnt(0)
s_or_b32 s3, vcc_lo, vcc_hi
v_mfma_f32_16x16x32_bf16 a[248:251], a[92:95], v[88:91], a[248:251]
s_or_b32 s64, s64, s3
v_mfma_f32_16x16x32_bf16 a[252:255], a[92:95], v[92:95], a[252:255]
s_cmp_lt_u32 s50, 2
s_cbranch_scc1 L_at_done
v_mov_b32 v216, v208
v_mov_b32 v217, v209
s_nop 0
v_permlane16_swap_b32 v208, v216
v_permlane16_swap_b32 v209, v217
v_add_f32 v208, v208, v216
v_add_f32 v209, v209, v217
v_mov_b32 v216, v208
v_mov_b32 v217, v209
s_nop 0
v_permlane32_swap_b32 v208, v216
v_permlane32_swap_b32 v209, v217
v_add_f32 v208, v208, v216
v_add_f32 v209, v209, v217
v_max_f32 v218, v208, v209
v_cmp_nle_f32 vcc, v218, v219
v_rcp_f32 v216, v208
v_rcp_f32 v217, v209
s_nop 1
s_or_b32 s3, vcc_lo, vcc_hi
s_or_b32 s64, s64, s3
s_lshl_b32 s52, s48, 12
s_add_u32 s52, s52, s80
v_accvgpr_read_b32 v240, a128
v_accvgpr_read_b32 v241, a129
v_accvgpr_read_b32 v242, a130
v_accvgpr_read_b32 v243, a131
v_accvgpr_read_b32 v244, a144
v_accvgpr_read_b32 v245, a145
v_accvgpr_read_b32 v246, a146
v_accvgpr_read_b32 v247, a147
v_pk_mul_f32 v[240:241], v[240:241], v[216:217] op_sel:[0,0] op_sel_hi:[1,0]
v_pk_mul_f32 v[242:243], v[242:243], v[216:217] op_sel:[0,0] op_sel_hi:[1,0]
v_pk_mul_f32 v[244:245], v[244:245], v[216:217] op_sel:[0,0] op_sel_hi:[1,0]
v_pk_mul_f32 v[246:247], v[246:247], v[216:217] op_sel:[0,0] op_sel_hi:[1,0]
v_cvt_pk_bf16_f32 v240, v240, v241
v_cvt_pk_bf16_f32 v241, v242, v243
v_cvt_pk_bf16_f32 v242, v244, v245
v_cvt_pk_bf16_f32 v243, v246, v247
buffer_store_dwordx4 v[240:243], v1, s[4:7], s52 offen offset:0 sc1
v_accvgpr_read_b32 v248, a160
v_accvgpr_read_b32 v249, a161
v_accvgpr_read_b32 v250, a162
v_accvgpr_read_b32 v251, a163
v_accvgpr_read_b32 v252, a176
v_accvgpr_read_b32 v253, a177
v_accvgpr_read_b32 v254, a178
v_accvgpr_read_b32 v255, a179
v_pk_mul_f32 v[248:249], v[248:249], v[216:217] op_sel:[0,0] op_sel_hi:[1,0]
v_pk_mul_f32 v[250:251], v[250:251], v[216:217] op_sel:[0,0] op_sel_hi:[1,0]
v_pk_mul_f32 v[252:253], v[252:253], v[216:217] op_sel:[0,0] op_sel_hi:[1,0]
v_pk_mul_f32 v[254:255], v[254:255], v[216:217] op_sel:[0,0] op_sel_hi:[1,0]
v_cvt_pk_bf16_f32 v248, v248, v249
v_cvt_pk_bf16_f32 v249, v250, v251
v_cvt_pk_bf16_f32 v250, v252, v253
v_cvt_pk_bf16_f32 v251, v254, v255
buffer_store_dwordx4 v[248:251], v1, s[4:7], s52 offen offset:1024 sc1
v_accvgpr_read_b32 v240, a192
v_accvgpr_read_b32 v241, a193
v_accvgpr_read_b32 v242, a194
v_accvgpr_read_b32 v243, a195
v_accvgpr_read_b32 v244, a208
v_accvgpr_read_b32 v245, a209
v_accvgpr_read_b32 v246, a210
v_accvgpr_read_b32 v247, a211
v_pk_mul_f32 v[240:241], v[240:241], v[216:217] op_sel:[0,0] op_sel_hi:[1,0]
v_pk_mul_f32 v[242:243], v[242:243], v[216:217] op_sel:[0,0] op_sel_hi:[1,0]
v_pk_mul_f32 v[244:245], v[244:245], v[216:217] op_sel:[0,0] op_sel_hi:[1,0]
v_pk_mul_f32 v[246:247], v[246:247], v[216:217] op_sel:[0,0] op_sel_hi:[1,0]
v_cvt_pk_bf16_f32 v240, v240, v241
v_cvt_pk_bf16_f32 v241, v242, v243
v_cvt_pk_bf16_f32 v242, v244, v245
v_cvt_pk_bf16_f32 v243, v246, v247
buffer_store_dwordx4 v[240:243], v1, s[4:7], s52 offen offset:2048 sc1
v_accvgpr_read_b32 v248, a224
v_accvgpr_read_b32 v249, a225
v_accvgpr_read_b32 v250, a226
v_accvgpr_read_b32 v251, a227
v_accvgpr_read_b32 v252, a240
v_accvgpr_read_b32 v253, a241
v_accvgpr_read_b32 v254, a242
v_accvgpr_read_b32 v255, a243
v_pk_mul_f32 v[248:249], v[248:249], v[216:217] op_sel:[0,0] op_sel_hi:[1,0]
v_pk_mul_f32 v[250:251], v[250:251], v[216:217] op_sel:[0,0] op_sel_hi:[1,0]
v_pk_mul_f32 v[252:253], v[252:253], v[216:217] op_sel:[0,0] op_sel_hi:[1,0]
v_pk_mul_f32 v[254:255], v[254:255], v[216:217] op_sel:[0,0] op_sel_hi:[1,0]
v_cvt_pk_bf16_f32 v248, v248, v249
v_cvt_pk_bf16_f32 v249, v250, v251
v_cvt_pk_bf16_f32 v250, v252, v253
v_cvt_pk_bf16_f32 v251, v254, v255
buffer_store_dwordx4 v[248:251], v1, s[4:7], s52 offen offset:3072 sc1
s_lshl_b32 s52, s48, 12
s_add_u32 s52, s52, s81
v_accvgpr_read_b32 v240, a132
v_accvgpr_read_b32 v241, a133
v_accvgpr_read_b32 v242, a134
v_accvgpr_read_b32 v243, a135
v_accvgpr_read_b32 v244, a148
v_accvgpr_read_b32 v245, a149
v_accvgpr_read_b32 v246, a150
v_accvgpr_read_b32 v247, a151
v_pk_mul_f32 v[240:241], v[240:241], v[216:217] op_sel:[0,1] op_sel_hi:[1,1]
v_pk_mul_f32 v[242:243], v[242:243], v[216:217] op_sel:[0,1] op_sel_hi:[1,1]
v_pk_mul_f32 v[244:245], v[244:245], v[216:217] op_sel:[0,1] op_sel_hi:[1,1]
v_pk_mul_f32 v[246:247], v[246:247], v[216:217] op_sel:[0,1] op_sel_hi:[1,1]
v_cvt_pk_bf16_f32 v240, v240, v241
v_cvt_pk_bf16_f32 v241, v242, v243
v_cvt_pk_bf16_f32 v242, v244, v245
v_cvt_pk_bf16_f32 v243, v246, v247
buffer_store_dwordx4 v[240:243], v1, s[4:7], s52 offen offset:0 sc1
v_accvgpr_read_b32 v248, a164
v_accvgpr_read_b32 v249, a165
v_accvgpr_read_b32 v250, a166
v_accvgpr_read_b32 v251, a167
v_accvgpr_read_b32 v252, a180
v_accvgpr_read_b32 v253, a181
v_accvgpr_read_b32 v254, a182
v_accvgpr_read_b32 v255, a183
v_pk_mul_f32 v[248:249], v[248:249], v[216:217] op_sel:[0,1] op_sel_hi:[1,1]
v_pk_mul_f32 v[250:251], v[250:251], v[216:217] op_sel:[0,1] op_sel_hi:[1,1]
v_pk_mul_f32 v[252:253], v[252:253], v[216:217] op_sel:[0,1] op_sel_hi:[1,1]
v_pk_mul_f32 v[254:255], v[254:255], v[216:217] op_sel:[0,1] op_sel_hi:[1,1]
v_cvt_pk_bf16_f32 v248, v248, v249
v_cvt_pk_bf16_f32 v249, v250, v251
v_cvt_pk_bf16_f32 v250, v252, v253
v_cvt_pk_bf16_f32 v251, v254, v255
buffer_store_dwordx4 v[248:251], v1, s[4:7], s52 offen offset:1024 sc1
v_accvgpr_read_b32 v240, a196
v_accvgpr_read_b32 v241, a197
v_accvgpr_read_b32 v242, a198
v_accvgpr_read_b32 v243, a199
v_accvgpr_read_b32 v244, a212
v_accvgpr_read_b32 v245, a213
v_accvgpr_read_b32 v246, a214
v_accvgpr_read_b32 v247, a215
v_pk_mul_f32 v[240:241], v[240:241], v[216:217] op_sel:[0,1] op_sel_hi:[1,1]
v_pk_mul_f32 v[242:243], v[242:243], v[216:217] op_sel:[0,1] op_sel_hi:[1,1]
v_pk_mul_f32 v[244:245], v[244:245], v[216:217] op_sel:[0,1] op_sel_hi:[1,1]
v_pk_mul_f32 v[246:247], v[246:247], v[216:217] op_sel:[0,1] op_sel_hi:[1,1]
v_cvt_pk_bf16_f32 v240, v240, v241
v_cvt_pk_bf16_f32 v241, v242, v243
v_cvt_pk_bf16_f32 v242, v244, v245
v_cvt_pk_bf16_f32 v243, v246, v247
buffer_store_dwordx4 v[240:243], v1, s[4:7], s52 offen offset:2048 sc1
v_accvgpr_read_b32 v248, a228
v_accvgpr_read_b32 v249, a229
v_accvgpr_read_b32 v250, a230
v_accvgpr_read_b32 v251, a231
v_accvgpr_read_b32 v252, a244
v_accvgpr_read_b32 v253, a245
v_accvgpr_read_b32 v254, a246
v_accvgpr_read_b32 v255, a247
v_pk_mul_f32 v[248:249], v[248:249], v[216:217] op_sel:[0,1] op_sel_hi:[1,1]
v_pk_mul_f32 v[250:251], v[250:251], v[216:217] op_sel:[0,1] op_sel_hi:[1,1]
v_pk_mul_f32 v[252:253], v[252:253], v[216:217] op_sel:[0,1] op_sel_hi:[1,1]
v_pk_mul_f32 v[254:255], v[254:255], v[216:217] op_sel:[0,1] op_sel_hi:[1,1]
v_cvt_pk_bf16_f32 v248, v248, v249
v_cvt_pk_bf16_f32 v249, v250, v251
v_cvt_pk_bf16_f32 v250, v252, v253
v_cvt_pk_bf16_f32 v251, v254, v255
buffer_store_dwordx4 v[248:251], v1, s[4:7], s52 offen offset:3072 sc1
L_at_done:
s_lshl_b32 s52, s48, 12
s_add_u32 s52, s52, s82
s_add_u32 s55, s76, 2048
buffer_load_dwordx4 a[64:67], v1, s[4:7], s55 offen offset:0 sc1
buffer_load_dwordx4 a[68:71], v1, s[4:7], s55 offen offset:1024 sc1
s_add_u32 s55, s77, 2048
buffer_load_dwordx4 a[80:83], v1, s[4:7], s55 offen offset:0 sc1
buffer_load_dwordx4 a[84:87], v1, s[4:7], s55 offen offset:1024 sc1
v_accvgpr_read_b32 v240, a136
v_accvgpr_read_b32 v241, a137
v_accvgpr_read_b32 v242, a138
v_accvgpr_read_b32 v243, a139
v_accvgpr_read_b32 v244, a152
v_accvgpr_read_b32 v245, a153
v_accvgpr_read_b32 v246, a154
v_accvgpr_read_b32 v247, a155
v_pk_mul_f32 v[240:241], v[240:241], v[222:223] op_sel:[0,0] op_sel_hi:[1,0]
v_pk_mul_f32 v[242:243], v[242:243], v[222:223] op_sel:[0,0] op_sel_hi:[1,0]
v_pk_mul_f32 v[244:245], v[244:245], v[222:223] op_sel:[0,0] op_sel_hi:[1,0]
v_pk_mul_f32 v[246:247], v[246:247], v[222:223] op_sel:[0,0] op_sel_hi:[1,0]
v_cvt_pk_bf16_f32 v240, v240, v241
v_cvt_pk_bf16_f32 v241, v242, v243
v_cvt_pk_bf16_f32 v242, v244, v245
v_cvt_pk_bf16_f32 v243, v246, v247
buffer_store_dwordx4 v[240:243], v1, s[4:7], s52 offen offset:0 sc1
v_accvgpr_read_b32 v248, a168
v_accvgpr_read_b32 v249, a169
v_accvgpr_read_b32 v250, a170
v_accvgpr_read_b32 v251, a171
v_accvgpr_read_b32 v252, a184
v_accvgpr_read_b32 v253, a185
v_accvgpr_read_b32 v254, a186
v_accvgpr_read_b32 v255, a187
v_pk_mul_f32 v[248:249], v[248:249], v[222:223] op_sel:[0,0] op_sel_hi:[1,0]
v_pk_mul_f32 v[250:251], v[250:251], v[222:223] op_sel:[0,0] op_sel_hi:[1,0]
v_pk_mul_f32 v[252:253], v[252:253], v[222:223] op_sel:[0,0] op_sel_hi:[1,0]
v_pk_mul_f32 v[254:255], v[254:255], v[222:223] op_sel:[0,0] op_sel_hi:[1,0]
v_cvt_pk_bf16_f32 v248, v248, v249
v_cvt_pk_bf16_f32 v249, v250, v251
v_cvt_pk_bf16_f32 v250, v252, v253
v_cvt_pk_bf16_f32 v251, v254, v255
buffer_store_dwordx4 v[248:251], v1, s[4:7], s52 offen offset:1024 sc1
v_accvgpr_read_b32 v240, a200
v_accvgpr_read_b32 v241, a201
v_accvgpr_read_b32 v242, a202
v_accvgpr_read_b32 v243, a203
v_accvgpr_read_b32 v244, a216
v_accvgpr_read_b32 v245, a217
v_accvgpr_read_b32 v246, a218
v_accvgpr_read_b32 v247, a219
v_pk_mul_f32 v[240:241], v[240:241], v[222:223] op_sel:[0,0] op_sel_hi:[1,0]
v_pk_mul_f32 v[242:243], v[242:243], v[222:223] op_sel:[0,0] op_sel_hi:[1,0]
v_pk_mul_f32 v[244:245], v[244:245], v[222:223] op_sel:[0,0] op_sel_hi:[1,0]
v_pk_mul_f32 v[246:247], v[246:247], v[222:223] op_sel:[0,0] op_sel_hi:[1,0]
v_cvt_pk_bf16_f32 v240, v240, v241
v_cvt_pk_bf16_f32 v241, v242, v243
v_cvt_pk_bf16_f32 v242, v244, v245
v_cvt_pk_bf16_f32 v243, v246, v247
buffer_store_dwordx4 v[240:243], v1, s[4:7], s52 offen offset:2048 sc1
v_accvgpr_read_b32 v248, a232
v_accvgpr_read_b32 v249, a233
v_accvgpr_read_b32 v250, a234
v_accvgpr_read_b32 v251, a235
v_accvgpr_read_b32 v252, a248
v_accvgpr_read_b32 v253, a249
v_accvgpr_read_b32 v254, a250
v_accvgpr_read_b32 v255, a251
v_pk_mul_f32 v[248:249], v[248:249], v[222:223] op_sel:[0,0] op_sel_hi:[1,0]
v_pk_mul_f32 v[250:251], v[250:251], v[222:223] op_sel:[0,0] op_sel_hi:[1,0]
v_pk_mul_f32 v[252:253], v[252:253], v[222:223] op_sel:[0,0] op_sel_hi:[1,0]
v_pk_mul_f32 v[254:255], v[254:255], v[222:223] op_sel:[0,0] op_sel_hi:[1,0]
v_cvt_pk_bf16_f32 v248, v248, v249
v_cvt_pk_bf16_f32 v249, v250, v251
v_cvt_pk_bf16_f32 v250, v252, v253
v_cvt_pk_bf16_f32 v251, v254, v255
buffer_store_dwordx4 v[248:251], v1, s[4:7], s52 offen offset:3072 sc1
s_lshl_b32 s52, s48, 12
s_add_u32 s52, s52, s83
v_accvgpr_read_b32 v240, a140
v_accvgpr_read_b32 v241, a141
v_accvgpr_read_b32 v242, a142
v_accvgpr_read_b32 v243, a143
v_accvgpr_read_b32 v244, a156
v_accvgpr_read_b32 v245, a157
v_accvgpr_read_b32 v246, a158
v_accvgpr_read_b32 v247, a159
v_pk_mul_f32 v[240:241], v[240:241], v[222:223] op_sel:[0,1] op_sel_hi:[1,1]
v_pk_mul_f32 v[242:243], v[242:243], v[222:223] op_sel:[0,1] op_sel_hi:[1,1]
v_pk_mul_f32 v[244:245], v[244:245], v[222:223] op_sel:[0,1] op_sel_hi:[1,1]
v_pk_mul_f32 v[246:247], v[246:247], v[222:223] op_sel:[0,1] op_sel_hi:[1,1]
v_cvt_pk_bf16_f32 v240, v240, v241
v_cvt_pk_bf16_f32 v241, v242, v243
v_cvt_pk_bf16_f32 v242, v244, v245
v_cvt_pk_bf16_f32 v243, v246, v247
buffer_store_dwordx4 v[240:243], v1, s[4:7], s52 offen offset:0 sc1
v_accvgpr_read_b32 v248, a172
v_accvgpr_read_b32 v249, a173
v_accvgpr_read_b32 v250, a174
v_accvgpr_read_b32 v251, a175
v_accvgpr_read_b32 v252, a188
v_accvgpr_read_b32 v253, a189
v_accvgpr_read_b32 v254, a190
v_accvgpr_read_b32 v255, a191
v_pk_mul_f32 v[248:249], v[248:249], v[222:223] op_sel:[0,1] op_sel_hi:[1,1]
v_pk_mul_f32 v[250:251], v[250:251], v[222:223] op_sel:[0,1] op_sel_hi:[1,1]
v_pk_mul_f32 v[252:253], v[252:253], v[222:223] op_sel:[0,1] op_sel_hi:[1,1]
v_pk_mul_f32 v[254:255], v[254:255], v[222:223] op_sel:[0,1] op_sel_hi:[1,1]
v_cvt_pk_bf16_f32 v248, v248, v249
v_cvt_pk_bf16_f32 v249, v250, v251
v_cvt_pk_bf16_f32 v250, v252, v253
v_cvt_pk_bf16_f32 v251, v254, v255
buffer_store_dwordx4 v[248:251], v1, s[4:7], s52 offen offset:1024 sc1
v_accvgpr_read_b32 v240, a204
v_accvgpr_read_b32 v241, a205
v_accvgpr_read_b32 v242, a206
v_accvgpr_read_b32 v243, a207
v_accvgpr_read_b32 v244, a220
v_accvgpr_read_b32 v245, a221
v_accvgpr_read_b32 v246, a222
v_accvgpr_read_b32 v247, a223
v_pk_mul_f32 v[240:241], v[240:241], v[222:223] op_sel:[0,1] op_sel_hi:[1,1]
v_pk_mul_f32 v[242:243], v[242:243], v[222:223] op_sel:[0,1] op_sel_hi:[1,1]
v_pk_mul_f32 v[244:245], v[244:245], v[222:223] op_sel:[0,1] op_sel_hi:[1,1]
v_pk_mul_f32 v[246:247], v[246:247], v[222:223] op_sel:[0,1] op_sel_hi:[1,1]
v_cvt_pk_bf16_f32 v240, v240, v241
v_cvt_pk_bf16_f32 v241, v242, v243
v_cvt_pk_bf16_f32 v242, v244, v245
v_cvt_pk_bf16_f32 v243, v246, v247
buffer_store_dwordx4 v[240:243], v1, s[4:7], s52 offen offset:2048 sc1
v_accvgpr_read_b32 v248, a236
v_accvgpr_read_b32 v249, a237
v_accvgpr_read_b32 v250, a238
v_accvgpr_read_b32 v251, a239
v_accvgpr_read_b32 v252, a252
v_accvgpr_read_b32 v253, a253
v_accvgpr_read_b32 v254, a254
v_accvgpr_read_b32 v255, a255
v_pk_mul_f32 v[248:249], v[248:249], v[222:223] op_sel:[0,1] op_sel_hi:[1,1]
v_pk_mul_f32 v[250:251], v[250:251], v[222:223] op_sel:[0,1] op_sel_hi:[1,1]
v_pk_mul_f32 v[252:253], v[252:253], v[222:223] op_sel:[0,1] op_sel_hi:[1,1]
v_pk_mul_f32 v[254:255], v[254:255], v[222:223] op_sel:[0,1] op_sel_hi:[1,1]
v_cvt_pk_bf16_f32 v248, v248, v249
v_cvt_pk_bf16_f32 v249, v250, v251
v_cvt_pk_bf16_f32 v250, v252, v253
v_cvt_pk_bf16_f32 v251, v254, v255
buffer_store_dwordx4 v[248:251], v1, s[4:7], s52 offen offset:3072 sc1
v_mov_b32 v240, s64
s_lshl_b32 s3, s50, 2
s_add_u32 s3, s3, 138240
v_mov_b32 v241, s3
ds_write_b32 v241, v240
s_waitcnt vmcnt(24)
s_waitcnt lgkmcnt(0)
s_barrier
v_mov_b32 v241, 138240
ds_read_b128 v[242:245], v241
ds_read_b64_tr_b16 v[32:33], v6 offset:0
ds_read_b64_tr_b16 v[34:35], v6 offset:6144
ds_read_b64_tr_b16 v[36:37], v6 offset:12288
ds_read_b64_tr_b16 v[38:39], v6 offset:18432
s_waitcnt lgkmcnt(4)
v_or_b32 v242, v242, v243
v_or3_b32 v242, v242, v244, v245
s_nop 0
v_readfirstlane_b32 s3, v242
s_nop 3
s_andn2_b32 s3, s3, s65
s_cmp_lg_u32 s3, 0
s_cbranch_scc1 L_redo
s_lshl_b32 s1, s14, 3
s_add_u32 s1, s1, s12
s_lshl_b32 s1, s1, 8
s_add_u32 s1, s1, 85993472
v_lshl_add_u32 v23, s50, 10, v1
v_cmp_gt_u32 vcc, 16, v23
v_lshlrev_b32 v22, 4, v1
v_mov_b32 v25, 2130706432
v_mov_b32 v23, 4
v_cndmask_b32 v22, v25, v22, vcc
v_cndmask_b32 v23, 0, v23, vcc
s_waitcnt vmcnt(23) lgkmcnt(2)
v_mfma_f32_16x16x32_bf16 v[64:67], v[32:35], a[0:3], 0
s_waitcnt vmcnt(22) lgkmcnt(0)
s_mul_i32 s54, s50, 20480
ds_read_b64_tr_b16 v[48:49], v7 offset:0
v_mfma_f32_16x16x32_bf16 v[64:67], v[36:39], a[4:7], v[64:67]
s_waitcnt vmcnt(21)
s_add_u32 s54, s54, s15
ds_read_b64_tr_b16 v[50:51], v7 offset:6144
v_mfma_f32_16x16x32_bf16 v[68:71], v[32:35], a[16:19], 0
s_waitcnt vmcnt(20)
s_mul_i32 s3, s50, 6144
ds_read_b64_tr_b16 v[52:53], v7 offset:12288
v_mfma_f32_16x16x32_bf16 v[68:71], v[36:39], a[20:23], v[68:71]
s_waitcnt vmcnt(19)
s_add_u32 m0, s3, 0
ds_read_b64_tr_b16 v[54:55], v7 offset:18432
v_mfma_f32_16x16x32_bf16 v[72:75], v[32:35], a[32:35], 0
s_waitcnt vmcnt(18)
s_add_u32 s54, s54, 81920
v_mfma_f32_16x16x32_bf16 v[72:75], v[36:39], a[36:39], v[72:75]
s_waitcnt vmcnt(17)
buffer_load_dwordx4 v26, s[36:39], s54 offen offset:0  lds
v_mfma_f32_16x16x32_bf16 v[76:79], v[32:35], a[48:51], 0
s_waitcnt vmcnt(17)
v_mfma_f32_16x16x32_bf16 v[76:79], v[36:39], a[52:55], v[76:79]
s_waitcnt lgkmcnt(2)
buffer_load_dwordx4 v27, s[36:39], s54 offen offset:1024  lds
v_mfma_f32_16x16x32_bf16 v[80:83], v[48:51], a[0:3], 0
s_waitcnt lgkmcnt(0)
ds_read_b64_tr_b16 v[32:33], v8 offset:0
v_mfma_f32_16x16x32_bf16 v[80:83], v[52:55], a[4:7], v[80:83]
ds_read_b64_tr_b16 v[34:35], v8 offset:6144
v_mfma_f32_16x16x32_bf16 v[84:87], v[48:51], a[16:19], 0
ds_read_b64_tr_b16 v[36:37], v8 offset:12288
v_mfma_f32_16x16x32_bf16 v[84:87], v[52:55], a[20:23], v[84:87]
ds_read_b64_tr_b16 v[38:39], v8 offset:18432
v_mfma_f32_16x16x32_bf16 v[88:91], v[48:51], a[32:35], 0
buffer_load_dwordx4 v28, s[36:39], s54 offen offset:2048  lds
v_mfma_f32_16x16x32_bf16 v[88:91], v[52:55], a[36:39], v[88:91]
v_mfma_f32_16x16x32_bf16 v[92:95], v[48:51], a[48:51], 0
v_mfma_f32_16x16x32_bf16 v[92:95], v[52:55], a[52:55], v[92:95]
s_waitcnt lgkmcnt(2)
v_mfma_f32_16x16x32_bf16 v[96:99], v[32:35], a[0:3], 0
s_waitcnt lgkmcnt(0)
s_add_u32 m0, s3, 3072
ds_read_b64_tr_b16 v[48:49], v9 offset:0
v_mfma_f32_16x16x32_bf16 v[96:99], v[36:39], a[4:7], v[96:99]
s_add_u32 s54, s54, 10240
ds_read_b64_tr_b16 v[50:51], v9 offset:6144
v_mfma_f32_16x16x32_bf16 v[100:103], v[32:35], a[16:19], 0
ds_read_b64_tr_b16 v[52:53], v9 offset:12288
v_mfma_f32_16x16x32_bf16 v[100:103], v[36:39], a[20:23], v[100:103]
ds_read_b64_tr_b16 v[54:55], v9 offset:18432
v_mfma_f32_16x16x32_bf16 v[104:107], v[32:35], a[32:35], 0
buffer_load_dwordx4 v26, s[36:39], s54 offen offset:0  lds
v_mfma_f32_16x16x32_bf16 v[104:107], v[36:39], a[36:39], v[104:107]
v_mfma_f32_16x16x32_bf16 v[108:111], v[32:35], a[48:51], 0
buffer_load_dwordx4 v27, s[36:39], s54 offen offset:1024  lds
v_mfma_f32_16x16x32_bf16 v[108:111], v[36:39], a[52:55], v[108:111]
s_waitcnt lgkmcnt(2)
v_mfma_f32_16x16x32_bf16 v[112:115], v[48:51], a[0:3], 0
s_waitcnt lgkmcnt(0)
ds_read_b64_tr_b16 v[32:33], v6 offset:128
v_mfma_f32_16x16x32_bf16 v[112:115], v[52:55], a[4:7], v[112:115]
ds_read_b64_tr_b16 v[34:35], v6 offset:6272
v_mfma_f32_16x16x32_bf16 v[116:119], v[48:51], a[16:19], 0
ds_read_b64_tr_b16 v[36:37], v6 offset:12416
v_mfma_f32_16x16x32_bf16 v[116:119], v[52:55], a[20:23], v[116:119]
ds_read_b64_tr_b16 v[38:39], v6 offset:18560
v_mfma_f32_16x16x32_bf16 v[120:123], v[48:51], a[32:35], 0
buffer_load_dwordx4 v28, s[36:39], s54 offen offset:2048  lds
v_mfma_f32_16x16x32_bf16 v[120:123], v[52:55], a[36:39], v[120:123]
s_mul_i32 s54, s50, 30720
v_mfma_f32_16x16x32_bf16 v[124:127], v[48:51], a[48:51], 0
s_add_u32 s54, s54, s15
v_mfma_f32_16x16x32_bf16 v[124:127], v[52:55], a[52:55], v[124:127]
s_waitcnt lgkmcnt(2)
s_mul_i32 s3, s50, 9216
v_mfma_f32_16x16x32_bf16 v[128:131], v[32:35], a[0:3], 0
s_waitcnt lgkmcnt(0)
s_add_u32 m0, s3, 49152
ds_read_b64_tr_b16 v[48:49], v7 offset:128
v_mfma_f32_16x16x32_bf16 v[128:131], v[36:39], a[4:7], v[128:131]
s_add_u32 s54, s54, 163840
ds_read_b64_tr_b16 v[50:51], v7 offset:6272
v_mfma_f32_16x16x32_bf16 v[132:135], v[32:35], a[16:19], 0
ds_read_b64_tr_b16 v[52:53], v7 offset:12416
v_mfma_f32_16x16x32_bf16 v[132:135], v[36:39], a[20:23], v[132:135]
ds_read_b64_tr_b16 v[54:55], v7 offset:18560
v_mfma_f32_16x16x32_bf16 v[136:139], v[32:35], a[32:35], 0
buffer_load_dwordx4 v26, s[36:39], s54 offen offset:0  lds
v_mfma_f32_16x16x32_bf16 v[136:139], v[36:39], a[36:39], v[136:139]
v_mfma_f32_16x16x32_bf16 v[140:143], v[32:35], a[48:51], 0
buffer_load_dwordx4 v27, s[36:39], s54 offen offset:1024  lds
v_mfma_f32_16x16x32_bf16 v[140:143], v[36:39], a[52:55], v[140:143]
s_waitcnt lgkmcnt(2)
v_mfma_f32_16x16x32_bf16 v[144:147], v[48:51], a[0:3], 0
s_waitcnt lgkmcnt(0)
ds_read_b64_tr_b16 v[32:33], v8 offset:128
v_mfma_f32_16x16x32_bf16 v[144:147], v[52:55], a[4:7], v[144:147]
ds_read_b64_tr_b16 v[34:35], v8 offset:6272
v_mfma_f32_16x16x32_bf16 v[148:151], v[48:51], a[16:19], 0
ds_read_b64_tr_b16 v[36:37], v8 offset:12416
v_mfma_f32_16x16x32_bf16 v[148:151], v[52:55], a[20:23], v[148:151]
ds_read_b64_tr_b16 v[38:39], v8 offset:18560
v_mfma_f32_16x16x32_bf16 v[152:155], v[48:51], a[32:35], 0
v_add_u32 v8, 0xfffde000, v8
v_mfma_f32_16x16x32_bf16 v[152:155], v[52:55], a[36:39], v[152:155]
buffer_load_dwordx4 v28, s[36:39], s54 offen offset:2048  lds
v_mfma_f32_16x16x32_bf16 v[156:159], v[48:51], a[48:51], 0
v_mfma_f32_16x16x32_bf16 v[156:159], v[52:55], a[52:55], v[156:159]
s_waitcnt lgkmcnt(2)
v_mfma_f32_16x16x32_bf16 v[160:163], v[32:35], a[0:3], 0
s_waitcnt vmcnt(9)
s_barrier
ds_read_b64_tr_b16 v[48:49], v9 offset:128
s_waitcnt lgkmcnt(1)
v_mfma_f32_16x16x32_bf16 v[160:163], v[36:39], a[4:7], v[160:163]
s_add_u32 m0, s3, 52224
ds_read_b64_tr_b16 v[50:51], v9 offset:6272
v_mfma_f32_16x16x32_bf16 v[164:167], v[32:35], a[16:19], 0
s_add_u32 s54, s54, 10240
ds_read_b64_tr_b16 v[52:53], v9 offset:12416
v_mfma_f32_16x16x32_bf16 v[164:167], v[36:39], a[20:23], v[164:167]
s_mov_b32 s53, s1
ds_read_b64_tr_b16 v[54:55], v9 offset:18560
v_mov_b32 v240, 1
v_mfma_f32_16x16x32_bf16 v[168:171], v[32:35], a[32:35], 0
v_add_u32 v9, 0xfffde000, v9
v_mfma_f32_16x16x32_bf16 v[168:171], v[36:39], a[36:39], v[168:171]
buffer_load_dwordx4 v26, s[36:39], s54 offen offset:0  lds
v_mfma_f32_16x16x32_bf16 v[172:175], v[32:35], a[48:51], 0
buffer_atomic_add v240, v0, s[4:7], s53 offen sc1
v_mfma_f32_16x16x32_bf16 v[172:175], v[36:39], a[52:55], v[172:175]
s_waitcnt lgkmcnt(2)
buffer_load_dwordx4 v27, s[36:39], s54 offen offset:1024  lds
v_mfma_f32_16x16x32_bf16 v[176:179], v[48:51], a[0:3], 0
s_waitcnt lgkmcnt(0)
ds_read_b64_tr_b16 v[32:33], v6 offset:256
v_mfma_f32_16x16x32_bf16 v[176:179], v[52:55], a[4:7], v[176:179]
ds_read_b64_tr_b16 v[34:35], v6 offset:6400
v_mfma_f32_16x16x32_bf16 v[180:183], v[48:51], a[16:19], 0
ds_read_b64_tr_b16 v[36:37], v6 offset:12544
v_mfma_f32_16x16x32_bf16 v[180:183], v[52:55], a[20:23], v[180:183]
ds_read_b64_tr_b16 v[38:39], v6 offset:18688
v_mfma_f32_16x16x32_bf16 v[184:187], v[48:51], a[32:35], 0
v_add_u32 v6, 0xfffde000, v6
v_mfma_f32_16x16x32_bf16 v[184:187], v[52:55], a[36:39], v[184:187]
buffer_load_dwordx4 v28, s[36:39], s54 offen offset:2048  lds
v_mfma_f32_16x16x32_bf16 v[188:191], v[48:51], a[48:51], 0
v_mfma_f32_16x16x32_bf16 v[188:191], v[52:55], a[52:55], v[188:191]
s_waitcnt lgkmcnt(2)
v_mfma_f32_16x16x32_bf16 v[192:195], v[32:35], a[0:3], 0
s_waitcnt lgkmcnt(0)
ds_read_b64_tr_b16 v[48:49], v7 offset:256
v_mfma_f32_16x16x32_bf16 v[192:195], v[36:39], a[4:7], v[192:195]
s_add_u32 m0, s3, 55296
ds_read_b64_tr_b16 v[50:51], v7 offset:6400
v_mfma_f32_16x16x32_bf16 v[196:199], v[32:35], a[16:19], 0
s_add_u32 s54, s54, 10240
ds_read_b64_tr_b16 v[52:53], v7 offset:12544
v_mfma_f32_16x16x32_bf16 v[196:199], v[36:39], a[20:23], v[196:199]
ds_read_b64_tr_b16 v[54:55], v7 offset:18688
v_mfma_f32_16x16x32_bf16 v[200:203], v[32:35], a[32:35], 0
v_add_u32 v7, 0xfffde000, v7
v_mfma_f32_16x16x32_bf16 v[200:203], v[36:39], a[36:39], v[200:203]
buffer_load_dwordx4 v26, s[36:39], s54 offen offset:0  lds
v_mfma_f32_16x16x32_bf16 v[204:207], v[32:35], a[48:51], 0
v_mfma_f32_16x16x32_bf16 v[204:207], v[36:39], a[52:55], v[204:207]
s_waitcnt lgkmcnt(2)
buffer_load_dwordx4 v27, s[36:39], s54 offen offset:1024  lds
v_mfma_f32_16x16x32_bf16 v[208:211], v[48:51], a[0:3], 0
s_waitcnt vmcnt(9)
s_waitcnt lgkmcnt(0)
s_barrier
v_mfma_f32_16x16x32_bf16 v[208:211], v[52:55], a[4:7], v[208:211]
ds_read_b64_tr_b16 v[32:33], v6 offset:0
v_mfma_f32_16x16x32_bf16 v[212:215], v[48:51], a[16:19], 0
ds_read_b64_tr_b16 v[34:35], v6 offset:6144
v_mfma_f32_16x16x32_bf16 v[212:215], v[52:55], a[20:23], v[212:215]
ds_read_b64_tr_b16 v[36:37], v6 offset:12288
v_mfma_f32_16x16x32_bf16 v[216:219], v[48:51], a[32:35], 0
ds_read_b64_tr_b16 v[38:39], v6 offset:18432
v_mfma_f32_16x16x32_bf16 v[216:219], v[52:55], a[36:39], v[216:219]
buffer_load_dwordx4 v28, s[36:39], s54 offen offset:2048  lds
v_mfma_f32_16x16x32_bf16 v[220:223], v[48:51], a[48:51], 0
v_mfma_f32_16x16x32_bf16 v[220:223], v[52:55], a[52:55], v[220:223]
s_waitcnt lgkmcnt(2)
v_mfma_f32_16x16x32_bf16 v[64:67], v[32:35], a[64:67], v[64:67]
s_waitcnt lgkmcnt(0)
ds_read_b64_tr_b16 v[48:49], v7 offset:0
v_mfma_f32_16x16x32_bf16 v[64:67], v[36:39], a[68:71], v[64:67]
s_add_u32 s55, s76, 4096
ds_read_b64_tr_b16 v[50:51], v7 offset:6144
v_mfma_f32_16x16x32_bf16 v[68:71], v[32:35], a[80:83], v[68:71]
ds_read_b64_tr_b16 v[52:53], v7 offset:12288
v_mfma_f32_16x16x32_bf16 v[68:71], v[36:39], a[84:87], v[68:71]
ds_read_b64_tr_b16 v[54:55], v7 offset:18432
v_mfma_f32_16x16x32_bf16 v[72:75], v[32:35], a[96:99], v[72:75]
buffer_load_dwordx4 a[128:131], v1, s[4:7], s55 offen offset:0 sc1
v_mfma_f32_16x16x32_bf16 v[72:75], v[36:39], a[100:103], v[72:75]
buffer_load_dwordx4 a[132:135], v1, s[4:7], s55 offen offset:1024 sc1
v_mfma_f32_16x16x32_bf16 v[76:79], v[32:35], a[112:115], v[76:79]
v_mfma_f32_16x16x32_bf16 v[76:79], v[36:39], a[116:119], v[76:79]
s_waitcnt lgkmcnt(2)
v_mfma_f32_16x16x32_bf16 v[80:83], v[48:51], a[64:67], v[80:83]
s_waitcnt lgkmcnt(0)
s_cmp_lt_u32 s12, 6
ds_read_b64_tr_b16 v[32:33], v8 offset:0
v_mfma_f32_16x16x32_bf16 v[80:83], v[52:55], a[68:71], v[80:83]
s_cselect_b32 s55, s55, 2130706432
ds_read_b64_tr_b16 v[34:35], v8 offset:6144
v_mfma_f32_16x16x32_bf16 v[84:87], v[48:51], a[80:83], v[84:87]
ds_read_b64_tr_b16 v[36:37], v8 offset:12288
v_mfma_f32_16x16x32_bf16 v[84:87], v[52:55], a[84:87], v[84:87]
ds_read_b64_tr_b16 v[38:39], v8 offset:18432
v_mfma_f32_16x16x32_bf16 v[88:91], v[48:51], a[96:99], v[88:91]
buffer_load_dwordx4 a[136:139], v1, s[4:7], s55 offen offset:2048 sc1
v_mfma_f32_16x16x32_bf16 v[88:91], v[52:55], a[100:103], v[88:91]
s_add_u32 s55, s77, 4096
v_mfma_f32_16x16x32_bf16 v[92:95], v[48:51], a[112:115], v[92:95]
buffer_load_dwordx4 a[144:147], v1, s[4:7], s55 offen offset:0 sc1
v_mfma_f32_16x16x32_bf16 v[92:95], v[52:55], a[116:119], v[92:95]
s_waitcnt lgkmcnt(2)
v_mfma_f32_16x16x32_bf16 v[96:99], v[32:35], a[64:67], v[96:99]
s_waitcnt lgkmcnt(0)
ds_read_b64_tr_b16 v[48:49], v9 offset:0
v_mfma_f32_16x16x32_bf16 v[96:99], v[36:39], a[68:71], v[96:99]
ds_read_b64_tr_b16 v[50:51], v9 offset:6144
v_mfma_f32_16x16x32_bf16 v[100:103], v[32:35], a[80:83], v[100:103]
ds_read_b64_tr_b16 v[52:53], v9 offset:12288
v_mfma_f32_16x16x32_bf16 v[100:103], v[36:39], a[84:87], v[100:103]
ds_read_b64_tr_b16 v[54:55], v9 offset:18432
v_mfma_f32_16x16x32_bf16 v[104:107], v[32:35], a[96:99], v[104:107]
buffer_load_dwordx4 a[148:151], v1, s[4:7], s55 offen offset:1024 sc1
v_mfma_f32_16x16x32_bf16 v[104:107], v[36:39], a[100:103], v[104:107]
s_cmp_lt_u32 s12, 6
v_mfma_f32_16x16x32_bf16 v[108:111], v[32:35], a[112:115], v[108:111]
s_cselect_b32 s55, s55, 2130706432
v_mfma_f32_16x16x32_bf16 v[108:111], v[36:39], a[116:119], v[108:111]
s_waitcnt lgkmcnt(2)
buffer_load_dwordx4 a[152:155], v1, s[4:7], s55 offen offset:2048 sc1
v_mfma_f32_16x16x32_bf16 v[112:115], v[48:51], a[64:67], v[112:115]
s_waitcnt lgkmcnt(0)
ds_read_b64_tr_b16 v[32:33], v6 offset:128
v_mfma_f32_16x16x32_bf16 v[112:115], v[52:55], a[68:71], v[112:115]
s_add_u32 s55, s78, 4096
ds_read_b64_tr_b16 v[34:35], v6 offset:6272
v_mfma_f32_16x16x32_bf16 v[116:119], v[48:51], a[80:83], v[116:119]
ds_read_b64_tr_b16 v[36:37], v6 offset:12416
v_mfma_f32_16x16x32_bf16 v[116:119], v[52:55], a[84:87], v[116:119]
ds_read_b64_tr_b16 v[38:39], v6 offset:18560
v_mfma_f32_16x16x32_bf16 v[120:123], v[48:51], a[96:99], v[120:123]
buffer_load_dwordx4 a[160:163], v1, s[4:7], s55 offen offset:0 sc1
v_mfma_f32_16x16x32_bf16 v[120:123], v[52:55], a[100:103], v[120:123]
buffer_load_dwordx4 a[164:167], v1, s[4:7], s55 offen offset:1024 sc1
v_mfma_f32_16x16x32_bf16 v[124:127], v[48:51], a[112:115], v[124:127]
v_mfma_f32_16x16x32_bf16 v[124:127], v[52:55], a[116:119], v[124:127]
s_waitcnt lgkmcnt(2)
v_mfma_f32_16x16x32_bf16 v[128:131], v[32:35], a[64:67], v[128:131]
s_waitcnt lgkmcnt(0)
s_cmp_lt_u32 s12, 6
ds_read_b64_tr_b16 v[48:49], v7 offset:128
v_mfma_f32_16x16x32_bf16 v[128:131], v[36:39], a[68:71], v[128:131]
s_cselect_b32 s55, s55, 2130706432
ds_read_b64_tr_b16 v[50:51], v7 offset:6272
v_mfma_f32_16x16x32_bf16 v[132:135], v[32:35], a[80:83], v[132:135]
ds_read_b64_tr_b16 v[52:53], v7 offset:12416
v_mfma_f32_16x16x32_bf16 v[132:135], v[36:39], a[84:87], v[132:135]
ds_read_b64_tr_b16 v[54:55], v7 offset:18560
v_mfma_f32_16x16x32_bf16 v[136:139], v[32:35], a[96:99], v[136:139]
buffer_load_dwordx4 a[168:171], v1, s[4:7], s55 offen offset:2048 sc1
v_mfma_f32_16x16x32_bf16 v[136:139], v[36:39], a[100:103], v[136:139]
s_add_u32 s55, s79, 4096
v_mfma_f32_16x16x32_bf16 v[140:143], v[32:35], a[112:115], v[140:143]
buffer_load_dwordx4 a[176:179], v1, s[4:7], s55 offen offset:0 sc1
v_mfma_f32_16x16x32_bf16 v[140:143], v[36:39], a[116:119], v[140:143]
s_waitcnt lgkmcnt(2)
v_mfma_f32_16x16x32_bf16 v[144:147], v[48:51], a[64:67], v[144:147]
s_waitcnt lgkmcnt(0)
ds_read_b64_tr_b16 v[32:33], v8 offset:128
v_mfma_f32_16x16x32_bf16 v[144:147], v[52:55], a[68:71], v[144:147]
ds_read_b64_tr_b16 v[34:35], v8 offset:6272
v_mfma_f32_16x16x32_bf16 v[148:151], v[48:51], a[80:83], v[148:151]
ds_read_b64_tr_b16 v[36:37], v8 offset:12416
v_mfma_f32_16x16x32_bf16 v[148:151], v[52:55], a[84:87], v[148:151]
ds_read_b64_tr_b16 v[38:39], v8 offset:18560
v_mfma_f32_16x16x32_bf16 v[152:155], v[48:51], a[96:99], v[152:155]
v_add_u32 v8, 0xc000, v8
v_mfma_f32_16x16x32_bf16 v[152:155], v[52:55], a[100:103], v[152:155]
buffer_load_dwordx4 a[180:183], v1, s[4:7], s55 offen offset:1024 sc1
v_mfma_f32_16x16x32_bf16 v[156:159], v[48:51], a[112:115], v[156:159]
v_mfma_f32_16x16x32_bf16 v[156:159], v[52:55], a[116:119], v[156:159]
s_waitcnt lgkmcnt(2)
v_mfma_f32_16x16x32_bf16 v[160:163], v[32:35], a[64:67], v[160:163]
s_waitcnt lgkmcnt(0)
ds_read_b64_tr_b16 v[48:49], v9 offset:128
v_mfma_f32_16x16x32_bf16 v[160:163], v[36:39], a[68:71], v[160:163]
s_cmp_lt_u32 s12, 6
ds_read_b64_tr_b16 v[50:51], v9 offset:6272
v_mfma_f32_16x16x32_bf16 v[164:167], v[32:35], a[80:83], v[164:167]
s_cselect_b32 s55, s55, 2130706432
ds_read_b64_tr_b16 v[52:53], v9 offset:12416
v_mfma_f32_16x16x32_bf16 v[164:167], v[36:39], a[84:87], v[164:167]
ds_read_b64_tr_b16 v[54:55], v9 offset:18560
v_mfma_f32_16x16x32_bf16 v[168:171], v[32:35], a[96:99], v[168:171]
v_add_u32 v9, 0xc000, v9
v_mfma_f32_16x16x32_bf16 v[168:171], v[36:39], a[100:103], v[168:171]
buffer_load_dwordx4 a[184:187], v1, s[4:7], s55 offen offset:2048 sc1
v_mfma_f32_16x16x32_bf16 v[172:175], v[32:35], a[112:115], v[172:175]
s_mul_i32 s54, s50, 40960
v_mfma_f32_16x16x32_bf16 v[172:175], v[36:39], a[116:119], v[172:175]
s_waitcnt lgkmcnt(2)
s_add_u32 s54, s54, s16
v_mfma_f32_16x16x32_bf16 v[176:179], v[48:51], a[64:67], v[176:179]
s_waitcnt lgkmcnt(0)
s_mul_i32 s3, s50, 12288
ds_read_b64_tr_b16 v[32:33], v6 offset:256
v_mfma_f32_16x16x32_bf16 v[176:179], v[52:55], a[68:71], v[176:179]
s_add_u32 m0, s3, 98304
ds_read_b64_tr_b16 v[34:35], v6 offset:6400
v_mfma_f32_16x16x32_bf16 v[180:183], v[48:51], a[80:83], v[180:183]
s_add_u32 s54, s54, 0
ds_read_b64_tr_b16 v[36:37], v6 offset:12544
v_mfma_f32_16x16x32_bf16 v[180:183], v[52:55], a[84:87], v[180:183]
ds_read_b64_tr_b16 v[38:39], v6 offset:18688
v_mfma_f32_16x16x32_bf16 v[184:187], v[48:51], a[96:99], v[184:187]
v_add_u32 v6, 0xc000, v6
v_mfma_f32_16x16x32_bf16 v[184:187], v[52:55], a[100:103], v[184:187]
buffer_load_dwordx4 v26, s[32:35], s54 offen offset:0  lds
v_mfma_f32_16x16x32_bf16 v[188:191], v[48:51], a[112:115], v[188:191]
buffer_load_dwordx4 v27, s[32:35], s54 offen offset:1024  lds
v_mfma_f32_16x16x32_bf16 v[188:191], v[52:55], a[116:119], v[188:191]
s_waitcnt lgkmcnt(2)
v_mfma_f32_16x16x32_bf16 v[192:195], v[32:35], a[64:67], v[192:195]
s_waitcnt lgkmcnt(0)
ds_read_b64_tr_b16 v[48:49], v7 offset:256
v_mfma_f32_16x16x32_bf16 v[192:195], v[36:39], a[68:71], v[192:195]
ds_read_b64_tr_b16 v[50:51], v7 offset:6400
v_mfma_f32_16x16x32_bf16 v[196:199], v[32:35], a[80:83], v[196:199]
ds_read_b64_tr_b16 v[52:53], v7 offset:12544
v_mfma_f32_16x16x32_bf16 v[196:199], v[36:39], a[84:87], v[196:199]
ds_read_b64_tr_b16 v[54:55], v7 offset:18688
v_mfma_f32_16x16x32_bf16 v[200:203], v[32:35], a[96:99], v[200:203]
v_add_u32 v7, 0xc000, v7
v_mfma_f32_16x16x32_bf16 v[200:203], v[36:39], a[100:103], v[200:203]
buffer_load_dwordx4 v28, s[32:35], s54 offen offset:2048  lds
v_mfma_f32_16x16x32_bf16 v[204:207], v[32:35], a[112:115], v[204:207]
s_add_u32 m0, s3, 101376
v_mfma_f32_16x16x32_bf16 v[204:207], v[36:39], a[116:119], v[204:207]
s_waitcnt lgkmcnt(2)
s_add_u32 s54, s54, 10240
v_mfma_f32_16x16x32_bf16 v[208:211], v[48:51], a[64:67], v[208:211]
s_waitcnt vmcnt(15)
s_waitcnt lgkmcnt(0)
s_barrier
buffer_load_dwordx4 v26, s[32:35], s54 offen offset:0  lds
v_mfma_f32_16x16x32_bf16 v[208:211], v[52:55], a[68:71], v[208:211]
ds_read_b64_tr_b16 v[32:33], v6 offset:0
v_mfma_f32_16x16x32_bf16 v[212:215], v[48:51], a[80:83], v[212:215]
ds_read_b64_tr_b16 v[34:35], v6 offset:6144
v_mfma_f32_16x16x32_bf16 v[212:215], v[52:55], a[84:87], v[212:215]
ds_read_b64_tr_b16 v[36:37], v6 offset:12288
v_mfma_f32_16x16x32_bf16 v[216:219], v[48:51], a[96:99], v[216:219]
ds_read_b64_tr_b16 v[38:39], v6 offset:18432
v_mfma_f32_16x16x32_bf16 v[216:219], v[52:55], a[100:103], v[216:219]
ds_read_b64_tr_b16 v[40:41], v6 offset:24576
v_mfma_f32_16x16x32_bf16 v[220:223], v[48:51], a[112:115], v[220:223]
ds_read_b64_tr_b16 v[42:43], v6 offset:30720
v_mfma_f32_16x16x32_bf16 v[220:223], v[52:55], a[116:119], v[220:223]
s_waitcnt vmcnt(15) lgkmcnt(4)
buffer_load_dwordx4 v27, s[32:35], s54 offen offset:1024  lds
v_mfma_f32_16x16x32_bf16 v[64:67], v[32:35], a[128:131], v[64:67]
s_waitcnt vmcnt(15) lgkmcnt(2)
ds_read_b64_tr_b16 v[48:49], v7 offset:0
v_mfma_f32_16x16x32_bf16 v[64:67], v[36:39], a[132:135], v[64:67]
s_waitcnt vmcnt(14) lgkmcnt(1)
ds_read_b64_tr_b16 v[50:51], v7 offset:6144
v_mfma_f32_16x16x32_bf16 v[64:67], v[40:43], a[136:139], v[64:67]
s_waitcnt vmcnt(13)
ds_read_b64_tr_b16 v[52:53], v7 offset:12288
v_mfma_f32_16x16x32_bf16 v[68:71], v[32:35], a[144:147], v[68:71]
s_waitcnt vmcnt(12)
ds_read_b64_tr_b16 v[54:55], v7 offset:18432
v_mfma_f32_16x16x32_bf16 v[68:71], v[36:39], a[148:151], v[68:71]
s_waitcnt vmcnt(11)
ds_read_b64_tr_b16 v[56:57], v7 offset:24576
v_mfma_f32_16x16x32_bf16 v[68:71], v[40:43], a[152:155], v[68:71]
s_waitcnt vmcnt(10)
ds_read_b64_tr_b16 v[58:59], v7 offset:30720
v_mfma_f32_16x16x32_bf16 v[72:75], v[32:35], a[160:163], v[72:75]
s_waitcnt vmcnt(9)
buffer_load_dwordx4 v28, s[32:35], s54 offen offset:2048  lds
v_mfma_f32_16x16x32_bf16 v[72:75], v[36:39], a[164:167], v[72:75]
s_waitcnt vmcnt(9)
s_add_u32 m0, s3, 104448
buffer_load_dword v25, v22, s[4:7], s1 offen sc1
v_mfma_f32_16x16x32_bf16 v[72:75], v[40:43], a[168:171], v[72:75]
s_waitcnt vmcnt(9)
s_add_u32 s54, s54, 10240
v_mfma_f32_16x16x32_bf16 v[76:79], v[32:35], a[176:179], v[76:79]
s_waitcnt vmcnt(8)
buffer_load_dwordx4 v26, s[32:35], s54 offen offset:0  lds
v_mfma_f32_16x16x32_bf16 v[76:79], v[36:39], a[180:183], v[76:79]
s_waitcnt vmcnt(8)
v_mfma_f32_16x16x32_bf16 v[76:79], v[40:43], a[184:187], v[76:79]
s_waitcnt lgkmcnt(4)
buffer_load_dwordx4 v27, s[32:35], s54 offen offset:1024  lds
v_mfma_f32_16x16x32_bf16 v[80:83], v[48:51], a[128:131], v[80:83]
s_waitcnt lgkmcnt(2)
ds_read_b64_tr_b16 v[32:33], v8 offset:0
v_mfma_f32_16x16x32_bf16 v[80:83], v[52:55], a[132:135], v[80:83]
s_waitcnt lgkmcnt(1)
ds_read_b64_tr_b16 v[34:35], v8 offset:6144
v_mfma_f32_16x16x32_bf16 v[80:83], v[56:59], a[136:139], v[80:83]
ds_read_b64_tr_b16 v[36:37], v8 offset:12288
v_mfma_f32_16x16x32_bf16 v[84:87], v[48:51], a[144:147], v[84:87]
ds_read_b64_tr_b16 v[38:39], v8 offset:18432
v_mfma_f32_16x16x32_bf16 v[84:87], v[52:55], a[148:151], v[84:87]
ds_read_b64_tr_b16 v[40:41], v8 offset:24576
v_mfma_f32_16x16x32_bf16 v[84:87], v[56:59], a[152:155], v[84:87]
ds_read_b64_tr_b16 v[42:43], v8 offset:30720
v_mfma_f32_16x16x32_bf16 v[88:91], v[48:51], a[160:163], v[88:91]
buffer_load_dwordx4 v28, s[32:35], s54 offen offset:2048  lds
v_mfma_f32_16x16x32_bf16 v[88:91], v[52:55], a[164:167], v[88:91]
s_add_u32 m0, s3, 107520
v_mfma_f32_16x16x32_bf16 v[88:91], v[56:59], a[168:171], v[88:91]
s_add_u32 s54, s54, 10240
v_mfma_f32_16x16x32_bf16 v[92:95], v[48:51], a[176:179], v[92:95]
buffer_load_dwordx4 v26, s[32:35], s54 offen offset:0  lds
v_mfma_f32_16x16x32_bf16 v[92:95], v[52:55], a[180:183], v[92:95]
v_mfma_f32_16x16x32_bf16 v[92:95], v[56:59], a[184:187], v[92:95]
s_waitcnt lgkmcnt(4)
buffer_load_dwordx4 v27, s[32:35], s54 offen offset:1024  lds
v_mfma_f32_16x16x32_bf16 v[96:99], v[32:35], a[128:131], v[96:99]
s_waitcnt lgkmcnt(2)
ds_read_b64_tr_b16 v[48:49], v9 offset:0
v_mfma_f32_16x16x32_bf16 v[96:99], v[36:39], a[132:135], v[96:99]
s_waitcnt lgkmcnt(1)
ds_read_b64_tr_b16 v[50:51], v9 offset:6144
v_mfma_f32_16x16x32_bf16 v[96:99], v[40:43], a[136:139], v[96:99]
ds_read_b64_tr_b16 v[52:53], v9 offset:12288
v_mfma_f32_16x16x32_bf16 v[100:103], v[32:35], a[144:147], v[100:103]
ds_read_b64_tr_b16 v[54:55], v9 offset:18432
v_mfma_f32_16x16x32_bf16 v[100:103], v[36:39], a[148:151], v[100:103]
ds_read_b64_tr_b16 v[56:57], v9 offset:24576
v_mfma_f32_16x16x32_bf16 v[100:103], v[40:43], a[152:155], v[100:103]
ds_read_b64_tr_b16 v[58:59], v9 offset:30720
v_mfma_f32_16x16x32_bf16 v[104:107], v[32:35], a[160:163], v[104:107]
buffer_load_dwordx4 v28, s[32:35], s54 offen offset:2048  lds
v_mfma_f32_16x16x32_bf16 v[104:107], v[36:39], a[164:167], v[104:107]
v_mfma_f32_16x16x32_bf16 v[104:107], v[40:43], a[168:171], v[104:107]
v_mfma_f32_16x16x32_bf16 v[108:111], v[32:35], a[176:179], v[108:111]
v_mfma_f32_16x16x32_bf16 v[108:111], v[36:39], a[180:183], v[108:111]
v_mfma_f32_16x16x32_bf16 v[108:111], v[40:43], a[184:187], v[108:111]
s_waitcnt lgkmcnt(4)
v_mfma_f32_16x16x32_bf16 v[112:115], v[48:51], a[128:131], v[112:115]
s_waitcnt lgkmcnt(2)
ds_read_b64_tr_b16 v[32:33], v6 offset:128
v_mfma_f32_16x16x32_bf16 v[112:115], v[52:55], a[132:135], v[112:115]
s_waitcnt lgkmcnt(1)
ds_read_b64_tr_b16 v[34:35], v6 offset:6272
v_mfma_f32_16x16x32_bf16 v[112:115], v[56:59], a[136:139], v[112:115]
ds_read_b64_tr_b16 v[36:37], v6 offset:12416
v_mfma_f32_16x16x32_bf16 v[116:119], v[48:51], a[144:147], v[116:119]
ds_read_b64_tr_b16 v[38:39], v6 offset:18560
v_mfma_f32_16x16x32_bf16 v[116:119], v[52:55], a[148:151], v[116:119]
s_waitcnt vmcnt(6)
ds_read_b64_tr_b16 v[40:41], v6 offset:24704
v_cmp_ge_u32 vcc, v25, v23
s_nop 3
s_cmp_eq_u64 vcc, -1
s_cbranch_scc0 L_spin_ctx
L_back_ctx:
s_barrier
v_mfma_f32_16x16x32_bf16 v[116:119], v[56:59], a[152:155], v[116:119]
s_mul_i32 s51, s12, 7
ds_read_b64_tr_b16 v[42:43], v6 offset:30848
v_mfma_f32_16x16x32_bf16 v[120:123], v[48:51], a[160:163], v[120:123]
s_min_u32 s51, s51, 48
v_mfma_f32_16x16x32_bf16 v[120:123], v[52:55], a[164:167], v[120:123]
s_add_u32 s51, s51, 128
v_mfma_f32_16x16x32_bf16 v[120:123], v[56:59], a[168:171], v[120:123]
s_lshl_b32 s55, s12, 4
v_mfma_f32_16x16x32_bf16 v[124:127], v[48:51], a[176:179], v[124:127]
s_sub_u32 s51, s51, s55
v_mfma_f32_16x16x32_bf16 v[124:127], v[52:55], a[180:183], v[124:127]
s_lshl_b32 s51, s51, 10
v_mfma_f32_16x16x32_bf16 v[124:127], v[56:59], a[184:187], v[124:127]
s_waitcnt lgkmcnt(4)
s_sub_u32 s76, s76, s51
v_mfma_f32_16x16x32_bf16 v[128:131], v[32:35], a[128:131], v[128:131]
s_waitcnt lgkmcnt(2)
s_sub_u32 s77, s77, s51
ds_read_b64_tr_b16 v[48:49], v7 offset:128
v_mfma_f32_16x16x32_bf16 v[128:131], v[36:39], a[132:135], v[128:131]
s_waitcnt lgkmcnt(1)
s_sub_u32 s78, s78, s51
ds_read_b64_tr_b16 v[50:51], v7 offset:6272
v_mfma_f32_16x16x32_bf16 v[128:131], v[40:43], a[136:139], v[128:131]
s_sub_u32 s79, s79, s51
ds_read_b64_tr_b16 v[52:53], v7 offset:12416
v_mfma_f32_16x16x32_bf16 v[132:135], v[32:35], a[144:147], v[132:135]
s_add_u32 s55, s76, 0
ds_read_b64_tr_b16 v[54:55], v7 offset:18560
v_mfma_f32_16x16x32_bf16 v[132:135], v[36:39], a[148:151], v[132:135]
ds_read_b64_tr_b16 v[56:57], v7 offset:24704
v_mfma_f32_16x16x32_bf16 v[132:135], v[40:43], a[152:155], v[132:135]
ds_read_b64_tr_b16 v[58:59], v7 offset:30848
v_mfma_f32_16x16x32_bf16 v[136:139], v[32:35], a[160:163], v[136:139]
buffer_load_dwordx4 a[192:195], v1, s[4:7], s55 offen offset:0 sc1
v_mfma_f32_16x16x32_bf16 v[136:139], v[36:39], a[164:167], v[136:139]
buffer_load_dwordx4 a[196:199], v1, s[4:7], s55 offen offset:1024 sc1
v_mfma_f32_16x16x32_bf16 v[136:139], v[40:43], a[168:171], v[136:139]
buffer_load_dwordx4 a[200:203], v1, s[4:7], s55 offen offset:2048 sc1
v_mfma_f32_16x16x32_bf16 v[140:143], v[32:35], a[176:179], v[140:143]
v_mfma_f32_16x16x32_bf16 v[140:143], v[36:39], a[180:183], v[140:143]
buffer_load_dwordx4 a[204:207], v1, s[4:7], s55 offen offset:3072 sc1
v_mfma_f32_16x16x32_bf16 v[140:143], v[40:43], a[184:187], v[140:143]
s_waitcnt lgkmcnt(4)
v_mfma_f32_16x16x32_bf16 v[144:147], v[48:51], a[128:131], v[144:147]
s_waitcnt lgkmcnt(2)
ds_read_b64_tr_b16 v[32:33], v8 offset:128
v_mfma_f32_16x16x32_bf16 v[144:147], v[52:55], a[132:135], v[144:147]
s_waitcnt lgkmcnt(1)
ds_read_b64_tr_b16 v[34:35], v8 offset:6272
v_mfma_f32_16x16x32_bf16 v[144:147], v[56:59], a[136:139], v[144:147]
ds_read_b64_tr_b16 v[36:37], v8 offset:12416
v_mfma_f32_16x16x32_bf16 v[148:151], v[48:51], a[144:147], v[148:151]
ds_read_b64_tr_b16 v[38:39], v8 offset:18560
v_mfma_f32_16x16x32_bf16 v[148:151], v[52:55], a[148:151], v[148:151]
s_add_u32 s55, s77, 0
ds_read_b64_tr_b16 v[40:41], v8 offset:24704
v_mfma_f32_16x16x32_bf16 v[148:151], v[56:59], a[152:155], v[148:151]
ds_read_b64_tr_b16 v[42:43], v8 offset:30848
v_mfma_f32_16x16x32_bf16 v[152:155], v[48:51], a[160:163], v[152:155]
v_add_u32 v8, 0xc000, v8
v_mfma_f32_16x16x32_bf16 v[152:155], v[52:55], a[164:167], v[152:155]
buffer_load_dwordx4 a[208:211], v1, s[4:7], s55 offen offset:0 sc1
v_mfma_f32_16x16x32_bf16 v[152:155], v[56:59], a[168:171], v[152:155]
buffer_load_dwordx4 a[212:215], v1, s[4:7], s55 offen offset:1024 sc1
v_mfma_f32_16x16x32_bf16 v[156:159], v[48:51], a[176:179], v[156:159]
buffer_load_dwordx4 a[216:219], v1, s[4:7], s55 offen offset:2048 sc1
v_mfma_f32_16x16x32_bf16 v[156:159], v[52:55], a[180:183], v[156:159]
v_mfma_f32_16x16x32_bf16 v[156:159], v[56:59], a[184:187], v[156:159]
s_waitcnt lgkmcnt(4)
buffer_load_dwordx4 a[220:223], v1, s[4:7], s55 offen offset:3072 sc1
v_mfma_f32_16x16x32_bf16 v[160:163], v[32:35], a[128:131], v[160:163]
s_waitcnt lgkmcnt(2)
ds_read_b64_tr_b16 v[48:49], v9 offset:128
v_mfma_f32_16x16x32_bf16 v[160:163], v[36:39], a[132:135], v[160:163]
s_waitcnt lgkmcnt(1)
ds_read_b64_tr_b16 v[50:51], v9 offset:6272
v_mfma_f32_16x16x32_bf16 v[160:163], v[40:43], a[136:139], v[160:163]
ds_read_b64_tr_b16 v[52:53], v9 offset:12416
v_mfma_f32_16x16x32_bf16 v[164:167], v[32:35], a[144:147], v[164:167]
ds_read_b64_tr_b16 v[54:55], v9 offset:18560
v_mfma_f32_16x16x32_bf16 v[164:167], v[36:39], a[148:151], v[164:167]
s_add_u32 s55, s78, 0
ds_read_b64_tr_b16 v[56:57], v9 offset:24704
v_mfma_f32_16x16x32_bf16 v[164:167], v[40:43], a[152:155], v[164:167]
ds_read_b64_tr_b16 v[58:59], v9 offset:30848
v_mfma_f32_16x16x32_bf16 v[168:171], v[32:35], a[160:163], v[168:171]
v_add_u32 v9, 0xc000, v9
v_mfma_f32_16x16x32_bf16 v[168:171], v[36:39], a[164:167], v[168:171]
buffer_load_dwordx4 a[224:227], v1, s[4:7], s55 offen offset:0 sc1
v_mfma_f32_16x16x32_bf16 v[168:171], v[40:43], a[168:171], v[168:171]
buffer_load_dwordx4 a[228:231], v1, s[4:7], s55 offen offset:1024 sc1
v_mfma_f32_16x16x32_bf16 v[172:175], v[32:35], a[176:179], v[172:175]
buffer_load_dwordx4 a[232:235], v1, s[4:7], s55 offen offset:2048 sc1
v_mfma_f32_16x16x32_bf16 v[172:175], v[36:39], a[180:183], v[172:175]
v_mfma_f32_16x16x32_bf16 v[172:175], v[40:43], a[184:187], v[172:175]
s_waitcnt lgkmcnt(4)
buffer_load_dwordx4 a[236:239], v1, s[4:7], s55 offen offset:3072 sc1
v_mfma_f32_16x16x32_bf16 v[176:179], v[48:51], a[128:131], v[176:179]
s_waitcnt lgkmcnt(2)
ds_read_b64_tr_b16 v[32:33], v6 offset:256
v_mfma_f32_16x16x32_bf16 v[176:179], v[52:55], a[132:135], v[176:179]
s_waitcnt lgkmcnt(1)
ds_read_b64_tr_b16 v[34:35], v6 offset:6400
v_mfma_f32_16x16x32_bf16 v[176:179], v[56:59], a[136:139], v[176:179]
ds_read_b64_tr_b16 v[36:37], v6 offset:12544
v_mfma_f32_16x16x32_bf16 v[180:183], v[48:51], a[144:147], v[180:183]
ds_read_b64_tr_b16 v[38:39], v6 offset:18688
v_mfma_f32_16x16x32_bf16 v[180:183], v[52:55], a[148:151], v[180:183]
s_add_u32 s55, s79, 0
ds_read_b64_tr_b16 v[40:41], v6 offset:24832
v_mfma_f32_16x16x32_bf16 v[180:183], v[56:59], a[152:155], v[180:183]
ds_read_b64_tr_b16 v[42:43], v6 offset:30976
v_mfma_f32_16x16x32_bf16 v[184:187], v[48:51], a[160:163], v[184:187]
v_add_u32 v6, 0xc000, v6
v_mfma_f32_16x16x32_bf16 v[184:187], v[52:55], a[164:167], v[184:187]
buffer_load_dwordx4 a[240:243], v1, s[4:7], s55 offen offset:0 sc1
v_mfma_f32_16x16x32_bf16 v[184:187], v[56:59], a[168:171], v[184:187]
buffer_load_dwordx4 a[244:247], v1, s[4:7], s55 offen offset:1024 sc1
v_mfma_f32_16x16x32_bf16 v[188:191], v[48:51], a[176:179], v[188:191]
buffer_load_dwordx4 a[248:251], v1, s[4:7], s55 offen offset:2048 sc1
v_mfma_f32_16x16x32_bf16 v[188:191], v[52:55], a[180:183], v[188:191]
v_mfma_f32_16x16x32_bf16 v[188:191], v[56:59], a[184:187], v[188:191]
s_waitcnt lgkmcnt(4)
buffer_load_dwordx4 a[252:255], v1, s[4:7], s55 offen offset:3072 sc1
v_mfma_f32_16x16x32_bf16 v[192:195], v[32:35], a[128:131], v[192:195]
s_waitcnt lgkmcnt(2)
s_mul_i32 s54, s50, 40960
ds_read_b64_tr_b16 v[48:49], v7 offset:256
v_mfma_f32_16x16x32_bf16 v[192:195], v[36:39], a[132:135], v[192:195]
s_waitcnt lgkmcnt(1)
s_add_u32 s54, s54, s16
ds_read_b64_tr_b16 v[50:51], v7 offset:6400
v_mfma_f32_16x16x32_bf16 v[192:195], v[40:43], a[136:139], v[192:195]
s_mul_i32 s3, s50, 12288
ds_read_b64_tr_b16 v[52:53], v7 offset:12544
v_mfma_f32_16x16x32_bf16 v[196:199], v[32:35], a[144:147], v[196:199]
s_add_u32 m0, s3, 0
ds_read_b64_tr_b16 v[54:55], v7 offset:18688
v_mfma_f32_16x16x32_bf16 v[196:199], v[36:39], a[148:151], v[196:199]
s_add_u32 s54, s54, 163840
ds_read_b64_tr_b16 v[56:57], v7 offset:24832
v_mfma_f32_16x16x32_bf16 v[196:199], v[40:43], a[152:155], v[196:199]
ds_read_b64_tr_b16 v[58:59], v7 offset:30976
v_mfma_f32_16x16x32_bf16 v[200:203], v[32:35], a[160:163], v[200:203]
v_add_u32 v7, 0xc000, v7
v_mfma_f32_16x16x32_bf16 v[200:203], v[36:39], a[164:167], v[200:203]
buffer_load_dwordx4 v26, s[32:35], s54 offen offset:0  lds
v_mfma_f32_16x16x32_bf16 v[200:203], v[40:43], a[168:171], v[200:203]
buffer_load_dwordx4 v27, s[32:35], s54 offen offset:1024  lds
v_mfma_f32_16x16x32_bf16 v[204:207], v[32:35], a[176:179], v[204:207]
v_mfma_f32_16x16x32_bf16 v[204:207], v[36:39], a[180:183], v[204:207]
v_mfma_f32_16x16x32_bf16 v[204:207], v[40:43], a[184:187], v[204:207]
s_waitcnt lgkmcnt(4)
v_mfma_f32_16x16x32_bf16 v[208:211], v[48:51], a[128:131], v[208:211]
s_waitcnt vmcnt(18)
s_waitcnt lgkmcnt(0)
s_barrier
buffer_load_dwordx4 v28, s[32:35], s54 offen offset:2048  lds
v_mfma_f32_16x16x32_bf16 v[208:211], v[52:55], a[132:135], v[208:211]
ds_read_b64_tr_b16 v[32:33], v6 offset:0
v_mfma_f32_16x16x32_bf16 v[208:211], v[56:59], a[136:139], v[208:211]
ds_read_b64_tr_b16 v[34:35], v6 offset:6144
v_mfma_f32_16x16x32_bf16 v[212:215], v[48:51], a[144:147], v[212:215]
ds_read_b64_tr_b16 v[36:37], v6 offset:12288
v_mfma_f32_16x16x32_bf16 v[212:215], v[52:55], a[148:151], v[212:215]
ds_read_b64_tr_b16 v[38:39], v6 offset:18432
v_mfma_f32_16x16x32_bf16 v[212:215], v[56:59], a[152:155], v[212:215]
s_add_u32 m0, s3, 3072
ds_read_b64_tr_b16 v[40:41], v6 offset:24576
v_mfma_f32_16x16x32_bf16 v[216:219], v[48:51], a[160:163], v[216:219]
s_add_u32 s54, s54, 10240
ds_read_b64_tr_b16 v[42:43], v6 offset:30720
v_mfma_f32_16x16x32_bf16 v[216:219], v[52:55], a[164:167], v[216:219]
ds_read_b64_tr_b16 v[44:45], v6 offset:36864
v_mfma_f32_16x16x32_bf16 v[216:219], v[56:59], a[168:171], v[216:219]
ds_read_b64_tr_b16 v[46:47], v6 offset:43008
v_mfma_f32_16x16x32_bf16 v[220:223], v[48:51], a[176:179], v[220:223]
buffer_load_dwordx4 v26, s[32:35], s54 offen offset:0  lds
v_mfma_f32_16x16x32_bf16 v[220:223], v[52:55], a[180:183], v[220:223]
buffer_load_dwordx4 v27, s[32:35], s54 offen offset:1024  lds
v_mfma_f32_16x16x32_bf16 v[220:223], v[56:59], a[184:187], v[220:223]
s_waitcnt vmcnt(20) lgkmcnt(6)
v_mfma_f32_16x16x32_bf16 v[64:67], v[32:35], a[192:195], v[64:67]
s_waitcnt vmcnt(19) lgkmcnt(4)
ds_read_b64_tr_b16 v[48:49], v7 offset:0
v_mfma_f32_16x16x32_bf16 v[64:67], v[36:39], a[196:199], v[64:67]
s_waitcnt vmcnt(18) lgkmcnt(3)
ds_read_b64_tr_b16 v[50:51], v7 offset:6144
v_mfma_f32_16x16x32_bf16 v[64:67], v[40:43], a[200:203], v[64:67]
s_waitcnt vmcnt(17) lgkmcnt(2)
ds_read_b64_tr_b16 v[52:53], v7 offset:12288
v_mfma_f32_16x16x32_bf16 v[64:67], v[44:47], a[204:207], v[64:67]
s_waitcnt vmcnt(16)
ds_read_b64_tr_b16 v[54:55], v7 offset:18432
v_mfma_f32_16x16x32_bf16 v[68:71], v[32:35], a[208:211], v[68:71]
s_waitcnt vmcnt(15)
ds_read_b64_tr_b16 v[56:57], v7 offset:24576
v_mfma_f32_16x16x32_bf16 v[68:71], v[36:39], a[212:215], v[68:71]
s_waitcnt vmcnt(14)
ds_read_b64_tr_b16 v[58:59], v7 offset:30720
v_mfma_f32_16x16x32_bf16 v[68:71], v[40:43], a[216:219], v[68:71]
s_waitcnt vmcnt(13)
ds_read_b64_tr_b16 v[60:61], v7 offset:36864
v_mfma_f32_16x16x32_bf16 v[68:71], v[44:47], a[220:223], v[68:71]
s_waitcnt vmcnt(12)
ds_read_b64_tr_b16 v[62:63], v7 offset:43008
v_mfma_f32_16x16x32_bf16 v[72:75], v[32:35], a[224:227], v[72:75]
s_waitcnt vmcnt(11)
buffer_load_dwordx4 v28, s[32:35], s54 offen offset:2048  lds
v_mfma_f32_16x16x32_bf16 v[72:75], v[36:39], a[228:231], v[72:75]
s_waitcnt vmcnt(11)
s_add_u32 m0, s3, 6144
v_mfma_f32_16x16x32_bf16 v[72:75], v[40:43], a[232:235], v[72:75]
s_waitcnt vmcnt(10)
s_add_u32 s54, s54, 10240
v_mfma_f32_16x16x32_bf16 v[72:75], v[44:47], a[236:239], v[72:75]
s_waitcnt vmcnt(9)
buffer_load_dwordx4 v26, s[32:35], s54 offen offset:0  lds
v_mfma_f32_16x16x32_bf16 v[76:79], v[32:35], a[240:243], v[76:79]
s_waitcnt vmcnt(9)
v_mfma_f32_16x16x32_bf16 v[76:79], v[36:39], a[244:247], v[76:79]
s_waitcnt vmcnt(8)
ds_read_b64_tr_b16 v[32:33], v8 offset:0
v_mfma_f32_16x16x32_bf16 v[76:79], v[40:43], a[248:251], v[76:79]
s_waitcnt vmcnt(7)
buffer_load_dwordx4 v27, s[32:35], s54 offen offset:1024  lds
v_mfma_f32_16x16x32_bf16 v[76:79], v[44:47], a[252:255], v[76:79]
s_waitcnt lgkmcnt(7)
ds_read_b64_tr_b16 v[34:35], v8 offset:6144
v_mfma_f32_16x16x32_bf16 v[80:83], v[48:51], a[192:195], v[80:83]
s_waitcnt lgkmcnt(6)
buffer_load_dwordx4 v28, s[32:35], s54 offen offset:2048  lds
v_mfma_f32_16x16x32_bf16 v[80:83], v[52:55], a[196:199], v[80:83]
s_waitcnt lgkmcnt(4)
s_add_u32 m0, s3, 9216
ds_read_b64_tr_b16 v[36:37], v8 offset:12288
v_mfma_f32_16x16x32_bf16 v[80:83], v[56:59], a[200:203], v[80:83]
s_waitcnt lgkmcnt(3)
s_add_u32 s54, s54, 10240
v_mfma_f32_16x16x32_bf16 v[80:83], v[60:63], a[204:207], v[80:83]
ds_read_b64_tr_b16 v[38:39], v8 offset:18432
v_mfma_f32_16x16x32_bf16 v[84:87], v[48:51], a[208:211], v[84:87]
buffer_load_dwordx4 v26, s[32:35], s54 offen offset:0  lds
v_mfma_f32_16x16x32_bf16 v[84:87], v[52:55], a[212:215], v[84:87]
ds_read_b64_tr_b16 v[40:41], v8 offset:24576
v_mfma_f32_16x16x32_bf16 v[84:87], v[56:59], a[216:219], v[84:87]
v_mfma_f32_16x16x32_bf16 v[84:87], v[60:63], a[220:223], v[84:87]
ds_read_b64_tr_b16 v[42:43], v8 offset:30720
v_mfma_f32_16x16x32_bf16 v[88:91], v[48:51], a[224:227], v[88:91]
buffer_load_dwordx4 v27, s[32:35], s54 offen offset:1024  lds
v_mfma_f32_16x16x32_bf16 v[88:91], v[52:55], a[228:231], v[88:91]
ds_read_b64_tr_b16 v[44:45], v8 offset:36864
v_mfma_f32_16x16x32_bf16 v[88:91], v[56:59], a[232:235], v[88:91]
v_mfma_f32_16x16x32_bf16 v[88:91], v[60:63], a[236:239], v[88:91]
ds_read_b64_tr_b16 v[46:47], v8 offset:43008
v_mfma_f32_16x16x32_bf16 v[92:95], v[48:51], a[240:243], v[92:95]
buffer_load_dwordx4 v28, s[32:35], s54 offen offset:2048  lds
v_mfma_f32_16x16x32_bf16 v[92:95], v[52:55], a[244:247], v[92:95]
s_add_u32 s55, s76, 4096
ds_read_b64_tr_b16 v[48:49], v9 offset:0
v_mfma_f32_16x16x32_bf16 v[92:95], v[56:59], a[248:251], v[92:95]
buffer_load_dwordx4 a[0:3], v1, s[4:7], s55 offen offset:0 sc1
v_mfma_f32_16x16x32_bf16 v[92:95], v[60:63], a[252:255], v[92:95]
s_waitcnt lgkmcnt(7)
ds_read_b64_tr_b16 v[50:51], v9 offset:6144
v_mfma_f32_16x16x32_bf16 v[96:99], v[32:35], a[192:195], v[96:99]
s_waitcnt lgkmcnt(6)
v_mfma_f32_16x16x32_bf16 v[96:99], v[36:39], a[196:199], v[96:99]
s_waitcnt lgkmcnt(4)
ds_read_b64_tr_b16 v[52:53], v9 offset:12288
v_mfma_f32_16x16x32_bf16 v[96:99], v[40:43], a[200:203], v[96:99]
s_waitcnt lgkmcnt(3)
buffer_load_dwordx4 a[4:7], v1, s[4:7], s55 offen offset:1024 sc1
v_mfma_f32_16x16x32_bf16 v[96:99], v[44:47], a[204:207], v[96:99]
ds_read_b64_tr_b16 v[54:55], v9 offset:18432
v_mfma_f32_16x16x32_bf16 v[100:103], v[32:35], a[208:211], v[100:103]
v_mfma_f32_16x16x32_bf16 v[100:103], v[36:39], a[212:215], v[100:103]
ds_read_b64_tr_b16 v[56:57], v9 offset:24576
v_mfma_f32_16x16x32_bf16 v[100:103], v[40:43], a[216:219], v[100:103]
buffer_load_dwordx4 a[8:11], v1, s[4:7], s55 offen offset:2048 sc1
v_mfma_f32_16x16x32_bf16 v[100:103], v[44:47], a[220:223], v[100:103]
ds_read_b64_tr_b16 v[58:59], v9 offset:30720
v_mfma_f32_16x16x32_bf16 v[104:107], v[32:35], a[224:227], v[104:107]
v_mfma_f32_16x16x32_bf16 v[104:107], v[36:39], a[228:231], v[104:107]
ds_read_b64_tr_b16 v[60:61], v9 offset:36864
v_mfma_f32_16x16x32_bf16 v[104:107], v[40:43], a[232:235], v[104:107]
buffer_load_dwordx4 a[12:15], v1, s[4:7], s55 offen offset:3072 sc1
v_mfma_f32_16x16x32_bf16 v[104:107], v[44:47], a[236:239], v[104:107]
s_add_u32 s55, s77, 4096
ds_read_b64_tr_b16 v[62:63], v9 offset:43008
v_mfma_f32_16x16x32_bf16 v[108:111], v[32:35], a[240:243], v[108:111]
buffer_load_dwordx4 a[16:19], v1, s[4:7], s55 offen offset:0 sc1
v_mfma_f32_16x16x32_bf16 v[108:111], v[36:39], a[244:247], v[108:111]
ds_read_b64_tr_b16 v[32:33], v6 offset:128
v_mfma_f32_16x16x32_bf16 v[108:111], v[40:43], a[248:251], v[108:111]
v_mfma_f32_16x16x32_bf16 v[108:111], v[44:47], a[252:255], v[108:111]
s_waitcnt lgkmcnt(7)
ds_read_b64_tr_b16 v[34:35], v6 offset:6272
v_mfma_f32_16x16x32_bf16 v[112:115], v[48:51], a[192:195], v[112:115]
s_waitcnt lgkmcnt(6)
buffer_load_dwordx4 a[20:23], v1, s[4:7], s55 offen offset:1024 sc1
v_mfma_f32_16x16x32_bf16 v[112:115], v[52:55], a[196:199], v[112:115]
s_waitcnt lgkmcnt(4)
ds_read_b64_tr_b16 v[36:37], v6 offset:12416
v_mfma_f32_16x16x32_bf16 v[112:115], v[56:59], a[200:203], v[112:115]
s_waitcnt lgkmcnt(3)
v_mfma_f32_16x16x32_bf16 v[112:115], v[60:63], a[204:207], v[112:115]
ds_read_b64_tr_b16 v[38:39], v6 offset:18560
v_mfma_f32_16x16x32_bf16 v[116:119], v[48:51], a[208:211], v[116:119]
buffer_load_dwordx4 a[24:27], v1, s[4:7], s55 offen offset:2048 sc1
v_mfma_f32_16x16x32_bf16 v[116:119], v[52:55], a[212:215], v[116:119]
ds_read_b64_tr_b16 v[40:41], v6 offset:24704
v_mfma_f32_16x16x32_bf16 v[116:119], v[56:59], a[216:219], v[116:119]
v_mfma_f32_16x16x32_bf16 v[116:119], v[60:63], a[220:223], v[116:119]
ds_read_b64_tr_b16 v[42:43], v6 offset:30848
v_mfma_f32_16x16x32_bf16 v[120:123], v[48:51], a[224:227], v[120:123]
buffer_load_dwordx4 a[28:31], v1, s[4:7], s55 offen offset:3072 sc1
v_mfma_f32_16x16x32_bf16 v[120:123], v[52:55], a[228:231], v[120:123]
s_add_u32 s55, s78, 4096
ds_read_b64_tr_b16 v[44:45], v6 offset:36992
v_mfma_f32_16x16x32_bf16 v[120:123], v[56:59], a[232:235], v[120:123]
buffer_load_dwordx4 a[32:35], v1, s[4:7], s55 offen offset:0 sc1
v_mfma_f32_16x16x32_bf16 v[120:123], v[60:63], a[236:239], v[120:123]
ds_read_b64_tr_b16 v[46:47], v6 offset:43136
v_mfma_f32_16x16x32_bf16 v[124:127], v[48:51], a[240:243], v[124:127]
v_mfma_f32_16x16x32_bf16 v[124:127], v[52:55], a[244:247], v[124:127]
ds_read_b64_tr_b16 v[48:49], v7 offset:128
v_mfma_f32_16x16x32_bf16 v[124:127], v[56:59], a[248:251], v[124:127]
buffer_load_dwordx4 a[36:39], v1, s[4:7], s55 offen offset:1024 sc1
v_mfma_f32_16x16x32_bf16 v[124:127], v[60:63], a[252:255], v[124:127]
s_waitcnt lgkmcnt(7)
ds_read_b64_tr_b16 v[50:51], v7 offset:6272
v_mfma_f32_16x16x32_bf16 v[128:131], v[32:35], a[192:195], v[128:131]
s_waitcnt lgkmcnt(6)
v_mfma_f32_16x16x32_bf16 v[128:131], v[36:39], a[196:199], v[128:131]
s_waitcnt lgkmcnt(4)
ds_read_b64_tr_b16 v[52:53], v7 offset:12416
v_mfma_f32_16x16x32_bf16 v[128:131], v[40:43], a[200:203], v[128:131]
s_waitcnt lgkmcnt(3)
buffer_load_dwordx4 a[40:43], v1, s[4:7], s55 offen offset:2048 sc1
v_mfma_f32_16x16x32_bf16 v[128:131], v[44:47], a[204:207], v[128:131]
ds_read_b64_tr_b16 v[54:55], v7 offset:18560
v_mfma_f32_16x16x32_bf16 v[132:135], v[32:35], a[208:211], v[132:135]
v_mfma_f32_16x16x32_bf16 v[132:135], v[36:39], a[212:215], v[132:135]
ds_read_b64_tr_b16 v[56:57], v7 offset:24704
v_mfma_f32_16x16x32_bf16 v[132:135], v[40:43], a[216:219], v[132:135]
buffer_load_dwordx4 a[44:47], v1, s[4:7], s55 offen offset:3072 sc1
v_mfma_f32_16x16x32_bf16 v[132:135], v[44:47], a[220:223], v[132:135]
s_add_u32 s55, s79, 4096
ds_read_b64_tr_b16 v[58:59], v7 offset:30848
v_mfma_f32_16x16x32_bf16 v[136:139], v[32:35], a[224:227], v[136:139]
buffer_load_dwordx4 a[48:51], v1, s[4:7], s55 offen offset:0 sc1
v_mfma_f32_16x16x32_bf16 v[136:139], v[36:39], a[228:231], v[136:139]
ds_read_b64_tr_b16 v[60:61], v7 offset:36992
v_mfma_f32_16x16x32_bf16 v[136:139], v[40:43], a[232:235], v[136:139]
v_mfma_f32_16x16x32_bf16 v[136:139], v[44:47], a[236:239], v[136:139]
ds_read_b64_tr_b16 v[62:63], v7 offset:43136
v_mfma_f32_16x16x32_bf16 v[140:143], v[32:35], a[240:243], v[140:143]
buffer_load_dwordx4 a[52:55], v1, s[4:7], s55 offen offset:1024 sc1
v_mfma_f32_16x16x32_bf16 v[140:143], v[36:39], a[244:247], v[140:143]
ds_read_b64_tr_b16 v[32:33], v8 offset:128
v_mfma_f32_16x16x32_bf16 v[140:143], v[40:43], a[248:251], v[140:143]
v_mfma_f32_16x16x32_bf16 v[140:143], v[44:47], a[252:255], v[140:143]
s_waitcnt lgkmcnt(7)
ds_read_b64_tr_b16 v[34:35], v8 offset:6272
v_mfma_f32_16x16x32_bf16 v[144:147], v[48:51], a[192:195], v[144:147]
s_waitcnt lgkmcnt(6)
buffer_load_dwordx4 a[56:59], v1, s[4:7], s55 offen offset:2048 sc1
v_mfma_f32_16x16x32_bf16 v[144:147], v[52:55], a[196:199], v[144:147]
s_waitcnt lgkmcnt(4)
ds_read_b64_tr_b16 v[36:37], v8 offset:12416
v_mfma_f32_16x16x32_bf16 v[144:147], v[56:59], a[200:203], v[144:147]
s_waitcnt lgkmcnt(3)
v_mfma_f32_16x16x32_bf16 v[144:147], v[60:63], a[204:207], v[144:147]
ds_read_b64_tr_b16 v[38:39], v8 offset:18560
v_mfma_f32_16x16x32_bf16 v[148:151], v[48:51], a[208:211], v[148:151]
buffer_load_dwordx4 a[60:63], v1, s[4:7], s55 offen offset:3072 sc1
v_mfma_f32_16x16x32_bf16 v[148:151], v[52:55], a[212:215], v[148:151]
s_mul_i32 s54, s50, 40960
ds_read_b64_tr_b16 v[40:41], v8 offset:24704
v_mfma_f32_16x16x32_bf16 v[148:151], v[56:59], a[216:219], v[148:151]
s_add_u32 s54, s54, s16
v_mfma_f32_16x16x32_bf16 v[148:151], v[60:63], a[220:223], v[148:151]
s_mul_i32 s3, s50, 12288
ds_read_b64_tr_b16 v[42:43], v8 offset:30848
v_mfma_f32_16x16x32_bf16 v[152:155], v[48:51], a[224:227], v[152:155]
s_add_u32 m0, s3, 49152
v_mfma_f32_16x16x32_bf16 v[152:155], v[52:55], a[228:231], v[152:155]
s_add_u32 s54, s54, 327680
ds_read_b64_tr_b16 v[44:45], v8 offset:36992
v_mfma_f32_16x16x32_bf16 v[152:155], v[56:59], a[232:235], v[152:155]
buffer_load_dwordx4 v26, s[32:35], s54 offen offset:0  lds
v_mfma_f32_16x16x32_bf16 v[152:155], v[60:63], a[236:239], v[152:155]
ds_read_b64_tr_b16 v[46:47], v8 offset:43136
v_mfma_f32_16x16x32_bf16 v[156:159], v[48:51], a[240:243], v[156:159]
v_add_u32 v8, 0xfffe8000, v8
v_mfma_f32_16x16x32_bf16 v[156:159], v[52:55], a[244:247], v[156:159]
ds_read_b64_tr_b16 v[48:49], v9 offset:128
v_mfma_f32_16x16x32_bf16 v[156:159], v[56:59], a[248:251], v[156:159]
buffer_load_dwordx4 v27, s[32:35], s54 offen offset:1024  lds
v_mfma_f32_16x16x32_bf16 v[156:159], v[60:63], a[252:255], v[156:159]
s_waitcnt lgkmcnt(7)
ds_read_b64_tr_b16 v[50:51], v9 offset:6272
v_mfma_f32_16x16x32_bf16 v[160:163], v[32:35], a[192:195], v[160:163]
s_waitcnt lgkmcnt(6)
buffer_load_dwordx4 v28, s[32:35], s54 offen offset:2048  lds
v_mfma_f32_16x16x32_bf16 v[160:163], v[36:39], a[196:199], v[160:163]
s_waitcnt lgkmcnt(4)
s_add_u32 m0, s3, 52224
ds_read_b64_tr_b16 v[52:53], v9 offset:12416
v_mfma_f32_16x16x32_bf16 v[160:163], v[40:43], a[200:203], v[160:163]
s_waitcnt lgkmcnt(3)
s_add_u32 s54, s54, 10240
v_mfma_f32_16x16x32_bf16 v[160:163], v[44:47], a[204:207], v[160:163]
ds_read_b64_tr_b16 v[54:55], v9 offset:18560
v_mfma_f32_16x16x32_bf16 v[164:167], v[32:35], a[208:211], v[164:167]
buffer_load_dwordx4 v26, s[32:35], s54 offen offset:0  lds
v_mfma_f32_16x16x32_bf16 v[164:167], v[36:39], a[212:215], v[164:167]
ds_read_b64_tr_b16 v[56:57], v9 offset:24704
v_mfma_f32_16x16x32_bf16 v[164:167], v[40:43], a[216:219], v[164:167]
buffer_load_dwordx4 v27, s[32:35], s54 offen offset:1024  lds
v_mfma_f32_16x16x32_bf16 v[164:167], v[44:47], a[220:223], v[164:167]
ds_read_b64_tr_b16 v[58:59], v9 offset:30848
v_mfma_f32_16x16x32_bf16 v[168:171], v[32:35], a[224:227], v[168:171]
v_mfma_f32_16x16x32_bf16 v[168:171], v[36:39], a[228:231], v[168:171]
ds_read_b64_tr_b16 v[60:61], v9 offset:36992
v_mfma_f32_16x16x32_bf16 v[168:171], v[40:43], a[232:235], v[168:171]
buffer_load_dwordx4 v28, s[32:35], s54 offen offset:2048  lds
v_mfma_f32_16x16x32_bf16 v[168:171], v[44:47], a[236:239], v[168:171]
s_add_u32 m0, s3, 55296
ds_read_b64_tr_b16 v[62:63], v9 offset:43136
v_mfma_f32_16x16x32_bf16 v[172:175], v[32:35], a[240:243], v[172:175]
s_add_u32 s54, s54, 10240
v_add_u32 v9, 0xfffe8000, v9
v_mfma_f32_16x16x32_bf16 v[172:175], v[36:39], a[244:247], v[172:175]
ds_read_b64_tr_b16 v[32:33], v6 offset:256
v_mfma_f32_16x16x32_bf16 v[172:175], v[40:43], a[248:251], v[172:175]
buffer_load_dwordx4 v26, s[32:35], s54 offen offset:0  lds
v_mfma_f32_16x16x32_bf16 v[172:175], v[44:47], a[252:255], v[172:175]
s_waitcnt lgkmcnt(7)
ds_read_b64_tr_b16 v[34:35], v6 offset:6400
v_mfma_f32_16x16x32_bf16 v[176:179], v[48:51], a[192:195], v[176:179]
s_waitcnt lgkmcnt(6)
v_mfma_f32_16x16x32_bf16 v[176:179], v[52:55], a[196:199], v[176:179]
s_waitcnt lgkmcnt(4)
ds_read_b64_tr_b16 v[36:37], v6 offset:12544
v_mfma_f32_16x16x32_bf16 v[176:179], v[56:59], a[200:203], v[176:179]
s_waitcnt lgkmcnt(3)
buffer_load_dwordx4 v27, s[32:35], s54 offen offset:1024  lds
v_mfma_f32_16x16x32_bf16 v[176:179], v[60:63], a[204:207], v[176:179]
ds_read_b64_tr_b16 v[38:39], v6 offset:18688
v_mfma_f32_16x16x32_bf16 v[180:183], v[48:51], a[208:211], v[180:183]
buffer_load_dwordx4 v28, s[32:35], s54 offen offset:2048  lds
v_mfma_f32_16x16x32_bf16 v[180:183], v[52:55], a[212:215], v[180:183]
s_add_u32 m0, s3, 58368
ds_read_b64_tr_b16 v[40:41], v6 offset:24832
v_mfma_f32_16x16x32_bf16 v[180:183], v[56:59], a[216:219], v[180:183]
s_add_u32 s54, s54, 10240
v_mfma_f32_16x16x32_bf16 v[180:183], v[60:63], a[220:223], v[180:183]
ds_read_b64_tr_b16 v[42:43], v6 offset:30976
v_mfma_f32_16x16x32_bf16 v[184:187], v[48:51], a[224:227], v[184:187]
buffer_load_dwordx4 v26, s[32:35], s54 offen offset:0  lds
v_mfma_f32_16x16x32_bf16 v[184:187], v[52:55], a[228:231], v[184:187]
ds_read_b64_tr_b16 v[44:45], v6 offset:37120
v_mfma_f32_16x16x32_bf16 v[184:187], v[56:59], a[232:235], v[184:187]
v_mfma_f32_16x16x32_bf16 v[184:187], v[60:63], a[236:239], v[184:187]
ds_read_b64_tr_b16 v[46:47], v6 offset:43264
v_mfma_f32_16x16x32_bf16 v[188:191], v[48:51], a[240:243], v[188:191]
v_add_u32 v6, 0xfffe8000, v6
v_mfma_f32_16x16x32_bf16 v[188:191], v[52:55], a[244:247], v[188:191]
ds_read_b64_tr_b16 v[48:49], v7 offset:256
v_mfma_f32_16x16x32_bf16 v[188:191], v[56:59], a[248:251], v[188:191]
buffer_load_dwordx4 v27, s[32:35], s54 offen offset:1024  lds
v_mfma_f32_16x16x32_bf16 v[188:191], v[60:63], a[252:255], v[188:191]
s_waitcnt lgkmcnt(7)
ds_read_b64_tr_b16 v[50:51], v7 offset:6400
v_mfma_f32_16x16x32_bf16 v[192:195], v[32:35], a[192:195], v[192:195]
s_waitcnt lgkmcnt(6)
buffer_load_dwordx4 v28, s[32:35], s54 offen offset:2048  lds
v_mfma_f32_16x16x32_bf16 v[192:195], v[36:39], a[196:199], v[192:195]
s_waitcnt lgkmcnt(4)
s_add_u32 s55, s76, 8192
ds_read_b64_tr_b16 v[52:53], v7 offset:12544
v_mfma_f32_16x16x32_bf16 v[192:195], v[40:43], a[200:203], v[192:195]
s_waitcnt lgkmcnt(3)
v_mfma_f32_16x16x32_bf16 v[192:195], v[44:47], a[204:207], v[192:195]
ds_read_b64_tr_b16 v[54:55], v7 offset:18688
v_mfma_f32_16x16x32_bf16 v[196:199], v[32:35], a[208:211], v[196:199]
buffer_load_dwordx4 a[64:67], v1, s[4:7], s55 offen offset:0 sc1
v_mfma_f32_16x16x32_bf16 v[196:199], v[36:39], a[212:215], v[196:199]
ds_read_b64_tr_b16 v[56:57], v7 offset:24832
v_mfma_f32_16x16x32_bf16 v[196:199], v[40:43], a[216:219], v[196:199]
buffer_load_dwordx4 a[68:71], v1, s[4:7], s55 offen offset:1024 sc1
v_mfma_f32_16x16x32_bf16 v[196:199], v[44:47], a[220:223], v[196:199]
ds_read_b64_tr_b16 v[58:59], v7 offset:30976
v_mfma_f32_16x16x32_bf16 v[200:203], v[32:35], a[224:227], v[200:203]
v_mfma_f32_16x16x32_bf16 v[200:203], v[36:39], a[228:231], v[200:203]
ds_read_b64_tr_b16 v[60:61], v7 offset:37120
v_mfma_f32_16x16x32_bf16 v[200:203], v[40:43], a[232:235], v[200:203]
buffer_load_dwordx4 a[72:75], v1, s[4:7], s55 offen offset:2048 sc1
v_mfma_f32_16x16x32_bf16 v[200:203], v[44:47], a[236:239], v[200:203]
ds_read_b64_tr_b16 v[62:63], v7 offset:43264
v_mfma_f32_16x16x32_bf16 v[204:207], v[32:35], a[240:243], v[204:207]
v_add_u32 v7, 0xfffe8000, v7
v_mfma_f32_16x16x32_bf16 v[204:207], v[36:39], a[244:247], v[204:207]
buffer_load_dwordx4 a[76:79], v1, s[4:7], s55 offen offset:3072 sc1
v_mfma_f32_16x16x32_bf16 v[204:207], v[40:43], a[248:251], v[204:207]
v_mfma_f32_16x16x32_bf16 v[204:207], v[44:47], a[252:255], v[204:207]
s_waitcnt lgkmcnt(6)
v_mfma_f32_16x16x32_bf16 v[208:211], v[48:51], a[192:195], v[208:211]
s_waitcnt vmcnt(32)
s_waitcnt lgkmcnt(0)
s_barrier
v_mfma_f32_16x16x32_bf16 v[208:211], v[52:55], a[196:199], v[208:211]
ds_read_b64_tr_b16 v[32:33], v6 offset:0
v_mfma_f32_16x16x32_bf16 v[208:211], v[56:59], a[200:203], v[208:211]
s_add_u32 s55, s77, 8192
ds_read_b64_tr_b16 v[34:35], v6 offset:6144
v_mfma_f32_16x16x32_bf16 v[208:211], v[60:63], a[204:207], v[208:211]
ds_read_b64_tr_b16 v[36:37], v6 offset:12288
v_mfma_f32_16x16x32_bf16 v[212:215], v[48:51], a[208:211], v[212:215]
ds_read_b64_tr_b16 v[38:39], v6 offset:18432
v_mfma_f32_16x16x32_bf16 v[212:215], v[52:55], a[212:215], v[212:215]
buffer_load_dwordx4 a[80:83], v1, s[4:7], s55 offen offset:0 sc1
v_mfma_f32_16x16x32_bf16 v[212:215], v[56:59], a[216:219], v[212:215]
ds_read_b64_tr_b16 v[40:41], v6 offset:24576
v_mfma_f32_16x16x32_bf16 v[212:215], v[60:63], a[220:223], v[212:215]
buffer_load_dwordx4 a[84:87], v1, s[4:7], s55 offen offset:1024 sc1
v_mfma_f32_16x16x32_bf16 v[216:219], v[48:51], a[224:227], v[216:219]
ds_read_b64_tr_b16 v[42:43], v6 offset:30720
v_mfma_f32_16x16x32_bf16 v[216:219], v[52:55], a[228:231], v[216:219]
v_mfma_f32_16x16x32_bf16 v[216:219], v[56:59], a[232:235], v[216:219]
ds_read_b64_tr_b16 v[44:45], v6 offset:36864
v_mfma_f32_16x16x32_bf16 v[216:219], v[60:63], a[236:239], v[216:219]
buffer_load_dwordx4 a[88:91], v1, s[4:7], s55 offen offset:2048 sc1
v_mfma_f32_16x16x32_bf16 v[220:223], v[48:51], a[240:243], v[220:223]
ds_read_b64_tr_b16 v[46:47], v6 offset:43008
v_mfma_f32_16x16x32_bf16 v[220:223], v[52:55], a[244:247], v[220:223]
ds_read_b64_tr_b16 v[48:49], v7 offset:0
v_mfma_f32_16x16x32_bf16 v[220:223], v[56:59], a[248:251], v[220:223]
buffer_load_dwordx4 a[92:95], v1, s[4:7], s55 offen offset:3072 sc1
v_mfma_f32_16x16x32_bf16 v[220:223], v[60:63], a[252:255], v[220:223]
s_waitcnt vmcnt(35) lgkmcnt(7)
s_add_u32 s55, s78, 8192
ds_read_b64_tr_b16 v[50:51], v7 offset:6144
v_mfma_f32_16x16x32_bf16 v[64:67], v[32:35], a[0:3], v[64:67]
s_waitcnt vmcnt(34) lgkmcnt(6)
v_mfma_f32_16x16x32_bf16 v[64:67], v[36:39], a[4:7], v[64:67]
s_waitcnt vmcnt(33) lgkmcnt(4)
ds_read_b64_tr_b16 v[52:53], v7 offset:12288
v_mfma_f32_16x16x32_bf16 v[64:67], v[40:43], a[8:11], v[64:67]
s_waitcnt vmcnt(32) lgkmcnt(3)
buffer_load_dwordx4 a[96:99], v1, s[4:7], s55 offen offset:0 sc1
v_mfma_f32_16x16x32_bf16 v[64:67], v[44:47], a[12:15], v[64:67]
s_waitcnt vmcnt(32)
ds_read_b64_tr_b16 v[54:55], v7 offset:18432
v_mfma_f32_16x16x32_bf16 v[68:71], v[32:35], a[16:19], v[68:71]
s_waitcnt vmcnt(31)
buffer_load_dwordx4 a[100:103], v1, s[4:7], s55 offen offset:1024 sc1
v_mfma_f32_16x16x32_bf16 v[68:71], v[36:39], a[20:23], v[68:71]
s_waitcnt vmcnt(31)
ds_read_b64_tr_b16 v[56:57], v7 offset:24576
v_mfma_f32_16x16x32_bf16 v[68:71], v[40:43], a[24:27], v[68:71]
s_waitcnt vmcnt(30)
v_mfma_f32_16x16x32_bf16 v[68:71], v[44:47], a[28:31], v[68:71]
s_waitcnt vmcnt(29)
ds_read_b64_tr_b16 v[58:59], v7 offset:30720
v_mfma_f32_16x16x32_bf16 v[72:75], v[32:35], a[32:35], v[72:75]
s_waitcnt vmcnt(28)
buffer_load_dwordx4 a[104:107], v1, s[4:7], s55 offen offset:2048 sc1
v_mfma_f32_16x16x32_bf16 v[72:75], v[36:39], a[36:39], v[72:75]
s_waitcnt vmcnt(28)
ds_read_b64_tr_b16 v[60:61], v7 offset:36864
v_mfma_f32_16x16x32_bf16 v[72:75], v[40:43], a[40:43], v[72:75]
s_waitcnt vmcnt(27)
v_mfma_f32_16x16x32_bf16 v[72:75], v[44:47], a[44:47], v[72:75]
s_waitcnt vmcnt(26)
ds_read_b64_tr_b16 v[62:63], v7 offset:43008
v_mfma_f32_16x16x32_bf16 v[76:79], v[32:35], a[48:51], v[76:79]
s_waitcnt vmcnt(25)
buffer_load_dwordx4 a[108:111], v1, s[4:7], s55 offen offset:3072 sc1
v_mfma_f32_16x16x32_bf16 v[76:79], v[36:39], a[52:55], v[76:79]
s_waitcnt vmcnt(25)
s_add_u32 s55, s79, 8192
ds_read_b64_tr_b16 v[32:33], v8 offset:0
v_mfma_f32_16x16x32_bf16 v[76:79], v[40:43], a[56:59], v[76:79]
s_waitcnt vmcnt(24)
v_mfma_f32_16x16x32_bf16 v[76:79], v[44:47], a[60:63], v[76:79]
s_waitcnt lgkmcnt(7)
ds_read_b64_tr_b16 v[34:35], v8 offset:6144
v_mfma_f32_16x16x32_bf16 v[80:83], v[48:51], a[0:3], v[80:83]
s_waitcnt lgkmcnt(6)
buffer_load_dwordx4 a[112:115], v1, s[4:7], s55 offen offset:0 sc1
v_mfma_f32_16x16x32_bf16 v[80:83], v[52:55], a[4:7], v[80:83]
s_waitcnt lgkmcnt(4)
ds_read_b64_tr_b16 v[36:37], v8 offset:12288
v_mfma_f32_16x16x32_bf16 v[80:83], v[56:59], a[8:11], v[80:83]
s_waitcnt lgkmcnt(3)
buffer_load_dwordx4 a[116:119], v1, s[4:7], s55 offen offset:1024 sc1
v_mfma_f32_16x16x32_bf16 v[80:83], v[60:63], a[12:15], v[80:83]
ds_read_b64_tr_b16 v[38:39], v8 offset:18432
v_mfma_f32_16x16x32_bf16 v[84:87], v[48:51], a[16:19], v[84:87]
v_mfma_f32_16x16x32_bf16 v[84:87], v[52:55], a[20:23], v[84:87]
ds_read_b64_tr_b16 v[40:41], v8 offset:24576
v_mfma_f32_16x16x32_bf16 v[84:87], v[56:59], a[24:27], v[84:87]
buffer_load_dwordx4 a[120:123], v1, s[4:7], s55 offen offset:2048 sc1
v_mfma_f32_16x16x32_bf16 v[84:87], v[60:63], a[28:31], v[84:87]
ds_read_b64_tr_b16 v[42:43], v8 offset:30720
v_mfma_f32_16x16x32_bf16 v[88:91], v[48:51], a[32:35], v[88:91]
v_mfma_f32_16x16x32_bf16 v[88:91], v[52:55], a[36:39], v[88:91]
ds_read_b64_tr_b16 v[44:45], v8 offset:36864
v_mfma_f32_16x16x32_bf16 v[88:91], v[56:59], a[40:43], v[88:91]
buffer_load_dwordx4 a[124:127], v1, s[4:7], s55 offen offset:3072 sc1
v_mfma_f32_16x16x32_bf16 v[88:91], v[60:63], a[44:47], v[88:91]
s_add_u32 s55, s76, 12288
ds_read_b64_tr_b16 v[46:47], v8 offset:43008
v_mfma_f32_16x16x32_bf16 v[92:95], v[48:51], a[48:51], v[92:95]
v_mfma_f32_16x16x32_bf16 v[92:95], v[52:55], a[52:55], v[92:95]
ds_read_b64_tr_b16 v[48:49], v9 offset:0
v_mfma_f32_16x16x32_bf16 v[92:95], v[56:59], a[56:59], v[92:95]
buffer_load_dwordx4 a[128:131], v1, s[4:7], s55 offen offset:0 sc1
v_mfma_f32_16x16x32_bf16 v[92:95], v[60:63], a[60:63], v[92:95]
s_waitcnt lgkmcnt(7)
ds_read_b64_tr_b16 v[50:51], v9 offset:6144
v_mfma_f32_16x16x32_bf16 v[96:99], v[32:35], a[0:3], v[96:99]
s_waitcnt lgkmcnt(6)
buffer_load_dwordx4 a[132:135], v1, s[4:7], s55 offen offset:1024 sc1
v_mfma_f32_16x16x32_bf16 v[96:99], v[36:39], a[4:7], v[96:99]
s_waitcnt lgkmcnt(4)
ds_read_b64_tr_b16 v[52:53], v9 offset:12288
v_mfma_f32_16x16x32_bf16 v[96:99], v[40:43], a[8:11], v[96:99]
s_waitcnt lgkmcnt(3)
v_mfma_f32_16x16x32_bf16 v[96:99], v[44:47], a[12:15], v[96:99]
ds_read_b64_tr_b16 v[54:55], v9 offset:18432
v_mfma_f32_16x16x32_bf16 v[100:103], v[32:35], a[16:19], v[100:103]
buffer_load_dwordx4 a[136:139], v1, s[4:7], s55 offen offset:2048 sc1
v_mfma_f32_16x16x32_bf16 v[100:103], v[36:39], a[20:23], v[100:103]
ds_read_b64_tr_b16 v[56:57], v9 offset:24576
v_mfma_f32_16x16x32_bf16 v[100:103], v[40:43], a[24:27], v[100:103]
v_mfma_f32_16x16x32_bf16 v[100:103], v[44:47], a[28:31], v[100:103]
ds_read_b64_tr_b16 v[58:59], v9 offset:30720
v_mfma_f32_16x16x32_bf16 v[104:107], v[32:35], a[32:35], v[104:107]
buffer_load_dwordx4 a[140:143], v1, s[4:7], s55 offen offset:3072 sc1
v_mfma_f32_16x16x32_bf16 v[104:107], v[36:39], a[36:39], v[104:107]
s_add_u32 s55, s77, 12288
ds_read_b64_tr_b16 v[60:61], v9 offset:36864
v_mfma_f32_16x16x32_bf16 v[104:107], v[40:43], a[40:43], v[104:107]
v_mfma_f32_16x16x32_bf16 v[104:107], v[44:47], a[44:47], v[104:107]
ds_read_b64_tr_b16 v[62:63], v9 offset:43008
v_mfma_f32_16x16x32_bf16 v[108:111], v[32:35], a[48:51], v[108:111]
buffer_load_dwordx4 a[144:147], v1, s[4:7], s55 offen offset:0 sc1
v_mfma_f32_16x16x32_bf16 v[108:111], v[36:39], a[52:55], v[108:111]
ds_read_b64_tr_b16 v[32:33], v6 offset:128
v_mfma_f32_16x16x32_bf16 v[108:111], v[40:43], a[56:59], v[108:111]
buffer_load_dwordx4 a[148:151], v1, s[4:7], s55 offen offset:1024 sc1
v_mfma_f32_16x16x32_bf16 v[108:111], v[44:47], a[60:63], v[108:111]
s_waitcnt lgkmcnt(7)
ds_read_b64_tr_b16 v[34:35], v6 offset:6272
v_mfma_f32_16x16x32_bf16 v[112:115], v[48:51], a[0:3], v[112:115]
s_waitcnt lgkmcnt(6)
v_mfma_f32_16x16x32_bf16 v[112:115], v[52:55], a[4:7], v[112:115]
s_waitcnt lgkmcnt(4)
ds_read_b64_tr_b16 v[36:37], v6 offset:12416
v_mfma_f32_16x16x32_bf16 v[112:115], v[56:59], a[8:11], v[112:115]
s_waitcnt lgkmcnt(3)
buffer_load_dwordx4 a[152:155], v1, s[4:7], s55 offen offset:2048 sc1
v_mfma_f32_16x16x32_bf16 v[112:115], v[60:63], a[12:15], v[112:115]
ds_read_b64_tr_b16 v[38:39], v6 offset:18560
v_mfma_f32_16x16x32_bf16 v[116:119], v[48:51], a[16:19], v[116:119]
v_mfma_f32_16x16x32_bf16 v[116:119], v[52:55], a[20:23], v[116:119]
ds_read_b64_tr_b16 v[40:41], v6 offset:24704
v_mfma_f32_16x16x32_bf16 v[116:119], v[56:59], a[24:27], v[116:119]
buffer_load_dwordx4 a[156:159], v1, s[4:7], s55 offen offset:3072 sc1
v_mfma_f32_16x16x32_bf16 v[116:119], v[60:63], a[28:31], v[116:119]
s_add_u32 s55, s78, 12288
ds_read_b64_tr_b16 v[42:43], v6 offset:30848
v_mfma_f32_16x16x32_bf16 v[120:123], v[48:51], a[32:35], v[120:123]
v_mfma_f32_16x16x32_bf16 v[120:123], v[52:55], a[36:39], v[120:123]
ds_read_b64_tr_b16 v[44:45], v6 offset:36992
v_mfma_f32_16x16x32_bf16 v[120:123], v[56:59], a[40:43], v[120:123]
buffer_load_dwordx4 a[160:163], v1, s[4:7], s55 offen offset:0 sc1
v_mfma_f32_16x16x32_bf16 v[120:123], v[60:63], a[44:47], v[120:123]
ds_read_b64_tr_b16 v[46:47], v6 offset:43136
v_mfma_f32_16x16x32_bf16 v[124:127], v[48:51], a[48:51], v[124:127]
buffer_load_dwordx4 a[164:167], v1, s[4:7], s55 offen offset:1024 sc1
v_mfma_f32_16x16x32_bf16 v[124:127], v[52:55], a[52:55], v[124:127]
ds_read_b64_tr_b16 v[48:49], v7 offset:128
v_mfma_f32_16x16x32_bf16 v[124:127], v[56:59], a[56:59], v[124:127]
v_mfma_f32_16x16x32_bf16 v[124:127], v[60:63], a[60:63], v[124:127]
s_waitcnt lgkmcnt(7)
ds_read_b64_tr_b16 v[50:51], v7 offset:6272
v_mfma_f32_16x16x32_bf16 v[128:131], v[32:35], a[0:3], v[128:131]
s_waitcnt lgkmcnt(6)
buffer_load_dwordx4 a[168:171], v1, s[4:7], s55 offen offset:2048 sc1
v_mfma_f32_16x16x32_bf16 v[128:131], v[36:39], a[4:7], v[128:131]
s_waitcnt lgkmcnt(4)
ds_read_b64_tr_b16 v[52:53], v7 offset:12416
v_mfma_f32_16x16x32_bf16 v[128:131], v[40:43], a[8:11], v[128:131]
s_waitcnt lgkmcnt(3)
v_mfma_f32_16x16x32_bf16 v[128:131], v[44:47], a[12:15], v[128:131]
ds_read_b64_tr_b16 v[54:55], v7 offset:18560
v_mfma_f32_16x16x32_bf16 v[132:135], v[32:35], a[16:19], v[132:135]
buffer_load_dwordx4 a[172:175], v1, s[4:7], s55 offen offset:3072 sc1
v_mfma_f32_16x16x32_bf16 v[132:135], v[36:39], a[20:23], v[132:135]
s_add_u32 s55, s79, 12288
ds_read_b64_tr_b16 v[56:57], v7 offset:24704
v_mfma_f32_16x16x32_bf16 v[132:135], v[40:43], a[24:27], v[132:135]
v_mfma_f32_16x16x32_bf16 v[132:135], v[44:47], a[28:31], v[132:135]
ds_read_b64_tr_b16 v[58:59], v7 offset:30848
v_mfma_f32_16x16x32_bf16 v[136:139], v[32:35], a[32:35], v[136:139]
buffer_load_dwordx4 a[176:179], v1, s[4:7], s55 offen offset:0 sc1
v_mfma_f32_16x16x32_bf16 v[136:139], v[36:39], a[36:39], v[136:139]
ds_read_b64_tr_b16 v[60:61], v7 offset:36992
v_mfma_f32_16x16x32_bf16 v[136:139], v[40:43], a[40:43], v[136:139]
buffer_load_dwordx4 a[180:183], v1, s[4:7], s55 offen offset:1024 sc1
v_mfma_f32_16x16x32_bf16 v[136:139], v[44:47], a[44:47], v[136:139]
ds_read_b64_tr_b16 v[62:63], v7 offset:43136
v_mfma_f32_16x16x32_bf16 v[140:143], v[32:35], a[48:51], v[140:143]
v_mfma_f32_16x16x32_bf16 v[140:143], v[36:39], a[52:55], v[140:143]
ds_read_b64_tr_b16 v[32:33], v8 offset:128
v_mfma_f32_16x16x32_bf16 v[140:143], v[40:43], a[56:59], v[140:143]
buffer_load_dwordx4 a[184:187], v1, s[4:7], s55 offen offset:2048 sc1
v_mfma_f32_16x16x32_bf16 v[140:143], v[44:47], a[60:63], v[140:143]
s_waitcnt lgkmcnt(7)
ds_read_b64_tr_b16 v[34:35], v8 offset:6272
v_mfma_f32_16x16x32_bf16 v[144:147], v[48:51], a[0:3], v[144:147]
s_waitcnt lgkmcnt(6)
v_mfma_f32_16x16x32_bf16 v[144:147], v[52:55], a[4:7], v[144:147]
s_waitcnt lgkmcnt(4)
ds_read_b64_tr_b16 v[36:37], v8 offset:12416
v_mfma_f32_16x16x32_bf16 v[144:147], v[56:59], a[8:11], v[144:147]
s_waitcnt lgkmcnt(3)
buffer_load_dwordx4 a[188:191], v1, s[4:7], s55 offen offset:3072 sc1
v_mfma_f32_16x16x32_bf16 v[144:147], v[60:63], a[12:15], v[144:147]
s_mul_i32 s54, s50, 40960
ds_read_b64_tr_b16 v[38:39], v8 offset:18560
v_mfma_f32_16x16x32_bf16 v[148:151], v[48:51], a[16:19], v[148:151]
s_add_u32 s54, s54, s16
v_mfma_f32_16x16x32_bf16 v[148:151], v[52:55], a[20:23], v[148:151]
s_mul_i32 s3, s50, 12288
ds_read_b64_tr_b16 v[40:41], v8 offset:24704
v_mfma_f32_16x16x32_bf16 v[148:151], v[56:59], a[24:27], v[148:151]
s_add_u32 m0, s3, 98304
v_mfma_f32_16x16x32_bf16 v[148:151], v[60:63], a[28:31], v[148:151]
s_add_u32 s54, s54, 491520
ds_read_b64_tr_b16 v[42:43], v8 offset:30848
v_mfma_f32_16x16x32_bf16 v[152:155], v[48:51], a[32:35], v[152:155]
buffer_load_dwordx4 v26, s[32:35], s54 offen offset:0  lds
v_mfma_f32_16x16x32_bf16 v[152:155], v[52:55], a[36:39], v[152:155]
ds_read_b64_tr_b16 v[44:45], v8 offset:36992
v_mfma_f32_16x16x32_bf16 v[152:155], v[56:59], a[40:43], v[152:155]
buffer_load_dwordx4 v27, s[32:35], s54 offen offset:1024  lds
v_mfma_f32_16x16x32_bf16 v[152:155], v[60:63], a[44:47], v[152:155]
ds_read_b64_tr_b16 v[46:47], v8 offset:43136
v_mfma_f32_16x16x32_bf16 v[156:159], v[48:51], a[48:51], v[156:159]
v_add_u32 v8, 0xc000, v8
v_mfma_f32_16x16x32_bf16 v[156:159], v[52:55], a[52:55], v[156:159]
ds_read_b64_tr_b16 v[48:49], v9 offset:128
v_mfma_f32_16x16x32_bf16 v[156:159], v[56:59], a[56:59], v[156:159]
buffer_load_dwordx4 v28, s[32:35], s54 offen offset:2048  lds
v_mfma_f32_16x16x32_bf16 v[156:159], v[60:63], a[60:63], v[156:159]
s_waitcnt lgkmcnt(7)
s_add_u32 m0, s3, 101376
ds_read_b64_tr_b16 v[50:51], v9 offset:6272
v_mfma_f32_16x16x32_bf16 v[160:163], v[32:35], a[0:3], v[160:163]
s_waitcnt lgkmcnt(6)
s_add_u32 s54, s54, 10240
v_mfma_f32_16x16x32_bf16 v[160:163], v[36:39], a[4:7], v[160:163]
s_waitcnt lgkmcnt(4)
ds_read_b64_tr_b16 v[52:53], v9 offset:12416
v_mfma_f32_16x16x32_bf16 v[160:163], v[40:43], a[8:11], v[160:163]
s_waitcnt lgkmcnt(3)
buffer_load_dwordx4 v26, s[32:35], s54 offen offset:0  lds
v_mfma_f32_16x16x32_bf16 v[160:163], v[44:47], a[12:15], v[160:163]
ds_read_b64_tr_b16 v[54:55], v9 offset:18560
v_mfma_f32_16x16x32_bf16 v[164:167], v[32:35], a[16:19], v[164:167]
buffer_load_dwordx4 v27, s[32:35], s54 offen offset:1024  lds
v_mfma_f32_16x16x32_bf16 v[164:167], v[36:39], a[20:23], v[164:167]
ds_read_b64_tr_b16 v[56:57], v9 offset:24704
v_mfma_f32_16x16x32_bf16 v[164:167], v[40:43], a[24:27], v[164:167]
v_mfma_f32_16x16x32_bf16 v[164:167], v[44:47], a[28:31], v[164:167]
ds_read_b64_tr_b16 v[58:59], v9 offset:30848
v_mfma_f32_16x16x32_bf16 v[168:171], v[32:35], a[32:35], v[168:171]
buffer_load_dwordx4 v28, s[32:35], s54 offen offset:2048  lds
v_mfma_f32_16x16x32_bf16 v[168:171], v[36:39], a[36:39], v[168:171]
ds_read_b64_tr_b16 v[60:61], v9 offset:36992
v_mfma_f32_16x16x32_bf16 v[168:171], v[40:43], a[40:43], v[168:171]
s_add_u32 m0, s3, 104448
v_mfma_f32_16x16x32_bf16 v[168:171], v[44:47], a[44:47], v[168:171]
s_add_u32 s54, s54, 10240
ds_read_b64_tr_b16 v[62:63], v9 offset:43136
v_mfma_f32_16x16x32_bf16 v[172:175], v[32:35], a[48:51], v[172:175]
v_add_u32 v9, 0xc000, v9
v_mfma_f32_16x16x32_bf16 v[172:175], v[36:39], a[52:55], v[172:175]
ds_read_b64_tr_b16 v[32:33], v6 offset:256
v_mfma_f32_16x16x32_bf16 v[172:175], v[40:43], a[56:59], v[172:175]
buffer_load_dwordx4 v26, s[32:35], s54 offen offset:0  lds
v_mfma_f32_16x16x32_bf16 v[172:175], v[44:47], a[60:63], v[172:175]
s_waitcnt lgkmcnt(7)
ds_read_b64_tr_b16 v[34:35], v6 offset:6400
v_mfma_f32_16x16x32_bf16 v[176:179], v[48:51], a[0:3], v[176:179]
s_waitcnt lgkmcnt(6)
buffer_load_dwordx4 v27, s[32:35], s54 offen offset:1024  lds
v_mfma_f32_16x16x32_bf16 v[176:179], v[52:55], a[4:7], v[176:179]
s_waitcnt lgkmcnt(4)
ds_read_b64_tr_b16 v[36:37], v6 offset:12544
v_mfma_f32_16x16x32_bf16 v[176:179], v[56:59], a[8:11], v[176:179]
s_waitcnt lgkmcnt(3)
v_mfma_f32_16x16x32_bf16 v[176:179], v[60:63], a[12:15], v[176:179]
ds_read_b64_tr_b16 v[38:39], v6 offset:18688
v_mfma_f32_16x16x32_bf16 v[180:183], v[48:51], a[16:19], v[180:183]
buffer_load_dwordx4 v28, s[32:35], s54 offen offset:2048  lds
v_mfma_f32_16x16x32_bf16 v[180:183], v[52:55], a[20:23], v[180:183]
s_add_u32 m0, s3, 107520
ds_read_b64_tr_b16 v[40:41], v6 offset:24832
v_mfma_f32_16x16x32_bf16 v[180:183], v[56:59], a[24:27], v[180:183]
s_add_u32 s54, s54, 10240
v_mfma_f32_16x16x32_bf16 v[180:183], v[60:63], a[28:31], v[180:183]
ds_read_b64_tr_b16 v[42:43], v6 offset:30976
v_mfma_f32_16x16x32_bf16 v[184:187], v[48:51], a[32:35], v[184:187]
buffer_load_dwordx4 v26, s[32:35], s54 offen offset:0  lds
v_mfma_f32_16x16x32_bf16 v[184:187], v[52:55], a[36:39], v[184:187]
ds_read_b64_tr_b16 v[44:45], v6 offset:37120
v_mfma_f32_16x16x32_bf16 v[184:187], v[56:59], a[40:43], v[184:187]
buffer_load_dwordx4 v27, s[32:35], s54 offen offset:1024  lds
v_mfma_f32_16x16x32_bf16 v[184:187], v[60:63], a[44:47], v[184:187]
ds_read_b64_tr_b16 v[46:47], v6 offset:43264
v_mfma_f32_16x16x32_bf16 v[188:191], v[48:51], a[48:51], v[188:191]
v_add_u32 v6, 0xc000, v6
v_mfma_f32_16x16x32_bf16 v[188:191], v[52:55], a[52:55], v[188:191]
ds_read_b64_tr_b16 v[48:49], v7 offset:256
v_mfma_f32_16x16x32_bf16 v[188:191], v[56:59], a[56:59], v[188:191]
buffer_load_dwordx4 v28, s[32:35], s54 offen offset:2048  lds
v_mfma_f32_16x16x32_bf16 v[188:191], v[60:63], a[60:63], v[188:191]
s_waitcnt lgkmcnt(7)
ds_read_b64_tr_b16 v[50:51], v7 offset:6400
v_mfma_f32_16x16x32_bf16 v[192:195], v[32:35], a[0:3], v[192:195]
s_waitcnt lgkmcnt(6)
v_mfma_f32_16x16x32_bf16 v[192:195], v[36:39], a[4:7], v[192:195]
ds_read_b64_tr_b16 v[52:53], v7 offset:12544
s_lshl_b32 s51, s14, 2
s_add_u32 s51, s51, s13
s_lshl_b32 s1, s51, 8
s_add_u32 s1, s1, 86009856
s_mul_i32 s51, s51, 655360
s_add_u32 s51, s51, 62914560
s_mul_i32 s52, s12, 10240
s_add_u32 s52, s52, s51
s_lshl_b32 s3, s50, 1
s_add_u32 s3, s3, 0
s_mul_i32 s53, s3, 81920
s_add_u32 s53, s53, s52
s_cmp_eq_u32 s3, s12
s_cselect_b32 s17, 2130706432, s53
s_lshl_b32 s3, s50, 1
s_add_u32 s3, s3, 1
s_mul_i32 s53, s3, 81920
s_add_u32 s53, s53, s52
s_cmp_eq_u32 s3, s12
s_cselect_b32 s18, 2130706432, s53
s_mul_i32 s52, s12, 81920
s_add_u32 s51, s51, s52
s_lshr_b32 s52, s12, 1
s_lshl_b32 s3, s14, 2
s_add_u32 s52, s52, s3
s_lshl_b32 s52, s52, 1
s_sub_u32 s3, 126, s52
s_bitcmp1_b32 s12, 0
s_cselect_b32 s52, s3, s52
s_mul_i32 s52, s52, 20480
s_mul_i32 s3, s13, 320
s_add_u32 s52, s52, s3
v_bfe_u32 v15, v1, 4, 4
v_mul_u32_u24 v15, 1280, v15
v_lshrrev_b32 v12, 8, v1
v_lshl_add_u32 v15, v12, 3, v15
s_add_u32 s3, s50, 0
s_and_b32 s53, s3, 1
s_lshr_b32 s3, s3, 1
s_mul_i32 s20, s53, 5
s_add_u32 s20, s20, s3
s_lshl_b32 s20, s20, 10
s_add_u32 s20, s20, s51
s_mul_i32 s53, s53, 20480
s_lshl_b32 s3, s3, 6
s_add_u32 s3, s3, s53
s_add_u32 s3, s3, s52
v_add_u32 v12, s3, v15
s_add_u32 s3, s50, 4
s_and_b32 s53, s3, 1
s_lshr_b32 s3, s3, 1
s_mul_i32 s21, s53, 5
s_add_u32 s21, s21, s3
s_lshl_b32 s21, s21, 10
s_add_u32 s21, s21, s51
s_mul_i32 s53, s53, 20480
s_lshl_b32 s3, s3, 6
s_add_u32 s3, s3, s53
s_add_u32 s3, s3, s52
v_add_u32 v13, s3, v15
s_add_u32 s3, s50, 8
s_and_b32 s53, s3, 1
s_lshr_b32 s3, s3, 1
s_mul_i32 s22, s53, 5
s_add_u32 s22, s22, s3
s_lshl_b32 s22, s22, 10
s_add_u32 s22, s22, s51
s_mul_i32 s53, s53, 20480
s_lshl_b32 s3, s3, 6
s_add_u32 s3, s3, s53
s_add_u32 s3, s3, s52
s_cmp_lt_u32 s50, 2
s_cselect_b32 s3, s3, 2130706432
s_cselect_b32 s22, s22, 2130706432
v_add_u32 v14, s3, v15
s_waitcnt lgkmcnt(5)
v_mfma_f32_16x16x32_bf16 v[192:195], v[40:43], a[8:11], v[192:195]
s_waitcnt lgkmcnt(3)
buffer_load_dwordx2 v[240:241], v12, s[8:11], 0 offen offset:0
v_mfma_f32_16x16x32_bf16 v[192:195], v[44:47], a[12:15], v[192:195]
ds_read_b64_tr_b16 v[54:55], v7 offset:18688
v_mfma_f32_16x16x32_bf16 v[196:199], v[32:35], a[16:19], v[196:199]
v_mfma_f32_16x16x32_bf16 v[196:199], v[36:39], a[20:23], v[196:199]
ds_read_b64_tr_b16 v[56:57], v7 offset:24832
v_mfma_f32_16x16x32_bf16 v[196:199], v[40:43], a[24:27], v[196:199]
buffer_load_dwordx2 v[242:243], v12, s[8:11], 0 offen offset:32
v_mfma_f32_16x16x32_bf16 v[196:199], v[44:47], a[28:31], v[196:199]
ds_read_b64_tr_b16 v[58:59], v7 offset:30976
v_mfma_f32_16x16x32_bf16 v[200:203], v[32:35], a[32:35], v[200:203]
v_mfma_f32_16x16x32_bf16 v[200:203], v[36:39], a[36:39], v[200:203]
ds_read_b64_tr_b16 v[60:61], v7 offset:37120
v_mfma_f32_16x16x32_bf16 v[200:203], v[40:43], a[40:43], v[200:203]
buffer_load_dwordx2 v[244:245], v13, s[8:11], 0 offen offset:0
v_mfma_f32_16x16x32_bf16 v[200:203], v[44:47], a[44:47], v[200:203]
ds_read_b64_tr_b16 v[62:63], v7 offset:43264
v_mfma_f32_16x16x32_bf16 v[204:207], v[32:35], a[48:51], v[204:207]
v_add_u32 v7, 0xc000, v7
v_mfma_f32_16x16x32_bf16 v[204:207], v[36:39], a[52:55], v[204:207]
buffer_load_dwordx2 v[246:247], v13, s[8:11], 0 offen offset:32
v_mfma_f32_16x16x32_bf16 v[204:207], v[40:43], a[56:59], v[204:207]
v_mfma_f32_16x16x32_bf16 v[204:207], v[44:47], a[60:63], v[204:207]
s_waitcnt lgkmcnt(6)
v_mfma_f32_16x16x32_bf16 v[208:211], v[48:51], a[0:3], v[208:211]
s_waitcnt vmcnt(48)
s_waitcnt lgkmcnt(0)
s_barrier
buffer_load_dwordx2 v[248:249], v14, s[8:11], 0 offen offset:0
v_mfma_f32_16x16x32_bf16 v[208:211], v[52:55], a[4:7], v[208:211]
ds_read_b64_tr_b16 v[32:33], v6 offset:0
v_mfma_f32_16x16x32_bf16 v[208:211], v[56:59], a[8:11], v[208:211]
ds_read_b64_tr_b16 v[34:35], v6 offset:6144
v_mfma_f32_16x16x32_bf16 v[208:211], v[60:63], a[12:15], v[208:211]
ds_read_b64_tr_b16 v[36:37], v6 offset:12288
v_mfma_f32_16x16x32_bf16 v[212:215], v[48:51], a[16:19], v[212:215]
ds_read_b64_tr_b16 v[38:39], v6 offset:18432
v_mfma_f32_16x16x32_bf16 v[212:215], v[52:55], a[20:23], v[212:215]
buffer_load_dwordx2 v[250:251], v14, s[8:11], 0 offen offset:32
v_mfma_f32_16x16x32_bf16 v[212:215], v[56:59], a[24:27], v[212:215]
ds_read_b64_tr_b16 v[40:41], v6 offset:24576
v_mfma_f32_16x16x32_bf16 v[212:215], v[60:63], a[28:31], v[212:215]
v_mfma_f32_16x16x32_bf16 v[216:219], v[48:51], a[32:35], v[216:219]
ds_read_b64_tr_b16 v[42:43], v6 offset:30720
v_mfma_f32_16x16x32_bf16 v[216:219], v[52:55], a[36:39], v[216:219]
v_mfma_f32_16x16x32_bf16 v[216:219], v[56:59], a[40:43], v[216:219]
ds_read_b64_tr_b16 v[44:45], v6 offset:36864
v_mfma_f32_16x16x32_bf16 v[216:219], v[60:63], a[44:47], v[216:219]
v_mfma_f32_16x16x32_bf16 v[220:223], v[48:51], a[48:51], v[220:223]
ds_read_b64_tr_b16 v[46:47], v6 offset:43008
v_mfma_f32_16x16x32_bf16 v[220:223], v[52:55], a[52:55], v[220:223]
v_add_u32 v6, 0xc000, v6
v_mfma_f32_16x16x32_bf16 v[220:223], v[56:59], a[56:59], v[220:223]
v_mfma_f32_16x16x32_bf16 v[220:223], v[60:63], a[60:63], v[220:223]
s_waitcnt vmcnt(49) lgkmcnt(6)
v_mfma_f32_16x16x32_bf16 v[64:67], v[32:35], a[64:67], v[64:67]
s_waitcnt vmcnt(6)
s_waitcnt lgkmcnt(0)
s_barrier
v_mfma_f32_16x16x32_bf16 v[64:67], v[36:39], a[68:71], v[64:67]
ds_read_b64_tr_b16 v[48:49], v6 offset:0
v_mfma_f32_16x16x32_bf16 v[64:67], v[40:43], a[72:75], v[64:67]
ds_read_b64_tr_b16 v[50:51], v6 offset:6144
v_mfma_f32_16x16x32_bf16 v[64:67], v[44:47], a[76:79], v[64:67]
ds_read_b64_tr_b16 v[52:53], v6 offset:12288
v_mfma_f32_16x16x32_bf16 v[68:71], v[32:35], a[80:83], v[68:71]
ds_read_b64_tr_b16 v[54:55], v6 offset:18432
v_mfma_f32_16x16x32_bf16 v[68:71], v[36:39], a[84:87], v[68:71]
v_mfma_f32_16x16x32_bf16 v[68:71], v[40:43], a[88:91], v[68:71]
ds_read_b64_tr_b16 v[56:57], v6 offset:24576
v_mfma_f32_16x16x32_bf16 v[68:71], v[44:47], a[92:95], v[68:71]
v_mfma_f32_16x16x32_bf16 v[72:75], v[32:35], a[96:99], v[72:75]
ds_read_b64_tr_b16 v[58:59], v6 offset:30720
v_mfma_f32_16x16x32_bf16 v[72:75], v[36:39], a[100:103], v[72:75]
v_mfma_f32_16x16x32_bf16 v[72:75], v[40:43], a[104:107], v[72:75]
ds_read_b64_tr_b16 v[60:61], v6 offset:36864
v_mfma_f32_16x16x32_bf16 v[72:75], v[44:47], a[108:111], v[72:75]
v_mfma_f32_16x16x32_bf16 v[76:79], v[32:35], a[112:115], v[76:79]
ds_read_b64_tr_b16 v[62:63], v6 offset:43008
v_mfma_f32_16x16x32_bf16 v[76:79], v[36:39], a[116:119], v[76:79]
ds_read_b64_tr_b16 v[32:33], v7 offset:0
v_add_u32 v6, 0xffff4000, v6
v_mfma_f32_16x16x32_bf16 v[76:79], v[40:43], a[120:123], v[76:79]
v_mfma_f32_16x16x32_bf16 v[76:79], v[44:47], a[124:127], v[76:79]
s_waitcnt lgkmcnt(7)
ds_read_b64_tr_b16 v[34:35], v7 offset:6144
v_mfma_f32_16x16x32_bf16 v[64:67], v[48:51], a[128:131], v[64:67]
s_waitcnt lgkmcnt(6)
v_mfma_f32_16x16x32_bf16 v[64:67], v[52:55], a[132:135], v[64:67]
s_waitcnt lgkmcnt(4)
ds_read_b64_tr_b16 v[36:37], v7 offset:12288
v_mfma_f32_16x16x32_bf16 v[64:67], v[56:59], a[136:139], v[64:67]
s_waitcnt lgkmcnt(3)
v_mfma_f32_16x16x32_bf16 v[64:67], v[60:63], a[140:143], v[64:67]
ds_read_b64_tr_b16 v[38:39], v7 offset:18432
v_mfma_f32_16x16x32_bf16 v[68:71], v[48:51], a[144:147], v[68:71]
v_mfma_f32_16x16x32_bf16 v[68:71], v[52:55], a[148:151], v[68:71]
ds_read_b64_tr_b16 v[40:41], v7 offset:24576
v_mfma_f32_16x16x32_bf16 v[68:71], v[56:59], a[152:155], v[68:71]
v_mfma_f32_16x16x32_bf16 v[68:71], v[60:63], a[156:159], v[68:71]
ds_read_b64_tr_b16 v[42:43], v7 offset:30720
v_mfma_f32_16x16x32_bf16 v[72:75], v[48:51], a[160:163], v[72:75]
v_mfma_f32_16x16x32_bf16 v[72:75], v[52:55], a[164:167], v[72:75]
ds_read_b64_tr_b16 v[44:45], v7 offset:36864
v_mfma_f32_16x16x32_bf16 v[72:75], v[56:59], a[168:171], v[72:75]
v_mfma_f32_16x16x32_bf16 v[72:75], v[60:63], a[172:175], v[72:75]
ds_read_b64_tr_b16 v[46:47], v7 offset:43008
v_mfma_f32_16x16x32_bf16 v[76:79], v[48:51], a[176:179], v[76:79]
v_add_u32 v7, 0xc000, v7
v_mfma_f32_16x16x32_bf16 v[76:79], v[52:55], a[180:183], v[76:79]
ds_read_b64_tr_b16 v[48:49], v7 offset:0
v_mfma_f32_16x16x32_bf16 v[76:79], v[56:59], a[184:187], v[76:79]
v_mfma_f32_16x16x32_bf16 v[76:79], v[60:63], a[188:191], v[76:79]
s_waitcnt lgkmcnt(7)
ds_read_b64_tr_b16 v[50:51], v7 offset:6144
v_mfma_f32_16x16x32_bf16 v[80:83], v[32:35], a[64:67], v[80:83]
s_waitcnt lgkmcnt(6)
v_mfma_f32_16x16x32_bf16 v[80:83], v[36:39], a[68:71], v[80:83]
s_waitcnt lgkmcnt(4)
ds_read_b64_tr_b16 v[52:53], v7 offset:12288
v_mfma_f32_16x16x32_bf16 v[80:83], v[40:43], a[72:75], v[80:83]
s_waitcnt lgkmcnt(3)
v_mfma_f32_16x16x32_bf16 v[80:83], v[44:47], a[76:79], v[80:83]
ds_read_b64_tr_b16 v[54:55], v7 offset:18432
v_mfma_f32_16x16x32_bf16 v[84:87], v[32:35], a[80:83], v[84:87]
v_mfma_f32_16x16x32_bf16 v[84:87], v[36:39], a[84:87], v[84:87]
ds_read_b64_tr_b16 v[56:57], v7 offset:24576
v_mfma_f32_16x16x32_bf16 v[84:87], v[40:43], a[88:91], v[84:87]
v_mfma_f32_16x16x32_bf16 v[84:87], v[44:47], a[92:95], v[84:87]
ds_read_b64_tr_b16 v[58:59], v7 offset:30720
v_mfma_f32_16x16x32_bf16 v[88:91], v[32:35], a[96:99], v[88:91]
v_mfma_f32_16x16x32_bf16 v[88:91], v[36:39], a[100:103], v[88:91]
ds_read_b64_tr_b16 v[60:61], v7 offset:36864
v_mfma_f32_16x16x32_bf16 v[88:91], v[40:43], a[104:107], v[88:91]
v_mfma_f32_16x16x32_bf16 v[88:91], v[44:47], a[108:111], v[88:91]
ds_read_b64_tr_b16 v[62:63], v7 offset:43008
v_mfma_f32_16x16x32_bf16 v[92:95], v[32:35], a[112:115], v[92:95]
v_add_u32 v7, 0xffff4000, v7
v_mfma_f32_16x16x32_bf16 v[92:95], v[36:39], a[116:119], v[92:95]
ds_read_b64_tr_b16 v[32:33], v8 offset:0
v_mfma_f32_16x16x32_bf16 v[92:95], v[40:43], a[120:123], v[92:95]
v_mfma_f32_16x16x32_bf16 v[92:95], v[44:47], a[124:127], v[92:95]
s_waitcnt lgkmcnt(7)
ds_read_b64_tr_b16 v[34:35], v8 offset:6144
v_mfma_f32_16x16x32_bf16 v[80:83], v[48:51], a[128:131], v[80:83]
s_waitcnt lgkmcnt(6)
v_mfma_f32_16x16x32_bf16 v[80:83], v[52:55], a[132:135], v[80:83]
s_waitcnt lgkmcnt(4)
ds_read_b64_tr_b16 v[36:37], v8 offset:12288
v_mfma_f32_16x16x32_bf16 v[80:83], v[56:59], a[136:139], v[80:83]
s_waitcnt lgkmcnt(3)
v_mfma_f32_16x16x32_bf16 v[80:83], v[60:63], a[140:143], v[80:83]
ds_read_b64_tr_b16 v[38:39], v8 offset:18432
v_mfma_f32_16x16x32_bf16 v[84:87], v[48:51], a[144:147], v[84:87]
v_mfma_f32_16x16x32_bf16 v[84:87], v[52:55], a[148:151], v[84:87]
ds_read_b64_tr_b16 v[40:41], v8 offset:24576
v_mfma_f32_16x16x32_bf16 v[84:87], v[56:59], a[152:155], v[84:87]
v_mfma_f32_16x16x32_bf16 v[84:87], v[60:63], a[156:159], v[84:87]
ds_read_b64_tr_b16 v[42:43], v8 offset:30720
v_mfma_f32_16x16x32_bf16 v[88:91], v[48:51], a[160:163], v[88:91]
v_cvt_pk_bf16_f32 v224, v64, v65
v_cvt_pk_bf16_f32 v225, v66, v67
v_mfma_f32_16x16x32_bf16 v[88:91], v[52:55], a[164:167], v[88:91]
ds_read_b64_tr_b16 v[44:45], v8 offset:36864
v_cvt_pk_bf16_f32 v226, v80, v81
v_mfma_f32_16x16x32_bf16 v[88:91], v[56:59], a[168:171], v[88:91]
v_cvt_pk_bf16_f32 v227, v82, v83
v_mfma_f32_16x16x32_bf16 v[88:91], v[60:63], a[172:175], v[88:91]
s_add_u32 s52, s17, 0
ds_read_b64_tr_b16 v[46:47], v8 offset:43008
v_mfma_f32_16x16x32_bf16 v[92:95], v[48:51], a[176:179], v[92:95]
v_add_u32 v8, 0xc000, v8
v_mfma_f32_16x16x32_bf16 v[92:95], v[52:55], a[180:183], v[92:95]
ds_read_b64_tr_b16 v[48:49], v8 offset:0
v_mfma_f32_16x16x32_bf16 v[92:95], v[56:59], a[184:187], v[92:95]
buffer_store_dwordx4 v[224:227], v1, s[4:7], s52 offen sc1
v_mfma_f32_16x16x32_bf16 v[92:95], v[60:63], a[188:191], v[92:95]
s_waitcnt lgkmcnt(7)
ds_read_b64_tr_b16 v[50:51], v8 offset:6144
v_mfma_f32_16x16x32_bf16 v[96:99], v[32:35], a[64:67], v[96:99]
s_waitcnt lgkmcnt(6)
v_mfma_f32_16x16x32_bf16 v[96:99], v[36:39], a[68:71], v[96:99]
s_waitcnt lgkmcnt(4)
ds_read_b64_tr_b16 v[52:53], v8 offset:12288
v_mfma_f32_16x16x32_bf16 v[96:99], v[40:43], a[72:75], v[96:99]
s_waitcnt lgkmcnt(3)
v_mfma_f32_16x16x32_bf16 v[96:99], v[44:47], a[76:79], v[96:99]
ds_read_b64_tr_b16 v[54:55], v8 offset:18432
v_mfma_f32_16x16x32_bf16 v[100:103], v[32:35], a[80:83], v[100:103]
v_mfma_f32_16x16x32_bf16 v[100:103], v[36:39], a[84:87], v[100:103]
ds_read_b64_tr_b16 v[56:57], v8 offset:24576
v_mfma_f32_16x16x32_bf16 v[100:103], v[40:43], a[88:91], v[100:103]
v_mfma_f32_16x16x32_bf16 v[100:103], v[44:47], a[92:95], v[100:103]
ds_read_b64_tr_b16 v[58:59], v8 offset:30720
v_mfma_f32_16x16x32_bf16 v[104:107], v[32:35], a[96:99], v[104:107]
v_mfma_f32_16x16x32_bf16 v[104:107], v[36:39], a[100:103], v[104:107]
ds_read_b64_tr_b16 v[60:61], v8 offset:36864
v_mfma_f32_16x16x32_bf16 v[104:107], v[40:43], a[104:107], v[104:107]
v_cvt_pk_bf16_f32 v228, v68, v69
v_cvt_pk_bf16_f32 v229, v70, v71
v_mfma_f32_16x16x32_bf16 v[104:107], v[44:47], a[108:111], v[104:107]
ds_read_b64_tr_b16 v[62:63], v8 offset:43008
v_cvt_pk_bf16_f32 v230, v84, v85
v_mfma_f32_16x16x32_bf16 v[108:111], v[32:35], a[112:115], v[108:111]
v_add_u32 v8, 0xffff4000, v8
v_cvt_pk_bf16_f32 v231, v86, v87
v_mfma_f32_16x16x32_bf16 v[108:111], v[36:39], a[116:119], v[108:111]
s_add_u32 s52, s17, 5120
ds_read_b64_tr_b16 v[32:33], v9 offset:0
v_mfma_f32_16x16x32_bf16 v[108:111], v[40:43], a[120:123], v[108:111]
buffer_store_dwordx4 v[228:231], v1, s[4:7], s52 offen sc1
v_mfma_f32_16x16x32_bf16 v[108:111], v[44:47], a[124:127], v[108:111]
s_waitcnt lgkmcnt(7)
ds_read_b64_tr_b16 v[34:35], v9 offset:6144
v_mfma_f32_16x16x32_bf16 v[96:99], v[48:51], a[128:131], v[96:99]
s_waitcnt lgkmcnt(6)
v_mfma_f32_16x16x32_bf16 v[96:99], v[52:55], a[132:135], v[96:99]
s_waitcnt lgkmcnt(4)
ds_read_b64_tr_b16 v[36:37], v9 offset:12288
v_mfma_f32_16x16x32_bf16 v[96:99], v[56:59], a[136:139], v[96:99]
s_waitcnt lgkmcnt(3)
v_mfma_f32_16x16x32_bf16 v[96:99], v[60:63], a[140:143], v[96:99]
ds_read_b64_tr_b16 v[38:39], v9 offset:18432
v_mfma_f32_16x16x32_bf16 v[100:103], v[48:51], a[144:147], v[100:103]
v_mfma_f32_16x16x32_bf16 v[100:103], v[52:55], a[148:151], v[100:103]
ds_read_b64_tr_b16 v[40:41], v9 offset:24576
v_mfma_f32_16x16x32_bf16 v[100:103], v[56:59], a[152:155], v[100:103]
v_mfma_f32_16x16x32_bf16 v[100:103], v[60:63], a[156:159], v[100:103]
ds_read_b64_tr_b16 v[42:43], v9 offset:30720
v_mfma_f32_16x16x32_bf16 v[104:107], v[48:51], a[160:163], v[104:107]
v_mfma_f32_16x16x32_bf16 v[104:107], v[52:55], a[164:167], v[104:107]
ds_read_b64_tr_b16 v[44:45], v9 offset:36864
v_mfma_f32_16x16x32_bf16 v[104:107], v[56:59], a[168:171], v[104:107]
v_cvt_pk_bf16_f32 v232, v72, v73
v_cvt_pk_bf16_f32 v233, v74, v75
v_mfma_f32_16x16x32_bf16 v[104:107], v[60:63], a[172:175], v[104:107]
ds_read_b64_tr_b16 v[46:47], v9 offset:43008
v_cvt_pk_bf16_f32 v234, v88, v89
v_mfma_f32_16x16x32_bf16 v[108:111], v[48:51], a[176:179], v[108:111]
v_add_u32 v9, 0xc000, v9
v_cvt_pk_bf16_f32 v235, v90, v91
v_mfma_f32_16x16x32_bf16 v[108:111], v[52:55], a[180:183], v[108:111]
s_add_u32 s52, s18, 0
ds_read_b64_tr_b16 v[48:49], v9 offset:0
v_mfma_f32_16x16x32_bf16 v[108:111], v[56:59], a[184:187], v[108:111]
buffer_store_dwordx4 v[232:235], v1, s[4:7], s52 offen sc1
v_mfma_f32_16x16x32_bf16 v[108:111], v[60:63], a[188:191], v[108:111]
s_waitcnt lgkmcnt(7)
ds_read_b64_tr_b16 v[50:51], v9 offset:6144
v_mfma_f32_16x16x32_bf16 v[112:115], v[32:35], a[64:67], v[112:115]
s_waitcnt lgkmcnt(6)
v_mfma_f32_16x16x32_bf16 v[112:115], v[36:39], a[68:71], v[112:115]
s_waitcnt lgkmcnt(4)
ds_read_b64_tr_b16 v[52:53], v9 offset:12288
v_mfma_f32_16x16x32_bf16 v[112:115], v[40:43], a[72:75], v[112:115]
s_waitcnt lgkmcnt(3)
v_mfma_f32_16x16x32_bf16 v[112:115], v[44:47], a[76:79], v[112:115]
ds_read_b64_tr_b16 v[54:55], v9 offset:18432
v_mfma_f32_16x16x32_bf16 v[116:119], v[32:35], a[80:83], v[116:119]
v_mfma_f32_16x16x32_bf16 v[116:119], v[36:39], a[84:87], v[116:119]
ds_read_b64_tr_b16 v[56:57], v9 offset:24576
v_mfma_f32_16x16x32_bf16 v[116:119], v[40:43], a[88:91], v[116:119]
v_mfma_f32_16x16x32_bf16 v[116:119], v[44:47], a[92:95], v[116:119]
ds_read_b64_tr_b16 v[58:59], v9 offset:30720
v_mfma_f32_16x16x32_bf16 v[120:123], v[32:35], a[96:99], v[120:123]
v_mfma_f32_16x16x32_bf16 v[120:123], v[36:39], a[100:103], v[120:123]
ds_read_b64_tr_b16 v[60:61], v9 offset:36864
v_mfma_f32_16x16x32_bf16 v[120:123], v[40:43], a[104:107], v[120:123]
v_cvt_pk_bf16_f32 v236, v76, v77
v_cvt_pk_bf16_f32 v237, v78, v79
v_mfma_f32_16x16x32_bf16 v[120:123], v[44:47], a[108:111], v[120:123]
ds_read_b64_tr_b16 v[62:63], v9 offset:43008
v_cvt_pk_bf16_f32 v238, v92, v93
v_mfma_f32_16x16x32_bf16 v[124:127], v[32:35], a[112:115], v[124:127]
v_add_u32 v9, 0xffff4000, v9
v_cvt_pk_bf16_f32 v239, v94, v95
v_mfma_f32_16x16x32_bf16 v[124:127], v[36:39], a[116:119], v[124:127]
s_add_u32 s52, s18, 5120
ds_read_b64_tr_b16 v[32:33], v6 offset:128
v_mfma_f32_16x16x32_bf16 v[124:127], v[40:43], a[120:123], v[124:127]
buffer_store_dwordx4 v[236:239], v1, s[4:7], s52 offen sc1
v_mfma_f32_16x16x32_bf16 v[124:127], v[44:47], a[124:127], v[124:127]
s_waitcnt lgkmcnt(7)
ds_read_b64_tr_b16 v[34:35], v6 offset:6272
v_mfma_f32_16x16x32_bf16 v[112:115], v[48:51], a[128:131], v[112:115]
s_waitcnt lgkmcnt(6)
v_mfma_f32_16x16x32_bf16 v[112:115], v[52:55], a[132:135], v[112:115]
s_waitcnt lgkmcnt(4)
ds_read_b64_tr_b16 v[36:37], v6 offset:12416
v_mfma_f32_16x16x32_bf16 v[112:115], v[56:59], a[136:139], v[112:115]
s_waitcnt lgkmcnt(3)
v_mfma_f32_16x16x32_bf16 v[112:115], v[60:63], a[140:143], v[112:115]
ds_read_b64_tr_b16 v[38:39], v6 offset:18560
v_mfma_f32_16x16x32_bf16 v[116:119], v[48:51], a[144:147], v[116:119]
v_mfma_f32_16x16x32_bf16 v[116:119], v[52:55], a[148:151], v[116:119]
ds_read_b64_tr_b16 v[40:41], v6 offset:24704
v_mfma_f32_16x16x32_bf16 v[116:119], v[56:59], a[152:155], v[116:119]
v_mfma_f32_16x16x32_bf16 v[116:119], v[60:63], a[156:159], v[116:119]
ds_read_b64_tr_b16 v[42:43], v6 offset:30848
v_mfma_f32_16x16x32_bf16 v[120:123], v[48:51], a[160:163], v[120:123]
v_cvt_pk_bf16_f32 v224, v96, v97
v_cvt_pk_bf16_f32 v225, v98, v99
v_mfma_f32_16x16x32_bf16 v[120:123], v[52:55], a[164:167], v[120:123]
ds_read_b64_tr_b16 v[44:45], v6 offset:36992
v_cvt_pk_bf16_f32 v226, v112, v113
v_mfma_f32_16x16x32_bf16 v[120:123], v[56:59], a[168:171], v[120:123]
v_cvt_pk_bf16_f32 v227, v114, v115
v_mfma_f32_16x16x32_bf16 v[120:123], v[60:63], a[172:175], v[120:123]
s_add_u32 s52, s17, 1024
ds_read_b64_tr_b16 v[46:47], v6 offset:43136
v_mfma_f32_16x16x32_bf16 v[124:127], v[48:51], a[176:179], v[124:127]
v_add_u32 v6, 0xc000, v6
v_mfma_f32_16x16x32_bf16 v[124:127], v[52:55], a[180:183], v[124:127]
ds_read_b64_tr_b16 v[48:49], v6 offset:128
v_mfma_f32_16x16x32_bf16 v[124:127], v[56:59], a[184:187], v[124:127]
buffer_store_dwordx4 v[224:227], v1, s[4:7], s52 offen sc1
v_mfma_f32_16x16x32_bf16 v[124:127], v[60:63], a[188:191], v[124:127]
s_waitcnt lgkmcnt(7)
ds_read_b64_tr_b16 v[50:51], v6 offset:6272
v_mfma_f32_16x16x32_bf16 v[128:131], v[32:35], a[64:67], v[128:131]
s_waitcnt lgkmcnt(6)
v_mfma_f32_16x16x32_bf16 v[128:131], v[36:39], a[68:71], v[128:131]
s_waitcnt lgkmcnt(4)
ds_read_b64_tr_b16 v[52:53], v6 offset:12416
v_mfma_f32_16x16x32_bf16 v[128:131], v[40:43], a[72:75], v[128:131]
s_waitcnt lgkmcnt(3)
v_mfma_f32_16x16x32_bf16 v[128:131], v[44:47], a[76:79], v[128:131]
ds_read_b64_tr_b16 v[54:55], v6 offset:18560
v_mfma_f32_16x16x32_bf16 v[132:135], v[32:35], a[80:83], v[132:135]
v_mfma_f32_16x16x32_bf16 v[132:135], v[36:39], a[84:87], v[132:135]
ds_read_b64_tr_b16 v[56:57], v6 offset:24704
v_mfma_f32_16x16x32_bf16 v[132:135], v[40:43], a[88:91], v[132:135]
v_mfma_f32_16x16x32_bf16 v[132:135], v[44:47], a[92:95], v[132:135]
ds_read_b64_tr_b16 v[58:59], v6 offset:30848
v_mfma_f32_16x16x32_bf16 v[136:139], v[32:35], a[96:99], v[136:139]
v_mfma_f32_16x16x32_bf16 v[136:139], v[36:39], a[100:103], v[136:139]
ds_read_b64_tr_b16 v[60:61], v6 offset:36992
v_mfma_f32_16x16x32_bf16 v[136:139], v[40:43], a[104:107], v[136:139]
v_cvt_pk_bf16_f32 v228, v100, v101
v_cvt_pk_bf16_f32 v229, v102, v103
v_mfma_f32_16x16x32_bf16 v[136:139], v[44:47], a[108:111], v[136:139]
ds_read_b64_tr_b16 v[62:63], v6 offset:43136
v_cvt_pk_bf16_f32 v230, v116, v117
v_mfma_f32_16x16x32_bf16 v[140:143], v[32:35], a[112:115], v[140:143]
v_add_u32 v6, 0xffff4000, v6
v_cvt_pk_bf16_f32 v231, v118, v119
v_mfma_f32_16x16x32_bf16 v[140:143], v[36:39], a[116:119], v[140:143]
s_add_u32 s52, s17, 6144
ds_read_b64_tr_b16 v[32:33], v7 offset:128
v_mfma_f32_16x16x32_bf16 v[140:143], v[40:43], a[120:123], v[140:143]
buffer_store_dwordx4 v[228:231], v1, s[4:7], s52 offen sc1
v_mfma_f32_16x16x32_bf16 v[140:143], v[44:47], a[124:127], v[140:143]
s_waitcnt lgkmcnt(7)
ds_read_b64_tr_b16 v[34:35], v7 offset:6272
v_mfma_f32_16x16x32_bf16 v[128:131], v[48:51], a[128:131], v[128:131]
s_waitcnt lgkmcnt(6)
v_mfma_f32_16x16x32_bf16 v[128:131], v[52:55], a[132:135], v[128:131]
s_waitcnt lgkmcnt(4)
ds_read_b64_tr_b16 v[36:37], v7 offset:12416
v_mfma_f32_16x16x32_bf16 v[128:131], v[56:59], a[136:139], v[128:131]
s_waitcnt lgkmcnt(3)
v_mfma_f32_16x16x32_bf16 v[128:131], v[60:63], a[140:143], v[128:131]
ds_read_b64_tr_b16 v[38:39], v7 offset:18560
v_mfma_f32_16x16x32_bf16 v[132:135], v[48:51], a[144:147], v[132:135]
v_mfma_f32_16x16x32_bf16 v[132:135], v[52:55], a[148:151], v[132:135]
ds_read_b64_tr_b16 v[40:41], v7 offset:24704
v_mfma_f32_16x16x32_bf16 v[132:135], v[56:59], a[152:155], v[132:135]
v_mfma_f32_16x16x32_bf16 v[132:135], v[60:63], a[156:159], v[132:135]
ds_read_b64_tr_b16 v[42:43], v7 offset:30848
v_mfma_f32_16x16x32_bf16 v[136:139], v[48:51], a[160:163], v[136:139]
v_mfma_f32_16x16x32_bf16 v[136:139], v[52:55], a[164:167], v[136:139]
ds_read_b64_tr_b16 v[44:45], v7 offset:36992
v_mfma_f32_16x16x32_bf16 v[136:139], v[56:59], a[168:171], v[136:139]
v_cvt_pk_bf16_f32 v232, v104, v105
v_cvt_pk_bf16_f32 v233, v106, v107
v_mfma_f32_16x16x32_bf16 v[136:139], v[60:63], a[172:175], v[136:139]
ds_read_b64_tr_b16 v[46:47], v7 offset:43136
v_cvt_pk_bf16_f32 v234, v120, v121
v_mfma_f32_16x16x32_bf16 v[140:143], v[48:51], a[176:179], v[140:143]
v_add_u32 v7, 0xc000, v7
v_cvt_pk_bf16_f32 v235, v122, v123
v_mfma_f32_16x16x32_bf16 v[140:143], v[52:55], a[180:183], v[140:143]
s_add_u32 s52, s18, 1024
ds_read_b64_tr_b16 v[48:49], v7 offset:128
v_mfma_f32_16x16x32_bf16 v[140:143], v[56:59], a[184:187], v[140:143]
buffer_store_dwordx4 v[232:235], v1, s[4:7], s52 offen sc1
v_mfma_f32_16x16x32_bf16 v[140:143], v[60:63], a[188:191], v[140:143]
s_waitcnt lgkmcnt(7)
ds_read_b64_tr_b16 v[50:51], v7 offset:6272
v_mfma_f32_16x16x32_bf16 v[144:147], v[32:35], a[64:67], v[144:147]
s_waitcnt lgkmcnt(6)
v_mfma_f32_16x16x32_bf16 v[144:147], v[36:39], a[68:71], v[144:147]
s_waitcnt lgkmcnt(4)
ds_read_b64_tr_b16 v[52:53], v7 offset:12416
v_mfma_f32_16x16x32_bf16 v[144:147], v[40:43], a[72:75], v[144:147]
s_waitcnt lgkmcnt(3)
v_mfma_f32_16x16x32_bf16 v[144:147], v[44:47], a[76:79], v[144:147]
ds_read_b64_tr_b16 v[54:55], v7 offset:18560
v_mfma_f32_16x16x32_bf16 v[148:151], v[32:35], a[80:83], v[148:151]
v_mfma_f32_16x16x32_bf16 v[148:151], v[36:39], a[84:87], v[148:151]
ds_read_b64_tr_b16 v[56:57], v7 offset:24704
v_mfma_f32_16x16x32_bf16 v[148:151], v[40:43], a[88:91], v[148:151]
v_mfma_f32_16x16x32_bf16 v[148:151], v[44:47], a[92:95], v[148:151]
ds_read_b64_tr_b16 v[58:59], v7 offset:30848
v_mfma_f32_16x16x32_bf16 v[152:155], v[32:35], a[96:99], v[152:155]
v_mfma_f32_16x16x32_bf16 v[152:155], v[36:39], a[100:103], v[152:155]
ds_read_b64_tr_b16 v[60:61], v7 offset:36992
v_mfma_f32_16x16x32_bf16 v[152:155], v[40:43], a[104:107], v[152:155]
v_cvt_pk_bf16_f32 v236, v108, v109
v_cvt_pk_bf16_f32 v237, v110, v111
v_mfma_f32_16x16x32_bf16 v[152:155], v[44:47], a[108:111], v[152:155]
ds_read_b64_tr_b16 v[62:63], v7 offset:43136
v_cvt_pk_bf16_f32 v238, v124, v125
v_mfma_f32_16x16x32_bf16 v[156:159], v[32:35], a[112:115], v[156:159]
v_add_u32 v7, 0xffff4000, v7
v_cvt_pk_bf16_f32 v239, v126, v127
v_mfma_f32_16x16x32_bf16 v[156:159], v[36:39], a[116:119], v[156:159]
s_add_u32 s52, s18, 6144
ds_read_b64_tr_b16 v[32:33], v8 offset:128
v_mfma_f32_16x16x32_bf16 v[156:159], v[40:43], a[120:123], v[156:159]
buffer_store_dwordx4 v[236:239], v1, s[4:7], s52 offen sc1
v_mfma_f32_16x16x32_bf16 v[156:159], v[44:47], a[124:127], v[156:159]
s_waitcnt lgkmcnt(7)
ds_read_b64_tr_b16 v[34:35], v8 offset:6272
v_mfma_f32_16x16x32_bf16 v[144:147], v[48:51], a[128:131], v[144:147]
s_waitcnt lgkmcnt(6)
v_mfma_f32_16x16x32_bf16 v[144:147], v[52:55], a[132:135], v[144:147]
s_waitcnt lgkmcnt(4)
ds_read_b64_tr_b16 v[36:37], v8 offset:12416
v_mfma_f32_16x16x32_bf16 v[144:147], v[56:59], a[136:139], v[144:147]
s_waitcnt lgkmcnt(3)
v_mfma_f32_16x16x32_bf16 v[144:147], v[60:63], a[140:143], v[144:147]
ds_read_b64_tr_b16 v[38:39], v8 offset:18560
v_mfma_f32_16x16x32_bf16 v[148:151], v[48:51], a[144:147], v[148:151]
v_mfma_f32_16x16x32_bf16 v[148:151], v[52:55], a[148:151], v[148:151]
ds_read_b64_tr_b16 v[40:41], v8 offset:24704
v_mfma_f32_16x16x32_bf16 v[148:151], v[56:59], a[152:155], v[148:151]
v_mfma_f32_16x16x32_bf16 v[148:151], v[60:63], a[156:159], v[148:151]
ds_read_b64_tr_b16 v[42:43], v8 offset:30848
v_mfma_f32_16x16x32_bf16 v[152:155], v[48:51], a[160:163], v[152:155]
v_cvt_pk_bf16_f32 v224, v128, v129
v_cvt_pk_bf16_f32 v225, v130, v131
v_mfma_f32_16x16x32_bf16 v[152:155], v[52:55], a[164:167], v[152:155]
ds_read_b64_tr_b16 v[44:45], v8 offset:36992
v_cvt_pk_bf16_f32 v226, v144, v145
v_mfma_f32_16x16x32_bf16 v[152:155], v[56:59], a[168:171], v[152:155]
v_cvt_pk_bf16_f32 v227, v146, v147
v_mfma_f32_16x16x32_bf16 v[152:155], v[60:63], a[172:175], v[152:155]
s_add_u32 s52, s17, 2048
ds_read_b64_tr_b16 v[46:47], v8 offset:43136
v_mfma_f32_16x16x32_bf16 v[156:159], v[48:51], a[176:179], v[156:159]
v_add_u32 v8, 0xc000, v8
v_mfma_f32_16x16x32_bf16 v[156:159], v[52:55], a[180:183], v[156:159]
ds_read_b64_tr_b16 v[48:49], v8 offset:128
v_mfma_f32_16x16x32_bf16 v[156:159], v[56:59], a[184:187], v[156:159]
buffer_store_dwordx4 v[224:227], v1, s[4:7], s52 offen sc1
v_mfma_f32_16x16x32_bf16 v[156:159], v[60:63], a[188:191], v[156:159]
s_waitcnt lgkmcnt(7)
ds_read_b64_tr_b16 v[50:51], v8 offset:6272
v_mfma_f32_16x16x32_bf16 v[160:163], v[32:35], a[64:67], v[160:163]
s_waitcnt lgkmcnt(6)
v_mfma_f32_16x16x32_bf16 v[160:163], v[36:39], a[68:71], v[160:163]
s_waitcnt lgkmcnt(4)
ds_read_b64_tr_b16 v[52:53], v8 offset:12416
v_mfma_f32_16x16x32_bf16 v[160:163], v[40:43], a[72:75], v[160:163]
s_waitcnt lgkmcnt(3)
v_mfma_f32_16x16x32_bf16 v[160:163], v[44:47], a[76:79], v[160:163]
ds_read_b64_tr_b16 v[54:55], v8 offset:18560
v_mfma_f32_16x16x32_bf16 v[164:167], v[32:35], a[80:83], v[164:167]
v_mfma_f32_16x16x32_bf16 v[164:167], v[36:39], a[84:87], v[164:167]
ds_read_b64_tr_b16 v[56:57], v8 offset:24704
v_mfma_f32_16x16x32_bf16 v[164:167], v[40:43], a[88:91], v[164:167]
v_mfma_f32_16x16x32_bf16 v[164:167], v[44:47], a[92:95], v[164:167]
ds_read_b64_tr_b16 v[58:59], v8 offset:30848
v_mfma_f32_16x16x32_bf16 v[168:171], v[32:35], a[96:99], v[168:171]
v_mfma_f32_16x16x32_bf16 v[168:171], v[36:39], a[100:103], v[168:171]
ds_read_b64_tr_b16 v[60:61], v8 offset:36992
v_mfma_f32_16x16x32_bf16 v[168:171], v[40:43], a[104:107], v[168:171]
v_cvt_pk_bf16_f32 v228, v132, v133
v_cvt_pk_bf16_f32 v229, v134, v135
v_mfma_f32_16x16x32_bf16 v[168:171], v[44:47], a[108:111], v[168:171]
ds_read_b64_tr_b16 v[62:63], v8 offset:43136
v_cvt_pk_bf16_f32 v230, v148, v149
v_mfma_f32_16x16x32_bf16 v[172:175], v[32:35], a[112:115], v[172:175]
v_cvt_pk_bf16_f32 v231, v150, v151
v_mfma_f32_16x16x32_bf16 v[172:175], v[36:39], a[116:119], v[172:175]
s_add_u32 s52, s17, 7168
ds_read_b64_tr_b16 v[32:33], v9 offset:128
v_mfma_f32_16x16x32_bf16 v[172:175], v[40:43], a[120:123], v[172:175]
buffer_store_dwordx4 v[228:231], v1, s[4:7], s52 offen sc1
v_mfma_f32_16x16x32_bf16 v[172:175], v[44:47], a[124:127], v[172:175]
s_waitcnt lgkmcnt(7)
ds_read_b64_tr_b16 v[34:35], v9 offset:6272
v_mfma_f32_16x16x32_bf16 v[160:163], v[48:51], a[128:131], v[160:163]
s_waitcnt lgkmcnt(6)
v_mfma_f32_16x16x32_bf16 v[160:163], v[52:55], a[132:135], v[160:163]
s_waitcnt lgkmcnt(4)
ds_read_b64_tr_b16 v[36:37], v9 offset:12416
v_mfma_f32_16x16x32_bf16 v[160:163], v[56:59], a[136:139], v[160:163]
s_waitcnt lgkmcnt(3)
v_mfma_f32_16x16x32_bf16 v[160:163], v[60:63], a[140:143], v[160:163]
ds_read_b64_tr_b16 v[38:39], v9 offset:18560
v_mfma_f32_16x16x32_bf16 v[164:167], v[48:51], a[144:147], v[164:167]
v_mfma_f32_16x16x32_bf16 v[164:167], v[52:55], a[148:151], v[164:167]
ds_read_b64_tr_b16 v[40:41], v9 offset:24704
v_mfma_f32_16x16x32_bf16 v[164:167], v[56:59], a[152:155], v[164:167]
v_mfma_f32_16x16x32_bf16 v[164:167], v[60:63], a[156:159], v[164:167]
ds_read_b64_tr_b16 v[42:43], v9 offset:30848
v_mfma_f32_16x16x32_bf16 v[168:171], v[48:51], a[160:163], v[168:171]
v_mfma_f32_16x16x32_bf16 v[168:171], v[52:55], a[164:167], v[168:171]
ds_read_b64_tr_b16 v[44:45], v9 offset:36992
v_mfma_f32_16x16x32_bf16 v[168:171], v[56:59], a[168:171], v[168:171]
v_cvt_pk_bf16_f32 v232, v136, v137
v_cvt_pk_bf16_f32 v233, v138, v139
v_mfma_f32_16x16x32_bf16 v[168:171], v[60:63], a[172:175], v[168:171]
ds_read_b64_tr_b16 v[46:47], v9 offset:43136
v_cvt_pk_bf16_f32 v234, v152, v153
v_mfma_f32_16x16x32_bf16 v[172:175], v[48:51], a[176:179], v[172:175]
v_add_u32 v9, 0xc000, v9
v_cvt_pk_bf16_f32 v235, v154, v155
v_mfma_f32_16x16x32_bf16 v[172:175], v[52:55], a[180:183], v[172:175]
s_add_u32 s52, s18, 2048
ds_read_b64_tr_b16 v[48:49], v9 offset:128
v_mfma_f32_16x16x32_bf16 v[172:175], v[56:59], a[184:187], v[172:175]
buffer_store_dwordx4 v[232:235], v1, s[4:7], s52 offen sc1
v_mfma_f32_16x16x32_bf16 v[172:175], v[60:63], a[188:191], v[172:175]
s_waitcnt lgkmcnt(7)
ds_read_b64_tr_b16 v[50:51], v9 offset:6272
v_mfma_f32_16x16x32_bf16 v[176:179], v[32:35], a[64:67], v[176:179]
s_waitcnt lgkmcnt(6)
v_mfma_f32_16x16x32_bf16 v[176:179], v[36:39], a[68:71], v[176:179]
s_waitcnt lgkmcnt(4)
ds_read_b64_tr_b16 v[52:53], v9 offset:12416
v_mfma_f32_16x16x32_bf16 v[176:179], v[40:43], a[72:75], v[176:179]
s_waitcnt lgkmcnt(3)
v_mfma_f32_16x16x32_bf16 v[176:179], v[44:47], a[76:79], v[176:179]
ds_read_b64_tr_b16 v[54:55], v9 offset:18560
v_mfma_f32_16x16x32_bf16 v[180:183], v[32:35], a[80:83], v[180:183]
v_mfma_f32_16x16x32_bf16 v[180:183], v[36:39], a[84:87], v[180:183]
ds_read_b64_tr_b16 v[56:57], v9 offset:24704
v_mfma_f32_16x16x32_bf16 v[180:183], v[40:43], a[88:91], v[180:183]
v_mfma_f32_16x16x32_bf16 v[180:183], v[44:47], a[92:95], v[180:183]
ds_read_b64_tr_b16 v[58:59], v9 offset:30848
v_mfma_f32_16x16x32_bf16 v[184:187], v[32:35], a[96:99], v[184:187]
v_mfma_f32_16x16x32_bf16 v[184:187], v[36:39], a[100:103], v[184:187]
ds_read_b64_tr_b16 v[60:61], v9 offset:36992
v_mfma_f32_16x16x32_bf16 v[184:187], v[40:43], a[104:107], v[184:187]
v_cvt_pk_bf16_f32 v236, v140, v141
v_cvt_pk_bf16_f32 v237, v142, v143
v_mfma_f32_16x16x32_bf16 v[184:187], v[44:47], a[108:111], v[184:187]
ds_read_b64_tr_b16 v[62:63], v9 offset:43136
v_cvt_pk_bf16_f32 v238, v156, v157
v_mfma_f32_16x16x32_bf16 v[188:191], v[32:35], a[112:115], v[188:191]
v_cvt_pk_bf16_f32 v239, v158, v159
v_mfma_f32_16x16x32_bf16 v[188:191], v[36:39], a[116:119], v[188:191]
s_add_u32 s52, s18, 7168
ds_read_b64_tr_b16 v[32:33], v6 offset:256
v_mfma_f32_16x16x32_bf16 v[188:191], v[40:43], a[120:123], v[188:191]
buffer_store_dwordx4 v[236:239], v1, s[4:7], s52 offen sc1
v_mfma_f32_16x16x32_bf16 v[188:191], v[44:47], a[124:127], v[188:191]
s_waitcnt lgkmcnt(7)
ds_read_b64_tr_b16 v[34:35], v6 offset:6400
v_mfma_f32_16x16x32_bf16 v[176:179], v[48:51], a[128:131], v[176:179]
s_waitcnt lgkmcnt(6)
v_mfma_f32_16x16x32_bf16 v[176:179], v[52:55], a[132:135], v[176:179]
s_waitcnt lgkmcnt(4)
ds_read_b64_tr_b16 v[36:37], v6 offset:12544
v_mfma_f32_16x16x32_bf16 v[176:179], v[56:59], a[136:139], v[176:179]
s_waitcnt lgkmcnt(3)
v_mfma_f32_16x16x32_bf16 v[176:179], v[60:63], a[140:143], v[176:179]
ds_read_b64_tr_b16 v[38:39], v6 offset:18688
v_mfma_f32_16x16x32_bf16 v[180:183], v[48:51], a[144:147], v[180:183]
v_mfma_f32_16x16x32_bf16 v[180:183], v[52:55], a[148:151], v[180:183]
ds_read_b64_tr_b16 v[40:41], v6 offset:24832
v_mfma_f32_16x16x32_bf16 v[180:183], v[56:59], a[152:155], v[180:183]
v_mfma_f32_16x16x32_bf16 v[180:183], v[60:63], a[156:159], v[180:183]
ds_read_b64_tr_b16 v[42:43], v6 offset:30976
v_mfma_f32_16x16x32_bf16 v[184:187], v[48:51], a[160:163], v[184:187]
v_cvt_pk_bf16_f32 v224, v160, v161
v_cvt_pk_bf16_f32 v225, v162, v163
v_mfma_f32_16x16x32_bf16 v[184:187], v[52:55], a[164:167], v[184:187]
ds_read_b64_tr_b16 v[44:45], v6 offset:37120
v_cvt_pk_bf16_f32 v226, v176, v177
v_mfma_f32_16x16x32_bf16 v[184:187], v[56:59], a[168:171], v[184:187]
v_cvt_pk_bf16_f32 v227, v178, v179
v_mfma_f32_16x16x32_bf16 v[184:187], v[60:63], a[172:175], v[184:187]
s_add_u32 s52, s17, 3072
ds_read_b64_tr_b16 v[46:47], v6 offset:43264
v_mfma_f32_16x16x32_bf16 v[188:191], v[48:51], a[176:179], v[188:191]
v_add_u32 v6, 0xc000, v6
v_mfma_f32_16x16x32_bf16 v[188:191], v[52:55], a[180:183], v[188:191]
ds_read_b64_tr_b16 v[48:49], v6 offset:256
v_mfma_f32_16x16x32_bf16 v[188:191], v[56:59], a[184:187], v[188:191]
buffer_store_dwordx4 v[224:227], v1, s[4:7], s52 offen sc1
v_mfma_f32_16x16x32_bf16 v[188:191], v[60:63], a[188:191], v[188:191]
s_waitcnt lgkmcnt(7)
ds_read_b64_tr_b16 v[50:51], v6 offset:6400
v_mfma_f32_16x16x32_bf16 v[192:195], v[32:35], a[64:67], v[192:195]
s_waitcnt lgkmcnt(6)
v_mfma_f32_16x16x32_bf16 v[192:195], v[36:39], a[68:71], v[192:195]
s_waitcnt lgkmcnt(4)
ds_read_b64_tr_b16 v[52:53], v6 offset:12544
v_mfma_f32_16x16x32_bf16 v[192:195], v[40:43], a[72:75], v[192:195]
s_waitcnt lgkmcnt(3)
v_mfma_f32_16x16x32_bf16 v[192:195], v[44:47], a[76:79], v[192:195]
ds_read_b64_tr_b16 v[54:55], v6 offset:18688
v_mfma_f32_16x16x32_bf16 v[196:199], v[32:35], a[80:83], v[196:199]
v_mfma_f32_16x16x32_bf16 v[196:199], v[36:39], a[84:87], v[196:199]
ds_read_b64_tr_b16 v[56:57], v6 offset:24832
v_mfma_f32_16x16x32_bf16 v[196:199], v[40:43], a[88:91], v[196:199]
v_mfma_f32_16x16x32_bf16 v[196:199], v[44:47], a[92:95], v[196:199]
ds_read_b64_tr_b16 v[58:59], v6 offset:30976
v_mfma_f32_16x16x32_bf16 v[200:203], v[32:35], a[96:99], v[200:203]
v_mfma_f32_16x16x32_bf16 v[200:203], v[36:39], a[100:103], v[200:203]
ds_read_b64_tr_b16 v[60:61], v6 offset:37120
v_mfma_f32_16x16x32_bf16 v[200:203], v[40:43], a[104:107], v[200:203]
v_cvt_pk_bf16_f32 v228, v164, v165
v_cvt_pk_bf16_f32 v229, v166, v167
v_mfma_f32_16x16x32_bf16 v[200:203], v[44:47], a[108:111], v[200:203]
ds_read_b64_tr_b16 v[62:63], v6 offset:43264
v_cvt_pk_bf16_f32 v230, v180, v181
v_mfma_f32_16x16x32_bf16 v[204:207], v[32:35], a[112:115], v[204:207]
v_cvt_pk_bf16_f32 v231, v182, v183
v_mfma_f32_16x16x32_bf16 v[204:207], v[36:39], a[116:119], v[204:207]
s_add_u32 s52, s17, 8192
ds_read_b64_tr_b16 v[32:33], v7 offset:256
v_mfma_f32_16x16x32_bf16 v[204:207], v[40:43], a[120:123], v[204:207]
buffer_store_dwordx4 v[228:231], v1, s[4:7], s52 offen sc1
v_mfma_f32_16x16x32_bf16 v[204:207], v[44:47], a[124:127], v[204:207]
s_waitcnt lgkmcnt(7)
ds_read_b64_tr_b16 v[34:35], v7 offset:6400
v_mfma_f32_16x16x32_bf16 v[192:195], v[48:51], a[128:131], v[192:195]
s_waitcnt lgkmcnt(6)
v_mfma_f32_16x16x32_bf16 v[192:195], v[52:55], a[132:135], v[192:195]
s_waitcnt lgkmcnt(4)
ds_read_b64_tr_b16 v[36:37], v7 offset:12544
v_mfma_f32_16x16x32_bf16 v[192:195], v[56:59], a[136:139], v[192:195]
s_waitcnt lgkmcnt(3)
v_mfma_f32_16x16x32_bf16 v[192:195], v[60:63], a[140:143], v[192:195]
ds_read_b64_tr_b16 v[38:39], v7 offset:18688
v_mfma_f32_16x16x32_bf16 v[196:199], v[48:51], a[144:147], v[196:199]
v_mfma_f32_16x16x32_bf16 v[196:199], v[52:55], a[148:151], v[196:199]
ds_read_b64_tr_b16 v[40:41], v7 offset:24832
v_mfma_f32_16x16x32_bf16 v[196:199], v[56:59], a[152:155], v[196:199]
v_mfma_f32_16x16x32_bf16 v[196:199], v[60:63], a[156:159], v[196:199]
ds_read_b64_tr_b16 v[42:43], v7 offset:30976
v_mfma_f32_16x16x32_bf16 v[200:203], v[48:51], a[160:163], v[200:203]
v_mfma_f32_16x16x32_bf16 v[200:203], v[52:55], a[164:167], v[200:203]
ds_read_b64_tr_b16 v[44:45], v7 offset:37120
v_mfma_f32_16x16x32_bf16 v[200:203], v[56:59], a[168:171], v[200:203]
v_cvt_pk_bf16_f32 v232, v168, v169
v_cvt_pk_bf16_f32 v233, v170, v171
v_mfma_f32_16x16x32_bf16 v[200:203], v[60:63], a[172:175], v[200:203]
ds_read_b64_tr_b16 v[46:47], v7 offset:43264
v_cvt_pk_bf16_f32 v234, v184, v185
v_mfma_f32_16x16x32_bf16 v[204:207], v[48:51], a[176:179], v[204:207]
v_add_u32 v7, 0xc000, v7
v_cvt_pk_bf16_f32 v235, v186, v187
v_mfma_f32_16x16x32_bf16 v[204:207], v[52:55], a[180:183], v[204:207]
s_add_u32 s52, s18, 3072
ds_read_b64_tr_b16 v[48:49], v7 offset:256
v_mfma_f32_16x16x32_bf16 v[204:207], v[56:59], a[184:187], v[204:207]
buffer_store_dwordx4 v[232:235], v1, s[4:7], s52 offen sc1
v_mfma_f32_16x16x32_bf16 v[204:207], v[60:63], a[188:191], v[204:207]
s_waitcnt lgkmcnt(7)
ds_read_b64_tr_b16 v[50:51], v7 offset:6400
v_mfma_f32_16x16x32_bf16 v[208:211], v[32:35], a[64:67], v[208:211]
s_waitcnt lgkmcnt(6)
v_mfma_f32_16x16x32_bf16 v[208:211], v[36:39], a[68:71], v[208:211]
s_waitcnt lgkmcnt(4)
ds_read_b64_tr_b16 v[52:53], v7 offset:12544
v_mfma_f32_16x16x32_bf16 v[208:211], v[40:43], a[72:75], v[208:211]
s_waitcnt lgkmcnt(3)
v_mfma_f32_16x16x32_bf16 v[208:211], v[44:47], a[76:79], v[208:211]
ds_read_b64_tr_b16 v[54:55], v7 offset:18688
v_mfma_f32_16x16x32_bf16 v[212:215], v[32:35], a[80:83], v[212:215]
v_mfma_f32_16x16x32_bf16 v[212:215], v[36:39], a[84:87], v[212:215]
ds_read_b64_tr_b16 v[56:57], v7 offset:24832
v_mfma_f32_16x16x32_bf16 v[212:215], v[40:43], a[88:91], v[212:215]
v_mfma_f32_16x16x32_bf16 v[212:215], v[44:47], a[92:95], v[212:215]
ds_read_b64_tr_b16 v[58:59], v7 offset:30976
v_mfma_f32_16x16x32_bf16 v[216:219], v[32:35], a[96:99], v[216:219]
v_mfma_f32_16x16x32_bf16 v[216:219], v[36:39], a[100:103], v[216:219]
ds_read_b64_tr_b16 v[60:61], v7 offset:37120
v_mfma_f32_16x16x32_bf16 v[216:219], v[40:43], a[104:107], v[216:219]
v_cvt_pk_bf16_f32 v236, v172, v173
v_cvt_pk_bf16_f32 v237, v174, v175
v_mfma_f32_16x16x32_bf16 v[216:219], v[44:47], a[108:111], v[216:219]
ds_read_b64_tr_b16 v[62:63], v7 offset:43264
v_cvt_pk_bf16_f32 v238, v188, v189
v_mfma_f32_16x16x32_bf16 v[220:223], v[32:35], a[112:115], v[220:223]
v_cvt_pk_bf16_f32 v239, v190, v191
v_mfma_f32_16x16x32_bf16 v[220:223], v[36:39], a[116:119], v[220:223]
s_add_u32 s52, s18, 8192
buffer_store_dwordx4 v[236:239], v1, s[4:7], s52 offen sc1
v_mfma_f32_16x16x32_bf16 v[220:223], v[40:43], a[120:123], v[220:223]
v_mfma_f32_16x16x32_bf16 v[220:223], v[44:47], a[124:127], v[220:223]
s_waitcnt lgkmcnt(6)
v_mfma_f32_16x16x32_bf16 v[208:211], v[48:51], a[128:131], v[208:211]
s_waitcnt lgkmcnt(4)
v_mfma_f32_16x16x32_bf16 v[208:211], v[52:55], a[132:135], v[208:211]
s_waitcnt lgkmcnt(2)
v_mfma_f32_16x16x32_bf16 v[208:211], v[56:59], a[136:139], v[208:211]
s_waitcnt lgkmcnt(0)
v_mfma_f32_16x16x32_bf16 v[208:211], v[60:63], a[140:143], v[208:211]
v_mfma_f32_16x16x32_bf16 v[212:215], v[48:51], a[144:147], v[212:215]
v_mfma_f32_16x16x32_bf16 v[212:215], v[52:55], a[148:151], v[212:215]
v_mfma_f32_16x16x32_bf16 v[212:215], v[56:59], a[152:155], v[212:215]
v_mfma_f32_16x16x32_bf16 v[212:215], v[60:63], a[156:159], v[212:215]
v_mfma_f32_16x16x32_bf16 v[216:219], v[48:51], a[160:163], v[216:219]
v_mfma_f32_16x16x32_bf16 v[216:219], v[52:55], a[164:167], v[216:219]
v_mfma_f32_16x16x32_bf16 v[216:219], v[56:59], a[168:171], v[216:219]
v_mfma_f32_16x16x32_bf16 v[216:219], v[60:63], a[172:175], v[216:219]
v_mfma_f32_16x16x32_bf16 v[220:223], v[48:51], a[176:179], v[220:223]
v_mfma_f32_16x16x32_bf16 v[220:223], v[52:55], a[180:183], v[220:223]
v_mfma_f32_16x16x32_bf16 v[220:223], v[56:59], a[184:187], v[220:223]
v_mfma_f32_16x16x32_bf16 v[220:223], v[60:63], a[188:191], v[220:223]
v_cvt_pk_bf16_f32 v224, v192, v193
v_cvt_pk_bf16_f32 v225, v194, v195
v_cvt_pk_bf16_f32 v226, v208, v209
v_cvt_pk_bf16_f32 v227, v210, v211
s_add_u32 s52, s17, 4096
buffer_store_dwordx4 v[224:227], v1, s[4:7], s52 offen sc1
v_cvt_pk_bf16_f32 v228, v196, v197
v_cvt_pk_bf16_f32 v229, v198, v199
v_cvt_pk_bf16_f32 v230, v212, v213
v_cvt_pk_bf16_f32 v231, v214, v215
s_add_u32 s52, s17, 9216
buffer_store_dwordx4 v[228:231], v1, s[4:7], s52 offen sc1
v_cvt_pk_bf16_f32 v232, v200, v201
v_cvt_pk_bf16_f32 v233, v202, v203
v_cvt_pk_bf16_f32 v234, v216, v217
v_cvt_pk_bf16_f32 v235, v218, v219
s_add_u32 s52, s18, 4096
buffer_store_dwordx4 v[232:235], v1, s[4:7], s52 offen sc1
v_cvt_pk_bf16_f32 v236, v204, v205
v_cvt_pk_bf16_f32 v237, v206, v207
v_cvt_pk_bf16_f32 v238, v220, v221
v_cvt_pk_bf16_f32 v239, v222, v223
s_add_u32 s52, s18, 9216
buffer_store_dwordx4 v[236:239], v1, s[4:7], s52 offen sc1
s_lshr_b32 s3, s12, 1
s_cmp_eq_u32 s50, s3
s_cbranch_scc0 L_d_notown
v_add_u32 v15, 0, v1
s_bitcmp1_b32 s12, 0
s_cbranch_scc1 L_d_own1
ds_write_b128 v15, v[64:67] offset:0
ds_write_b128 v15, v[68:71] offset:10240
ds_write_b128 v15, v[80:83] offset:1024
ds_write_b128 v15, v[84:87] offset:11264
ds_write_b128 v15, v[96:99] offset:2048
ds_write_b128 v15, v[100:103] offset:12288
ds_write_b128 v15, v[112:115] offset:3072
ds_write_b128 v15, v[116:119] offset:13312
ds_write_b128 v15, v[128:131] offset:4096
ds_write_b128 v15, v[132:135] offset:14336
ds_write_b128 v15, v[144:147] offset:5120
ds_write_b128 v15, v[148:151] offset:15360
ds_write_b128 v15, v[160:163] offset:6144
ds_write_b128 v15, v[164:167] offset:16384
ds_write_b128 v15, v[176:179] offset:7168
ds_write_b128 v15, v[180:183] offset:17408
ds_write_b128 v15, v[192:195] offset:8192
ds_write_b128 v15, v[196:199] offset:18432
ds_write_b128 v15, v[208:211] offset:9216
ds_write_b128 v15, v[212:215] offset:19456
s_branch L_d_notown
L_d_own1:
ds_write_b128 v15, v[72:75] offset:0
ds_write_b128 v15, v[76:79] offset:10240
ds_write_b128 v15, v[88:91] offset:1024
ds_write_b128 v15, v[92:95] offset:11264
ds_write_b128 v15, v[104:107] offset:2048
ds_write_b128 v15, v[108:111] offset:12288
ds_write_b128 v15, v[120:123] offset:3072
ds_write_b128 v15, v[124:127] offset:13312
ds_write_b128 v15, v[136:139] offset:4096
ds_write_b128 v15, v[140:143] offset:14336
ds_write_b128 v15, v[152:155] offset:5120
ds_write_b128 v15, v[156:159] offset:15360
ds_write_b128 v15, v[168:171] offset:6144
ds_write_b128 v15, v[172:175] offset:16384
ds_write_b128 v15, v[184:187] offset:7168
ds_write_b128 v15, v[188:191] offset:17408
ds_write_b128 v15, v[200:203] offset:8192
ds_write_b128 v15, v[204:207] offset:18432
ds_write_b128 v15, v[216:219] offset:9216
ds_write_b128 v15, v[220:223] offset:19456
L_d_notown:
v_lshl_add_u32 v23, s50, 10, v1
v_cmp_gt_u32 vcc, 16, v23
v_lshlrev_b32 v22, 4, v1
v_mov_b32 v25, 2130706432
v_mov_b32 v23, 8
v_cndmask_b32 v22, v25, v22, vcc
v_cndmask_b32 v23, 0, v23, vcc
s_waitcnt vmcnt(25)
v_lshlrev_b32 v200, 16, v240
v_and_b32 v201, 0xffff0000, v240
v_lshlrev_b32 v202, 16, v241
v_and_b32 v203, 0xffff0000, v241
s_waitcnt vmcnt(24)
v_lshlrev_b32 v204, 16, v242
v_and_b32 v205, 0xffff0000, v242
v_lshlrev_b32 v206, 16, v243
v_and_b32 v207, 0xffff0000, v243
s_waitcnt vmcnt(23)
v_lshlrev_b32 v208, 16, v244
v_and_b32 v209, 0xffff0000, v244
v_lshlrev_b32 v210, 16, v245
v_and_b32 v211, 0xffff0000, v245
s_waitcnt vmcnt(22)
v_lshlrev_b32 v212, 16, v246
v_and_b32 v213, 0xffff0000, v246
v_lshlrev_b32 v214, 16, v247
v_and_b32 v215, 0xffff0000, v247
s_waitcnt vmcnt(21)
v_lshlrev_b32 v216, 16, v248
v_and_b32 v217, 0xffff0000, v248
v_lshlrev_b32 v218, 16, v249
v_and_b32 v219, 0xffff0000, v249
s_waitcnt vmcnt(20)
v_lshlrev_b32 v220, 16, v250
v_and_b32 v221, 0xffff0000, v250
v_lshlrev_b32 v222, 16, v251
v_and_b32 v223, 0xffff0000, v251
s_and_b32 s3, s50, 1
s_mul_i32 s3, s3, 10240
s_lshr_b32 s53, s50, 1
s_lshl_b32 s53, s53, 11
s_add_u32 s3, s3, s53
s_add_u32 s3, s3, 0
v_add_u32 v15, s3, v1
s_waitcnt vmcnt(0) lgkmcnt(0)
s_barrier
s_mov_b32 s53, s1
v_mov_b32 v240, 1
buffer_atomic_add v240, v0, s[4:7], s53 offen sc1
buffer_load_dword v25, v22, s[4:7], s1 offen sc1
ds_read_b128 v[32:35], v15 offset:0
ds_read_b128 v[36:39], v15 offset:1024
ds_read_b128 v[40:43], v15 offset:4096
ds_read_b128 v[44:47], v15 offset:5120
ds_read_b128 v[48:51], v15 offset:8192
ds_read_b128 v[52:55], v15 offset:9216
s_add_u32 s3, s12, 1
s_and_b32 s3, s3, 7
s_mul_i32 s68, s3, 10240
s_add_u32 s3, s12, 2
s_and_b32 s3, s3, 7
s_mul_i32 s69, s3, 10240
s_add_u32 s3, s12, 3
s_and_b32 s3, s3, 7
s_mul_i32 s70, s3, 10240
s_add_u32 s3, s12, 4
s_and_b32 s3, s3, 7
s_mul_i32 s71, s3, 10240
s_add_u32 s3, s12, 5
s_and_b32 s3, s3, 7
s_mul_i32 s72, s3, 10240
s_add_u32 s3, s12, 6
s_and_b32 s3, s3, 7
s_mul_i32 s73, s3, 10240
s_add_u32 s3, s12, 7
s_and_b32 s3, s3, 7
s_mul_i32 s74, s3, 10240
s_waitcnt lgkmcnt(5)
v_pk_add_f32 v[32:33], v[32:33], v[200:201]
v_pk_add_f32 v[34:35], v[34:35], v[202:203]
s_waitcnt lgkmcnt(4)
v_pk_add_f32 v[36:37], v[36:37], v[204:205]
v_pk_add_f32 v[38:39], v[38:39], v[206:207]
s_waitcnt lgkmcnt(3)
v_pk_add_f32 v[40:41], v[40:41], v[208:209]
v_pk_add_f32 v[42:43], v[42:43], v[210:211]
s_waitcnt lgkmcnt(2)
v_pk_add_f32 v[44:45], v[44:45], v[212:213]
v_pk_add_f32 v[46:47], v[46:47], v[214:215]
s_waitcnt lgkmcnt(1)
v_pk_add_f32 v[48:49], v[48:49], v[216:217]
v_pk_add_f32 v[50:51], v[50:51], v[218:219]
s_waitcnt lgkmcnt(0)
v_pk_add_f32 v[52:53], v[52:53], v[220:221]
v_pk_add_f32 v[54:55], v[54:55], v[222:223]
s_mov_b32 s51, 0x3f80
s_mov_b32 s52, 0x3f800000
s_waitcnt vmcnt(0)
v_cmp_ge_u32 vcc, v25, v23
s_nop 3
s_cmp_eq_u64 vcc, -1
s_cbranch_scc0 L_spin_ex
L_back_ex:
s_barrier
s_add_u32 s3, s20, s68
buffer_load_dwordx4 v[64:67], v1, s[4:7], s3 offen sc1
s_add_u32 s3, s20, s69
buffer_load_dwordx4 v[68:71], v1, s[4:7], s3 offen sc1
s_add_u32 s3, s20, s70
buffer_load_dwordx4 v[72:75], v1, s[4:7], s3 offen sc1
s_add_u32 s3, s20, s71
buffer_load_dwordx4 v[76:79], v1, s[4:7], s3 offen sc1
s_add_u32 s3, s20, s72
buffer_load_dwordx4 v[80:83], v1, s[4:7], s3 offen sc1
s_add_u32 s3, s20, s73
buffer_load_dwordx4 v[84:87], v1, s[4:7], s3 offen sc1
s_add_u32 s3, s20, s74
buffer_load_dwordx4 v[88:91], v1, s[4:7], s3 offen sc1
s_add_u32 s3, s21, s68
buffer_load_dwordx4 v[92:95], v1, s[4:7], s3 offen sc1
s_add_u32 s3, s21, s69
buffer_load_dwordx4 v[96:99], v1, s[4:7], s3 offen sc1
s_add_u32 s3, s21, s70
buffer_load_dwordx4 v[100:103], v1, s[4:7], s3 offen sc1
s_add_u32 s3, s21, s71
buffer_load_dwordx4 v[104:107], v1, s[4:7], s3 offen sc1
s_add_u32 s3, s21, s72
buffer_load_dwordx4 v[108:111], v1, s[4:7], s3 offen sc1
s_add_u32 s3, s21, s73
buffer_load_dwordx4 v[112:115], v1, s[4:7], s3 offen sc1
s_add_u32 s3, s21, s74
buffer_load_dwordx4 v[116:119], v1, s[4:7], s3 offen sc1
s_add_u32 s3, s22, s68
buffer_load_dwordx4 v[120:123], v1, s[4:7], s3 offen sc1
s_add_u32 s3, s22, s69
buffer_load_dwordx4 v[124:127], v1, s[4:7], s3 offen sc1
s_add_u32 s3, s22, s70
buffer_load_dwordx4 v[128:131], v1, s[4:7], s3 offen sc1
s_add_u32 s3, s22, s71
buffer_load_dwordx4 v[132:135], v1, s[4:7], s3 offen sc1
s_add_u32 s3, s22, s72
buffer_load_dwordx4 v[136:139], v1, s[4:7], s3 offen sc1
s_add_u32 s3, s22, s73
buffer_load_dwordx4 v[140:143], v1, s[4:7], s3 offen sc1
s_add_u32 s3, s22, s74
buffer_load_dwordx4 v[144:147], v1, s[4:7], s3 offen sc1
s_waitcnt vmcnt(20)
v_dot2_f32_bf16 v32, v64, s51, v32
v_dot2_f32_bf16 v33, v64, s52, v33
v_dot2_f32_bf16 v34, v65, s51, v34
v_dot2_f32_bf16 v35, v65, s52, v35
v_dot2_f32_bf16 v36, v66, s51, v36
v_dot2_f32_bf16 v37, v66, s52, v37
v_dot2_f32_bf16 v38, v67, s51, v38
v_dot2_f32_bf16 v39, v67, s52, v39
s_waitcnt vmcnt(19)
v_dot2_f32_bf16 v32, v68, s51, v32
v_dot2_f32_bf16 v33, v68, s52, v33
v_dot2_f32_bf16 v34, v69, s51, v34
v_dot2_f32_bf16 v35, v69, s52, v35
v_dot2_f32_bf16 v36, v70, s51, v36
v_dot2_f32_bf16 v37, v70, s52, v37
v_dot2_f32_bf16 v38, v71, s51, v38
v_dot2_f32_bf16 v39, v71, s52, v39
s_waitcnt vmcnt(18)
v_dot2_f32_bf16 v32, v72, s51, v32
v_dot2_f32_bf16 v33, v72, s52, v33
v_dot2_f32_bf16 v34, v73, s51, v34
v_dot2_f32_bf16 v35, v73, s52, v35
v_dot2_f32_bf16 v36, v74, s51, v36
v_dot2_f32_bf16 v37, v74, s52, v37
v_dot2_f32_bf16 v38, v75, s51, v38
v_dot2_f32_bf16 v39, v75, s52, v39
s_waitcnt vmcnt(17)
v_dot2_f32_bf16 v32, v76, s51, v32
v_dot2_f32_bf16 v33, v76, s52, v33
v_dot2_f32_bf16 v34, v77, s51, v34
v_dot2_f32_bf16 v35, v77, s52, v35
v_dot2_f32_bf16 v36, v78, s51, v36
v_dot2_f32_bf16 v37, v78, s52, v37
v_dot2_f32_bf16 v38, v79, s51, v38
v_dot2_f32_bf16 v39, v79, s52, v39
s_waitcnt vmcnt(16)
v_dot2_f32_bf16 v32, v80, s51, v32
v_dot2_f32_bf16 v33, v80, s52, v33
v_dot2_f32_bf16 v34, v81, s51, v34
v_dot2_f32_bf16 v35, v81, s52, v35
v_dot2_f32_bf16 v36, v82, s51, v36
v_dot2_f32_bf16 v37, v82, s52, v37
v_dot2_f32_bf16 v38, v83, s51, v38
v_dot2_f32_bf16 v39, v83, s52, v39
s_waitcnt vmcnt(15)
v_dot2_f32_bf16 v32, v84, s51, v32
v_dot2_f32_bf16 v33, v84, s52, v33
v_dot2_f32_bf16 v34, v85, s51, v34
v_dot2_f32_bf16 v35, v85, s52, v35
v_dot2_f32_bf16 v36, v86, s51, v36
v_dot2_f32_bf16 v37, v86, s52, v37
v_dot2_f32_bf16 v38, v87, s51, v38
v_dot2_f32_bf16 v39, v87, s52, v39
s_waitcnt vmcnt(14)
v_dot2_f32_bf16 v32, v88, s51, v32
v_dot2_f32_bf16 v33, v88, s52, v33
v_dot2_f32_bf16 v34, v89, s51, v34
v_dot2_f32_bf16 v35, v89, s52, v35
v_dot2_f32_bf16 v36, v90, s51, v36
v_dot2_f32_bf16 v37, v90, s52, v37
v_dot2_f32_bf16 v38, v91, s51, v38
v_dot2_f32_bf16 v39, v91, s52, v39
v_cvt_pk_bf16_f32 v240, v32, v33
v_cvt_pk_bf16_f32 v241, v34, v35
v_cvt_pk_bf16_f32 v242, v36, v37
v_cvt_pk_bf16_f32 v243, v38, v39
buffer_store_dwordx2 v[240:241], v12, s[40:43], 0 offen offset:0
buffer_store_dwordx2 v[242:243], v12, s[40:43], 0 offen offset:32
s_waitcnt vmcnt(15)
v_dot2_f32_bf16 v40, v92, s51, v40
v_dot2_f32_bf16 v41, v92, s52, v41
v_dot2_f32_bf16 v42, v93, s51, v42
v_dot2_f32_bf16 v43, v93, s52, v43
v_dot2_f32_bf16 v44, v94, s51, v44
v_dot2_f32_bf16 v45, v94, s52, v45
v_dot2_f32_bf16 v46, v95, s51, v46
v_dot2_f32_bf16 v47, v95, s52, v47
s_waitcnt vmcnt(14)
v_dot2_f32_bf16 v40, v96, s51, v40
v_dot2_f32_bf16 v41, v96, s52, v41
v_dot2_f32_bf16 v42, v97, s51, v42
v_dot2_f32_bf16 v43, v97, s52, v43
v_dot2_f32_bf16 v44, v98, s51, v44
v_dot2_f32_bf16 v45, v98, s52, v45
v_dot2_f32_bf16 v46, v99, s51, v46
v_dot2_f32_bf16 v47, v99, s52, v47
s_waitcnt vmcnt(13)
v_dot2_f32_bf16 v40, v100, s51, v40
v_dot2_f32_bf16 v41, v100, s52, v41
v_dot2_f32_bf16 v42, v101, s51, v42
v_dot2_f32_bf16 v43, v101, s52, v43
v_dot2_f32_bf16 v44, v102, s51, v44
v_dot2_f32_bf16 v45, v102, s52, v45
v_dot2_f32_bf16 v46, v103, s51, v46
v_dot2_f32_bf16 v47, v103, s52, v47
s_waitcnt vmcnt(12)
v_dot2_f32_bf16 v40, v104, s51, v40
v_dot2_f32_bf16 v41, v104, s52, v41
v_dot2_f32_bf16 v42, v105, s51, v42
v_dot2_f32_bf16 v43, v105, s52, v43
v_dot2_f32_bf16 v44, v106, s51, v44
v_dot2_f32_bf16 v45, v106, s52, v45
v_dot2_f32_bf16 v46, v107, s51, v46
v_dot2_f32_bf16 v47, v107, s52, v47
s_waitcnt vmcnt(11)
v_dot2_f32_bf16 v40, v108, s51, v40
v_dot2_f32_bf16 v41, v108, s52, v41
v_dot2_f32_bf16 v42, v109, s51, v42
v_dot2_f32_bf16 v43, v109, s52, v43
v_dot2_f32_bf16 v44, v110, s51, v44
v_dot2_f32_bf16 v45, v110, s52, v45
v_dot2_f32_bf16 v46, v111, s51, v46
v_dot2_f32_bf16 v47, v111, s52, v47
s_waitcnt vmcnt(10)
v_dot2_f32_bf16 v40, v112, s51, v40
v_dot2_f32_bf16 v41, v112, s52, v41
v_dot2_f32_bf16 v42, v113, s51, v42
v_dot2_f32_bf16 v43, v113, s52, v43
v_dot2_f32_bf16 v44, v114, s51, v44
v_dot2_f32_bf16 v45, v114, s52, v45
v_dot2_f32_bf16 v46, v115, s51, v46
v_dot2_f32_bf16 v47, v115, s52, v47
s_waitcnt vmcnt(9)
v_dot2_f32_bf16 v40, v116, s51, v40
v_dot2_f32_bf16 v41, v116, s52, v41
v_dot2_f32_bf16 v42, v117, s51, v42
v_dot2_f32_bf16 v43, v117, s52, v43
v_dot2_f32_bf16 v44, v118, s51, v44
v_dot2_f32_bf16 v45, v118, s52, v45
v_dot2_f32_bf16 v46, v119, s51, v46
v_dot2_f32_bf16 v47, v119, s52, v47
v_cvt_pk_bf16_f32 v244, v40, v41
v_cvt_pk_bf16_f32 v245, v42, v43
v_cvt_pk_bf16_f32 v246, v44, v45
v_cvt_pk_bf16_f32 v247, v46, v47
buffer_store_dwordx2 v[244:245], v13, s[40:43], 0 offen offset:0
buffer_store_dwordx2 v[246:247], v13, s[40:43], 0 offen offset:32
s_waitcnt vmcnt(10)
v_dot2_f32_bf16 v48, v120, s51, v48
v_dot2_f32_bf16 v49, v120, s52, v49
v_dot2_f32_bf16 v50, v121, s51, v50
v_dot2_f32_bf16 v51, v121, s52, v51
v_dot2_f32_bf16 v52, v122, s51, v52
v_dot2_f32_bf16 v53, v122, s52, v53
v_dot2_f32_bf16 v54, v123, s51, v54
v_dot2_f32_bf16 v55, v123, s52, v55
s_waitcnt vmcnt(9)
v_dot2_f32_bf16 v48, v124, s51, v48
v_dot2_f32_bf16 v49, v124, s52, v49
v_dot2_f32_bf16 v50, v125, s51, v50
v_dot2_f32_bf16 v51, v125, s52, v51
v_dot2_f32_bf16 v52, v126, s51, v52
v_dot2_f32_bf16 v53, v126, s52, v53
v_dot2_f32_bf16 v54, v127, s51, v54
v_dot2_f32_bf16 v55, v127, s52, v55
s_waitcnt vmcnt(8)
v_dot2_f32_bf16 v48, v128, s51, v48
v_dot2_f32_bf16 v49, v128, s52, v49
v_dot2_f32_bf16 v50, v129, s51, v50
v_dot2_f32_bf16 v51, v129, s52, v51
v_dot2_f32_bf16 v52, v130, s51, v52
v_dot2_f32_bf16 v53, v130, s52, v53
v_dot2_f32_bf16 v54, v131, s51, v54
v_dot2_f32_bf16 v55, v131, s52, v55
s_waitcnt vmcnt(7)
v_dot2_f32_bf16 v48, v132, s51, v48
v_dot2_f32_bf16 v49, v132, s52, v49
v_dot2_f32_bf16 v50, v133, s51, v50
v_dot2_f32_bf16 v51, v133, s52, v51
v_dot2_f32_bf16 v52, v134, s51, v52
v_dot2_f32_bf16 v53, v134, s52, v53
v_dot2_f32_bf16 v54, v135, s51, v54
v_dot2_f32_bf16 v55, v135, s52, v55
s_waitcnt vmcnt(6)
v_dot2_f32_bf16 v48, v136, s51, v48
v_dot2_f32_bf16 v49, v136, s52, v49
v_dot2_f32_bf16 v50, v137, s51, v50
v_dot2_f32_bf16 v51, v137, s52, v51
v_dot2_f32_bf16 v52, v138, s51, v52
v_dot2_f32_bf16 v53, v138, s52, v53
v_dot2_f32_bf16 v54, v139, s51, v54
v_dot2_f32_bf16 v55, v139, s52, v55
s_waitcnt vmcnt(5)
v_dot2_f32_bf16 v48, v140, s51, v48
v_dot2_f32_bf16 v49, v140, s52, v49
v_dot2_f32_bf16 v50, v141, s51, v50
v_dot2_f32_bf16 v51, v141, s52, v51
v_dot2_f32_bf16 v52, v142, s51, v52
v_dot2_f32_bf16 v53, v142, s52, v53
v_dot2_f32_bf16 v54, v143, s51, v54
v_dot2_f32_bf16 v55, v143, s52, v55
s_waitcnt vmcnt(4)
v_dot2_f32_bf16 v48, v144, s51, v48
v_dot2_f32_bf16 v49, v144, s52, v49
v_dot2_f32_bf16 v50, v145, s51, v50
v_dot2_f32_bf16 v51, v145, s52, v51
v_dot2_f32_bf16 v52, v146, s51, v52
v_dot2_f32_bf16 v53, v146, s52, v53
v_dot2_f32_bf16 v54, v147, s51, v54
v_dot2_f32_bf16 v55, v147, s52, v55
v_cvt_pk_bf16_f32 v248, v48, v49
v_cvt_pk_bf16_f32 v249, v50, v51
v_cvt_pk_bf16_f32 v250, v52, v53
v_cvt_pk_bf16_f32 v251, v54, v55
buffer_store_dwordx2 v[248:249], v14, s[40:43], 0 offen offset:0
buffer_store_dwordx2 v[250:251], v14, s[40:43], 0 offen offset:32
L_end:
s_endpgm
L_redo:
s_waitcnt vmcnt(0) lgkmcnt(0)
s_barrier
s_mov_b32 s65, -1
v_mov_b32 v208, 0xff800000
v_mov_b32 v209, 0xff800000
v_mov_b32 v210, 0xff800000
v_mov_b32 v211, 0xff800000
v_mov_b32 v212, 0
v_mov_b32 v213, 0
v_mov_b32 v214, 0
v_mov_b32 v215, 0
s_lshl_b32 s60, s48, 20
s_add_u32 s60, s60, 4194304
s_lshr_b32 s54, s67, 1
s_add_u32 s60, s60, s54
s_mov_b32 s56, 0
s_lshl_b32 s61, s49, 2
s_add_u32 s61, s61, s50
s_sub_u32 s62, 63, s61
s_lshl_b32 s63, s59, 1
L_redo_loop:
s_mov_b32 m0, s54
s_nop 0
buffer_load_dwordx4 v1, s[4:7], s60 offen offset:0 sc1 lds
buffer_load_dwordx4 v1, s[4:7], s60 offen offset:1024 sc1 lds
s_cmp_eq_u32 s56, s61
s_cbranch_scc1 L_redo_d0
s_cmp_lt_u32 s56, s61
s_cselect_b32 s3, 0, 0xff800000
v_mov_b32 v96, s3
v_mov_b32 v97, s3
v_mov_b32 v98, s3
v_mov_b32 v99, s3
v_mov_b32 v100, s3
v_mov_b32 v101, s3
v_mov_b32 v102, s3
v_mov_b32 v103, s3
v_mov_b32 v112, s3
v_mov_b32 v113, s3
v_mov_b32 v114, s3
v_mov_b32 v115, s3
v_mov_b32 v116, s3
v_mov_b32 v117, s3
v_mov_b32 v118, s3
v_mov_b32 v119, s3
s_branch L_redo_e0
L_redo_d0:
v_mov_b32 v216, 0xff800000
v_cndmask_b32 v96, v212, v216, s[68:69]
v_mov_b32 v100, v213
v_mov_b32 v112, v216
v_cndmask_b32 v116, v213, v216, s[68:69]
v_cndmask_b32 v97, v212, v216, s[70:71]
v_mov_b32 v101, v213
v_mov_b32 v113, v216
v_cndmask_b32 v117, v213, v216, s[70:71]
v_cndmask_b32 v98, v212, v216, s[72:73]
v_mov_b32 v102, v213
v_mov_b32 v114, v216
v_cndmask_b32 v118, v213, v216, s[72:73]
v_cndmask_b32 v99, v212, v216, s[74:75]
v_mov_b32 v103, v213
v_mov_b32 v115, v216
v_cndmask_b32 v119, v213, v216, s[74:75]
L_redo_e0:
s_cmp_eq_u32 s56, s62
s_cbranch_scc1 L_redo_d2
s_cmp_lt_u32 s56, s62
s_cselect_b32 s3, 0, 0xff800000
v_mov_b32 v104, s3
v_mov_b32 v105, s3
v_mov_b32 v106, s3
v_mov_b32 v107, s3
v_mov_b32 v108, s3
v_mov_b32 v109, s3
v_mov_b32 v110, s3
v_mov_b32 v111, s3
v_mov_b32 v120, s3
v_mov_b32 v121, s3
v_mov_b32 v122, s3
v_mov_b32 v123, s3
v_mov_b32 v124, s3
v_mov_b32 v125, s3
v_mov_b32 v126, s3
v_mov_b32 v127, s3
s_branch L_redo_e2
L_redo_d2:
v_mov_b32 v216, 0xff800000
v_cndmask_b32 v104, v214, v216, s[68:69]
v_mov_b32 v108, v215
v_mov_b32 v120, v216
v_cndmask_b32 v124, v215, v216, s[68:69]
v_cndmask_b32 v105, v214, v216, s[70:71]
v_mov_b32 v109, v215
v_mov_b32 v121, v216
v_cndmask_b32 v125, v215, v216, s[70:71]
v_cndmask_b32 v106, v214, v216, s[72:73]
v_mov_b32 v110, v215
v_mov_b32 v122, v216
v_cndmask_b32 v126, v215, v216, s[72:73]
v_cndmask_b32 v107, v214, v216, s[74:75]
v_mov_b32 v111, v215
v_mov_b32 v123, v216
v_cndmask_b32 v127, v215, v216, s[74:75]
L_redo_e2:
s_waitcnt vmcnt(0)
s_barrier
ds_read_b128 a[64:67], v1 offset:0
ds_read_b128 a[68:71], v1 offset:1024
ds_read_b128 a[72:75], v1 offset:2048
ds_read_b128 a[76:79], v1 offset:3072
ds_read_b128 a[80:83], v1 offset:4096
ds_read_b128 a[84:87], v1 offset:5120
ds_read_b128 a[88:91], v1 offset:6144
ds_read_b128 a[92:95], v1 offset:7168
s_waitcnt lgkmcnt(0)
s_barrier
v_mfma_f32_16x16x32_bf16 v[32:35], a[64:67], v[128:131], v[96:99]
v_mfma_f32_16x16x32_bf16 v[32:35], a[68:71], v[160:163], v[32:35]
v_mfma_f32_16x16x32_bf16 v[32:35], a[72:75], v[192:195], v[32:35]
v_mfma_f32_16x16x32_bf16 v[32:35], a[76:79], v[224:227], v[32:35]
v_mfma_f32_16x16x32_bf16 v[36:39], a[64:67], v[132:135], v[100:103]
v_mfma_f32_16x16x32_bf16 v[36:39], a[68:71], v[164:167], v[36:39]
v_mfma_f32_16x16x32_bf16 v[36:39], a[72:75], v[196:199], v[36:39]
v_mfma_f32_16x16x32_bf16 v[36:39], a[76:79], v[228:231], v[36:39]
v_mfma_f32_16x16x32_bf16 v[40:43], a[64:67], v[136:139], v[104:107]
v_mfma_f32_16x16x32_bf16 v[40:43], a[68:71], v[168:171], v[40:43]
v_mfma_f32_16x16x32_bf16 v[40:43], a[72:75], v[200:203], v[40:43]
v_mfma_f32_16x16x32_bf16 v[40:43], a[76:79], v[232:235], v[40:43]
v_mfma_f32_16x16x32_bf16 v[44:47], a[64:67], v[140:143], v[108:111]
v_mfma_f32_16x16x32_bf16 v[44:47], a[68:71], v[172:175], v[44:47]
v_mfma_f32_16x16x32_bf16 v[44:47], a[72:75], v[204:207], v[44:47]
v_mfma_f32_16x16x32_bf16 v[44:47], a[76:79], v[236:239], v[44:47]
v_mfma_f32_16x16x32_bf16 v[48:51], a[80:83], v[128:131], v[112:115]
v_mfma_f32_16x16x32_bf16 v[48:51], a[84:87], v[160:163], v[48:51]
v_mfma_f32_16x16x32_bf16 v[48:51], a[88:91], v[192:195], v[48:51]
v_mfma_f32_16x16x32_bf16 v[48:51], a[92:95], v[224:227], v[48:51]
v_mfma_f32_16x16x32_bf16 v[52:55], a[80:83], v[132:135], v[116:119]
v_mfma_f32_16x16x32_bf16 v[52:55], a[84:87], v[164:167], v[52:55]
v_mfma_f32_16x16x32_bf16 v[52:55], a[88:91], v[196:199], v[52:55]
v_mfma_f32_16x16x32_bf16 v[52:55], a[92:95], v[228:231], v[52:55]
v_mfma_f32_16x16x32_bf16 v[56:59], a[80:83], v[136:139], v[120:123]
v_mfma_f32_16x16x32_bf16 v[56:59], a[84:87], v[168:171], v[56:59]
v_mfma_f32_16x16x32_bf16 v[56:59], a[88:91], v[200:203], v[56:59]
v_mfma_f32_16x16x32_bf16 v[56:59], a[92:95], v[232:235], v[56:59]
v_mfma_f32_16x16x32_bf16 v[60:63], a[80:83], v[140:143], v[124:127]
v_mfma_f32_16x16x32_bf16 v[60:63], a[84:87], v[172:175], v[60:63]
v_mfma_f32_16x16x32_bf16 v[60:63], a[88:91], v[204:207], v[60:63]
v_mfma_f32_16x16x32_bf16 v[60:63], a[92:95], v[236:239], v[60:63]
s_nop 7
v_max3_f32 v208, v208, v32, v33
v_max3_f32 v208, v208, v34, v35
v_max3_f32 v208, v208, v48, v49
v_max3_f32 v208, v208, v50, v51
v_max3_f32 v209, v209, v36, v37
v_max3_f32 v209, v209, v38, v39
v_max3_f32 v209, v209, v52, v53
v_max3_f32 v209, v209, v54, v55
v_max3_f32 v210, v210, v40, v41
v_max3_f32 v210, v210, v42, v43
v_max3_f32 v210, v210, v56, v57
v_max3_f32 v210, v210, v58, v59
v_max3_f32 v211, v211, v44, v45
v_max3_f32 v211, v211, v46, v47
v_max3_f32 v211, v211, v60, v61
v_max3_f32 v211, v211, v62, v63
s_add_u32 s60, s60, 8192
s_add_u32 s56, s56, 1
s_cmp_lt_u32 s56, s63
s_cbranch_scc1 L_redo_loop
v_mov_b32 v216, v208
s_nop 1
v_permlane16_swap_b32 v208, v216
v_max_f32 v208, v208, v216
v_mov_b32 v216, v208
s_nop 1
v_permlane32_swap_b32 v208, v216
v_max_f32 v208, v208, v216
v_sub_f32 v212, 0, v208
v_mov_b32 v216, v209
s_nop 1
v_permlane16_swap_b32 v209, v216
v_max_f32 v209, v209, v216
v_mov_b32 v216, v209
s_nop 1
v_permlane32_swap_b32 v209, v216
v_max_f32 v209, v209, v216
v_sub_f32 v213, 0, v209
v_mov_b32 v216, v210
s_nop 1
v_permlane16_swap_b32 v210, v216
v_max_f32 v210, v210, v216
v_mov_b32 v216, v210
s_nop 1
v_permlane32_swap_b32 v210, v216
v_max_f32 v210, v210, v216
v_sub_f32 v214, 0, v210
v_mov_b32 v216, v211
s_nop 1
v_permlane16_swap_b32 v211, v216
v_max_f32 v211, v211, v216
v_mov_b32 v216, v211
s_nop 1
v_permlane32_swap_b32 v211, v216
v_max_f32 v211, v211, v216
v_sub_f32 v215, 0, v211
v_add_u32 v24, s67, v1
s_lshl_b32 s60, s48, 20
s_add_u32 s60, s60, 4202496
s_lshl_b32 s61, s59, 14
s_add_u32 s61, s61, s60
s_mov_b32 s62, s67
s_lshr_b32 s54, s67, 1
s_add_u32 m0, s54, 131072
s_add_u32 s54, s54, s60
s_sub_u32 s54, s54, 8192
buffer_load_dwordx4 v1, s[4:7], s54 offen offset:0 sc1 lds
buffer_load_dwordx4 v1, s[4:7], s54 offen offset:1024 sc1 lds
s_and_b32 m0, s62, 0x1ffff
s_nop 0
buffer_load_dwordx4 v24, s[4:7], s60 offen offset:0 sc1  lds
buffer_load_dwordx4 v24, s[4:7], s60 offen offset:1024 sc1  lds
buffer_load_dwordx4 v24, s[4:7], s60 offen offset:2048 sc1  lds
buffer_load_dwordx4 v24, s[4:7], s60 offen offset:3072 sc1  lds
s_add_u32 m0, m0, 16384
s_add_u32 s60, s60, 516096
buffer_load_dwordx4 v24, s[4:7], s60 offen offset:0 sc1  lds
buffer_load_dwordx4 v24, s[4:7], s60 offen offset:1024 sc1  lds
buffer_load_dwordx4 v24, s[4:7], s60 offen offset:2048 sc1  lds
buffer_load_dwordx4 v24, s[4:7], s60 offen offset:3072 sc1  lds
s_sub_u32 s60, s60, 516096
s_add_u32 s60, s60, 16384
s_add_u32 s62, s62, 32768
s_and_b32 m0, s62, 0x1ffff
s_nop 0
buffer_load_dwordx4 v24, s[4:7], s60 offen offset:0 sc1  lds
buffer_load_dwordx4 v24, s[4:7], s60 offen offset:1024 sc1  lds
buffer_load_dwordx4 v24, s[4:7], s60 offen offset:2048 sc1  lds
buffer_load_dwordx4 v24, s[4:7], s60 offen offset:3072 sc1  lds
s_add_u32 m0, m0, 16384
s_add_u32 s60, s60, 516096
buffer_load_dwordx4 v24, s[4:7], s60 offen offset:0 sc1  lds
buffer_load_dwordx4 v24, s[4:7], s60 offen offset:1024 sc1  lds
buffer_load_dwordx4 v24, s[4:7], s60 offen offset:2048 sc1  lds
buffer_load_dwordx4 v24, s[4:7], s60 offen offset:3072 sc1  lds
s_sub_u32 s60, s60, 516096
s_add_u32 s60, s60, 16384
s_add_u32 s62, s62, 32768
s_waitcnt vmcnt(0)
L_at_again:
s_barrier
v_mov_b32 v10, v1
v_add_u32 v11, 131072, v1
ds_read_b128 a[96:99], v11 offset:0
ds_read_b128 a[100:103], v11 offset:1024
ds_read_b128 a[104:107], v11 offset:2048
ds_read_b128 a[108:111], v11 offset:3072
ds_read_b128 a[112:115], v11 offset:4096
ds_read_b128 a[116:119], v11 offset:5120
ds_read_b128 a[120:123], v11 offset:6144
ds_read_b128 a[124:127], v11 offset:7168
ds_read_b128 a[64:67], v10 offset:0
ds_read_b128 a[68:71], v10 offset:1024
ds_read_b128 a[72:75], v10 offset:2048
ds_read_b128 a[76:79], v10 offset:3072
ds_read_b128 a[80:83], v10 offset:4096
ds_read_b128 a[84:87], v10 offset:5120
ds_read_b128 a[88:91], v10 offset:6144
ds_read_b128 a[92:95], v10 offset:7168
v_add_u32 v11, 0x8000, v1
v_add_u32 v12, 516096, v24
s_and_b32 m0, s62, 0x1ffff
s_nop 0
buffer_load_dwordx4 v24, s[4:7], s60 offen offset:0 sc1  lds
buffer_load_dwordx4 v24, s[4:7], s60 offen offset:1024 sc1  lds
buffer_load_dwordx4 v24, s[4:7], s60 offen offset:2048 sc1  lds
s_waitcnt lgkmcnt(15)
v_mfma_f32_16x16x32_bf16 v[32:35], a[96:99], v[128:131], 0
s_waitcnt lgkmcnt(14)
v_mfma_f32_16x16x32_bf16 v[32:35], a[100:103], v[160:163], v[32:35]
s_waitcnt lgkmcnt(13)
v_mfma_f32_16x16x32_bf16 v[32:35], a[104:107], v[192:195], v[32:35]
s_waitcnt lgkmcnt(12)
v_mfma_f32_16x16x32_bf16 v[32:35], a[108:111], v[224:227], v[32:35]
s_waitcnt lgkmcnt(11)
v_mfma_f32_16x16x32_bf16 v[48:51], a[112:115], v[128:131], 0
s_waitcnt lgkmcnt(10)
v_mfma_f32_16x16x32_bf16 v[48:51], a[116:119], v[160:163], v[48:51]
s_waitcnt lgkmcnt(9)
v_mfma_f32_16x16x32_bf16 v[48:51], a[120:123], v[192:195], v[48:51]
s_waitcnt lgkmcnt(8)
v_mfma_f32_16x16x32_bf16 v[48:51], a[124:127], v[224:227], v[48:51]
v_mfma_f32_16x16x32_bf16 v[36:39], a[96:99], v[132:135], 0
v_mfma_f32_16x16x32_bf16 v[36:39], a[100:103], v[164:167], v[36:39]
v_mfma_f32_16x16x32_bf16 v[36:39], a[104:107], v[196:199], v[36:39]
v_mfma_f32_16x16x32_bf16 v[36:39], a[108:111], v[228:231], v[36:39]
v_mfma_f32_16x16x32_bf16 v[52:55], a[112:115], v[132:135], 0
v_mfma_f32_16x16x32_bf16 v[52:55], a[116:119], v[164:167], v[52:55]
v_mfma_f32_16x16x32_bf16 v[52:55], a[120:123], v[196:199], v[52:55]
v_mfma_f32_16x16x32_bf16 v[52:55], a[124:127], v[228:231], v[52:55]
v_mfma_f32_16x16x32_bf16 v[40:43], a[96:99], v[136:139], 0
v_mfma_f32_16x16x32_bf16 v[40:43], a[100:103], v[168:171], v[40:43]
v_mfma_f32_16x16x32_bf16 v[40:43], a[104:107], v[200:203], v[40:43]
v_mfma_f32_16x16x32_bf16 v[40:43], a[108:111], v[232:235], v[40:43]
v_mfma_f32_16x16x32_bf16 v[56:59], a[112:115], v[136:139], 0
v_mfma_f32_16x16x32_bf16 v[56:59], a[116:119], v[168:171], v[56:59]
v_mfma_f32_16x16x32_bf16 v[56:59], a[120:123], v[200:203], v[56:59]
v_mfma_f32_16x16x32_bf16 v[56:59], a[124:127], v[232:235], v[56:59]
v_mfma_f32_16x16x32_bf16 v[44:47], a[96:99], v[140:143], 0
v_mfma_f32_16x16x32_bf16 v[44:47], a[100:103], v[172:175], v[44:47]
v_mfma_f32_16x16x32_bf16 v[44:47], a[104:107], v[204:207], v[44:47]
v_mfma_f32_16x16x32_bf16 v[44:47], a[108:111], v[236:239], v[44:47]
v_mfma_f32_16x16x32_bf16 v[60:63], a[112:115], v[140:143], 0
v_mfma_f32_16x16x32_bf16 v[60:63], a[116:119], v[172:175], v[60:63]
v_mfma_f32_16x16x32_bf16 v[60:63], a[120:123], v[204:207], v[60:63]
v_mfma_f32_16x16x32_bf16 v[60:63], a[124:127], v[236:239], v[60:63]
s_nop 7
s_add_u32 s3, s49, s50
s_cmp_eq_u32 s3, 0
s_cbranch_scc0 L_at_nmr
v_mov_b32 v216, 0xff800000
v_cndmask_b32 v32, v32, v216, s[68:69]
v_mov_b32 v48, v216
v_cndmask_b32 v52, v52, v216, s[68:69]
v_cndmask_b32 v33, v33, v216, s[70:71]
v_mov_b32 v49, v216
v_cndmask_b32 v53, v53, v216, s[70:71]
v_cndmask_b32 v34, v34, v216, s[72:73]
v_mov_b32 v50, v216
v_cndmask_b32 v54, v54, v216, s[72:73]
v_cndmask_b32 v35, v35, v216, s[74:75]
v_mov_b32 v51, v216
v_cndmask_b32 v55, v55, v216, s[74:75]
L_at_nmr:
v_mov_b32 v220, 0xff800000
v_mov_b32 v221, 0xff800000
v_mov_b32 v219, 0x53800000
s_mov_b32 s56, 0
s_mov_b32 s64, 0
v_mov_b32 v208, 0
v_mov_b32 v209, 0
v_mov_b32 v210, 0
v_mov_b32 v211, 0
v_pk_add_f32 v[32:33], v[32:33], v[212:213] op_sel:[0,0] op_sel_hi:[1,0]
v_pk_add_f32 v[34:35], v[34:35], v[212:213] op_sel:[0,0] op_sel_hi:[1,0]
v_pk_add_f32 v[36:37], v[36:37], v[212:213] op_sel:[0,1] op_sel_hi:[1,1]
v_pk_add_f32 v[38:39], v[38:39], v[212:213] op_sel:[0,1] op_sel_hi:[1,1]
v_pk_add_f32 v[40:41], v[40:41], v[214:215] op_sel:[0,0] op_sel_hi:[1,0]
v_pk_add_f32 v[42:43], v[42:43], v[214:215] op_sel:[0,0] op_sel_hi:[1,0]
v_pk_add_f32 v[44:45], v[44:45], v[214:215] op_sel:[0,1] op_sel_hi:[1,1]
v_pk_add_f32 v[46:47], v[46:47], v[214:215] op_sel:[0,1] op_sel_hi:[1,1]
v_pk_add_f32 v[48:49], v[48:49], v[212:213] op_sel:[0,0] op_sel_hi:[1,0]
v_pk_add_f32 v[50:51], v[50:51], v[212:213] op_sel:[0,0] op_sel_hi:[1,0]
v_pk_add_f32 v[52:53], v[52:53], v[212:213] op_sel:[0,1] op_sel_hi:[1,1]
v_pk_add_f32 v[54:55], v[54:55], v[212:213] op_sel:[0,1] op_sel_hi:[1,1]
v_pk_add_f32 v[56:57], v[56:57], v[214:215] op_sel:[0,0] op_sel_hi:[1,0]
v_pk_add_f32 v[58:59], v[58:59], v[214:215] op_sel:[0,0] op_sel_hi:[1,0]
v_pk_add_f32 v[60:61], v[60:61], v[214:215] op_sel:[0,1] op_sel_hi:[1,1]
v_pk_add_f32 v[62:63], v[62:63], v[214:215] op_sel:[0,1] op_sel_hi:[1,1]
v_pk_mov_b32 v[144:145], v[212:213], v[212:213] op_sel:[0,0]
v_pk_mov_b32 v[146:147], v[212:213], v[212:213] op_sel:[0,0]
v_pk_mov_b32 v[148:149], v[212:213], v[212:213] op_sel:[1,1]
v_pk_mov_b32 v[150:151], v[212:213], v[212:213] op_sel:[1,1]
v_pk_mov_b32 v[152:153], v[214:215], v[214:215] op_sel:[0,0]
v_pk_mov_b32 v[154:155], v[214:215], v[214:215] op_sel:[0,0]
v_pk_mov_b32 v[156:157], v[214:215], v[214:215] op_sel:[1,1]
v_pk_mov_b32 v[158:159], v[214:215], v[214:215] op_sel:[1,1]
v_pk_mov_b32 v[176:177], v[212:213], v[212:213] op_sel:[0,0]
v_pk_mov_b32 v[178:179], v[212:213], v[212:213] op_sel:[0,0]
v_pk_mov_b32 v[180:181], v[212:213], v[212:213] op_sel:[1,1]
v_pk_mov_b32 v[182:183], v[212:213], v[212:213] op_sel:[1,1]
v_pk_mov_b32 v[184:185], v[214:215], v[214:215] op_sel:[0,0]
v_pk_mov_b32 v[186:187], v[214:215], v[214:215] op_sel:[0,0]
v_pk_mov_b32 v[188:189], v[214:215], v[214:215] op_sel:[1,1]
v_pk_mov_b32 v[190:191], v[214:215], v[214:215] op_sel:[1,1]
v_pk_mov_b32 v[96:97], v[212:213], v[212:213] op_sel:[0,0]
v_pk_mov_b32 v[98:99], v[212:213], v[212:213] op_sel:[0,0]
v_pk_mov_b32 v[100:101], v[212:213], v[212:213] op_sel:[1,1]
v_pk_mov_b32 v[102:103], v[212:213], v[212:213] op_sel:[1,1]
v_pk_mov_b32 v[104:105], v[214:215], v[214:215] op_sel:[0,0]
v_pk_mov_b32 v[106:107], v[214:215], v[214:215] op_sel:[0,0]
v_pk_mov_b32 v[108:109], v[214:215], v[214:215] op_sel:[1,1]
v_pk_mov_b32 v[110:111], v[214:215], v[214:215] op_sel:[1,1]
v_pk_mov_b32 v[112:113], v[212:213], v[212:213] op_sel:[0,0]
v_pk_mov_b32 v[114:115], v[212:213], v[212:213] op_sel:[0,0]
v_pk_mov_b32 v[116:117], v[212:213], v[212:213] op_sel:[1,1]
v_pk_mov_b32 v[118:119], v[212:213], v[212:213] op_sel:[1,1]
v_pk_mov_b32 v[120:121], v[214:215], v[214:215] op_sel:[0,0]
v_pk_mov_b32 v[122:123], v[214:215], v[214:215] op_sel:[0,0]
v_pk_mov_b32 v[124:125], v[214:215], v[214:215] op_sel:[1,1]
v_pk_mov_b32 v[126:127], v[214:215], v[214:215] op_sel:[1,1]
v_exp_f32 v32, v32
v_exp_f32 v33, v33
v_exp_f32 v34, v34
v_exp_f32 v35, v35
v_add_f32 v208, v208, v32
v_add_f32 v208, v208, v33
v_cvt_pk_bf16_f32 v64, v32, v33
v_add_f32 v208, v208, v34
v_add_f32 v208, v208, v35
v_cvt_pk_bf16_f32 v65, v34, v35
v_exp_f32 v36, v36
v_exp_f32 v37, v37
v_exp_f32 v38, v38
v_exp_f32 v39, v39
v_add_f32 v209, v209, v36
v_add_f32 v209, v209, v37
v_cvt_pk_bf16_f32 v68, v36, v37
v_add_f32 v209, v209, v38
v_add_f32 v209, v209, v39
v_cvt_pk_bf16_f32 v69, v38, v39
v_exp_f32 v40, v40
v_exp_f32 v41, v41
v_exp_f32 v42, v42
v_exp_f32 v43, v43
v_add_f32 v210, v210, v40
v_add_f32 v210, v210, v41
v_cvt_pk_bf16_f32 v72, v40, v41
v_add_f32 v210, v210, v42
v_add_f32 v210, v210, v43
v_cvt_pk_bf16_f32 v73, v42, v43
v_exp_f32 v44, v44
v_exp_f32 v45, v45
v_exp_f32 v46, v46
v_exp_f32 v47, v47
v_add_f32 v211, v211, v44
v_add_f32 v211, v211, v45
v_cvt_pk_bf16_f32 v76, v44, v45
v_add_f32 v211, v211, v46
v_add_f32 v211, v211, v47
v_cvt_pk_bf16_f32 v77, v46, v47
v_exp_f32 v48, v48
v_exp_f32 v49, v49
v_exp_f32 v50, v50
v_exp_f32 v51, v51
v_add_f32 v208, v208, v48
v_add_f32 v208, v208, v49
v_cvt_pk_bf16_f32 v66, v48, v49
v_add_f32 v208, v208, v50
v_add_f32 v208, v208, v51
v_cvt_pk_bf16_f32 v67, v50, v51
v_exp_f32 v52, v52
v_exp_f32 v53, v53
v_exp_f32 v54, v54
v_exp_f32 v55, v55
v_add_f32 v209, v209, v52
v_add_f32 v209, v209, v53
v_cvt_pk_bf16_f32 v70, v52, v53
v_add_f32 v209, v209, v54
v_add_f32 v209, v209, v55
v_cvt_pk_bf16_f32 v71, v54, v55
s_branch L_at_disp
L_spin_xn:
s_mov_b32 s0, 200000
L_spin_xn_l:
s_sleep 16
buffer_load_dword v20, v18, s[44:47], s1 offen sc1
s_waitcnt vmcnt(0)
v_and_b32 v20, 15, v20
v_cmp_ge_u32 vcc, v20, v19
s_nop 3
s_cmp_eq_u64 vcc, -1
s_cbranch_scc1 L_back_xn
s_sub_u32 s0, s0, 1
s_cmp_lg_u32 s0, 0
s_cbranch_scc1 L_spin_xn_l
s_branch L_back_xn
L_spin_kvH:
s_mov_b32 s0, 200000
L_spin_kvH_l:
s_sleep 8
buffer_load_dword v29, v22, s[4:7], s1 offen sc1
s_waitcnt vmcnt(0)
v_cmp_ge_u32 vcc, v29, v23
s_nop 3
s_cmp_eq_u64 vcc, -1
s_cbranch_scc1 L_back_kvH
s_sub_u32 s0, s0, 1
s_cmp_lg_u32 s0, 0
s_cbranch_scc1 L_spin_kvH_l
s_branch L_back_kvH
L_spin_kvN:
s_mov_b32 s0, 200000
L_spin_kvN_l:
s_sleep 8
buffer_load_dword v20, v18, s[4:7], s1 offen sc1
s_waitcnt vmcnt(0)
v_cmp_ge_u32 vcc, v20, v19
s_nop 3
s_cmp_eq_u64 vcc, -1
s_cbranch_scc1 L_back_kvN
s_sub_u32 s0, s0, 1
s_cmp_lg_u32 s0, 0
s_cbranch_scc1 L_spin_kvN_l
s_branch L_back_kvN
L_spin_pre:
s_mov_b32 s0, 200000
L_spin_pre_l:
s_sleep 8
buffer_load_dword v25, v22, s[4:7], s1 offen sc1
s_waitcnt vmcnt(0)
v_cmp_ge_u32 vcc, v25, v23
s_nop 3
s_cmp_eq_u64 vcc, -1
s_cbranch_scc1 L_back_pre
s_sub_u32 s0, s0, 1
s_cmp_lg_u32 s0, 0
s_cbranch_scc1 L_spin_pre_l
s_branch L_back_pre
L_spin_ctx:
s_mov_b32 s0, 200000
L_spin_ctx_l:
s_sleep 4
buffer_load_dword v25, v22, s[4:7], s1 offen sc1
s_waitcnt vmcnt(0)
v_cmp_ge_u32 vcc, v25, v23
s_nop 3
s_cmp_eq_u64 vcc, -1
s_cbranch_scc1 L_back_ctx
s_sub_u32 s0, s0, 1
s_cmp_lg_u32 s0, 0
s_cbranch_scc1 L_spin_ctx_l
s_branch L_back_ctx
L_spin_ex:
s_mov_b32 s0, 200000
L_spin_ex_l:
s_sleep 2
buffer_load_dword v25, v22, s[4:7], s1 offen sc1
s_waitcnt vmcnt(0)
v_cmp_ge_u32 vcc, v25, v23
s_nop 3
s_cmp_eq_u64 vcc, -1
s_cbranch_scc1 L_back_ex
s_sub_u32 s0, s0, 1
s_cmp_lg_u32 s0, 0
s_cbranch_scc1 L_spin_ex_l
s_branch L_back_ex
.section .rodata,"a"
.p2align 6
.amdhsa_kernel parallel_sum__compressed_kv_cla__dense_activation_silu__prompt_kernel
  .amdhsa_next_free_vgpr 512
  .amdhsa_next_free_sgpr 102
  .amdhsa_accum_offset 256
  .amdhsa_group_segment_fixed_size 0
  .amdhsa_kernarg_size 96
  .amdhsa_user_sgpr_count 2
  .amdhsa_user_sgpr_kernarg_segment_ptr 1
  .amdhsa_system_sgpr_workgroup_id_x 1
  .amdhsa_float_denorm_mode_32 3
.end_amdhsa_kernel
```
